```python
import torch

def _softmax(x, axis=-1):
    return torch.softmax(x, dim=axis)
def _gelu(x):
    return torch.nn.functional.gelu(x, approximate="tanh")
def _silu(x):
    return torch.nn.functional.silu(x)
def _sigmoid(x):
    return torch.sigmoid(x)
def _layernorm(x, axis=-1, eps=1e-5):
    m = x.mean(dim=axis, keepdim=True)
    v = x.var(dim=axis, keepdim=True, unbiased=False)
    return (x - m) / torch.sqrt(v + eps)
def _scatter_add(tgt, idx, src, axis=0):
    return tgt.clone().index_add_(axis, idx, src)
def _segment_sum(src, seg, n):
    out = torch.zeros((n,) + src.shape[1:], dtype=src.dtype)
    return out.index_add_(0, seg, src)
def _pad(x, pw):
    flat = tuple(v for pair in reversed(pw) for v in pair)
    return torch.nn.functional.pad(x, flat)

kernel_name = 'interleave_layers__spectral_fnet__swiglu_ffn__prompt'

def setup_inputs():

    _w = (lambda a: (lambda t: t.to(torch.bfloat16) if t.is_floating_point() else t)(torch.as_tensor(a)))
    def _A_setup():
        B, S, D = 1, 2048, 512
        ns = torch.arange(S)[:, None] * torch.arange(S)[None, :]
        nd = torch.arange(D)[:, None] * torch.arange(D)[None, :]
        Ws_re = torch.cos(-2.0 * torch.pi * ns / S).to(float)
        Ws_im = torch.sin(-2.0 * torch.pi * ns / S).to(float)
        Wd_re = torch.cos(-2.0 * torch.pi * nd / D).to(float)
        Wd_im = torch.sin(-2.0 * torch.pi * nd / D).to(float)
        return {
            "x": _w((lambda *s: torch.randn(*s, dtype=torch.bfloat16) * 0.05)(B, S, D)),
            "dft_seq_re": _w(Ws_re),
            "dft_seq_im": _w(Ws_im),
            "dft_hid_re": _w(Wd_re),
            "dft_hid_im": _w(Wd_im),
        }
    _A_in = _A_setup()

    def _B_setup():
        B, S, D, F = 1, 2048, 512, 1792
        return {
            "x": _w((lambda *s: torch.randn(*s, dtype=torch.bfloat16) * 0.05)(B, S, D)),
            "w_gate": _w((lambda *s: torch.randn(*s, dtype=torch.bfloat16) * 0.4)(D, F)),
            "w_up": _w((lambda *s: torch.randn(*s, dtype=torch.bfloat16) * 0.4)(D, F)),
            "w_down": _w((lambda *s: torch.randn(*s, dtype=torch.bfloat16) * 0.4)(F, D)),
        }
    _B_in = _B_setup()

    return {
        "A_x": _A_in["x"],
        "A_dft_seq_re": _A_in["dft_seq_re"],
        "A_dft_seq_im": _A_in["dft_seq_im"],
        "A_dft_hid_re": _A_in["dft_hid_re"],
        "A_dft_hid_im": _A_in["dft_hid_im"],
        "B_x": _B_in["x"],
        "B_w_gate": _B_in["w_gate"],
        "B_w_up": _B_in["w_up"],
        "B_w_down": _B_in["w_down"],
    }

def reference(A_x, A_dft_seq_re, A_dft_seq_im, A_dft_hid_re, A_dft_hid_im, B_x, B_w_gate, B_w_up, B_w_down):
    def _A_ref(x, dft_seq_re, dft_seq_im, dft_hid_re, dft_hid_im):
        a = torch.einsum("bsd,ed->bse", x, dft_hid_re)
        b = torch.einsum("bsd,ed->bse", x, dft_hid_im)
        y = torch.einsum("ts,bse->bte", dft_seq_re, a) - torch.einsum("ts,bse->bte", dft_seq_im, b)
        return y

    def _B_ref(x, w_gate, w_up, w_down):
        g = _silu(x @ w_gate)
        u = x @ w_up
        return (g * u) @ w_down

    x = A_x
    x = x + _A_ref(_layernorm(x, axis=-1), A_dft_seq_re, A_dft_seq_im, A_dft_hid_re, A_dft_hid_im)
    x = x + _B_ref(_layernorm(x, axis=-1), B_w_gate, B_w_up, B_w_down)
    x = x + _A_ref(_layernorm(x, axis=-1), A_dft_seq_re, A_dft_seq_im, A_dft_hid_re, A_dft_hid_im)
    x = x + _B_ref(_layernorm(x, axis=-1), B_w_gate, B_w_up, B_w_down)
    return x
```

```asm
; @launch grid=(256,1,1) block=(256,1,1) lds=163840
.amdgcn_target "amdgcn-amd-amdhsa--gfx950"
.text
.globl interleave_layers__spectral_fnet__swiglu_ffn__prompt_kernel
.p2align 8
.type interleave_layers__spectral_fnet__swiglu_ffn__prompt_kernel,@function
interleave_layers__spectral_fnet__swiglu_ffn__prompt_kernel:
    s_cmp_ge_u32 s2, 256
    s_cbranch_scc1 L_end
L_code_begin:
    s_getpc_b64 s[42:43]
L_pc:
    s_lshr_b32 s40, s2, 3
    s_lshl_b32 s40, s40, 12
    v_lshlrev_b32 v2, 4, v0
    v_add_u32 v2, s40, v2
    v_min_u32 v2, L_code_end-L_pc-16, v2
    global_load_dwordx4 v[132:135], v2, s[42:43]
    s_load_dwordx2 s[4:5], s[0:1], 0
    s_load_dwordx2 s[24:25], s[0:1], 88
    s_load_dwordx4 s[40:43], s[0:1], 48
    s_load_dwordx4 s[44:47], s[0:1], 64
    v_and_b32 v1, 63, v0
    v_lshrrev_b32_e64 v2, 6, v0
    s_and_b32 s28, s2, 7
    s_lshr_b32 s29, s2, 3
    v_readfirstlane_b32 s30, v2
    s_lshr_b32 s34, s29, 4
    s_and_b32 s35, s29, 7
    s_lshr_b32 s36, s29, 3
    s_and_b32 s36, s36, 1
    s_mov_b32 s38, s28
    s_sub_u32 s39, 16, s28
    s_cmp_eq_u32 s28, 0
    s_cselect_b32 s39, 8, s39
    s_cmp_eq_u32 s34, 0
    s_cselect_b32 s37, s38, s39
    s_mov_b32 s6, 2097152
    s_mov_b32 s7, 0x00020000
    s_mov_b32 s26, 0x10000000
    s_mov_b32 s27, 0x00020000
    s_waitcnt lgkmcnt(0)
    s_load_dwordx2 s[48:49], s[24:25], 0
    s_mov_b32 s8, s40
    s_mov_b32 s9, s41
    s_mov_b32 s10, 1835008
    s_mov_b32 s11, 0x00020000
    s_mov_b32 s12, s42
    s_mov_b32 s13, s43
    s_mov_b32 s14, 1835008
    s_mov_b32 s15, 0x00020000
    s_mov_b32 s16, s44
    s_mov_b32 s17, s45
    s_mov_b32 s18, 1835008
    s_mov_b32 s19, 0x00020000
    s_mov_b32 s20, s46
    s_mov_b32 s21, s47
    s_mov_b32 s22, 2097152
    s_mov_b32 s23, 0x00020000
    v_lshlrev_b32 v14, 4, v1
    s_lshl_b32 s50, s36, 2
    s_add_u32 s50, s50, s30
    s_lshl_b32 s50, s50, 4
    s_add_u32 s50, s50, s37
    s_lshl_b32 s50, s50, 10
    s_lshl_b32 s51, s30, 14
    s_add_u32 s51, s51, 40960
    v_xor_b32_e64 v15, 0, v14
    s_mov_b32 m0, s51
    s_nop 0
    buffer_load_dwordx4 v15, s[4:7], s50 offen lds
    s_add_u32 s50, s50, 131072
    s_add_u32 s51, s51, 1024
    v_xor_b32_e64 v15, 16, v14
    s_mov_b32 m0, s51
    s_nop 0
    buffer_load_dwordx4 v15, s[4:7], s50 offen lds
    s_add_u32 s50, s50, 131072
    s_add_u32 s51, s51, 1024
    v_xor_b32_e64 v15, 32, v14
    s_mov_b32 m0, s51
    s_nop 0
    buffer_load_dwordx4 v15, s[4:7], s50 offen lds
    s_add_u32 s50, s50, 131072
    s_add_u32 s51, s51, 1024
    v_xor_b32_e64 v15, 48, v14
    s_mov_b32 m0, s51
    s_nop 0
    buffer_load_dwordx4 v15, s[4:7], s50 offen lds
    s_add_u32 s50, s50, 131072
    s_add_u32 s51, s51, 1024
    v_xor_b32_e64 v15, 64, v14
    s_mov_b32 m0, s51
    s_nop 0
    buffer_load_dwordx4 v15, s[4:7], s50 offen lds
    s_add_u32 s50, s50, 131072
    s_add_u32 s51, s51, 1024
    v_xor_b32 v15, 80, v14
    s_mov_b32 m0, s51
    s_nop 0
    buffer_load_dwordx4 v15, s[4:7], s50 offen lds
    s_add_u32 s50, s50, 131072
    s_add_u32 s51, s51, 1024
    v_xor_b32 v15, 96, v14
    s_mov_b32 m0, s51
    s_nop 0
    buffer_load_dwordx4 v15, s[4:7], s50 offen lds
    s_add_u32 s50, s50, 131072
    s_add_u32 s51, s51, 1024
    v_xor_b32 v15, 112, v14
    s_mov_b32 m0, s51
    s_nop 0
    buffer_load_dwordx4 v15, s[4:7], s50 offen lds
    s_add_u32 s50, s50, 131072
    s_add_u32 s51, s51, 1024
    v_xor_b32 v15, 128, v14
    s_mov_b32 m0, s51
    s_nop 0
    buffer_load_dwordx4 v15, s[4:7], s50 offen lds
    s_add_u32 s50, s50, 131072
    s_add_u32 s51, s51, 1024
    v_xor_b32 v15, 144, v14
    s_mov_b32 m0, s51
    s_nop 0
    buffer_load_dwordx4 v15, s[4:7], s50 offen lds
    s_add_u32 s50, s50, 131072
    s_add_u32 s51, s51, 1024
    s_cmp_eq_u32 s30, 0
    s_cbranch_scc1 L_w0_1
    s_lshl_b32 s40, s30, 3
    s_lshl_b32 s41, s35, 5
    s_add_u32 s40, s40, s41
    v_lshlrev_b32 v8, 4, v1
    s_lshl_b32 s44, s30, 12
    v_add_u32 v8, s44, v8
    v_lshrrev_b32 v12, 5, v1
    v_and_b32 v9, 31, v1
    s_and_b32 s43, s30, 1
    s_lshl_b32 s43, s43, 3
    v_add_u32 v13, s43, v12
    v_xor_b32 v9, v9, v13
    v_add_u32 v12, s40, v12
    v_cvt_f32_u32 v12, v12
    v_mul_f32 v12, 0x3b000000, v12
    s_mov_b32 s46, 0x3b800000
    s_mov_b32 s47, 0x41000000
    s_or_b32 s45, s35, s30
    v_xor_b32 v10, 0, v9
    v_cvt_f32_u32 v10, v10
    v_add_f32 v11, v12, v12
    v_mul_f32 v10, s47, v10
    v_add_f32 v13, v11, v11
    v_mul_f32 v80, v10, v12
    v_add_f32 v81, v80, v12
    v_add_f32 v82, v80, v11
    v_add_f32 v84, v80, v13
    v_add_f32 v83, v81, v11
    v_add_f32 v85, v81, v13
    v_add_f32 v86, v82, v13
    v_add_f32 v87, v83, v13
    v_fract_f32 v80, v80
    v_fract_f32 v81, v81
    v_fract_f32 v82, v82
    v_fract_f32 v83, v83
    v_fract_f32 v84, v84
    v_fract_f32 v85, v85
    v_fract_f32 v86, v86
    v_fract_f32 v87, v87
    s_cmp_eq_u32 s45, 0
    s_cselect_b32 vcc_lo, -1, 0
    s_mov_b32 vcc_hi, 0
    v_mov_b32 v6, 0
    v_mov_b32 v7, 0.5
    v_cndmask_b32 v88, v80, v6, vcc
    v_cndmask_b32 v89, v81, v7, vcc
    v_cndmask_b32 v90, v82, v6, vcc
    v_cndmask_b32 v91, v83, v7, vcc
    v_cndmask_b32 v92, v84, v6, vcc
    v_cndmask_b32 v93, v85, v7, vcc
    v_cndmask_b32 v94, v86, v6, vcc
    v_cndmask_b32 v95, v87, v7, vcc
    v_cos_f32 v88, v88
    v_cos_f32 v89, v89
    v_cos_f32 v90, v90
    v_cos_f32 v91, v91
    v_cos_f32 v92, v92
    v_cos_f32 v93, v93
    v_cos_f32 v94, v94
    v_cos_f32 v95, v95
    v_sin_f32 v96, v80
    v_sin_f32 v97, v81
    v_sin_f32 v98, v82
    v_sin_f32 v99, v83
    v_sin_f32 v100, v84
    v_sin_f32 v101, v85
    v_sin_f32 v102, v86
    v_sin_f32_e64 v103, v87
    v_cvt_pk_bf16_f32 v104, v88, v89
    v_cvt_pk_bf16_f32 v105, v90, v91
    v_cvt_pk_bf16_f32 v106, v92, v93
    v_cvt_pk_bf16_f32 v107, v94, v95
    ds_write_b128 v8, v[104:107] offset:0
    v_cvt_pk_bf16_f32 v108, -v96, -v97
    v_cvt_pk_bf16_f32 v109, -v98, -v99
    v_cvt_pk_bf16_f32 v110, -v100, -v101
    v_cvt_pk_bf16_f32 v111, -v102, -v103
    ds_write_b128 v8, v[108:111] offset:16384
    v_add_f32 v12, s46, v12
    v_xor_b32 v10, 2, v9
    v_cvt_f32_u32 v10, v10
    v_add_f32 v11, v12, v12
    v_mul_f32 v10, s47, v10
    v_add_f32 v13, v11, v11
    v_mul_f32 v80, v10, v12
    v_add_f32 v81, v80, v12
    v_add_f32 v82, v80, v11
    v_add_f32 v84, v80, v13
    v_add_f32 v83, v81, v11
    v_add_f32 v85, v81, v13
    v_add_f32 v86, v82, v13
    v_add_f32 v87, v83, v13
    v_fract_f32 v80, v80
    v_fract_f32 v81, v81
    v_fract_f32 v82, v82
    v_fract_f32 v83, v83
    v_fract_f32 v84, v84
    v_fract_f32 v85, v85
    v_fract_f32 v86, v86
    v_fract_f32 v87, v87
    v_cos_f32 v88, v80
    v_cos_f32 v89, v81
    v_cos_f32 v90, v82
    v_cos_f32 v91, v83
    v_cos_f32 v92, v84
    v_cos_f32 v93, v85
    v_cos_f32 v94, v86
    v_cos_f32 v95, v87
    v_sin_f32 v96, v80
    v_sin_f32 v97, v81
    v_sin_f32 v98, v82
    v_sin_f32 v99, v83
    v_sin_f32 v100, v84
    v_sin_f32 v101, v85
    v_sin_f32 v102, v86
    v_sin_f32 v103, v87
    v_cvt_pk_bf16_f32 v104, v88, v89
    v_cvt_pk_bf16_f32 v105, v90, v91
    v_cvt_pk_bf16_f32 v106, v92, v93
    v_cvt_pk_bf16_f32 v107, v94, v95
    ds_write_b128 v8, v[104:107] offset:1024
    v_cvt_pk_bf16_f32 v108, -v96, -v97
    v_cvt_pk_bf16_f32 v109, -v98, -v99
    v_cvt_pk_bf16_f32 v110, -v100, -v101
    v_cvt_pk_bf16_f32 v111, -v102, -v103
    ds_write_b128 v8, v[108:111] offset:17408
    v_xor_b32 v15, 160, v14
    s_mov_b32 m0, s51
    s_nop 0
    buffer_load_dwordx4 v15, s[4:7], s50 offen lds
    s_add_u32 s50, s50, 131072
    s_add_u32 s51, s51, 1024
    v_xor_b32 v15, 176, v14
    s_mov_b32 m0, s51
    s_nop 0
    buffer_load_dwordx4 v15, s[4:7], s50 offen lds
    s_add_u32 s50, s50, 131072
    s_add_u32 s51, s51, 1024
    v_xor_b32 v15, 192, v14
    s_mov_b32 m0, s51
    s_nop 0
    buffer_load_dwordx4 v15, s[4:7], s50 offen lds
    s_add_u32 s50, s50, 131072
    s_add_u32 s51, s51, 1024
    v_xor_b32 v15, 208, v14
    s_mov_b32 m0, s51
    s_nop 0
    buffer_load_dwordx4 v15, s[4:7], s50 offen lds
    s_add_u32 s50, s50, 131072
    s_add_u32 s51, s51, 1024
    v_xor_b32 v15, 224, v14
    s_mov_b32 m0, s51
    s_nop 0
    buffer_load_dwordx4 v15, s[4:7], s50 offen lds
    s_add_u32 s50, s50, 131072
    s_add_u32 s51, s51, 1024
    v_xor_b32 v15, 240, v14
    s_mov_b32 m0, s51
    s_nop 0
    buffer_load_dwordx4 v15, s[4:7], s50 offen lds
    v_add_f32 v12, s46, v12
    v_xor_b32 v10, 4, v9
    v_cvt_f32_u32 v10, v10
    v_add_f32 v11, v12, v12
    v_mul_f32 v10, s47, v10
    v_add_f32 v13, v11, v11
    v_mul_f32 v80, v10, v12
    v_add_f32 v81, v80, v12
    v_add_f32 v82, v80, v11
    v_add_f32 v84, v80, v13
    v_add_f32 v83, v81, v11
    v_add_f32 v85, v81, v13
    v_add_f32 v86, v82, v13
    v_add_f32 v87, v83, v13
    v_fract_f32 v80, v80
    v_fract_f32 v81, v81
    v_fract_f32 v82, v82
    v_fract_f32 v83, v83
    v_fract_f32 v84, v84
    v_fract_f32 v85, v85
    v_fract_f32 v86, v86
    v_fract_f32 v87, v87
    v_cos_f32 v88, v80
    v_cos_f32 v89, v81
    v_cos_f32 v90, v82
    v_cos_f32 v91, v83
    v_cos_f32 v92, v84
    v_cos_f32 v93, v85
    v_cos_f32 v94, v86
    v_cos_f32 v95, v87
    v_sin_f32 v96, v80
    v_sin_f32 v97, v81
    v_sin_f32 v98, v82
    v_sin_f32 v99, v83
    v_sin_f32 v100, v84
    v_sin_f32 v101, v85
    v_sin_f32 v102, v86
    v_sin_f32 v103, v87
    v_cvt_pk_bf16_f32 v104, v88, v89
    v_cvt_pk_bf16_f32 v105, v90, v91
    v_cvt_pk_bf16_f32 v106, v92, v93
    v_cvt_pk_bf16_f32 v107, v94, v95
    ds_write_b128 v8, v[104:107] offset:2048
    v_cvt_pk_bf16_f32 v108, -v96, -v97
    v_cvt_pk_bf16_f32 v109, -v98, -v99
    v_cvt_pk_bf16_f32 v110, -v100, -v101
    v_cvt_pk_bf16_f32 v111, -v102, -v103
    ds_write_b128 v8, v[108:111] offset:18432
    v_add_f32 v12, s46, v12
    v_xor_b32 v10, 6, v9
    v_cvt_f32_u32 v10, v10
    v_add_f32 v11, v12, v12
    v_mul_f32 v10, s47, v10
    v_add_f32 v13, v11, v11
    v_mul_f32 v80, v10, v12
    v_add_f32 v81, v80, v12
    v_add_f32 v82, v80, v11
    v_add_f32 v84, v80, v13
    v_add_f32 v83, v81, v11
    v_add_f32 v85, v81, v13
    v_add_f32 v86, v82, v13
    v_add_f32 v87, v83, v13
    v_fract_f32 v80, v80
    v_fract_f32 v81, v81
    v_fract_f32 v82, v82
    v_fract_f32 v83, v83
    v_fract_f32 v84, v84
    v_fract_f32 v85, v85
    v_fract_f32 v86, v86
    v_fract_f32 v87, v87
    v_cos_f32 v88, v80
    v_cos_f32 v89, v81
    v_cos_f32 v90, v82
    v_cos_f32 v91, v83
    v_cos_f32 v92, v84
    v_cos_f32 v93, v85
    v_cos_f32 v94, v86
    v_cos_f32 v95, v87
    v_sin_f32 v96, v80
    v_sin_f32 v97, v81
    v_sin_f32 v98, v82
    v_sin_f32 v99, v83
    v_sin_f32 v100, v84
    v_sin_f32 v101, v85
    v_sin_f32 v102, v86
    v_sin_f32 v103, v87
    v_cvt_pk_bf16_f32 v104, v88, v89
    v_cvt_pk_bf16_f32 v105, v90, v91
    v_cvt_pk_bf16_f32 v106, v92, v93
    v_cvt_pk_bf16_f32 v107, v94, v95
    ds_write_b128 v8, v[104:107] offset:3072
    v_cvt_pk_bf16_f32 v108, -v96, -v97
    v_cvt_pk_bf16_f32 v109, -v98, -v99
    v_cvt_pk_bf16_f32 v110, -v100, -v101
    v_cvt_pk_bf16_f32 v111, -v102, -v103
    ds_write_b128 v8, v[108:111] offset:19456
    s_waitcnt lgkmcnt(0)
    s_add_u32 s32, s48, 0x7F4A7C15
    s_addc_u32 s33, s49, 0x9E3779B9
    s_mov_b32 s99, s32
    s_and_b32 s32, s32, 0xFFFFFF00
    v_and_b32 v2, 15, v1
    v_lshrrev_b32 v3, 4, v1
    v_cvt_f32_u32 v2, v2
    s_lshl_b32 s40, s36, 2
    s_add_u32 s40, s40, s30
    s_lshl_b32 s40, s40, 4
    s_add_u32 s40, s40, s37
    v_lshlrev_b32 v3, 9, v3
    v_add_u32 v3, s40, v3
    v_cvt_f32_u32 v3, v3
    v_mul_f32 v3, 0x3a000000, v3
    v_mul_f32_e64 v4, v2, v3
    v_mul_f32 v5, 0x3d800000, v2
    v_fract_f32 v8, v4
    v_add_f32 v4, v4, v5
    v_fract_f32 v9, v4
    v_add_f32 v4, v4, v5
    v_fract_f32 v10, v4
    v_add_f32 v4, v4, v5
    v_fract_f32 v11, v4
    v_cos_f32 v12, v8
    v_cos_f32 v13, v9
    v_cos_f32 v14, v10
    v_cos_f32 v15, v11
    v_sin_f32 v8, v8
    v_sin_f32 v9, v9
    v_sin_f32 v10, v10
    v_sin_f32_e64 v11, v11
    v_cvt_pk_bf16_f32 v136, v12, v13
    v_cvt_pk_bf16_f32 v137, v14, v15
    v_cvt_pk_bf16_f32 v138, v8, v9
    v_cvt_pk_bf16_f32 v139, v10, v11
    v_xor_b32 v140, 0x80008000, v138
    v_xor_b32 v141, 0x80008000, v139
    v_mov_b32 v142, v136
    v_mov_b32 v143, v137
    v_lshrrev_b32 v2, 3, v1
    v_and_b32 v3, 7, v1
    v_bfe_u32 v4, v2, 1, 1
    v_lshlrev_b32 v4, 1, v4
    v_xor_b32 v3, v3, v4
    v_mul_u32_u24 v2, 3584, v2
    v_lshl_add_u32 v112, v3, 4, v2
    v_xor_b32_e64 v3, 4, v3
    v_lshl_add_u32 v113, v3, 4, v2
    s_add_u32 s40, s30, -1
    s_mul_i32 s41, s40, 28672
    s_min_u32 s42, s29, 27
    s_lshl_b32 s42, s42, 7
    s_add_u32 s41, s41, s42
    s_lshr_b32 s42, s40, 1
    s_lshl_b32 s42, s42, 12
    s_and_b32 s43, s40, 1
    s_lshl_b32 s43, s43, 10
    s_add_u32 s42, s42, s43
    s_add_u32 s42, s42, 106496
    s_mov_b32 m0, s42
    s_nop 0
    buffer_load_dwordx4 v112, s[8:11], s41 offen lds
    s_add_u32 m0, s42, 2048
    s_nop 0
    buffer_load_dwordx4 v113, s[12:15], s41 offen lds
    s_add_u32 s40, s30, 2
    s_mul_i32 s41, s40, 28672
    s_min_u32 s42, s29, 27
    s_lshl_b32 s42, s42, 7
    s_add_u32 s41, s41, s42
    s_lshr_b32 s42, s40, 1
    s_lshl_b32 s42, s42, 12
    s_and_b32 s43, s40, 1
    s_lshl_b32 s43, s43, 10
    s_add_u32 s42, s42, s43
    s_add_u32 s42, s42, 106496
    s_mov_b32 m0, s42
    s_nop 0
    buffer_load_dwordx4 v112, s[8:11], s41 offen lds
    s_add_u32 m0, s42, 2048
    s_nop 0
    buffer_load_dwordx4 v113, s[12:15], s41 offen lds
    s_add_u32 s40, s30, 5
    s_mul_i32 s41, s40, 28672
    s_min_u32 s42, s29, 27
    s_lshl_b32 s42, s42, 7
    s_add_u32 s41, s41, s42
    s_lshr_b32 s42, s40, 1
    s_lshl_b32 s42, s42, 12
    s_and_b32 s43, s40, 1
    s_lshl_b32 s43, s43, 10
    s_add_u32 s42, s42, s43
    s_add_u32 s42, s42, 106496
    s_mov_b32 m0, s42
    s_nop 0
    buffer_load_dwordx4 v112, s[8:11], s41 offen lds
    s_add_u32 m0, s42, 2048
    s_nop 0
    buffer_load_dwordx4 v113, s[12:15], s41 offen lds
    s_add_u32 s40, s30, 8
    s_mul_i32 s41, s40, 28672
    s_min_u32 s42, s29, 27
    s_lshl_b32 s42, s42, 7
    s_add_u32 s41, s41, s42
    s_lshr_b32 s42, s40, 1
    s_lshl_b32 s42, s42, 12
    s_and_b32 s43, s40, 1
    s_lshl_b32 s43, s43, 10
    s_add_u32 s42, s42, s43
    s_add_u32 s42, s42, 106496
    s_mov_b32 m0, s42
    s_nop 0
    buffer_load_dwordx4 v112, s[8:11], s41 offen lds
    s_add_u32 m0, s42, 2048
    s_nop 0
    buffer_load_dwordx4 v113, s[12:15], s41 offen lds
    s_barrier
    v_and_b32 v2, 15, v1
    v_lshrrev_b32 v3, 4, v1
    v_and_b32 v8, 3, v2
    v_xor_b32 v8, v8, v3
    v_lshlrev_b32 v8, 4, v8
    v_lshrrev_b32_e64 v9, 2, v2
    v_lshl_add_u32 v11, v2, 10, v8
    s_lshl_b32 s40, s30, 14
    s_add_u32 s40, s40, 40960
    v_add_u32 v11, s40, v11
    v_lshl_add_u32 v8, v2, 9, v8
    v_xor_b32_e64 v10, 0, v9
    v_lshl_add_u32 v4, v10, 6, v8
    v_lshl_add_u32 v16, v10, 6, v11
    v_xor_b32_e64 v10, 1, v9
    v_lshl_add_u32 v5, v10, 6, v8
    v_lshl_add_u32 v17, v10, 6, v11
    v_xor_b32_e64 v10, 2, v9
    v_lshl_add_u32 v6, v10, 6, v8
    v_lshl_add_u32 v18, v10, 6, v11
    v_xor_b32_e64 v10, 3, v9
    v_lshl_add_u32 v7, v10, 6, v8
    v_lshl_add_u32 v19, v10, 6, v11
    v_mov_b32 v12, 0x3f803f80
    v_mov_b32 v13, 0x3f803f80
    v_mov_b32 v14, 0x3f803f80
    v_mov_b32 v15, 0x3f803f80
    ds_read_b128 v[104:107], v4 offset:0
    ds_read_b128 v[108:111], v4 offset:8192
    ds_read_b128 v[112:115], v4 offset:16384
    ds_read_b128 v[116:119], v4 offset:24576
    s_waitcnt vmcnt(8)
    ds_read_b128 v[24:27], v16 offset:0
    ds_read_b128 v[28:31], v17 offset:0
    ds_read_b128 v[32:35], v18 offset:0
    ds_read_b128 v[36:39], v19 offset:0
    ds_read_b128 v[40:43], v16 offset:256
    ds_read_b128 v[44:47], v17 offset:256
    ds_read_b128 v[48:51], v18 offset:256
    s_waitcnt lgkmcnt(6)
    v_mfma_f32_16x16x32_bf16 v[96:99], v[24:27], v[12:15], 0
    v_mfma_f32_16x16x32_bf16 v[100:103], v[24:27], v[24:27], 0
    ds_read_b128 v[52:55], v19 offset:256
    s_waitcnt lgkmcnt(6)
    v_mfma_f32_16x16x32_bf16 v[96:99], v[28:31], v[12:15], v[96:99]
    v_mfma_f32_16x16x32_bf16 v[100:103], v[28:31], v[28:31], v[100:103]
    ds_read_b128 v[24:27], v16 offset:512
    s_waitcnt lgkmcnt(6)
    v_mfma_f32_16x16x32_bf16 v[96:99], v[32:35], v[12:15], v[96:99]
    v_mfma_f32_16x16x32_bf16 v[100:103], v[32:35], v[32:35], v[100:103]
    ds_read_b128 v[28:31], v17 offset:512
    s_waitcnt lgkmcnt(6)
    v_mfma_f32_16x16x32_bf16 v[96:99], v[36:39], v[12:15], v[96:99]
    v_mfma_f32_16x16x32_bf16 v[100:103], v[36:39], v[36:39], v[100:103]
    ds_read_b128 v[32:35], v18 offset:512
    s_waitcnt lgkmcnt(6)
    v_mfma_f32_16x16x32_bf16 v[96:99], v[40:43], v[12:15], v[96:99]
    v_mfma_f32_16x16x32_bf16 v[100:103], v[40:43], v[40:43], v[100:103]
    ds_read_b128 v[36:39], v19 offset:512
    s_waitcnt lgkmcnt(6)
    v_mfma_f32_16x16x32_bf16 v[96:99], v[44:47], v[12:15], v[96:99]
    v_mfma_f32_16x16x32_bf16 v[100:103], v[44:47], v[44:47], v[100:103]
    ds_read_b128 v[40:43], v16 offset:768
    s_waitcnt lgkmcnt(6)
    v_mfma_f32_16x16x32_bf16 v[96:99], v[48:51], v[12:15], v[96:99]
    v_mfma_f32_16x16x32_bf16 v[100:103], v[48:51], v[48:51], v[100:103]
    ds_read_b128 v[44:47], v17 offset:768
    s_waitcnt lgkmcnt(6)
    v_mfma_f32_16x16x32_bf16 v[96:99], v[52:55], v[12:15], v[96:99]
    v_mfma_f32_16x16x32_bf16 v[100:103], v[52:55], v[52:55], v[100:103]
    ds_read_b128 v[48:51], v18 offset:768
    s_waitcnt lgkmcnt(6)
    v_mfma_f32_16x16x32_bf16 v[96:99], v[24:27], v[12:15], v[96:99]
    v_mfma_f32_16x16x32_bf16 v[100:103], v[24:27], v[24:27], v[100:103]
    ds_read_b128 v[52:55], v19 offset:768
    s_waitcnt lgkmcnt(6)
    v_mfma_f32_16x16x32_bf16 v[96:99], v[28:31], v[12:15], v[96:99]
    v_mfma_f32_16x16x32_bf16 v[100:103], v[28:31], v[28:31], v[100:103]
    s_waitcnt lgkmcnt(5)
    v_mfma_f32_16x16x32_bf16 v[96:99], v[32:35], v[12:15], v[96:99]
    v_mfma_f32_16x16x32_bf16 v[100:103], v[32:35], v[32:35], v[100:103]
    s_waitcnt lgkmcnt(4)
    v_mfma_f32_16x16x32_bf16 v[96:99], v[36:39], v[12:15], v[96:99]
    v_mfma_f32_16x16x32_bf16 v[100:103], v[36:39], v[36:39], v[100:103]
    s_waitcnt lgkmcnt(3)
    v_mfma_f32_16x16x32_bf16 v[96:99], v[40:43], v[12:15], v[96:99]
    v_mfma_f32_16x16x32_bf16 v[100:103], v[40:43], v[40:43], v[100:103]
    s_waitcnt lgkmcnt(2)
    v_mfma_f32_16x16x32_bf16 v[96:99], v[44:47], v[12:15], v[96:99]
    v_mfma_f32_16x16x32_bf16 v[100:103], v[44:47], v[44:47], v[100:103]
    s_waitcnt lgkmcnt(1)
    v_mfma_f32_16x16x32_bf16 v[96:99], v[48:51], v[12:15], v[96:99]
    v_mfma_f32_16x16x32_bf16 v[100:103], v[48:51], v[48:51], v[100:103]
    s_waitcnt lgkmcnt(0)
    v_mfma_f32_16x16x32_bf16 v[96:99], v[52:55], v[12:15], v[96:99]
    v_mfma_f32_16x16x32_bf16 v[100:103], v[52:55], v[52:55], v[100:103]
    ds_read_b128 v[24:27], v16 offset:0
    ds_read_b128 v[28:31], v16 offset:512
    ds_read_b128 v[32:35], v17 offset:0
    ds_read_b128 v[36:39], v17 offset:512
    s_waitcnt lgkmcnt(3)
    v_mfma_f32_16x16x32_bf16 v[80:83], v[24:27], v[104:107], 0
    s_waitcnt lgkmcnt(2)
    v_mfma_f32_16x16x32_bf16 v[120:123], v[28:31], v[104:107], 0
    ds_read_b128 v[104:107], v5 offset:0
    v_mfma_f32_16x16x32_bf16 v[84:87], v[24:27], v[108:111], 0
    v_mfma_f32_16x16x32_bf16 v[124:127], v[28:31], v[108:111], 0
    ds_read_b128 v[108:111], v5 offset:8192
    v_mfma_f32_16x16x32_bf16 v[88:91], v[24:27], v[112:115], 0
    v_mfma_f32_16x16x32_bf16 v[128:131], v[28:31], v[112:115], 0
    ds_read_b128 v[112:115], v5 offset:16384
    v_mfma_f32_16x16x32_bf16 v[92:95], v[24:27], v[116:119], 0
    v_mfma_f32_16x16x32_bf16 v[132:135], v[28:31], v[116:119], 0
    ds_read_b128 v[116:119], v5 offset:24576
    ds_read_b128 v[40:43], v18 offset:0
    ds_read_b128 v[44:47], v18 offset:512
    s_waitcnt lgkmcnt(5)
    v_mfma_f32_16x16x32_bf16 v[80:83], v[32:35], v[104:107], v[80:83]
    v_mfma_f32_16x16x32_bf16 v[120:123], v[36:39], v[104:107], v[120:123]
    ds_read_b128 v[104:107], v6 offset:0
    v_lshrrev_b32_e64 v3, 4, v1
    v_mul_u32_u24 v3, 80, v3
    s_waitcnt lgkmcnt(5)
    v_mfma_f32_16x16x32_bf16 v[84:87], v[32:35], v[108:111], v[84:87]
    v_mfma_f32_16x16x32_bf16 v[124:127], v[36:39], v[108:111], v[124:127]
    ds_read_b128 v[108:111], v6 offset:8192
    v_add_u32 v2, 0, v3
    ds_bpermute_b32 v8, v2, v100
    s_waitcnt lgkmcnt(6)
    v_mfma_f32_16x16x32_bf16 v[88:91], v[32:35], v[112:115], v[88:91]
    v_mfma_f32_16x16x32_bf16 v[128:131], v[36:39], v[112:115], v[128:131]
    ds_read_b128 v[112:115], v6 offset:16384
    v_add_u32 v2, 4, v3
    ds_bpermute_b32 v9, v2, v101
    s_waitcnt lgkmcnt(7)
    v_mfma_f32_16x16x32_bf16 v[92:95], v[32:35], v[116:119], v[92:95]
    v_mfma_f32_16x16x32_bf16 v[132:135], v[36:39], v[116:119], v[132:135]
    ds_read_b128 v[116:119], v6 offset:24576
    v_add_u32 v2, 8, v3
    ds_bpermute_b32 v10, v2, v102
    ds_read_b128 v[48:51], v19 offset:0
    ds_read_b128 v[52:55], v19 offset:512
    s_waitcnt lgkmcnt(8)
    v_mfma_f32_16x16x32_bf16 v[80:83], v[40:43], v[104:107], v[80:83]
    v_mfma_f32_16x16x32_bf16 v[120:123], v[44:47], v[104:107], v[120:123]
    ds_read_b128 v[104:107], v7 offset:0
    v_add_u32 v2, 12, v3
    ds_bpermute_b32 v11, v2, v103
    s_waitcnt lgkmcnt(9)
    v_mfma_f32_16x16x32_bf16 v[84:87], v[40:43], v[108:111], v[84:87]
    v_mfma_f32_16x16x32_bf16 v[124:127], v[44:47], v[108:111], v[124:127]
    ds_read_b128 v[108:111], v7 offset:8192
    v_mul_f32 v96, 0x3b000000, v96
    v_mul_f32 v97, 0x3b000000, v97
    s_waitcnt lgkmcnt(8)
    v_mfma_f32_16x16x32_bf16 v[88:91], v[40:43], v[112:115], v[88:91]
    v_mfma_f32_16x16x32_bf16 v[128:131], v[44:47], v[112:115], v[128:131]
    ds_read_b128 v[112:115], v7 offset:16384
    v_mul_f32 v98, 0x3b000000, v98
    v_mul_f32 v99, 0x3b000000, v99
    s_waitcnt lgkmcnt(7)
    v_mfma_f32_16x16x32_bf16 v[92:95], v[40:43], v[116:119], v[92:95]
    v_mfma_f32_16x16x32_bf16 v[132:135], v[44:47], v[116:119], v[132:135]
    ds_read_b128 v[116:119], v7 offset:24576
    v_mul_f32 v8, 0x3b000000, v8
    v_mul_f32 v9, 0x3b000000, v9
    ds_read_b128 v[24:27], v16 offset:256
    ds_read_b128 v[28:31], v16 offset:768
    s_waitcnt lgkmcnt(6)
    v_mfma_f32_16x16x32_bf16 v[80:83], v[48:51], v[104:107], v[80:83]
    v_mfma_f32_16x16x32_bf16 v[120:123], v[52:55], v[104:107], v[120:123]
    ds_read_b128 v[104:107], v4 offset:256
    v_mul_f32 v10, 0x3b000000, v10
    s_waitcnt lgkmcnt(6)
    v_mul_f32 v11, 0x3b000000, v11
    s_waitcnt lgkmcnt(5)
    v_mfma_f32_16x16x32_bf16 v[84:87], v[48:51], v[108:111], v[84:87]
    v_mfma_f32_16x16x32_bf16 v[124:127], v[52:55], v[108:111], v[124:127]
    ds_read_b128 v[108:111], v4 offset:8448
    v_fma_f32 v8, -v96, v96, v8
    v_fma_f32 v9, -v97, v97, v9
    s_waitcnt lgkmcnt(5)
    v_mfma_f32_16x16x32_bf16 v[88:91], v[48:51], v[112:115], v[88:91]
    v_mfma_f32_16x16x32_bf16 v[128:131], v[52:55], v[112:115], v[128:131]
    ds_read_b128 v[112:115], v4 offset:16640
    v_fma_f32 v10, -v98, v98, v10
    v_fma_f32 v11, -v99, v99, v11
    s_waitcnt lgkmcnt(5)
    v_mfma_f32_16x16x32_bf16 v[92:95], v[48:51], v[116:119], v[92:95]
    v_mfma_f32_16x16x32_bf16 v[132:135], v[52:55], v[116:119], v[132:135]
    ds_read_b128 v[116:119], v4 offset:24832
    v_add_f32 v8, 0x3727c5ac, v8
    v_add_f32 v9, 0x3727c5ac, v9
    ds_read_b128 v[32:35], v17 offset:256
    ds_read_b128 v[36:39], v17 offset:768
    s_waitcnt lgkmcnt(5)
    v_mfma_f32_16x16x32_bf16 v[80:83], v[24:27], v[104:107], v[80:83]
    v_mfma_f32_16x16x32_bf16 v[120:123], v[28:31], v[104:107], v[120:123]
    ds_read_b128 v[104:107], v5 offset:256
    v_add_f32 v10, 0x3727c5ac, v10
    v_add_f32 v11, 0x3727c5ac, v11
    s_waitcnt lgkmcnt(5)
    v_mfma_f32_16x16x32_bf16 v[84:87], v[24:27], v[108:111], v[84:87]
    v_mfma_f32_16x16x32_bf16 v[124:127], v[28:31], v[108:111], v[124:127]
    ds_read_b128 v[108:111], v5 offset:8448
    v_rsq_f32 v8, v8
    v_rsq_f32_e64 v9, v9
    s_waitcnt lgkmcnt(5)
    v_mfma_f32_16x16x32_bf16 v[88:91], v[24:27], v[112:115], v[88:91]
    v_mfma_f32_16x16x32_bf16 v[128:131], v[28:31], v[112:115], v[128:131]
    ds_read_b128 v[112:115], v5 offset:16640
    v_rsq_f32 v10, v10
    v_rsq_f32_e64 v11, v11
    s_waitcnt lgkmcnt(5)
    v_mfma_f32_16x16x32_bf16 v[92:95], v[24:27], v[116:119], v[92:95]
    v_mfma_f32_16x16x32_bf16 v[132:135], v[28:31], v[116:119], v[132:135]
    ds_read_b128 v[116:119], v5 offset:24832
    v_and_b32 v2, 1, v1
    v_lshlrev_b32 v2, 31, v2
    ds_read_b128 v[40:43], v18 offset:256
    ds_read_b128 v[44:47], v18 offset:768
    s_waitcnt lgkmcnt(5)
    v_mfma_f32_16x16x32_bf16 v[80:83], v[32:35], v[104:107], v[80:83]
    v_mfma_f32_16x16x32_bf16 v[120:123], v[36:39], v[104:107], v[120:123]
    ds_read_b128 v[104:107], v6 offset:256
    v_or_b32_e64 v2, 1.0, v2
    s_waitcnt lgkmcnt(5)
    v_mfma_f32_16x16x32_bf16 v[84:87], v[32:35], v[108:111], v[84:87]
    v_mfma_f32_16x16x32_bf16 v[124:127], v[36:39], v[108:111], v[124:127]
    ds_read_b128 v[108:111], v6 offset:8448
    s_waitcnt lgkmcnt(5)
    v_mfma_f32_16x16x32_bf16 v[88:91], v[32:35], v[112:115], v[88:91]
    v_mfma_f32_16x16x32_bf16 v[128:131], v[36:39], v[112:115], v[128:131]
    ds_read_b128 v[112:115], v6 offset:16640
    s_waitcnt lgkmcnt(5)
    v_mfma_f32_16x16x32_bf16 v[92:95], v[32:35], v[116:119], v[92:95]
    v_mfma_f32_16x16x32_bf16 v[132:135], v[36:39], v[116:119], v[132:135]
    ds_read_b128 v[116:119], v6 offset:24832
    ds_read_b128 v[48:51], v19 offset:256
    ds_read_b128 v[52:55], v19 offset:768
    s_waitcnt lgkmcnt(5)
    v_mfma_f32_16x16x32_bf16 v[80:83], v[40:43], v[104:107], v[80:83]
    v_mfma_f32_16x16x32_bf16 v[120:123], v[44:47], v[104:107], v[120:123]
    ds_read_b128 v[104:107], v7 offset:256
    s_waitcnt lgkmcnt(5)
    v_mfma_f32_16x16x32_bf16 v[84:87], v[40:43], v[108:111], v[84:87]
    v_mfma_f32_16x16x32_bf16 v[124:127], v[44:47], v[108:111], v[124:127]
    ds_read_b128 v[108:111], v7 offset:8448
    s_waitcnt lgkmcnt(5)
    v_mfma_f32_16x16x32_bf16 v[88:91], v[40:43], v[112:115], v[88:91]
    v_mfma_f32_16x16x32_bf16 v[128:131], v[44:47], v[112:115], v[128:131]
    ds_read_b128 v[112:115], v7 offset:16640
    s_waitcnt lgkmcnt(5)
    v_mfma_f32_16x16x32_bf16 v[92:95], v[40:43], v[116:119], v[92:95]
    v_mfma_f32_16x16x32_bf16 v[132:135], v[44:47], v[116:119], v[132:135]
    ds_read_b128 v[116:119], v7 offset:24832
    s_waitcnt lgkmcnt(3)
    v_mfma_f32_16x16x32_bf16 v[80:83], v[48:51], v[104:107], v[80:83]
    v_mfma_f32_16x16x32_bf16 v[120:123], v[52:55], v[104:107], v[120:123]
    s_waitcnt lgkmcnt(2)
    v_mfma_f32_16x16x32_bf16 v[84:87], v[48:51], v[108:111], v[84:87]
    v_mfma_f32_16x16x32_bf16 v[124:127], v[52:55], v[108:111], v[124:127]
    s_waitcnt lgkmcnt(1)
    v_mfma_f32_16x16x32_bf16 v[88:91], v[48:51], v[112:115], v[88:91]
    v_mfma_f32_16x16x32_bf16 v[128:131], v[52:55], v[112:115], v[128:131]
    s_waitcnt lgkmcnt(0)
    v_mfma_f32_16x16x32_bf16 v[92:95], v[48:51], v[116:119], v[92:95]
    v_mfma_f32_16x16x32_bf16 v[132:135], v[52:55], v[116:119], v[132:135]
    v_fmac_f32 v80, v2, v120
    v_fmac_f32 v81, v2, v121
    v_fmac_f32 v82, v2, v122
    v_fmac_f32 v83, v2, v123
    v_fmac_f32 v84, v2, v124
    v_fmac_f32 v85, v2, v125
    v_fmac_f32 v86, v2, v126
    v_fmac_f32 v87, v2, v127
    v_fmac_f32 v88, v2, v128
    v_fmac_f32 v89, v2, v129
    v_fmac_f32 v90, v2, v130
    v_fmac_f32 v91, v2, v131
    v_fmac_f32 v92, v2, v132
    v_fmac_f32 v93, v2, v133
    v_fmac_f32 v94, v2, v134
    v_fmac_f32 v95, v2, v135
    v_mul_f32 v80, v80, v8
    v_mul_f32 v81, v81, v9
    v_mul_f32 v82, v82, v10
    v_mul_f32 v83, v83, v11
    v_mul_f32 v84, v84, v8
    v_mul_f32 v85, v85, v9
    v_mul_f32 v86, v86, v10
    v_mul_f32 v87, v87, v11
    v_mul_f32 v88, v88, v8
    v_mul_f32 v89, v89, v9
    v_mul_f32 v90, v90, v10
    v_mul_f32 v91, v91, v11
    v_mul_f32 v92, v92, v8
    v_mul_f32 v93, v93, v9
    v_mul_f32 v94, v94, v10
    v_mul_f32 v95, v95, v11
    v_cvt_pk_bf16_f32 v16, v80, v81
    v_cvt_pk_bf16_f32 v17, v82, v83
    v_cvt_pk_bf16_f32 v18, v88, v89
    v_cvt_pk_bf16_f32 v19, v90, v91
    v_cvt_pk_bf16_f32 v20, v84, v85
    v_cvt_pk_bf16_f32 v21, v86, v87
    v_cvt_pk_bf16_f32 v22, v92, v93
    v_cvt_pk_bf16_f32 v23, v94, v95
    v_mfma_f32_16x16x32_bf16 v[24:27], v[136:139], v[16:19], 0
    v_mfma_f32_16x16x32_bf16 v[28:31], v[140:143], v[16:19], 0
    v_mfma_f32_16x16x32_bf16 v[32:35], v[136:139], v[20:23], 0
    v_mfma_f32_16x16x32_bf16 v[36:39], v[140:143], v[20:23], 0
    v_and_b32 v2, 15, v1
    v_lshrrev_b32 v3, 4, v1
    v_lshlrev_b32_e64 v2, 4, v2
    v_lshl_add_u32 v2, v3, 11, v2
    s_lshl_b32 s40, s30, 2
    s_add_u32 s40, s40, 32768
    v_add_u32 v2, s40, v2
    v_cvt_pk_bf16_f32 v40, v24, v28
    ds_write_b32 v2, v40 offset:0
    v_cvt_pk_bf16_f32 v41, v25, v29
    ds_write_b32 v2, v41 offset:512
    v_cvt_pk_bf16_f32 v42, v26, v30
    ds_write_b32 v2, v42 offset:1024
    v_cvt_pk_bf16_f32 v43, v27, v31
    ds_write_b32 v2, v43 offset:1536
    v_cvt_pk_bf16_f32 v44, v32, v36
    ds_write_b32 v2, v44 offset:256
    v_cvt_pk_bf16_f32 v45, v33, v37
    ds_write_b32 v2, v45 offset:768
    v_cvt_pk_bf16_f32 v46, v34, v38
    ds_write_b32 v2, v46 offset:1280
    v_cvt_pk_bf16_f32 v47, v35, v39
    ds_write_b32 v2, v47 offset:1792
    s_waitcnt lgkmcnt(0)
    s_barrier
    v_lshrrev_b32 v2, 3, v1
    v_and_b32 v3, 7, v1
    v_bfe_u32 v4, v2, 1, 1
    v_lshlrev_b32 v4, 1, v4
    v_xor_b32 v3, v3, v4
    v_mul_u32_u24 v2, 3584, v2
    v_lshl_add_u32 v112, v3, 4, v2
    v_xor_b32_e64 v3, 4, v3
    v_lshl_add_u32 v113, v3, 4, v2
    v_and_b32 v2, 15, v1
    v_lshrrev_b32 v3, 4, v1
    v_and_b32 v4, 7, v2
    v_lshrrev_b32 v2, 3, v2
    v_lshl_add_u32 v2, v4, 3, v2
    s_lshl_b32 s40, s36, 6
    s_lshl_b32 s41, s30, 1
    s_add_u32 s40, s40, s41
    v_add_u32 v2, s40, v2
    v_cvt_f32_u32_e64 v4, v2
    v_mul_f32 v4, 0x3c000000, v4
    v_and_b32 v5, 1, v3
    v_lshrrev_b32 v6, 1, v3
    v_cvt_f32_u32 v5, v5
    v_cvt_f32_u32 v6, v6
    v_mul_f32 v6, v4, v6
    v_mul_f32 v5, v4, v5
    v_mul_f32 v5, 0x42800000, v5
    v_mul_f32 v7, 0x41000000, v6
    v_add_f32_e64 v5, v5, v7
    v_mul_f32 v7, 0x40c00000, v6
    v_add_f32 v7, v4, v7
    v_add_f32 v8, v6, v6
    v_sub_f32_e64 v8, v4, v8
    v_mul_f32 v9, 0x41800000, v4
    v_add_f32 v10, v9, v9
    v_add_f32 v49, v5, v9
    v_add_f32 v50, v5, v10
    v_fract_f32 v48, v5
    v_add_f32 v51, v49, v10
    v_fract_f32 v49, v49
    v_fract_f32 v50, v50
    v_fract_f32 v51, v51
    v_cos_f32 v52, v48
    v_cos_f32 v53, v49
    v_cos_f32 v54, v50
    v_cos_f32 v55, v51
    v_sin_f32 v56, v48
    v_sin_f32 v57, v49
    v_sin_f32 v58, v50
    v_sin_f32 v59, v51
    v_cvt_pk_bf16_f32 v16, v52, v56
    v_cvt_pk_bf16_f32 v17, v53, v57
    v_cvt_pk_bf16_f32 v18, v54, v58
    v_cvt_pk_bf16_f32 v19, v55, v59
    v_add_f32 v5, v5, v7
    v_add_f32 v49, v5, v9
    v_add_f32 v50, v5, v10
    v_fract_f32 v48, v5
    v_add_f32 v51, v49, v10
    v_fract_f32 v49, v49
    v_fract_f32 v50, v50
    v_fract_f32 v51, v51
    v_cos_f32 v52, v48
    v_cos_f32 v53, v49
    v_cos_f32 v54, v50
    v_cos_f32 v55, v51
    v_sin_f32 v56, v48
    v_sin_f32 v57, v49
    v_sin_f32 v58, v50
    v_sin_f32 v59, v51
    v_cvt_pk_bf16_f32 v20, v52, v56
    v_cvt_pk_bf16_f32 v21, v53, v57
    v_cvt_pk_bf16_f32 v22, v54, v58
    v_cvt_pk_bf16_f32 v23, v55, v59
    v_add_f32 v5, v5, v8
    v_add_f32 v49, v5, v9
    v_add_f32 v50, v5, v10
    v_fract_f32 v48, v5
    v_add_f32 v51, v49, v10
    v_fract_f32 v49, v49
    v_fract_f32 v50, v50
    v_fract_f32 v51, v51
    v_cos_f32 v52, v48
    v_cos_f32 v53, v49
    v_cos_f32 v54, v50
    v_cos_f32 v55, v51
    v_sin_f32 v56, v48
    v_sin_f32 v57, v49
    v_sin_f32 v58, v50
    v_sin_f32 v59, v51
    v_cvt_pk_bf16_f32 v24, v52, v56
    v_cvt_pk_bf16_f32 v25, v53, v57
    v_cvt_pk_bf16_f32 v26, v54, v58
    v_cvt_pk_bf16_f32 v27, v55, v59
    v_add_f32 v5, v5, v8
    v_add_f32 v49, v5, v9
    v_add_f32 v50, v5, v10
    v_fract_f32 v48, v5
    v_add_f32 v51, v49, v10
    v_fract_f32 v49, v49
    v_fract_f32 v50, v50
    v_fract_f32 v51, v51
    v_cos_f32 v52, v48
    v_cos_f32 v53, v49
    v_cos_f32 v54, v50
    v_cos_f32 v55, v51
    v_sin_f32 v56, v48
    v_sin_f32 v57, v49
    v_sin_f32 v58, v50
    v_sin_f32 v59, v51
    v_cvt_pk_bf16_f32 v28, v52, v56
    v_cvt_pk_bf16_f32 v29, v53, v57
    v_cvt_pk_bf16_f32 v30, v54, v58
    v_cvt_pk_bf16_f32 v31, v55, v59
    v_add_f32 v5, v5, v8
    v_add_f32 v49, v5, v9
    v_add_f32 v50, v5, v10
    v_fract_f32 v48, v5
    v_add_f32 v51, v49, v10
    v_fract_f32 v49, v49
    v_fract_f32 v50, v50
    v_fract_f32 v51, v51
    v_cos_f32 v52, v48
    v_cos_f32 v53, v49
    v_cos_f32 v54, v50
    v_cos_f32 v55, v51
    v_sin_f32 v56, v48
    v_sin_f32 v57, v49
    v_sin_f32 v58, v50
    v_sin_f32 v59, v51
    v_cvt_pk_bf16_f32 v32, v52, v56
    v_cvt_pk_bf16_f32 v33, v53, v57
    v_cvt_pk_bf16_f32 v34, v54, v58
    v_cvt_pk_bf16_f32 v35, v55, v59
    s_add_u32 s40, s30, 11
    s_mul_i32 s41, s40, 28672
    s_min_u32 s42, s29, 27
    s_lshl_b32 s42, s42, 7
    s_add_u32 s41, s41, s42
    s_lshr_b32 s42, s40, 1
    s_lshl_b32 s42, s42, 12
    s_and_b32 s43, s40, 1
    s_lshl_b32 s43, s43, 10
    s_add_u32 s42, s42, s43
    s_add_u32 s42, s42, 106496
    s_mov_b32 m0, s42
    s_nop 0
    buffer_load_dwordx4 v112, s[8:11], s41 offen lds
    s_add_u32 m0, s42, 2048
    s_nop 0
    buffer_load_dwordx4 v113, s[12:15], s41 offen lds
    v_add_f32 v5, v5, v8
    v_add_f32 v49, v5, v9
    v_add_f32 v50, v5, v10
    v_fract_f32 v48, v5
    v_add_f32 v51, v49, v10
    v_fract_f32 v49, v49
    v_fract_f32 v50, v50
    v_fract_f32 v51, v51
    v_cos_f32 v52, v48
    v_cos_f32 v53, v49
    v_cos_f32 v54, v50
    v_cos_f32 v55, v51
    v_sin_f32 v56, v48
    v_sin_f32 v57, v49
    v_sin_f32 v58, v50
    v_sin_f32 v59, v51
    v_cvt_pk_bf16_f32 v36, v52, v56
    v_cvt_pk_bf16_f32 v37, v53, v57
    v_cvt_pk_bf16_f32 v38, v54, v58
    v_cvt_pk_bf16_f32 v39, v55, v59
    s_add_u32 s40, s30, 14
    s_mul_i32 s41, s40, 28672
    s_min_u32 s42, s29, 27
    s_lshl_b32 s42, s42, 7
    s_add_u32 s41, s41, s42
    s_lshr_b32 s42, s40, 1
    s_lshl_b32 s42, s42, 12
    s_and_b32 s43, s40, 1
    s_lshl_b32 s43, s43, 10
    s_add_u32 s42, s42, s43
    s_add_u32 s42, s42, 106496
    s_mov_b32 m0, s42
    s_nop 0
    buffer_load_dwordx4 v112, s[8:11], s41 offen lds
    s_add_u32 m0, s42, 2048
    s_nop 0
    buffer_load_dwordx4 v113, s[12:15], s41 offen lds
    s_add_u32 s40, s30, 17
    s_mul_i32 s41, s40, 28672
    s_min_u32 s42, s29, 27
    s_lshl_b32 s42, s42, 7
    s_add_u32 s41, s41, s42
    s_lshr_b32 s42, s40, 1
    s_lshl_b32 s42, s42, 12
    s_and_b32 s43, s40, 1
    s_lshl_b32 s43, s43, 10
    s_add_u32 s42, s42, s43
    s_add_u32 s42, s42, 106496
    s_mov_b32 m0, s42
    s_nop 0
    buffer_load_dwordx4 v112, s[8:11], s41 offen lds
    s_add_u32 m0, s42, 2048
    s_nop 0
    buffer_load_dwordx4 v113, s[12:15], s41 offen lds
    v_add_f32 v5, v5, v8
    v_add_f32 v49, v5, v9
    v_add_f32 v50, v5, v10
    v_fract_f32 v48, v5
    v_add_f32 v51, v49, v10
    v_fract_f32 v49, v49
    v_fract_f32 v50, v50
    v_fract_f32 v51, v51
    v_cos_f32 v52, v48
    v_cos_f32 v53, v49
    v_cos_f32 v54, v50
    v_cos_f32 v55, v51
    v_sin_f32 v56, v48
    v_sin_f32 v57, v49
    v_sin_f32 v58, v50
    v_sin_f32 v59, v51
    v_cvt_pk_bf16_f32 v40, v52, v56
    v_cvt_pk_bf16_f32 v41, v53, v57
    v_cvt_pk_bf16_f32 v42, v54, v58
    v_cvt_pk_bf16_f32 v43, v55, v59
    s_add_u32 s40, s30, 20
    s_mul_i32 s41, s40, 28672
    s_min_u32 s42, s29, 27
    s_lshl_b32 s42, s42, 7
    s_add_u32 s41, s41, s42
    s_lshr_b32 s42, s40, 1
    s_lshl_b32 s42, s42, 12
    s_and_b32 s43, s40, 1
    s_lshl_b32 s43, s43, 10
    s_add_u32 s42, s42, s43
    s_add_u32 s42, s42, 106496
    s_mov_b32 m0, s42
    s_nop 0
    buffer_load_dwordx4 v112, s[8:11], s41 offen lds
    s_add_u32 m0, s42, 2048
    s_nop 0
    buffer_load_dwordx4 v113, s[12:15], s41 offen lds
    v_add_f32 v5, v5, v8
    v_add_f32 v49, v5, v9
    v_add_f32 v50, v5, v10
    v_fract_f32 v48, v5
    v_add_f32 v51, v49, v10
    v_fract_f32 v49, v49
    v_fract_f32 v50, v50
    v_fract_f32 v51, v51
    v_cos_f32 v52, v48
    v_cos_f32 v53, v49
    v_cos_f32 v54, v50
    v_cos_f32 v55, v51
    v_sin_f32 v56, v48
    v_sin_f32 v57, v49
    v_sin_f32 v58, v50
    v_sin_f32 v59, v51
    v_cvt_pk_bf16_f32 v44, v52, v56
    v_cvt_pk_bf16_f32 v45, v53, v57
    v_cvt_pk_bf16_f32 v46, v54, v58
    v_cvt_pk_bf16_f32 v47, v55, v59
    s_add_u32 s40, s30, 23
    s_mul_i32 s41, s40, 28672
    s_min_u32 s42, s29, 27
    s_lshl_b32 s42, s42, 7
    s_add_u32 s41, s41, s42
    s_lshr_b32 s42, s40, 1
    s_lshl_b32 s42, s42, 12
    s_and_b32 s43, s40, 1
    s_lshl_b32 s43, s43, 10
    s_add_u32 s42, s42, s43
    s_add_u32 s42, s42, 106496
    s_mov_b32 m0, s42
    s_nop 0
    buffer_load_dwordx4 v112, s[8:11], s41 offen lds
    s_add_u32 m0, s42, 2048
    s_nop 0
    buffer_load_dwordx4 v113, s[12:15], s41 offen lds
    s_add_u32 s40, s30, 26
    s_mul_i32 s41, s40, 28672
    s_min_u32 s42, s29, 27
    s_lshl_b32 s42, s42, 7
    s_add_u32 s41, s41, s42
    s_lshr_b32 s42, s40, 1
    s_lshl_b32 s42, s42, 12
    s_and_b32 s43, s40, 1
    s_lshl_b32 s43, s43, 10
    s_add_u32 s42, s42, s43
    s_mov_b32 s43, 4294950912
    s_cmp_lt_u32 s40, 28
    s_cselect_b32 s43, 106496, s43
    s_add_u32 s42, s42, s43
    s_mov_b32 m0, s42
    s_nop 0
    buffer_load_dwordx4 v112, s[8:11], s41 offen lds
    s_add_u32 m0, s42, 2048
    s_nop 0
    buffer_load_dwordx4 v113, s[12:15], s41 offen lds
    v_lshrrev_b32 v2, 2, v1
    v_and_b32 v3, 3, v1
    v_and_b32 v4, 7, v2
    v_lshrrev_b32 v2, 3, v2
    v_lshl_add_u32 v2, v4, 3, v2
    s_lshl_b32 s40, s36, 6
    s_lshl_b32 s41, s30, 1
    s_add_u32 s40, s40, s41
    v_add_u32 v2, s40, v2
    s_cmp_eq_u32 s37, 0
    s_cselect_b32 s43, 1, 0
    s_add_u32 s43, s43, 127
    v_sub_u32_e64 v4, s43, v2
    v_and_b32 v4, 127, v4
    s_sub_u32 s44, 1, s34
    s_cmp_eq_u32 s28, 0
    s_cselect_b32 s44, s34, s44
    v_bfe_u32 v60, v2, 1, 2
    v_lshlrev_b32 v60, 5, v60
    v_and_b32_e64 v61, 1, v2
    v_lshl_add_u32 v60, v61, 4, v60
    v_lshrrev_b32 v61, 3, v2
    v_add_u32 v60, v60, v61
    s_lshl_b32 s42, s34, 7
    v_add_u32 v5, s42, v60
    v_bfe_u32 v60, v4, 1, 2
    v_lshlrev_b32 v60, 5, v60
    v_and_b32 v61, 1, v4
    v_lshl_add_u32 v60, v61, 4, v60
    v_lshrrev_b32 v61, 3, v4
    v_add_u32 v60, v60, v61
    s_lshl_b32 s42, s44, 7
    v_add_u32 v6, s42, v60
    s_lshl_b32 s45, s28, 4
    s_add_u32 s45, s45, s35
    s_lshl_b32 s45, s45, 11
    v_lshlrev_b32 v10, 3, v5
    v_add_u32_e64 v10, s45, v10
    s_add_u32 s45, s45, 16384
    v_lshlrev_b32 v11, 3, v6
    v_add_u32 v11, s45, v11
    s_lshl_b32 s45, s28, 8
    v_add_u32 v5, s45, v5
    v_add_u32 v6, s45, v6
    s_lshl_b32 s46, s35, 6
    v_lshlrev_b32 v7, 4, v3
    v_add_u32 v7, s46, v7
    v_sub_u32 v12, 1010, v7
    s_movk_i32 s46, 1152
    v_mul_lo_u32 v5, v5, s46
    v_mul_lo_u32 v6, v6, s46
    v_add_u32 v8, v5, v7
    v_add_u32 v9, v6, v12
    s_cmp_eq_u32 s35, 0
    s_cselect_b32 s52, 0x11111111, 0
    s_mov_b32 s53, s52
    v_lshlrev_b32 v13, 4, v2
    v_add_u32_e64 v13, s37, v13
    v_sub_u32 v14, 2048, v13
    v_and_b32 v14, 2047, v14
    v_lshl_add_u32 v13, v13, 10, v7
    v_lshlrev_b32 v15, 10, v14
    v_add_u32 v14, v15, v12
    v_add_u32 v15, 512, v15
    v_subrev_u32_e64 v12, 2, v14
    v_cndmask_b32 v12, v14, v12, s[52:53]
    buffer_load_dwordx4 v[88:91], v13, s[4:7], 0 offen
    buffer_load_dwordx4 v[92:95], v12, s[4:7], 0 offen
    buffer_load_ushort v96, v15, s[4:7], 0 offen
    s_mov_b32 s46, 5242880
    s_mov_b32 s45, 13107200
    v_and_b32_e64 v12, 0xfffffffc, v9
    buffer_load_dword v97, v8, s[24:27], s46 offen
    buffer_load_dword v98, v12, s[24:27], s46 offen offset:4
    buffer_load_dword v100, v10, s[24:27], s45 offen
    buffer_load_dword v101, v11, s[24:27], s45 offen
    s_getpc_b64 s[42:43]
L_pc_3:
    s_lshl_b32 s40, s29, 2
    s_add_u32 s40, s40, s30
    s_lshl_b32 s40, s40, 10
    v_lshlrev_b32 v2, 4, v1
    v_add_u32 v2, s40, v2
    v_min_u32 v2, 24560, v2
    v_add_u32_e64 v2, 0, v2
    v_min_u32 v2, L_code_end-L_pc_3-16, v2
    global_load_dwordx4 v[128:131], v2, s[42:43]
    v_lshrrev_b32 v2, 3, v1
    v_and_b32 v3, 7, v1
    v_bfe_u32 v4, v2, 1, 1
    v_lshlrev_b32 v4, 1, v4
    v_xor_b32 v3, v3, v4
    v_mul_u32_u24 v2, 3584, v2
    v_lshl_add_u32 v112, v3, 4, v2
    v_xor_b32_e64 v3, 4, v3
    v_lshl_add_u32 v113, v3, 4, v2
    s_barrier
    s_add_u32 s40, s30, 29
    s_mul_i32 s41, s40, 28672
    s_min_u32 s42, s29, 27
    s_lshl_b32 s42, s42, 7
    s_add_u32 s41, s41, s42
    s_lshr_b32 s42, s40, 1
    s_lshl_b32 s42, s42, 12
    s_and_b32 s43, s40, 1
    s_lshl_b32 s43, s43, 10
    s_add_u32 s42, s42, s43
    s_add_u32 s42, s42, 4294950912
    s_mov_b32 m0, s42
    s_nop 0
    buffer_load_dwordx4 v112, s[8:11], s41 offen lds
    s_add_u32 m0, s42, 2048
    s_nop 0
    buffer_load_dwordx4 v113, s[12:15], s41 offen lds
    s_add_u32 s40, s30, 32
    s_mul_i32 s41, s40, 28672
    s_min_u32 s42, s29, 27
    s_lshl_b32 s42, s42, 7
    s_add_u32 s41, s41, s42
    s_lshr_b32 s42, s40, 1
    s_lshl_b32 s42, s42, 12
    s_and_b32 s43, s40, 1
    s_lshl_b32 s43, s43, 10
    s_add_u32 s42, s42, s43
    s_add_u32 s42, s42, 4294950912
    s_mov_b32 m0, s42
    s_nop 0
    buffer_load_dwordx4 v112, s[8:11], s41 offen lds
    s_add_u32 m0, s42, 2048
    s_nop 0
    buffer_load_dwordx4 v113, s[12:15], s41 offen lds
    s_add_u32 s40, s30, 35
    s_mul_i32 s41, s40, 28672
    s_min_u32 s42, s29, 27
    s_lshl_b32 s42, s42, 7
    s_add_u32 s41, s41, s42
    s_lshr_b32 s42, s40, 1
    s_lshl_b32 s42, s42, 12
    s_and_b32 s43, s40, 1
    s_lshl_b32 s43, s43, 10
    s_add_u32 s42, s42, s43
    s_add_u32 s42, s42, 4294950912
    s_mov_b32 m0, s42
    s_nop 0
    buffer_load_dwordx4 v112, s[8:11], s41 offen lds
    s_add_u32 m0, s42, 2048
    s_nop 0
    buffer_load_dwordx4 v113, s[12:15], s41 offen lds
    s_add_u32 s40, s30, 38
    s_mul_i32 s41, s40, 28672
    s_min_u32 s42, s29, 27
    s_lshl_b32 s42, s42, 7
    s_add_u32 s41, s41, s42
    s_lshr_b32 s42, s40, 1
    s_lshl_b32 s42, s42, 12
    s_and_b32 s43, s40, 1
    s_lshl_b32 s43, s43, 10
    s_add_u32 s42, s42, s43
    s_add_u32 s42, s42, 4294950912
    s_mov_b32 m0, s42
    s_nop 0
    buffer_load_dwordx4 v112, s[8:11], s41 offen lds
    s_add_u32 m0, s42, 2048
    s_nop 0
    buffer_load_dwordx4 v113, s[12:15], s41 offen lds
    s_barrier
    s_branch L_wj_2
L_w0_1:
    s_lshl_b32 s40, s30, 3
    s_lshl_b32 s41, s35, 5
    s_add_u32 s40, s40, s41
    v_lshlrev_b32 v8, 4, v1
    s_lshl_b32 s44, s30, 12
    v_add_u32 v8, s44, v8
    v_lshrrev_b32 v12, 5, v1
    v_and_b32 v9, 31, v1
    s_and_b32 s43, s30, 1
    s_lshl_b32 s43, s43, 3
    v_add_u32 v13, s43, v12
    v_xor_b32 v9, v9, v13
    v_add_u32 v12, s40, v12
    v_cvt_f32_u32_e64 v12, v12
    v_mul_f32 v12, 0x3b000000, v12
    s_mov_b32 s46, 0x3b800000
    s_mov_b32 s47, 0x41000000
    s_or_b32 s45, s35, s30
    v_xor_b32 v10, 0, v9
    v_cvt_f32_u32 v10, v10
    v_add_f32 v11, v12, v12
    v_mul_f32 v10, s47, v10
    v_add_f32 v13, v11, v11
    v_mul_f32 v80, v10, v12
    v_add_f32 v81, v80, v12
    v_add_f32 v82, v80, v11
    v_add_f32 v84, v80, v13
    v_add_f32 v83, v81, v11
    v_add_f32 v85, v81, v13
    v_add_f32 v86, v82, v13
    v_add_f32 v87, v83, v13
    v_fract_f32 v80, v80
    v_fract_f32 v81, v81
    v_fract_f32 v82, v82
    v_fract_f32 v83, v83
    v_fract_f32 v84, v84
    v_fract_f32 v85, v85
    v_fract_f32 v86, v86
    v_fract_f32 v87, v87
    s_cmp_eq_u32 s45, 0
    s_cselect_b32 vcc_lo, -1, 0
    s_mov_b32 vcc_hi, 0
    v_mov_b32 v6, 0
    v_mov_b32 v7, 0.5
    v_cndmask_b32 v88, v80, v6, vcc
    v_cndmask_b32 v89, v81, v7, vcc
    v_cndmask_b32 v90, v82, v6, vcc
    v_cndmask_b32 v91, v83, v7, vcc
    v_cndmask_b32 v92, v84, v6, vcc
    v_cndmask_b32 v93, v85, v7, vcc
    v_cndmask_b32 v94, v86, v6, vcc
    v_cndmask_b32 v95, v87, v7, vcc
    v_cos_f32 v88, v88
    v_cos_f32 v89, v89
    v_cos_f32 v90, v90
    v_cos_f32 v91, v91
    v_cos_f32 v92, v92
    v_cos_f32 v93, v93
    v_cos_f32 v94, v94
    v_cos_f32 v95, v95
    v_sin_f32 v96, v80
    v_sin_f32 v97, v81
    v_sin_f32 v98, v82
    v_sin_f32 v99, v83
    v_sin_f32 v100, v84
    v_sin_f32 v101, v85
    v_sin_f32 v102, v86
    v_sin_f32_e64 v103, v87
    v_cvt_pk_bf16_f32 v104, v88, v89
    v_cvt_pk_bf16_f32 v105, v90, v91
    v_cvt_pk_bf16_f32 v106, v92, v93
    v_cvt_pk_bf16_f32 v107, v94, v95
    ds_write_b128 v8, v[104:107] offset:0
    v_cvt_pk_bf16_f32 v108, -v96, -v97
    v_cvt_pk_bf16_f32 v109, -v98, -v99
    v_cvt_pk_bf16_f32 v110, -v100, -v101
    v_cvt_pk_bf16_f32 v111, -v102, -v103
    ds_write_b128 v8, v[108:111] offset:16384
    v_add_f32 v12, s46, v12
    v_xor_b32 v10, 2, v9
    v_cvt_f32_u32 v10, v10
    v_add_f32 v11, v12, v12
    v_mul_f32 v10, s47, v10
    v_add_f32 v13, v11, v11
    v_mul_f32 v80, v10, v12
    v_add_f32 v81, v80, v12
    v_add_f32 v82, v80, v11
    v_add_f32 v84, v80, v13
    v_add_f32 v83, v81, v11
    v_add_f32 v85, v81, v13
    v_add_f32 v86, v82, v13
    v_add_f32 v87, v83, v13
    v_fract_f32 v80, v80
    v_fract_f32 v81, v81
    v_fract_f32 v82, v82
    v_fract_f32 v83, v83
    v_fract_f32 v84, v84
    v_fract_f32 v85, v85
    v_fract_f32 v86, v86
    v_fract_f32 v87, v87
    v_cos_f32 v88, v80
    v_cos_f32 v89, v81
    v_cos_f32 v90, v82
    v_cos_f32 v91, v83
    v_cos_f32 v92, v84
    v_cos_f32 v93, v85
    v_cos_f32 v94, v86
    v_cos_f32 v95, v87
    v_sin_f32 v96, v80
    v_sin_f32 v97, v81
    v_sin_f32 v98, v82
    v_sin_f32 v99, v83
    v_sin_f32 v100, v84
    v_sin_f32 v101, v85
    v_sin_f32 v102, v86
    v_sin_f32 v103, v87
    v_cvt_pk_bf16_f32 v104, v88, v89
    v_cvt_pk_bf16_f32 v105, v90, v91
    v_cvt_pk_bf16_f32 v106, v92, v93
    v_cvt_pk_bf16_f32 v107, v94, v95
    ds_write_b128 v8, v[104:107] offset:1024
    v_cvt_pk_bf16_f32 v108, -v96, -v97
    v_cvt_pk_bf16_f32 v109, -v98, -v99
    v_cvt_pk_bf16_f32 v110, -v100, -v101
    v_cvt_pk_bf16_f32 v111, -v102, -v103
    ds_write_b128 v8, v[108:111] offset:17408
    v_xor_b32 v15, 160, v14
    s_mov_b32 m0, s51
    s_nop 0
    buffer_load_dwordx4 v15, s[4:7], s50 offen lds
    s_add_u32 s50, s50, 131072
    s_add_u32 s51, s51, 1024
    v_xor_b32 v15, 176, v14
    s_mov_b32 m0, s51
    s_nop 0
    buffer_load_dwordx4 v15, s[4:7], s50 offen lds
    s_add_u32 s50, s50, 131072
    s_add_u32 s51, s51, 1024
    v_xor_b32 v15, 192, v14
    s_mov_b32 m0, s51
    s_nop 0
    buffer_load_dwordx4 v15, s[4:7], s50 offen lds
    s_add_u32 s50, s50, 131072
    s_add_u32 s51, s51, 1024
    v_xor_b32 v15, 208, v14
    s_mov_b32 m0, s51
    s_nop 0
    buffer_load_dwordx4 v15, s[4:7], s50 offen lds
    s_add_u32 s50, s50, 131072
    s_add_u32 s51, s51, 1024
    v_xor_b32 v15, 224, v14
    s_mov_b32 m0, s51
    s_nop 0
    buffer_load_dwordx4 v15, s[4:7], s50 offen lds
    s_add_u32 s50, s50, 131072
    s_add_u32 s51, s51, 1024
    v_xor_b32 v15, 240, v14
    s_mov_b32 m0, s51
    s_nop 0
    buffer_load_dwordx4 v15, s[4:7], s50 offen lds
    v_add_f32 v12, s46, v12
    v_xor_b32 v10, 4, v9
    v_cvt_f32_u32 v10, v10
    v_add_f32 v11, v12, v12
    v_mul_f32 v10, s47, v10
    v_add_f32 v13, v11, v11
    v_mul_f32 v80, v10, v12
    v_add_f32 v81, v80, v12
    v_add_f32 v82, v80, v11
    v_add_f32 v84, v80, v13
    v_add_f32 v83, v81, v11
    v_add_f32 v85, v81, v13
    v_add_f32 v86, v82, v13
    v_add_f32 v87, v83, v13
    v_fract_f32 v80, v80
    v_fract_f32 v81, v81
    v_fract_f32 v82, v82
    v_fract_f32 v83, v83
    v_fract_f32 v84, v84
    v_fract_f32 v85, v85
    v_fract_f32 v86, v86
    v_fract_f32 v87, v87
    v_cos_f32 v88, v80
    v_cos_f32 v89, v81
    v_cos_f32 v90, v82
    v_cos_f32 v91, v83
    v_cos_f32 v92, v84
    v_cos_f32 v93, v85
    v_cos_f32 v94, v86
    v_cos_f32 v95, v87
    v_sin_f32 v96, v80
    v_sin_f32 v97, v81
    v_sin_f32 v98, v82
    v_sin_f32 v99, v83
    v_sin_f32 v100, v84
    v_sin_f32 v101, v85
    v_sin_f32 v102, v86
    v_sin_f32 v103, v87
    v_cvt_pk_bf16_f32 v104, v88, v89
    v_cvt_pk_bf16_f32 v105, v90, v91
    v_cvt_pk_bf16_f32 v106, v92, v93
    v_cvt_pk_bf16_f32 v107, v94, v95
    ds_write_b128 v8, v[104:107] offset:2048
    v_cvt_pk_bf16_f32 v108, -v96, -v97
    v_cvt_pk_bf16_f32 v109, -v98, -v99
    v_cvt_pk_bf16_f32 v110, -v100, -v101
    v_cvt_pk_bf16_f32 v111, -v102, -v103
    ds_write_b128 v8, v[108:111] offset:18432
    v_add_f32 v12, s46, v12
    v_xor_b32 v10, 6, v9
    v_cvt_f32_u32 v10, v10
    v_add_f32 v11, v12, v12
    v_mul_f32 v10, s47, v10
    v_add_f32 v13, v11, v11
    v_mul_f32 v80, v10, v12
    v_add_f32 v81, v80, v12
    v_add_f32 v82, v80, v11
    v_add_f32 v84, v80, v13
    v_add_f32 v83, v81, v11
    v_add_f32 v85, v81, v13
    v_add_f32 v86, v82, v13
    v_add_f32 v87, v83, v13
    v_fract_f32 v80, v80
    v_fract_f32 v81, v81
    v_fract_f32 v82, v82
    v_fract_f32 v83, v83
    v_fract_f32 v84, v84
    v_fract_f32 v85, v85
    v_fract_f32 v86, v86
    v_fract_f32 v87, v87
    v_cos_f32 v88, v80
    v_cos_f32 v89, v81
    v_cos_f32 v90, v82
    v_cos_f32 v91, v83
    v_cos_f32 v92, v84
    v_cos_f32 v93, v85
    v_cos_f32 v94, v86
    v_cos_f32 v95, v87
    v_sin_f32 v96, v80
    v_sin_f32 v97, v81
    v_sin_f32 v98, v82
    v_sin_f32 v99, v83
    v_sin_f32 v100, v84
    v_sin_f32 v101, v85
    v_sin_f32 v102, v86
    v_sin_f32 v103, v87
    v_cvt_pk_bf16_f32 v104, v88, v89
    v_cvt_pk_bf16_f32 v105, v90, v91
    v_cvt_pk_bf16_f32 v106, v92, v93
    v_cvt_pk_bf16_f32 v107, v94, v95
    ds_write_b128 v8, v[104:107] offset:3072
    v_cvt_pk_bf16_f32 v108, -v96, -v97
    v_cvt_pk_bf16_f32 v109, -v98, -v99
    v_cvt_pk_bf16_f32 v110, -v100, -v101
    v_cvt_pk_bf16_f32 v111, -v102, -v103
    ds_write_b128 v8, v[108:111] offset:19456
    s_waitcnt lgkmcnt(0)
    s_add_u32 s32, s48, 0x7F4A7C15
    s_addc_u32 s33, s49, 0x9E3779B9
    s_mov_b32 s99, s32
    s_and_b32 s32, s32, 0xFFFFFF00
    s_getreg_b32 s44, hwreg(HW_REG_XCC_ID)
    s_and_b32 s44, s44, 15
    s_add_u32 s40, s32, s44
    v_mov_b32 v2, s40
    v_mov_b32 v3, s33
    s_lshl_b32 s41, s2, 6
    s_add_u32 s41, s41, 65536
    v_mov_b32 v4, s41
    s_mov_b64 exec, 1
    buffer_store_dwordx2 v[2:3], v4, s[24:27], 0 offen sc1
    s_mov_b64 exec, -1
    v_and_b32 v2, 15, v1
    v_lshrrev_b32 v3, 4, v1
    v_cvt_f32_u32 v2, v2
    s_lshl_b32 s40, s36, 2
    s_add_u32 s40, s40, s30
    s_lshl_b32 s40, s40, 4
    s_add_u32 s40, s40, s37
    v_lshlrev_b32 v3, 9, v3
    v_add_u32 v3, s40, v3
    v_cvt_f32_u32_e64 v3, v3
    v_mul_f32 v3, 0x3a000000, v3
    v_mul_f32_e64 v4, v2, v3
    v_mul_f32 v5, 0x3d800000, v2
    v_fract_f32 v8, v4
    v_add_f32 v4, v4, v5
    v_fract_f32 v9, v4
    v_add_f32 v4, v4, v5
    v_fract_f32 v10, v4
    v_add_f32 v4, v4, v5
    v_fract_f32 v11, v4
    v_cos_f32 v12, v8
    v_cos_f32 v13, v9
    v_cos_f32 v14, v10
    v_cos_f32 v15, v11
    v_sin_f32 v8, v8
    v_sin_f32 v9, v9
    v_sin_f32 v10, v10
    v_sin_f32_e64 v11, v11
    v_cvt_pk_bf16_f32 v136, v12, v13
    v_cvt_pk_bf16_f32 v137, v14, v15
    v_cvt_pk_bf16_f32 v138, v8, v9
    v_cvt_pk_bf16_f32 v139, v10, v11
    v_xor_b32 v140, 0x80008000, v138
    v_xor_b32 v141, 0x80008000, v139
    v_mov_b32 v142, v136
    v_mov_b32 v143, v137
    s_barrier
    v_and_b32 v2, 15, v1
    v_lshrrev_b32 v3, 4, v1
    v_and_b32 v8, 3, v2
    v_xor_b32 v8, v8, v3
    v_lshlrev_b32 v8, 4, v8
    v_lshrrev_b32_e64 v9, 2, v2
    v_lshl_add_u32 v11, v2, 10, v8
    s_lshl_b32 s40, s30, 14
    s_add_u32 s40, s40, 40960
    v_add_u32 v11, s40, v11
    v_lshl_add_u32 v8, v2, 9, v8
    v_xor_b32_e64 v10, 0, v9
    v_lshl_add_u32 v4, v10, 6, v8
    v_lshl_add_u32 v16, v10, 6, v11
    v_xor_b32_e64 v10, 1, v9
    v_lshl_add_u32 v5, v10, 6, v8
    v_lshl_add_u32 v17, v10, 6, v11
    v_xor_b32_e64 v10, 2, v9
    v_lshl_add_u32 v6, v10, 6, v8
    v_lshl_add_u32 v18, v10, 6, v11
    v_xor_b32_e64 v10, 3, v9
    v_lshl_add_u32 v7, v10, 6, v8
    v_lshl_add_u32 v19, v10, 6, v11
    v_mov_b32 v12, 0x3f803f80
    v_mov_b32 v13, 0x3f803f80
    v_mov_b32 v14, 0x3f803f80
    v_mov_b32 v15, 0x3f803f80
    ds_read_b128 v[104:107], v4 offset:0
    ds_read_b128 v[108:111], v4 offset:8192
    ds_read_b128 v[112:115], v4 offset:16384
    ds_read_b128 v[116:119], v4 offset:24576
    s_waitcnt vmcnt(1)
    ds_read_b128 v[24:27], v16 offset:0
    ds_read_b128 v[28:31], v17 offset:0
    ds_read_b128 v[32:35], v18 offset:0
    ds_read_b128 v[36:39], v19 offset:0
    ds_read_b128 v[40:43], v16 offset:256
    ds_read_b128 v[44:47], v17 offset:256
    ds_read_b128 v[48:51], v18 offset:256
    s_waitcnt lgkmcnt(6)
    v_mfma_f32_16x16x32_bf16 v[96:99], v[24:27], v[12:15], 0
    v_mfma_f32_16x16x32_bf16 v[100:103], v[24:27], v[24:27], 0
    ds_read_b128 v[52:55], v19 offset:256
    s_waitcnt lgkmcnt(6)
    v_mfma_f32_16x16x32_bf16 v[96:99], v[28:31], v[12:15], v[96:99]
    v_mfma_f32_16x16x32_bf16 v[100:103], v[28:31], v[28:31], v[100:103]
    ds_read_b128 v[24:27], v16 offset:512
    s_waitcnt lgkmcnt(6)
    v_mfma_f32_16x16x32_bf16 v[96:99], v[32:35], v[12:15], v[96:99]
    v_mfma_f32_16x16x32_bf16 v[100:103], v[32:35], v[32:35], v[100:103]
    ds_read_b128 v[28:31], v17 offset:512
    s_waitcnt lgkmcnt(6)
    v_mfma_f32_16x16x32_bf16 v[96:99], v[36:39], v[12:15], v[96:99]
    v_mfma_f32_16x16x32_bf16 v[100:103], v[36:39], v[36:39], v[100:103]
    ds_read_b128 v[32:35], v18 offset:512
    s_waitcnt lgkmcnt(6)
    v_mfma_f32_16x16x32_bf16 v[96:99], v[40:43], v[12:15], v[96:99]
    v_mfma_f32_16x16x32_bf16 v[100:103], v[40:43], v[40:43], v[100:103]
    ds_read_b128 v[36:39], v19 offset:512
    s_waitcnt lgkmcnt(6)
    v_mfma_f32_16x16x32_bf16 v[96:99], v[44:47], v[12:15], v[96:99]
    v_mfma_f32_16x16x32_bf16 v[100:103], v[44:47], v[44:47], v[100:103]
    ds_read_b128 v[40:43], v16 offset:768
    s_waitcnt lgkmcnt(6)
    v_mfma_f32_16x16x32_bf16 v[96:99], v[48:51], v[12:15], v[96:99]
    v_mfma_f32_16x16x32_bf16 v[100:103], v[48:51], v[48:51], v[100:103]
    ds_read_b128 v[44:47], v17 offset:768
    s_waitcnt lgkmcnt(6)
    v_mfma_f32_16x16x32_bf16 v[96:99], v[52:55], v[12:15], v[96:99]
    v_mfma_f32_16x16x32_bf16 v[100:103], v[52:55], v[52:55], v[100:103]
    ds_read_b128 v[48:51], v18 offset:768
    s_waitcnt lgkmcnt(6)
    v_mfma_f32_16x16x32_bf16 v[96:99], v[24:27], v[12:15], v[96:99]
    v_mfma_f32_16x16x32_bf16 v[100:103], v[24:27], v[24:27], v[100:103]
    ds_read_b128 v[52:55], v19 offset:768
    s_waitcnt lgkmcnt(6)
    v_mfma_f32_16x16x32_bf16 v[96:99], v[28:31], v[12:15], v[96:99]
    v_mfma_f32_16x16x32_bf16 v[100:103], v[28:31], v[28:31], v[100:103]
    s_waitcnt lgkmcnt(5)
    v_mfma_f32_16x16x32_bf16 v[96:99], v[32:35], v[12:15], v[96:99]
    v_mfma_f32_16x16x32_bf16 v[100:103], v[32:35], v[32:35], v[100:103]
    s_waitcnt lgkmcnt(4)
    v_mfma_f32_16x16x32_bf16 v[96:99], v[36:39], v[12:15], v[96:99]
    v_mfma_f32_16x16x32_bf16 v[100:103], v[36:39], v[36:39], v[100:103]
    s_waitcnt lgkmcnt(3)
    v_mfma_f32_16x16x32_bf16 v[96:99], v[40:43], v[12:15], v[96:99]
    v_mfma_f32_16x16x32_bf16 v[100:103], v[40:43], v[40:43], v[100:103]
    s_waitcnt lgkmcnt(2)
    v_mfma_f32_16x16x32_bf16 v[96:99], v[44:47], v[12:15], v[96:99]
    v_mfma_f32_16x16x32_bf16 v[100:103], v[44:47], v[44:47], v[100:103]
    s_waitcnt lgkmcnt(1)
    v_mfma_f32_16x16x32_bf16 v[96:99], v[48:51], v[12:15], v[96:99]
    v_mfma_f32_16x16x32_bf16 v[100:103], v[48:51], v[48:51], v[100:103]
    s_waitcnt lgkmcnt(0)
    v_mfma_f32_16x16x32_bf16 v[96:99], v[52:55], v[12:15], v[96:99]
    v_mfma_f32_16x16x32_bf16 v[100:103], v[52:55], v[52:55], v[100:103]
    ds_read_b128 v[24:27], v16 offset:0
    ds_read_b128 v[28:31], v16 offset:512
    ds_read_b128 v[32:35], v17 offset:0
    ds_read_b128 v[36:39], v17 offset:512
    s_waitcnt lgkmcnt(3)
    v_mfma_f32_16x16x32_bf16 v[80:83], v[24:27], v[104:107], 0
    s_waitcnt lgkmcnt(2)
    v_mfma_f32_16x16x32_bf16 v[120:123], v[28:31], v[104:107], 0
    ds_read_b128 v[104:107], v5 offset:0
    v_mfma_f32_16x16x32_bf16 v[84:87], v[24:27], v[108:111], 0
    v_mfma_f32_16x16x32_bf16 v[124:127], v[28:31], v[108:111], 0
    ds_read_b128 v[108:111], v5 offset:8192
    v_mfma_f32_16x16x32_bf16 v[88:91], v[24:27], v[112:115], 0
    v_mfma_f32_16x16x32_bf16 v[128:131], v[28:31], v[112:115], 0
    ds_read_b128 v[112:115], v5 offset:16384
    v_mfma_f32_16x16x32_bf16 v[92:95], v[24:27], v[116:119], 0
    v_mfma_f32_16x16x32_bf16 v[132:135], v[28:31], v[116:119], 0
    ds_read_b128 v[116:119], v5 offset:24576
    ds_read_b128 v[40:43], v18 offset:0
    ds_read_b128 v[44:47], v18 offset:512
    s_waitcnt lgkmcnt(5)
    v_mfma_f32_16x16x32_bf16 v[80:83], v[32:35], v[104:107], v[80:83]
    v_mfma_f32_16x16x32_bf16 v[120:123], v[36:39], v[104:107], v[120:123]
    ds_read_b128 v[104:107], v6 offset:0
    v_lshrrev_b32_e64 v3, 4, v1
    v_mul_u32_u24 v3, 80, v3
    s_waitcnt lgkmcnt(5)
    v_mfma_f32_16x16x32_bf16 v[84:87], v[32:35], v[108:111], v[84:87]
    v_mfma_f32_16x16x32_bf16 v[124:127], v[36:39], v[108:111], v[124:127]
    ds_read_b128 v[108:111], v6 offset:8192
    v_add_u32 v2, 0, v3
    ds_bpermute_b32 v8, v2, v100
    s_waitcnt lgkmcnt(6)
    v_mfma_f32_16x16x32_bf16 v[88:91], v[32:35], v[112:115], v[88:91]
    v_mfma_f32_16x16x32_bf16 v[128:131], v[36:39], v[112:115], v[128:131]
    ds_read_b128 v[112:115], v6 offset:16384
    v_add_u32 v2, 4, v3
    ds_bpermute_b32 v9, v2, v101
    s_waitcnt lgkmcnt(7)
    v_mfma_f32_16x16x32_bf16 v[92:95], v[32:35], v[116:119], v[92:95]
    v_mfma_f32_16x16x32_bf16 v[132:135], v[36:39], v[116:119], v[132:135]
    ds_read_b128 v[116:119], v6 offset:24576
    v_add_u32 v2, 8, v3
    ds_bpermute_b32 v10, v2, v102
    ds_read_b128 v[48:51], v19 offset:0
    ds_read_b128 v[52:55], v19 offset:512
    s_waitcnt lgkmcnt(8)
    v_mfma_f32_16x16x32_bf16 v[80:83], v[40:43], v[104:107], v[80:83]
    v_mfma_f32_16x16x32_bf16 v[120:123], v[44:47], v[104:107], v[120:123]
    ds_read_b128 v[104:107], v7 offset:0
    v_add_u32 v2, 12, v3
    ds_bpermute_b32 v11, v2, v103
    s_waitcnt lgkmcnt(9)
    v_mfma_f32_16x16x32_bf16 v[84:87], v[40:43], v[108:111], v[84:87]
    v_mfma_f32_16x16x32_bf16 v[124:127], v[44:47], v[108:111], v[124:127]
    ds_read_b128 v[108:111], v7 offset:8192
    v_mul_f32 v96, 0x3b000000, v96
    v_mul_f32 v97, 0x3b000000, v97
    s_waitcnt lgkmcnt(8)
    v_mfma_f32_16x16x32_bf16 v[88:91], v[40:43], v[112:115], v[88:91]
    v_mfma_f32_16x16x32_bf16 v[128:131], v[44:47], v[112:115], v[128:131]
    ds_read_b128 v[112:115], v7 offset:16384
    v_mul_f32 v98, 0x3b000000, v98
    v_mul_f32 v99, 0x3b000000, v99
    s_waitcnt lgkmcnt(7)
    v_mfma_f32_16x16x32_bf16 v[92:95], v[40:43], v[116:119], v[92:95]
    v_mfma_f32_16x16x32_bf16 v[132:135], v[44:47], v[116:119], v[132:135]
    ds_read_b128 v[116:119], v7 offset:24576
    v_mul_f32 v8, 0x3b000000, v8
    v_mul_f32 v9, 0x3b000000, v9
    ds_read_b128 v[24:27], v16 offset:256
    ds_read_b128 v[28:31], v16 offset:768
    s_waitcnt lgkmcnt(6)
    v_mfma_f32_16x16x32_bf16 v[80:83], v[48:51], v[104:107], v[80:83]
    v_mfma_f32_16x16x32_bf16 v[120:123], v[52:55], v[104:107], v[120:123]
    ds_read_b128 v[104:107], v4 offset:256
    v_mul_f32 v10, 0x3b000000, v10
    s_waitcnt lgkmcnt(6)
    v_mul_f32 v11, 0x3b000000, v11
    s_waitcnt lgkmcnt(5)
    v_mfma_f32_16x16x32_bf16 v[84:87], v[48:51], v[108:111], v[84:87]
    v_mfma_f32_16x16x32_bf16 v[124:127], v[52:55], v[108:111], v[124:127]
    ds_read_b128 v[108:111], v4 offset:8448
    v_fma_f32 v8, -v96, v96, v8
    v_fma_f32 v9, -v97, v97, v9
    s_waitcnt lgkmcnt(5)
    v_mfma_f32_16x16x32_bf16 v[88:91], v[48:51], v[112:115], v[88:91]
    v_mfma_f32_16x16x32_bf16 v[128:131], v[52:55], v[112:115], v[128:131]
    ds_read_b128 v[112:115], v4 offset:16640
    v_fma_f32 v10, -v98, v98, v10
    v_fma_f32 v11, -v99, v99, v11
    s_waitcnt lgkmcnt(5)
    v_mfma_f32_16x16x32_bf16 v[92:95], v[48:51], v[116:119], v[92:95]
    v_mfma_f32_16x16x32_bf16 v[132:135], v[52:55], v[116:119], v[132:135]
    ds_read_b128 v[116:119], v4 offset:24832
    v_add_f32 v8, 0x3727c5ac, v8
    v_add_f32 v9, 0x3727c5ac, v9
    ds_read_b128 v[32:35], v17 offset:256
    ds_read_b128 v[36:39], v17 offset:768
    s_waitcnt lgkmcnt(5)
    v_mfma_f32_16x16x32_bf16 v[80:83], v[24:27], v[104:107], v[80:83]
    v_mfma_f32_16x16x32_bf16 v[120:123], v[28:31], v[104:107], v[120:123]
    ds_read_b128 v[104:107], v5 offset:256
    v_add_f32 v10, 0x3727c5ac, v10
    v_add_f32 v11, 0x3727c5ac, v11
    s_waitcnt lgkmcnt(5)
    v_mfma_f32_16x16x32_bf16 v[84:87], v[24:27], v[108:111], v[84:87]
    v_mfma_f32_16x16x32_bf16 v[124:127], v[28:31], v[108:111], v[124:127]
    ds_read_b128 v[108:111], v5 offset:8448
    v_rsq_f32 v8, v8
    v_rsq_f32_e64 v9, v9
    s_waitcnt lgkmcnt(5)
    v_mfma_f32_16x16x32_bf16 v[88:91], v[24:27], v[112:115], v[88:91]
    v_mfma_f32_16x16x32_bf16 v[128:131], v[28:31], v[112:115], v[128:131]
    ds_read_b128 v[112:115], v5 offset:16640
    v_rsq_f32 v10, v10
    v_rsq_f32_e64 v11, v11
    s_waitcnt lgkmcnt(5)
    v_mfma_f32_16x16x32_bf16 v[92:95], v[24:27], v[116:119], v[92:95]
    v_mfma_f32_16x16x32_bf16 v[132:135], v[28:31], v[116:119], v[132:135]
    ds_read_b128 v[116:119], v5 offset:24832
    v_and_b32 v2, 1, v1
    v_lshlrev_b32 v2, 31, v2
    ds_read_b128 v[40:43], v18 offset:256
    ds_read_b128 v[44:47], v18 offset:768
    s_waitcnt lgkmcnt(5)
    v_mfma_f32_16x16x32_bf16 v[80:83], v[32:35], v[104:107], v[80:83]
    v_mfma_f32_16x16x32_bf16 v[120:123], v[36:39], v[104:107], v[120:123]
    ds_read_b128 v[104:107], v6 offset:256
    v_or_b32_e64 v2, 1.0, v2
    s_waitcnt lgkmcnt(5)
    v_mfma_f32_16x16x32_bf16 v[84:87], v[32:35], v[108:111], v[84:87]
    v_mfma_f32_16x16x32_bf16 v[124:127], v[36:39], v[108:111], v[124:127]
    ds_read_b128 v[108:111], v6 offset:8448
    s_waitcnt lgkmcnt(5)
    v_mfma_f32_16x16x32_bf16 v[88:91], v[32:35], v[112:115], v[88:91]
    v_mfma_f32_16x16x32_bf16 v[128:131], v[36:39], v[112:115], v[128:131]
    ds_read_b128 v[112:115], v6 offset:16640
    s_waitcnt lgkmcnt(5)
    v_mfma_f32_16x16x32_bf16 v[92:95], v[32:35], v[116:119], v[92:95]
    v_mfma_f32_16x16x32_bf16 v[132:135], v[36:39], v[116:119], v[132:135]
    ds_read_b128 v[116:119], v6 offset:24832
    ds_read_b128 v[48:51], v19 offset:256
    ds_read_b128 v[52:55], v19 offset:768
    s_waitcnt lgkmcnt(5)
    v_mfma_f32_16x16x32_bf16 v[80:83], v[40:43], v[104:107], v[80:83]
    v_mfma_f32_16x16x32_bf16 v[120:123], v[44:47], v[104:107], v[120:123]
    ds_read_b128 v[104:107], v7 offset:256
    s_waitcnt lgkmcnt(5)
    v_mfma_f32_16x16x32_bf16 v[84:87], v[40:43], v[108:111], v[84:87]
    v_mfma_f32_16x16x32_bf16 v[124:127], v[44:47], v[108:111], v[124:127]
    ds_read_b128 v[108:111], v7 offset:8448
    s_waitcnt lgkmcnt(5)
    v_mfma_f32_16x16x32_bf16 v[88:91], v[40:43], v[112:115], v[88:91]
    v_mfma_f32_16x16x32_bf16 v[128:131], v[44:47], v[112:115], v[128:131]
    ds_read_b128 v[112:115], v7 offset:16640
    s_waitcnt lgkmcnt(5)
    v_mfma_f32_16x16x32_bf16 v[92:95], v[40:43], v[116:119], v[92:95]
    v_mfma_f32_16x16x32_bf16 v[132:135], v[44:47], v[116:119], v[132:135]
    ds_read_b128 v[116:119], v7 offset:24832
    s_waitcnt lgkmcnt(3)
    v_mfma_f32_16x16x32_bf16 v[80:83], v[48:51], v[104:107], v[80:83]
    v_mfma_f32_16x16x32_bf16 v[120:123], v[52:55], v[104:107], v[120:123]
    s_waitcnt lgkmcnt(2)
    v_mfma_f32_16x16x32_bf16 v[84:87], v[48:51], v[108:111], v[84:87]
    v_mfma_f32_16x16x32_bf16 v[124:127], v[52:55], v[108:111], v[124:127]
    s_waitcnt lgkmcnt(1)
    v_mfma_f32_16x16x32_bf16 v[88:91], v[48:51], v[112:115], v[88:91]
    v_mfma_f32_16x16x32_bf16 v[128:131], v[52:55], v[112:115], v[128:131]
    s_waitcnt lgkmcnt(0)
    v_mfma_f32_16x16x32_bf16 v[92:95], v[48:51], v[116:119], v[92:95]
    v_mfma_f32_16x16x32_bf16 v[132:135], v[52:55], v[116:119], v[132:135]
    v_fmac_f32 v80, v2, v120
    v_fmac_f32 v81, v2, v121
    v_fmac_f32 v82, v2, v122
    v_fmac_f32 v83, v2, v123
    v_fmac_f32 v84, v2, v124
    v_fmac_f32 v85, v2, v125
    v_fmac_f32 v86, v2, v126
    v_fmac_f32 v87, v2, v127
    v_fmac_f32 v88, v2, v128
    v_fmac_f32 v89, v2, v129
    v_fmac_f32 v90, v2, v130
    v_fmac_f32 v91, v2, v131
    v_fmac_f32 v92, v2, v132
    v_fmac_f32 v93, v2, v133
    v_fmac_f32 v94, v2, v134
    v_fmac_f32 v95, v2, v135
    v_mul_f32 v80, v80, v8
    v_mul_f32 v81, v81, v9
    v_mul_f32 v82, v82, v10
    v_mul_f32 v83, v83, v11
    v_mul_f32 v84, v84, v8
    v_mul_f32 v85, v85, v9
    v_mul_f32 v86, v86, v10
    v_mul_f32 v87, v87, v11
    v_mul_f32 v88, v88, v8
    v_mul_f32 v89, v89, v9
    v_mul_f32 v90, v90, v10
    v_mul_f32 v91, v91, v11
    v_mul_f32 v92, v92, v8
    v_mul_f32 v93, v93, v9
    v_mul_f32 v94, v94, v10
    v_mul_f32 v95, v95, v11
    v_cvt_pk_bf16_f32 v16, v80, v81
    v_cvt_pk_bf16_f32 v17, v82, v83
    v_cvt_pk_bf16_f32 v18, v88, v89
    v_cvt_pk_bf16_f32 v19, v90, v91
    v_cvt_pk_bf16_f32 v20, v84, v85
    v_cvt_pk_bf16_f32 v21, v86, v87
    v_cvt_pk_bf16_f32 v22, v92, v93
    v_cvt_pk_bf16_f32 v23, v94, v95
    v_mfma_f32_16x16x32_bf16 v[24:27], v[136:139], v[16:19], 0
    v_mfma_f32_16x16x32_bf16 v[28:31], v[140:143], v[16:19], 0
    v_mfma_f32_16x16x32_bf16 v[32:35], v[136:139], v[20:23], 0
    v_mfma_f32_16x16x32_bf16 v[36:39], v[140:143], v[20:23], 0
    v_and_b32 v2, 15, v1
    v_lshrrev_b32 v3, 4, v1
    v_lshlrev_b32_e64 v2, 4, v2
    v_lshl_add_u32 v2, v3, 11, v2
    s_lshl_b32 s40, s30, 2
    s_add_u32 s40, s40, 32768
    v_add_u32 v2, s40, v2
    v_cvt_pk_bf16_f32 v40, v24, v28
    ds_write_b32 v2, v40 offset:0
    v_cvt_pk_bf16_f32 v41, v25, v29
    ds_write_b32 v2, v41 offset:512
    v_cvt_pk_bf16_f32 v42, v26, v30
    ds_write_b32 v2, v42 offset:1024
    v_cvt_pk_bf16_f32 v43, v27, v31
    ds_write_b32 v2, v43 offset:1536
    v_cvt_pk_bf16_f32 v44, v32, v36
    ds_write_b32 v2, v44 offset:256
    v_cvt_pk_bf16_f32 v45, v33, v37
    ds_write_b32 v2, v45 offset:768
    v_cvt_pk_bf16_f32 v46, v34, v38
    ds_write_b32 v2, v46 offset:1280
    v_cvt_pk_bf16_f32 v47, v35, v39
    ds_write_b32 v2, v47 offset:1792
    s_waitcnt lgkmcnt(0)
    s_barrier
    v_lshlrev_b32_e64 v2, 4, v1
    v_add_u32 v3, 32768, v2
    ds_read_b128 v[16:19], v3 offset:0
    ds_read_b128 v[20:23], v3 offset:1024
    ds_read_b128 v[24:27], v3 offset:2048
    ds_read_b128 v[28:31], v3 offset:3072
    ds_read_b128 v[32:35], v3 offset:4096
    ds_read_b128 v[36:39], v3 offset:5120
    ds_read_b128 v[40:43], v3 offset:6144
    ds_read_b128 v[44:47], v3 offset:7168
    v_lshrrev_b32 v4, 5, v1
    v_and_b32 v5, 31, v1
    v_lshlrev_b32_e64 v4, 17, v4
    v_lshl_add_u32 v4, v5, 4, v4
    s_lshl_b32 s40, s28, 1
    s_add_u32 s40, s40, s34
    s_lshl_b32 s40, s40, 13
    s_lshl_b32 s41, s36, 12
    s_add_u32 s40, s40, s41
    s_lshl_b32 s41, s35, 9
    s_add_u32 s40, s40, s41
    s_add_u32 s40, s40, 1048576
    s_waitcnt lgkmcnt(7)
    buffer_store_dwordx4 v[16:19], v4, s[24:27], s40 offen sc1
    s_add_u32 s40, s40, 0x40000
    s_waitcnt lgkmcnt(6)
    buffer_store_dwordx4 v[20:23], v4, s[24:27], s40 offen sc1
    s_add_u32 s40, s40, 0x40000
    s_waitcnt lgkmcnt(5)
    buffer_store_dwordx4 v[24:27], v4, s[24:27], s40 offen sc1
    s_add_u32 s40, s40, 0x40000
    s_waitcnt lgkmcnt(4)
    buffer_store_dwordx4 v[28:31], v4, s[24:27], s40 offen sc1
    s_add_u32 s40, s40, 0x40000
    s_waitcnt lgkmcnt(3)
    buffer_store_dwordx4 v[32:35], v4, s[24:27], s40 offen sc1
    s_add_u32 s40, s40, 0x40000
    s_waitcnt lgkmcnt(2)
    buffer_store_dwordx4 v[36:39], v4, s[24:27], s40 offen sc1
    s_add_u32 s40, s40, 0x40000
    s_waitcnt lgkmcnt(1)
    buffer_store_dwordx4 v[40:43], v4, s[24:27], s40 offen sc1
    s_add_u32 s40, s40, 0x40000
    s_waitcnt lgkmcnt(0)
    buffer_store_dwordx4 v[44:47], v4, s[24:27], s40 offen sc1
    s_lshl_b32 s40, s28, 2
    s_lshl_b32 s41, s34, 1
    s_add_u32 s40, s40, s41
    s_add_u32 s40, s40, s36
    s_lshl_b32 s40, s40, 10
    v_lshlrev_b32 v2, 4, v1
    v_add_u32 v3, s40, v2
    ds_read_b128 v[8:11], v3
    s_lshl_b32 s41, s35, 15
    s_add_u32 s40, s40, s41
    s_add_u32 s40, s40, 524288
    s_waitcnt lgkmcnt(0)
    buffer_store_dwordx4 v[8:11], v2, s[24:27], s40 offen sc1
    v_and_b32 v2, 15, v1
    v_lshrrev_b32 v3, 4, v1
    v_and_b32 v4, 7, v2
    v_lshrrev_b32_e64 v2, 3, v2
    v_lshl_add_u32 v2, v4, 3, v2
    s_lshl_b32 s40, s36, 6
    s_lshl_b32 s41, s30, 1
    s_add_u32 s40, s40, s41
    v_add_u32 v2, s40, v2
    v_cvt_f32_u32_e64 v4, v2
    v_mul_f32 v4, 0x3c000000, v4
    v_and_b32 v5, 1, v3
    v_lshrrev_b32 v6, 1, v3
    v_cvt_f32_u32 v5, v5
    v_cvt_f32_u32 v6, v6
    v_mul_f32 v6, v4, v6
    v_mul_f32 v5, v4, v5
    v_mul_f32 v5, 0x42800000, v5
    v_mul_f32 v7, 0x41000000, v6
    v_add_f32_e64 v5, v5, v7
    v_mul_f32 v7, 0x40c00000, v6
    v_add_f32 v7, v4, v7
    v_add_f32 v8, v6, v6
    v_sub_f32_e64 v8, v4, v8
    v_mul_f32 v9, 0x41800000, v4
    v_add_f32 v10, v9, v9
    v_add_f32 v49, v5, v9
    v_add_f32 v50, v5, v10
    v_fract_f32 v48, v5
    v_add_f32 v51, v49, v10
    v_fract_f32 v49, v49
    v_fract_f32 v50, v50
    v_fract_f32 v51, v51
    v_cos_f32 v52, v48
    v_cos_f32 v53, v49
    v_cos_f32 v54, v50
    v_cos_f32 v55, v51
    v_sin_f32 v56, v48
    v_sin_f32 v57, v49
    v_sin_f32 v58, v50
    v_sin_f32 v59, v51
    v_cvt_pk_bf16_f32 v16, v52, v56
    v_cvt_pk_bf16_f32 v17, v53, v57
    v_cvt_pk_bf16_f32 v18, v54, v58
    v_cvt_pk_bf16_f32 v19, v55, v59
    v_add_f32 v5, v5, v7
    v_add_f32 v49, v5, v9
    v_add_f32 v50, v5, v10
    v_fract_f32 v48, v5
    v_add_f32 v51, v49, v10
    v_fract_f32 v49, v49
    v_fract_f32 v50, v50
    v_fract_f32 v51, v51
    v_cos_f32 v52, v48
    v_cos_f32 v53, v49
    v_cos_f32 v54, v50
    v_cos_f32 v55, v51
    v_sin_f32 v56, v48
    v_sin_f32 v57, v49
    v_sin_f32 v58, v50
    v_sin_f32 v59, v51
    v_cvt_pk_bf16_f32 v20, v52, v56
    v_cvt_pk_bf16_f32 v21, v53, v57
    v_cvt_pk_bf16_f32 v22, v54, v58
    v_cvt_pk_bf16_f32 v23, v55, v59
    v_add_f32 v5, v5, v8
    v_add_f32 v49, v5, v9
    v_add_f32 v50, v5, v10
    v_fract_f32 v48, v5
    v_add_f32 v51, v49, v10
    v_fract_f32 v49, v49
    v_fract_f32 v50, v50
    v_fract_f32 v51, v51
    v_cos_f32 v52, v48
    v_cos_f32 v53, v49
    v_cos_f32 v54, v50
    v_cos_f32 v55, v51
    v_sin_f32 v56, v48
    v_sin_f32 v57, v49
    v_sin_f32 v58, v50
    v_sin_f32 v59, v51
    v_cvt_pk_bf16_f32 v24, v52, v56
    v_cvt_pk_bf16_f32 v25, v53, v57
    v_cvt_pk_bf16_f32 v26, v54, v58
    v_cvt_pk_bf16_f32 v27, v55, v59
    v_add_f32 v5, v5, v8
    v_add_f32 v49, v5, v9
    v_add_f32 v50, v5, v10
    v_fract_f32 v48, v5
    v_add_f32 v51, v49, v10
    v_fract_f32 v49, v49
    v_fract_f32 v50, v50
    v_fract_f32 v51, v51
    v_cos_f32 v52, v48
    v_cos_f32 v53, v49
    v_cos_f32 v54, v50
    v_cos_f32 v55, v51
    v_sin_f32 v56, v48
    v_sin_f32 v57, v49
    v_sin_f32 v58, v50
    v_sin_f32 v59, v51
    v_cvt_pk_bf16_f32 v28, v52, v56
    v_cvt_pk_bf16_f32 v29, v53, v57
    v_cvt_pk_bf16_f32 v30, v54, v58
    v_cvt_pk_bf16_f32 v31, v55, v59
    v_add_f32 v5, v5, v8
    v_add_f32 v49, v5, v9
    v_add_f32 v50, v5, v10
    v_fract_f32 v48, v5
    v_add_f32 v51, v49, v10
    v_fract_f32 v49, v49
    v_fract_f32 v50, v50
    v_fract_f32 v51, v51
    v_cos_f32 v52, v48
    v_cos_f32 v53, v49
    v_cos_f32 v54, v50
    v_cos_f32 v55, v51
    v_sin_f32 v56, v48
    v_sin_f32 v57, v49
    v_sin_f32 v58, v50
    v_sin_f32 v59, v51
    v_cvt_pk_bf16_f32 v32, v52, v56
    v_cvt_pk_bf16_f32 v33, v53, v57
    v_cvt_pk_bf16_f32 v34, v54, v58
    v_cvt_pk_bf16_f32 v35, v55, v59
    v_add_f32 v5, v5, v8
    v_add_f32 v49, v5, v9
    v_add_f32 v50, v5, v10
    v_fract_f32 v48, v5
    v_add_f32 v51, v49, v10
    v_fract_f32 v49, v49
    v_fract_f32 v50, v50
    v_fract_f32 v51, v51
    v_cos_f32 v52, v48
    v_cos_f32 v53, v49
    v_cos_f32 v54, v50
    v_cos_f32 v55, v51
    v_sin_f32 v56, v48
    v_sin_f32 v57, v49
    v_sin_f32 v58, v50
    v_sin_f32 v59, v51
    v_cvt_pk_bf16_f32 v36, v52, v56
    v_cvt_pk_bf16_f32 v37, v53, v57
    v_cvt_pk_bf16_f32 v38, v54, v58
    v_cvt_pk_bf16_f32 v39, v55, v59
    v_add_f32 v5, v5, v8
    v_add_f32 v49, v5, v9
    v_add_f32 v50, v5, v10
    v_fract_f32 v48, v5
    v_add_f32 v51, v49, v10
    v_fract_f32 v49, v49
    v_fract_f32 v50, v50
    v_fract_f32 v51, v51
    v_cos_f32 v52, v48
    v_cos_f32 v53, v49
    v_cos_f32 v54, v50
    v_cos_f32 v55, v51
    v_sin_f32 v56, v48
    v_sin_f32 v57, v49
    v_sin_f32 v58, v50
    v_sin_f32 v59, v51
    v_cvt_pk_bf16_f32 v40, v52, v56
    v_cvt_pk_bf16_f32 v41, v53, v57
    v_cvt_pk_bf16_f32 v42, v54, v58
    v_cvt_pk_bf16_f32 v43, v55, v59
    v_add_f32 v5, v5, v8
    v_add_f32 v49, v5, v9
    v_add_f32 v50, v5, v10
    v_fract_f32 v48, v5
    v_add_f32 v51, v49, v10
    v_fract_f32 v49, v49
    v_fract_f32 v50, v50
    v_fract_f32 v51, v51
    v_cos_f32 v52, v48
    v_cos_f32 v53, v49
    v_cos_f32 v54, v50
    v_cos_f32 v55, v51
    v_sin_f32 v56, v48
    v_sin_f32 v57, v49
    v_sin_f32 v58, v50
    v_sin_f32 v59, v51
    v_cvt_pk_bf16_f32 v44, v52, v56
    v_cvt_pk_bf16_f32 v45, v53, v57
    v_cvt_pk_bf16_f32 v46, v54, v58
    v_cvt_pk_bf16_f32 v47, v55, v59
    s_waitcnt vmcnt(0)
    s_add_u32 s40, s32, 1
    v_mov_b32 v2, s40
    v_mov_b32_e64 v3, s33
    s_lshl_b32 s41, s2, 6
    s_add_u32 s41, s41, 81920
    v_mov_b32 v4, s41
    s_mov_b64 exec, 1
    buffer_store_dwordx2 v[2:3], v4, s[24:27], 0 offen sc1
    s_mov_b64 exec, -1
    v_lshrrev_b32 v2, 2, v1
    v_and_b32 v3, 3, v1
    v_and_b32 v4, 7, v2
    v_lshrrev_b32_e64 v2, 3, v2
    v_lshl_add_u32 v2, v4, 3, v2
    s_lshl_b32 s40, s36, 6
    s_lshl_b32 s41, s30, 1
    s_add_u32 s40, s40, s41
    v_add_u32 v2, s40, v2
    s_cmp_eq_u32 s37, 0
    s_cselect_b32 s43, 1, 0
    s_add_u32 s43, s43, 127
    v_sub_u32_e64 v4, s43, v2
    v_and_b32 v4, 127, v4
    s_sub_u32 s44, 1, s34
    s_cmp_eq_u32 s28, 0
    s_cselect_b32 s44, s34, s44
    v_bfe_u32 v60, v2, 1, 2
    v_lshlrev_b32 v60, 5, v60
    v_and_b32_e64 v61, 1, v2
    v_lshl_add_u32 v60, v61, 4, v60
    v_lshrrev_b32 v61, 3, v2
    v_add_u32 v60, v60, v61
    s_lshl_b32 s42, s34, 7
    v_add_u32 v5, s42, v60
    v_bfe_u32 v60, v4, 1, 2
    v_lshlrev_b32 v60, 5, v60
    v_and_b32 v61, 1, v4
    v_lshl_add_u32 v60, v61, 4, v60
    v_lshrrev_b32 v61, 3, v4
    v_add_u32 v60, v60, v61
    s_lshl_b32 s42, s44, 7
    v_add_u32 v6, s42, v60
    s_lshl_b32 s45, s28, 4
    s_add_u32 s45, s45, s35
    s_lshl_b32 s45, s45, 11
    v_lshlrev_b32 v10, 3, v5
    v_add_u32_e64 v10, s45, v10
    s_add_u32 s45, s45, 16384
    v_lshlrev_b32 v11, 3, v6
    v_add_u32 v11, s45, v11
    s_lshl_b32 s45, s28, 8
    v_add_u32 v5, s45, v5
    v_add_u32 v6, s45, v6
    s_lshl_b32 s46, s35, 6
    v_lshlrev_b32 v7, 4, v3
    v_add_u32 v7, s46, v7
    v_sub_u32 v12, 1010, v7
    s_movk_i32 s46, 1152
    v_mul_lo_u32 v5, v5, s46
    v_mul_lo_u32 v6, v6, s46
    v_add_u32 v8, v5, v7
    v_add_u32 v9, v6, v12
    s_cmp_eq_u32 s35, 0
    s_cselect_b32 s52, 0x11111111, 0
    s_mov_b32 s53, s52
    v_lshlrev_b32 v13, 4, v2
    v_add_u32_e64 v13, s37, v13
    v_sub_u32 v14, 2048, v13
    v_and_b32 v14, 2047, v14
    v_lshl_add_u32 v13, v13, 10, v7
    v_lshlrev_b32 v15, 10, v14
    v_add_u32 v14, v15, v12
    v_add_u32 v15, 512, v15
    v_subrev_u32_e64 v12, 2, v14
    v_cndmask_b32 v12, v14, v12, s[52:53]
    buffer_load_dwordx4 v[88:91], v13, s[4:7], 0 offen
    buffer_load_dwordx4 v[92:95], v12, s[4:7], 0 offen
    buffer_load_ushort v96, v15, s[4:7], 0 offen
    s_mov_b32 s46, 5242880
    s_mov_b32 s45, 13107200
    v_and_b32_e64 v12, 0xfffffffc, v9
    buffer_load_dword v97, v8, s[24:27], s46 offen
    buffer_load_dword v98, v12, s[24:27], s46 offen offset:4
    buffer_load_dword v100, v10, s[24:27], s45 offen
    buffer_load_dword v101, v11, s[24:27], s45 offen
    s_getpc_b64 s[42:43]
L_pc_4:
    s_lshl_b32 s40, s29, 2
    s_add_u32 s40, s40, s30
    s_lshl_b32 s40, s40, 10
    v_lshlrev_b32 v2, 4, v1
    v_add_u32 v2, s40, v2
    v_min_u32 v2, 24560, v2
    v_add_u32_e64 v2, 0, v2
    v_min_u32 v2, L_code_end-L_pc_4-16, v2
    global_load_dwordx4 v[128:131], v2, s[42:43]
    v_lshlrev_b32 v2, 3, v1
    v_add_u32 v2, s28, v2
    v_lshlrev_b32_e64 v2, 6, v2
    v_add_u32 v4, 65536, v2
    s_add_u32 s40, s32, 0
    s_mov_b32 exec_lo, -1
    s_mov_b32 exec_hi, 0
    s_mov_b32 s98, 0
    v_mov_b32 v2, 0
    v_mov_b32_e64 v3, 0
    s_nop 1
L_poll_5:
    buffer_load_dwordx2 v[2:3], v4, s[24:27], 0 offen sc1
    s_add_u32 s98, s98, 1
    s_cmp_gt_u32 s98, 0x40000
    s_cbranch_scc1 L_pd_6
    s_waitcnt vmcnt(0)
    v_subrev_u32_e64 v2, s40, v2
    v_cmp_gt_u32 vcc, 64, v2
    v_cmp_eq_u32 s[42:43], s33, v3
    s_nop 1
    s_and_b64 vcc, vcc, s[42:43]
    s_cmp_eq_u64 vcc, exec
    s_cbranch_scc0 L_poll_5
L_pd_6:
    s_waitcnt vmcnt(0)
    s_mov_b64 exec, -1
    s_getreg_b32 s44, hwreg(HW_REG_XCC_ID)
    s_and_b32 s44, s44, 15
    s_mov_b32 exec_lo, -1
    s_mov_b32 exec_hi, 0
    v_cmp_ne_u32 vcc, s44, v2
    s_mov_b64 exec, -1
    s_cmp_lg_u64 vcc, 0
    s_cselect_b32 s45, 1, 0
    v_mov_b32_e64 v2, s45
    v_mov_b32 v3, 28672
    ds_write_b32 v3, v2
    v_and_b32 v2, 7, v1
    v_lshrrev_b32 v3, 3, v1
    v_lshlrev_b32 v3, 6, v3
    v_add_u32 v2, v2, v3
    s_lshl_b32 s40, s35, 3
    v_add_u32 v2, s40, v2
    v_lshlrev_b32_e64 v2, 6, v2
    v_add_u32 v4, 81920, v2
    s_add_u32 s40, s32, 1
    s_mov_b32 exec_lo, -1
    s_mov_b32 exec_hi, 0
    s_mov_b32 s98, 0
    v_mov_b32 v2, 0
    v_mov_b32_e64 v3, 0
    s_nop 1
L_poll_8:
    buffer_load_dwordx2 v[2:3], v4, s[24:27], 0 offen sc1
    s_add_u32 s98, s98, 1
    s_cmp_gt_u32 s98, 0x40000
    s_cbranch_scc1 L_pd_9
    s_waitcnt vmcnt(0)
    v_subrev_u32_e64 v2, s40, v2
    v_cmp_gt_u32 vcc, 64, v2
    v_cmp_eq_u32 s[42:43], s33, v3
    s_nop 1
    s_and_b64 vcc, vcc, s[42:43]
    s_cmp_eq_u64 vcc, exec
    s_cbranch_scc0 L_poll_8
L_pd_9:
    s_waitcnt vmcnt(0)
    s_mov_b64 exec, -1
    v_and_b32 v2, 15, v1
    v_lshrrev_b32 v3, 4, v1
    v_lshlrev_b32_e64 v2, 4, v2
    v_lshl_add_u32 v2, v3, 12, v2
    s_lshl_b32 s40, s37, 17
    s_lshl_b32 s41, s35, 9
    s_add_u32 s40, s40, s41
    s_add_u32 s40, s40, 1048576
    s_mov_b32 m0, 0
    s_add_u32 s41, s40, 0
    buffer_load_dwordx4 v2, s[24:27], s41 offen lds
    s_mov_b32 m0, 1024
    s_add_u32 s41, s40, 16384
    buffer_load_dwordx4 v2, s[24:27], s41 offen lds
    s_mov_b32 m0, 2048
    s_add_u32 s41, s40, 32768
    buffer_load_dwordx4 v2, s[24:27], s41 offen lds
    s_mov_b32 m0, 3072
    s_add_u32 s41, s40, 49152
    buffer_load_dwordx4 v2, s[24:27], s41 offen lds
    s_mov_b32 m0, 4096
    s_add_u32 s41, s40, 65536
    buffer_load_dwordx4 v2, s[24:27], s41 offen lds
    s_mov_b32 m0, 5120
    s_add_u32 s41, s40, 81920
    buffer_load_dwordx4 v2, s[24:27], s41 offen lds
    s_mov_b32 m0, 6144
    s_add_u32 s41, s40, 98304
    buffer_load_dwordx4 v2, s[24:27], s41 offen lds
    s_mov_b32 m0, 7168
    s_add_u32 s41, s40, 114688
    buffer_load_dwordx4 v2, s[24:27], s41 offen lds
    s_mov_b32 m0, 8192
    s_add_u32 s41, s40, 256
    buffer_load_dwordx4 v2, s[24:27], s41 offen lds
    s_mov_b32 m0, 9216
    s_add_u32 s41, s40, 16640
    buffer_load_dwordx4 v2, s[24:27], s41 offen lds
    s_mov_b32 m0, 10240
    s_add_u32 s41, s40, 33024
    buffer_load_dwordx4 v2, s[24:27], s41 offen lds
    s_mov_b32 m0, 11264
    s_add_u32 s41, s40, 49408
    buffer_load_dwordx4 v2, s[24:27], s41 offen lds
    s_mov_b32 m0, 12288
    s_add_u32 s41, s40, 65792
    buffer_load_dwordx4 v2, s[24:27], s41 offen lds
    s_mov_b32 m0, 13312
    s_add_u32 s41, s40, 82176
    buffer_load_dwordx4 v2, s[24:27], s41 offen lds
    s_mov_b32 m0, 14336
    s_add_u32 s41, s40, 98560
    buffer_load_dwordx4 v2, s[24:27], s41 offen lds
    s_mov_b32 m0, 15360
    s_add_u32 s41, s40, 114944
    buffer_load_dwordx4 v2, s[24:27], s41 offen lds
    s_waitcnt lgkmcnt(0)
    s_barrier
    s_waitcnt vmcnt(0)
    s_barrier
L_wj_2:
    v_mov_b32 v2, 28672
    ds_read_b32 v2, v2
    s_waitcnt lgkmcnt(0)
    v_readfirstlane_b32 s45, v2
    s_nop 0
    s_cmp_lg_u32 s45, 0
    s_cbranch_scc1 L_safe
    v_lshlrev_b32 v2, 4, v1
    v_add_u32 v2, 0, v2
    ds_read_b128 v[48:51], v2 offset:0
    ds_read_b128 v[52:55], v2 offset:8192
    ds_read_b128 v[56:59], v2 offset:1024
    ds_read_b128 v[60:63], v2 offset:9216
    ds_read_b128 v[64:67], v2 offset:2048
    ds_read_b128 v[68:71], v2 offset:10240
    ds_read_b128 v[72:75], v2 offset:3072
    s_waitcnt lgkmcnt(6)
    v_mfma_f32_16x16x32_bf16 v[80:83], v[48:51], v[16:19], 0
    ds_read_b128 v[76:79], v2 offset:11264
    s_waitcnt lgkmcnt(6)
    v_mfma_f32_16x16x32_bf16 v[84:87], v[52:55], v[16:19], 0
    ds_read_b128 v[48:51], v2 offset:4096
    s_waitcnt lgkmcnt(6)
    v_mfma_f32_16x16x32_bf16 v[80:83], v[56:59], v[20:23], v[80:83]
    ds_read_b128 v[52:55], v2 offset:12288
    s_waitcnt lgkmcnt(6)
    v_mfma_f32_16x16x32_bf16 v[84:87], v[60:63], v[20:23], v[84:87]
    ds_read_b128 v[56:59], v2 offset:5120
    s_waitcnt lgkmcnt(6)
    v_mfma_f32_16x16x32_bf16 v[80:83], v[64:67], v[24:27], v[80:83]
    ds_read_b128 v[60:63], v2 offset:13312
    s_waitcnt lgkmcnt(6)
    v_mfma_f32_16x16x32_bf16 v[84:87], v[68:71], v[24:27], v[84:87]
    ds_read_b128 v[64:67], v2 offset:6144
    s_waitcnt lgkmcnt(6)
    v_mfma_f32_16x16x32_bf16 v[80:83], v[72:75], v[28:31], v[80:83]
    ds_read_b128 v[68:71], v2 offset:14336
    s_waitcnt lgkmcnt(6)
    v_mfma_f32_16x16x32_bf16 v[84:87], v[76:79], v[28:31], v[84:87]
    ds_read_b128 v[72:75], v2 offset:7168
    s_waitcnt lgkmcnt(6)
    v_mfma_f32_16x16x32_bf16 v[80:83], v[48:51], v[32:35], v[80:83]
    ds_read_b128 v[76:79], v2 offset:15360
    s_waitcnt lgkmcnt(6)
    v_mfma_f32_16x16x32_bf16 v[84:87], v[52:55], v[32:35], v[84:87]
    s_waitcnt lgkmcnt(5)
    v_mfma_f32_16x16x32_bf16 v[80:83], v[56:59], v[36:39], v[80:83]
    s_waitcnt lgkmcnt(4)
    v_mfma_f32_16x16x32_bf16 v[84:87], v[60:63], v[36:39], v[84:87]
    s_waitcnt lgkmcnt(3)
    v_mfma_f32_16x16x32_bf16 v[80:83], v[64:67], v[40:43], v[80:83]
    s_waitcnt lgkmcnt(2)
    v_mfma_f32_16x16x32_bf16 v[84:87], v[68:71], v[40:43], v[84:87]
    s_waitcnt lgkmcnt(1)
    v_mfma_f32_16x16x32_bf16 v[80:83], v[72:75], v[44:47], v[80:83]
    s_waitcnt lgkmcnt(0)
    v_mfma_f32_16x16x32_bf16 v[84:87], v[76:79], v[44:47], v[84:87]
    v_and_b32 v2, 15, v1
    v_lshrrev_b32 v3, 4, v1
    v_and_b32 v4, 7, v2
    v_xor_b32 v3, v3, v4
    v_lshlrev_b32_e64 v5, 4, v3
    v_lshl_add_u32 v5, v2, 7, v5
    s_lshl_b32 s40, s30, 11
    s_add_u32 s40, s40, 16384
    v_add_u32 v5, s40, v5
    v_xor_b32_e64 v6, 64, v5
    ds_write_b128 v5, v[80:83]
    ds_write_b128 v6, v[84:87]
    v_lshrrev_b32 v2, 2, v1
    v_and_b32 v3, 3, v1
    v_lshlrev_b32 v3, 1, v3
    v_and_b32 v4, 7, v2
    v_xor_b32 v3, v3, v4
    v_lshlrev_b32 v7, 4, v3
    v_lshl_add_u32 v7, v2, 7, v7
    v_add_u32 v7, s40, v7
    v_xor_b32 v6, 16, v7
    ds_read_b128 v[80:83], v7
    ds_read_b128 v[84:87], v6
    s_waitcnt vmcnt(0)
    v_alignbit_b32 v104, v93, v92, 16
    v_alignbit_b32 v105, v94, v93, 16
    v_alignbit_b32 v106, v95, v94, 16
    v_lshrrev_b32 v107, 16, v95
    v_lshl_or_b32 v107, v96, 16, v107
    v_cndmask_b32 v92, v92, v104, s[52:53]
    v_cndmask_b32 v93, v93, v105, s[52:53]
    v_cndmask_b32 v94, v94, v106, s[52:53]
    v_cndmask_b32 v95, v95, v107, s[52:53]
    s_mov_b32 s54, 0xffff0000
    v_lshlrev_b32 v104, 16, v88
    v_and_b32 v105, s54, v88
    v_lshlrev_b32 v119, 16, v92
    v_and_b32 v118, s54, v92
    v_lshlrev_b32 v106, 16, v89
    v_and_b32 v107, s54, v89
    v_lshlrev_b32 v117, 16, v93
    v_and_b32 v116, s54, v93
    v_lshlrev_b32 v108, 16, v90
    v_and_b32 v109, s54, v90
    v_lshlrev_b32 v115, 16, v94
    v_and_b32 v114, s54, v94
    v_lshlrev_b32 v110, 16, v91
    v_and_b32 v111, s54, v91
    v_lshlrev_b32 v113, 16, v95
    v_and_b32 v112, s54, v95
    s_waitcnt lgkmcnt(1)
    v_add_f32 v112, v112, v80
    v_add_f32 v113, v113, v81
    v_add_f32 v114, v114, v82
    v_add_f32 v115, v115, v83
    s_waitcnt lgkmcnt(0)
    v_add_f32 v116, v116, v84
    v_add_f32 v117, v117, v85
    v_add_f32 v118, v118, v86
    v_add_f32 v119, v119, v87
    v_mov_b32_e64 v99, 0
    v_cndmask_b32 v80, v80, v99, s[52:53]
    v_add_f32 v104, v104, v80
    v_add_f32 v105, v105, v81
    v_add_f32 v106, v106, v82
    v_add_f32 v107, v107, v83
    v_add_f32 v108, v108, v84
    v_add_f32 v109, v109, v85
    v_add_f32 v110, v110, v86
    v_add_f32 v111, v111, v87
    v_cvt_pk_bf16_f32 v120, v104, v105
    v_cvt_pk_bf16_f32 v121, v106, v107
    v_cvt_pk_bf16_f32 v122, v108, v109
    v_cvt_pk_bf16_f32 v123, v110, v111
    v_cvt_pk_bf16_f32 v124, v119, v118
    v_cvt_pk_bf16_f32 v125, v117, v116
    v_cvt_pk_bf16_f32 v126, v115, v114
    v_cvt_pk_bf16_f32 v127, v113, v112
    s_mov_b32 s46, 5242880
    s_mov_b32 s47, 13107200
    buffer_store_dwordx4 v[120:123], v8, s[24:27], s46 offen
    s_not_b64 exec, s[52:53]
    buffer_store_dwordx4 v[124:127], v9, s[24:27], s46 offen
    s_mov_b64 exec, -1
    s_nop 0
    s_cmp_lg_u32 s35, 0
    s_cbranch_scc1 L_qsp_11
    v_subrev_u32 v13, 498, v9
    s_mov_b64 exec, s[52:53]
    buffer_store_dwordx3 v[124:126], v9, s[24:27], s46 offen
    buffer_store_short v127, v9, s[24:27], s46 offen offset:12
    buffer_store_short_d16_hi v127, v13, s[24:27], s46 offen
    s_mov_b64 exec, -1
L_qsp_11:
    v_add_f32 v128, v104, v105
    v_mul_f32 v129, v104, v104
    v_fmac_f32 v129, v105, v105
    v_add_f32 v128, v128, v106
    v_fmac_f32 v129, v106, v106
    v_add_f32 v128, v128, v107
    v_fmac_f32 v129, v107, v107
    v_add_f32 v128, v128, v108
    v_fmac_f32 v129, v108, v108
    v_add_f32 v128, v128, v109
    v_fmac_f32 v129, v109, v109
    v_add_f32 v128, v128, v110
    v_fmac_f32 v129, v110, v110
    v_add_f32 v128, v128, v111
    v_fmac_f32 v129, v111, v111
    v_add_f32 v130, v112, v113
    v_mul_f32 v131, v112, v112
    v_fmac_f32 v131, v113, v113
    v_add_f32 v130, v130, v114
    v_fmac_f32 v131, v114, v114
    v_add_f32 v130, v130, v115
    v_fmac_f32 v131, v115, v115
    v_add_f32 v130, v130, v116
    v_fmac_f32 v131, v116, v116
    v_add_f32 v130, v130, v117
    v_fmac_f32 v131, v117, v117
    v_add_f32 v130, v130, v118
    v_fmac_f32 v131, v118, v118
    v_add_f32 v130, v130, v119
    v_fmac_f32_e64 v131, v119, v119
    v_add_f32_dpp v128, v128, v128 quad_perm:[1,0,3,2] row_mask:0xf bank_mask:0xf
    v_add_f32_dpp v129, v129, v129 quad_perm:[1,0,3,2] row_mask:0xf bank_mask:0xf
    v_add_f32_dpp v130, v130, v130 quad_perm:[1,0,3,2] row_mask:0xf bank_mask:0xf
    v_add_f32_dpp v131, v131, v131 quad_perm:[1,0,3,2] row_mask:0xf bank_mask:0xf
    v_add_f32_dpp v128, v128, v128 quad_perm:[2,3,0,1] row_mask:0xf bank_mask:0xf
    v_add_f32_dpp v129, v129, v129 quad_perm:[2,3,0,1] row_mask:0xf bank_mask:0xf
    v_add_f32_dpp v130, v130, v130 quad_perm:[2,3,0,1] row_mask:0xf bank_mask:0xf
    v_add_f32_dpp v131, v131, v131 quad_perm:[2,3,0,1] row_mask:0xf bank_mask:0xf
    s_mov_b32 exec_lo, 0x11111111
    s_mov_b32 exec_hi, 0x11111111
    buffer_store_dwordx2 v[128:129], v10, s[24:27], s47 offen
    buffer_store_dwordx2 v[130:131], v11, s[24:27], s47 offen
    s_mov_b64 exec, -1
    s_cmp_eq_u32 s30, 0
    s_cbranch_scc1 L_w0_12
    v_lshrrev_b32 v2, 3, v1
    v_and_b32_e64 v3, 7, v1
    v_bfe_u32 v4, v2, 1, 1
    v_lshlrev_b32 v4, 1, v4
    v_xor_b32 v3, v3, v4
    v_mul_u32_u24 v2, 3584, v2
    v_lshl_add_u32 v112, v3, 4, v2
    v_xor_b32_e64 v3, 4, v3
    v_lshl_add_u32 v113, v3, 4, v2
    s_waitcnt vmcnt(0)
    s_barrier
    s_branch L_wj_13
L_w0_12:
    v_lshrrev_b32 v2, 3, v1
    v_and_b32_e64 v3, 7, v1
    v_bfe_u32 v4, v2, 1, 1
    v_lshlrev_b32 v4, 1, v4
    v_xor_b32 v3, v3, v4
    v_mul_u32_u24 v2, 3584, v2
    v_lshl_add_u32 v112, v3, 4, v2
    v_xor_b32_e64 v3, 4, v3
    v_lshl_add_u32 v113, v3, 4, v2
    s_waitcnt vmcnt(0)
    s_barrier
    s_add_u32 s40, s32, 1
    v_mov_b32 v2, s40
    v_mov_b32 v3, s33
    s_lshl_b32 s41, s2, 6
    s_add_u32 s41, s41, 98304
    v_mov_b32 v4, s41
    s_mov_b64 exec, 1
    buffer_store_dwordx2 v[2:3], v4, s[24:27], 0 offen
    s_mov_b64 exec, -1
L_wj_13:
    s_cmp_ge_u32 s29, 28
    s_cbranch_scc1 L_idle_14
    s_cmp_eq_u32 s30, 0
    s_cbranch_scc1 L_w0_16
    s_add_u32 s40, s30, 41
    s_mul_i32 s41, s40, 28672
    s_min_u32 s42, s29, 27
    s_lshl_b32 s42, s42, 7
    s_add_u32 s41, s41, s42
    s_lshr_b32 s42, s40, 1
    s_lshl_b32 s42, s42, 12
    s_and_b32 s43, s40, 1
    s_lshl_b32 s43, s43, 10
    s_add_u32 s42, s42, s43
    s_add_u32 s42, s42, 4294950912
    s_mov_b32 m0, s42
    s_nop 0
    buffer_load_dwordx4 v112, s[8:11], s41 offen lds
    s_add_u32 m0, s42, 2048
    s_nop 0
    buffer_load_dwordx4 v113, s[12:15], s41 offen lds
    s_add_u32 s40, s30, 44
    s_mul_i32 s41, s40, 28672
    s_min_u32 s42, s29, 27
    s_lshl_b32 s42, s42, 7
    s_add_u32 s41, s41, s42
    s_lshr_b32 s42, s40, 1
    s_lshl_b32 s42, s42, 12
    s_and_b32 s43, s40, 1
    s_lshl_b32 s43, s43, 10
    s_add_u32 s42, s42, s43
    s_add_u32 s42, s42, 4294950912
    s_mov_b32 m0, s42
    s_nop 0
    buffer_load_dwordx4 v112, s[8:11], s41 offen lds
    s_add_u32 m0, s42, 2048
    s_nop 0
    buffer_load_dwordx4 v113, s[12:15], s41 offen lds
    s_add_u32 s40, s30, 47
    s_mul_i32 s41, s40, 28672
    s_min_u32 s42, s29, 27
    s_lshl_b32 s42, s42, 7
    s_add_u32 s41, s41, s42
    s_lshr_b32 s42, s40, 1
    s_lshl_b32 s42, s42, 12
    s_and_b32 s43, s40, 1
    s_lshl_b32 s43, s43, 10
    s_add_u32 s42, s42, s43
    s_add_u32 s42, s42, 4294950912
    s_mov_b32 m0, s42
    s_nop 0
    buffer_load_dwordx4 v112, s[8:11], s41 offen lds
    s_add_u32 m0, s42, 2048
    s_nop 0
    buffer_load_dwordx4 v113, s[12:15], s41 offen lds
    s_add_u32 s40, s30, 50
    s_mul_i32 s41, s40, 28672
    s_min_u32 s42, s29, 27
    s_lshl_b32 s42, s42, 7
    s_add_u32 s41, s41, s42
    s_lshr_b32 s42, s40, 1
    s_lshl_b32 s42, s42, 12
    s_and_b32 s43, s40, 1
    s_lshl_b32 s43, s43, 10
    s_add_u32 s42, s42, s43
    s_add_u32 s42, s42, 4294950912
    s_mov_b32 m0, s42
    s_nop 0
    buffer_load_dwordx4 v112, s[8:11], s41 offen lds
    s_add_u32 m0, s42, 2048
    s_nop 0
    buffer_load_dwordx4 v113, s[12:15], s41 offen lds
    s_add_u32 s40, s30, 53
    s_mul_i32 s41, s40, 28672
    s_min_u32 s42, s29, 27
    s_lshl_b32 s42, s42, 7
    s_add_u32 s41, s41, s42
    s_lshr_b32 s42, s40, 1
    s_lshl_b32 s42, s42, 12
    s_and_b32 s43, s40, 1
    s_lshl_b32 s43, s43, 10
    s_add_u32 s42, s42, s43
    s_add_u32 s42, s42, 4294950912
    s_mov_b32 m0, s42
    s_nop 0
    buffer_load_dwordx4 v112, s[8:11], s41 offen lds
    s_add_u32 m0, s42, 2048
    s_nop 0
    buffer_load_dwordx4 v113, s[12:15], s41 offen lds
    s_add_u32 s40, s30, 56
    s_mul_i32 s41, s40, 28672
    s_min_u32 s42, s29, 27
    s_lshl_b32 s42, s42, 7
    s_add_u32 s41, s41, s42
    s_lshr_b32 s42, s40, 1
    s_lshl_b32 s42, s42, 12
    s_and_b32 s43, s40, 1
    s_lshl_b32 s43, s43, 10
    s_add_u32 s42, s42, s43
    s_add_u32 s42, s42, 4294950912
    s_mov_b32 m0, s42
    s_nop 0
    buffer_load_dwordx4 v112, s[8:11], s41 offen lds
    s_add_u32 m0, s42, 2048
    s_nop 0
    buffer_load_dwordx4 v113, s[12:15], s41 offen lds
    s_branch L_wj_17
L_w0_16:
L_wj_17:
    s_add_u32 s40, s30, 60
    s_mul_i32 s41, s40, 28672
    s_min_u32 s42, s29, 27
    s_lshl_b32 s42, s42, 7
    s_add_u32 s41, s41, s42
    s_lshr_b32 s42, s30, 1
    s_lshl_b32 s42, s42, 12
    s_and_b32 s40, s30, 1
    s_lshl_b32 s40, s40, 10
    s_add_u32 s42, s42, s40
    s_add_u32 m0, s42, 16384
    s_nop 0
    buffer_load_dwordx4 v112, s[8:11], s41 offen lds
    s_add_u32 m0, s42, 18432
    s_nop 0
    buffer_load_dwordx4 v113, s[12:15], s41 offen lds
    s_and_b32 s40, s30, 1
    s_lshl_b32 s40, s40, 3
    s_or_b32 s41, s40, 0
    v_xor_b32 v2, s41, v1
    v_lshlrev_b32 v2, 4, v2
    v_add_u32 v120, 0, v2
    s_or_b32 s41, s40, 1
    v_xor_b32 v2, s41, v1
    v_lshlrev_b32 v2, 4, v2
    v_add_u32 v121, 128, v2
    s_or_b32 s41, s40, 2
    v_xor_b32 v2, s41, v1
    v_lshlrev_b32_e64 v2, 4, v2
    v_add_u32 v122, 256, v2
    s_or_b32 s41, s40, 3
    v_xor_b32 v2, s41, v1
    v_lshlrev_b32_e64 v2, 4, v2
    v_add_u32 v123, 384, v2
    s_or_b32 s41, s40, 4
    v_xor_b32 v2, s41, v1
    v_lshlrev_b32 v2, 4, v2
    v_add_u32 v124, 0, v2
    s_or_b32 s41, s40, 5
    v_xor_b32 v2, s41, v1
    v_lshlrev_b32_e64 v2, 4, v2
    v_add_u32 v125, 128, v2
    s_or_b32 s41, s40, 6
    v_xor_b32 v2, s41, v1
    v_lshlrev_b32_e64 v2, 4, v2
    v_add_u32 v126, 256, v2
    s_or_b32 s41, s40, 7
    v_xor_b32 v2, s41, v1
    v_lshlrev_b32_e64 v2, 4, v2
    v_add_u32 v127, 384, v2
    v_and_b32 v3, 31, v1
    v_lshrrev_b32 v4, 5, v1
    v_and_b32 v5, 15, v3
    v_add_u32 v6, 0, v4
    v_xor_b32 v6, v6, v5
    v_lshlrev_b32 v6, 4, v6
    v_lshl_add_u32 v128, v3, 10, v6
    v_add_u32 v6, 2, v4
    v_xor_b32 v6, v6, v5
    v_lshlrev_b32_e64 v6, 4, v6
    v_lshl_add_u32 v129, v3, 10, v6
    v_add_u32 v6, 4, v4
    v_xor_b32 v6, v6, v5
    v_lshlrev_b32_e64 v6, 4, v6
    v_lshl_add_u32 v130, v3, 10, v6
    v_add_u32 v6, 6, v4
    v_xor_b32 v6, v6, v5
    v_lshlrev_b32_e64 v6, 4, v6
    v_lshl_add_u32 v131, v3, 10, v6
    v_add_u32 v6, 8, v4
    v_xor_b32 v6, v6, v5
    v_lshlrev_b32_e64 v6, 4, v6
    v_lshl_add_u32 v132, v3, 10, v6
    v_add_u32 v6, 10, v4
    v_xor_b32 v6, v6, v5
    v_lshlrev_b32_e64 v6, 4, v6
    v_lshl_add_u32 v133, v3, 10, v6
    v_add_u32 v6, 12, v4
    v_xor_b32 v6, v6, v5
    v_lshlrev_b32_e64 v6, 4, v6
    v_lshl_add_u32 v134, v3, 10, v6
    v_add_u32 v6, 14, v4
    v_xor_b32 v6, v6, v5
    v_lshlrev_b32_e64 v6, 4, v6
    v_lshl_add_u32 v135, v3, 10, v6
    v_lshlrev_b32_e64 v115, 4, v3
    v_add_u32 v115, 0x20000, v115
    s_lshl_b32 s40, s30, 1
    v_add_u32 v6, s40, v4
    v_and_b32 v7, 7, v3
    v_xor_b32 v6, v6, v7
    v_lshlrev_b32_e64 v6, 4, v6
    v_lshl_add_u32 v6, v3, 7, v6
    v_add_u32 v112, 0x21000, v6
    v_lshrrev_b32 v6, 3, v1
    v_and_b32 v7, 7, v1
    v_xor_b32 v8, v6, v7
    v_lshlrev_b32 v8, 4, v8
    s_lshl_b32 s40, s30, 3
    v_add_u32 v6, s40, v6
    v_lshl_add_u32 v8, v6, 7, v8
    v_add_u32 v113, 0x21000, v8
    s_movk_i32 s40, 3712
    v_mul_lo_u32 v6, v6, s40
    v_lshl_add_u32 v114, v7, 4, v6
    s_lshl_b32 s57, s28, 8
    s_lshl_b32 s40, s30, 3
    s_add_u32 s57, s57, s40
    s_mul_i32 s57, s57, 1152
    s_add_u32 s57, s57, 5242880
    s_lshl_b32 s58, s30, 13
    s_mul_i32 s59, s28, 950272
    s_lshl_b32 s40, s29, 7
    s_add_u32 s59, s59, s40
    s_add_u32 s59, s59, 13631488
    s_movk_i32 s60, 4608
    s_mov_b32 s61, 32256
    s_mov_b32 s62, 118784
    s_waitcnt vmcnt(0)
    s_barrier
    v_and_b32 v2, 15, v1
    v_lshrrev_b32 v3, 4, v1
    v_lshrrev_b32 v4, 2, v2
    v_and_b32 v5, 3, v2
    v_and_b32 v6, 1, v3
    v_lshrrev_b32 v7, 1, v3
    v_and_b32 v8, 1, v5
    s_lshl_b32 s40, s30, 1
    v_add_u32 v8, s40, v8
    v_lshlrev_b32 v9, 2, v6
    v_and_b32 v10, 2, v4
    v_or_b32 v9, v9, v10
    v_xor_b32 v8, v8, v9
    v_lshlrev_b32 v8, 4, v8
    v_lshrrev_b32_e64 v5, 1, v5
    v_lshl_add_u32 v8, v5, 3, v8
    v_lshl_add_u32 v8, v6, 11, v8
    v_lshl_add_u32 v4, v7, 3, v4
    v_lshl_add_u32 v8, v4, 7, v8
    v_add_u32 v9, 106496, v8
    v_add_u32 v10, 40960, v8
    ds_read_b64_tr_b16 a[0:1], v9 offset:0
    ds_read_b64_tr_b16 a[2:3], v9 offset:512
    ds_read_b64_tr_b16 a[4:5], v9 offset:4096
    ds_read_b64_tr_b16 a[6:7], v9 offset:4608
    ds_read_b64_tr_b16 a[8:9], v9 offset:8192
    ds_read_b64_tr_b16 a[10:11], v9 offset:8704
    ds_read_b64_tr_b16 a[12:13], v9 offset:12288
    ds_read_b64_tr_b16 a[14:15], v9 offset:12800
    ds_read_b64_tr_b16 a[16:17], v9 offset:16384
    ds_read_b64_tr_b16 a[18:19], v9 offset:16896
    ds_read_b64_tr_b16 a[20:21], v9 offset:20480
    ds_read_b64_tr_b16 a[22:23], v9 offset:20992
    ds_read_b64_tr_b16 a[24:25], v9 offset:24576
    ds_read_b64_tr_b16 a[26:27], v9 offset:25088
    ds_read_b64_tr_b16 a[28:29], v9 offset:28672
    ds_read_b64_tr_b16 a[30:31], v9 offset:29184
    ds_read_b64_tr_b16 a[32:33], v9 offset:32768
    ds_read_b64_tr_b16 a[34:35], v9 offset:33280
    ds_read_b64_tr_b16 a[36:37], v9 offset:36864
    ds_read_b64_tr_b16 a[38:39], v9 offset:37376
    ds_read_b64_tr_b16 a[40:41], v9 offset:40960
    ds_read_b64_tr_b16 a[42:43], v9 offset:41472
    ds_read_b64_tr_b16 a[44:45], v9 offset:45056
    ds_read_b64_tr_b16 a[46:47], v9 offset:45568
    ds_read_b64_tr_b16 a[48:49], v9 offset:49152
    ds_read_b64_tr_b16 a[50:51], v9 offset:49664
    ds_read_b64_tr_b16 a[52:53], v9 offset:53248
    ds_read_b64_tr_b16 a[54:55], v9 offset:53760
    ds_read_b64_tr_b16 a[56:57], v10 offset:0
    ds_read_b64_tr_b16 a[58:59], v10 offset:512
    ds_read_b64_tr_b16 a[60:61], v10 offset:4096
    ds_read_b64_tr_b16 a[62:63], v10 offset:4608
    ds_read_b64_tr_b16 a[64:65], v10 offset:8192
    ds_read_b64_tr_b16 a[66:67], v10 offset:8704
    ds_read_b64_tr_b16 a[68:69], v10 offset:12288
    ds_read_b64_tr_b16 a[70:71], v10 offset:12800
    ds_read_b64_tr_b16 a[72:73], v10 offset:16384
    ds_read_b64_tr_b16 a[74:75], v10 offset:16896
    ds_read_b64_tr_b16 a[76:77], v10 offset:20480
    ds_read_b64_tr_b16 a[78:79], v10 offset:20992
    ds_read_b64_tr_b16 a[80:81], v10 offset:24576
    ds_read_b64_tr_b16 a[82:83], v10 offset:25088
    ds_read_b64_tr_b16 a[84:85], v10 offset:28672
    ds_read_b64_tr_b16 a[86:87], v10 offset:29184
    ds_read_b64_tr_b16 a[88:89], v10 offset:32768
    ds_read_b64_tr_b16 a[90:91], v10 offset:33280
    ds_read_b64_tr_b16 a[92:93], v10 offset:36864
    ds_read_b64_tr_b16 a[94:95], v10 offset:37376
    ds_read_b64_tr_b16 a[96:97], v10 offset:40960
    ds_read_b64_tr_b16 a[98:99], v10 offset:41472
    ds_read_b64_tr_b16 a[100:101], v10 offset:45056
    ds_read_b64_tr_b16 a[102:103], v10 offset:45568
    ds_read_b64_tr_b16 a[104:105], v10 offset:49152
    ds_read_b64_tr_b16 a[106:107], v10 offset:49664
    ds_read_b64_tr_b16 a[108:109], v10 offset:53248
    ds_read_b64_tr_b16 a[110:111], v10 offset:53760
    ds_read_b64_tr_b16 a[112:113], v10 offset:57344
    ds_read_b64_tr_b16 a[114:115], v10 offset:57856
    ds_read_b64_tr_b16 a[116:117], v10 offset:61440
    ds_read_b64_tr_b16 a[118:119], v10 offset:61952
    ds_read_b64_tr_b16 a[120:121], v8 offset:16384
    ds_read_b64_tr_b16 a[122:123], v8 offset:16896
    ds_read_b64_tr_b16 a[124:125], v8 offset:20480
    ds_read_b64_tr_b16 a[126:127], v8 offset:20992
    v_lshlrev_b32 v2, 3, v1
    v_add_u32 v2, s28, v2
    v_lshlrev_b32_e64 v2, 6, v2
    v_add_u32 v4, 98304, v2
    s_nop 1
    s_cmp_lg_u32 s30, 0
    s_cbranch_scc1 L_ps_20
    s_add_u32 s40, s32, 1
    s_mov_b32 exec_lo, -1
    s_mov_b32 exec_hi, 0
    s_mov_b32 s98, 0
    v_mov_b32 v2, 0
    v_mov_b32 v3, 0
    s_nop 1
L_poll_18:
    buffer_load_dwordx2 v[2:3], v4, s[24:27], 0 offen sc1
    s_add_u32 s98, s98, 1
    s_cmp_gt_u32 s98, 0x40000
    s_cbranch_scc1 L_pd_19
    s_waitcnt vmcnt(0)
    v_subrev_u32_e64 v2, s40, v2
    v_cmp_gt_u32 vcc, 64, v2
    v_cmp_eq_u32 s[42:43], s33, v3
    s_nop 1
    s_and_b64 vcc, vcc, s[42:43]
    s_cmp_eq_u64 vcc, exec
    s_cbranch_scc0 L_poll_18
L_pd_19:
    s_waitcnt vmcnt(0)
    s_mov_b64 exec, -1
L_ps_20:
    s_waitcnt lgkmcnt(0)
    s_barrier
    s_add_u32 m0, s58, 0
    s_nop 0
    buffer_load_dwordx4 v120, s[24:27], s57 offen offset:0 lds
    buffer_load_dwordx4 v121, s[24:27], s57 offen offset:1024 lds
    buffer_load_dwordx4 v122, s[24:27], s57 offen offset:2048 lds
    buffer_load_dwordx4 v123, s[24:27], s57 offen offset:3072 lds
    s_add_u32 s57, s57, s60
    s_add_u32 m0, s58, 4096
    s_nop 0
    buffer_load_dwordx4 v124, s[24:27], s57 offen offset:0 lds
    buffer_load_dwordx4 v125, s[24:27], s57 offen offset:1024 lds
    buffer_load_dwordx4 v126, s[24:27], s57 offen offset:2048 lds
    buffer_load_dwordx4 v127, s[24:27], s57 offen offset:3072 lds
    s_add_u32 s57, s57, s61
    s_lshl_b32 s41, s30, 6
    v_add_u32 v2, s41, v1
    v_lshlrev_b32 v116, 4, v2
    v_add_u32 v116, 0x20000, v116
    v_lshlrev_b32 v2, 3, v2
    s_lshl_b32 s40, s28, 15
    s_add_u32 s40, s40, 13107200
    buffer_load_dwordx2 v[32:33], v2, s[24:27], s40 offen offset:0
    buffer_load_dwordx2 v[34:35], v2, s[24:27], s40 offen offset:2048
    s_add_u32 s40, s40, 4096
    buffer_load_dwordx2 v[36:37], v2, s[24:27], s40 offen offset:0
    buffer_load_dwordx2 v[38:39], v2, s[24:27], s40 offen offset:2048
    s_add_u32 s40, s40, 4096
    buffer_load_dwordx2 v[40:41], v2, s[24:27], s40 offen offset:0
    buffer_load_dwordx2 v[42:43], v2, s[24:27], s40 offen offset:2048
    s_add_u32 s40, s40, 4096
    buffer_load_dwordx2 v[44:45], v2, s[24:27], s40 offen offset:0
    buffer_load_dwordx2 v[46:47], v2, s[24:27], s40 offen offset:2048
    s_add_u32 s40, s40, 4096
    buffer_load_dwordx2 v[104:105], v2, s[24:27], s40 offen offset:0
    buffer_load_dwordx2 v[106:107], v2, s[24:27], s40 offen offset:2048
    s_add_u32 s40, s40, 4096
    buffer_load_dwordx2 v[108:109], v2, s[24:27], s40 offen offset:0
    buffer_load_dwordx2 v[110:111], v2, s[24:27], s40 offen offset:2048
    s_add_u32 s40, s40, 4096
    buffer_load_dwordx2 v[136:137], v2, s[24:27], s40 offen offset:0
    buffer_load_dwordx2 v[138:139], v2, s[24:27], s40 offen offset:2048
    s_add_u32 s40, s40, 4096
    buffer_load_dwordx2 v[140:141], v2, s[24:27], s40 offen offset:0
    buffer_load_dwordx2 v[142:143], v2, s[24:27], s40 offen offset:2048
    s_add_u32 m0, s58, 32768
    s_nop 0
    buffer_load_dwordx4 v120, s[24:27], s57 offen offset:0 lds
    buffer_load_dwordx4 v121, s[24:27], s57 offen offset:1024 lds
    buffer_load_dwordx4 v122, s[24:27], s57 offen offset:2048 lds
    buffer_load_dwordx4 v123, s[24:27], s57 offen offset:3072 lds
    s_add_u32 s57, s57, s60
    s_add_u32 m0, s58, 36864
    s_nop 0
    buffer_load_dwordx4 v124, s[24:27], s57 offen offset:0 lds
    buffer_load_dwordx4 v125, s[24:27], s57 offen offset:1024 lds
    buffer_load_dwordx4 v126, s[24:27], s57 offen offset:2048 lds
    buffer_load_dwordx4 v127, s[24:27], s57 offen offset:3072 lds
    s_add_u32 s57, s57, s61
    s_mov_b32 s51, s59
    buffer_load_dword v90, v114, s[24:27], s51 offen
    s_add_u32 s51, s51, s62
    buffer_load_dword v91, v114, s[24:27], s51 offen
    s_add_u32 s51, s51, s62
    s_getpc_b64 s[42:43]
L_pc_21:
    s_lshl_b32 s40, s29, 2
    s_add_u32 s40, s40, s30
    s_lshl_b32 s40, s40, 10
    v_lshlrev_b32 v2, 4, v1
    v_add_u32_e64 v2, s40, v2
    v_min_u32 v2, 24560, v2
    v_add_u32 v2, 12288, v2
    v_min_u32 v2, L_code_end-L_pc_21-16, v2
    global_load_dwordx4 v[92:95], v2, s[42:43]
    v_lshlrev_b32_e64 v117, 4, v1
    s_lshl_b32 s63, s35, 2
    s_add_u32 s63, s63, s30
    s_mul_i32 s63, s63, 57344
    s_add_u32 s63, s63, 29360128
    s_lshl_b32 s40, s30, 3
    s_add_u32 s40, s40, s35
    s_lshl_b32 s40, s40, 6
    s_add_u32 s40, s40, 114688
    v_mov_b32 v118, s40
    v_mov_b32 v12, 0x3f803f80
    v_mov_b32 v13, 0x3f803f80
    v_mov_b32 v14, 0x3f803f80
    v_mov_b32 v15, 0x3f803f80
    s_nop 1
    v_mfma_f32_32x32x16_bf16 v[144:159], a[0:3], v[12:15], 0
    v_mfma_f32_32x32x16_bf16 v[144:159], a[4:7], v[12:15], v[144:159]
    v_mfma_f32_32x32x16_bf16 v[144:159], a[8:11], v[12:15], v[144:159]
    v_mfma_f32_32x32x16_bf16 v[144:159], a[12:15], v[12:15], v[144:159]
    v_mfma_f32_32x32x16_bf16 v[144:159], a[16:19], v[12:15], v[144:159]
    v_mfma_f32_32x32x16_bf16 v[144:159], a[20:23], v[12:15], v[144:159]
    v_mfma_f32_32x32x16_bf16 v[144:159], a[24:27], v[12:15], v[144:159]
    v_mfma_f32_32x32x16_bf16 v[144:159], a[28:31], v[12:15], v[144:159]
    v_mfma_f32_32x32x16_bf16 v[144:159], a[32:35], v[12:15], v[144:159]
    v_mfma_f32_32x32x16_bf16 v[144:159], a[36:39], v[12:15], v[144:159]
    v_mfma_f32_32x32x16_bf16 v[144:159], a[40:43], v[12:15], v[144:159]
    v_mfma_f32_32x32x16_bf16 v[144:159], a[44:47], v[12:15], v[144:159]
    v_mfma_f32_32x32x16_bf16 v[144:159], a[48:51], v[12:15], v[144:159]
    v_mfma_f32_32x32x16_bf16 v[144:159], a[52:55], v[12:15], v[144:159]
    v_mfma_f32_32x32x16_bf16 v[144:159], a[56:59], v[12:15], v[144:159]
    v_mfma_f32_32x32x16_bf16 v[144:159], a[60:63], v[12:15], v[144:159]
    v_mfma_f32_32x32x16_bf16 v[144:159], a[64:67], v[12:15], v[144:159]
    v_mfma_f32_32x32x16_bf16 v[144:159], a[68:71], v[12:15], v[144:159]
    v_mfma_f32_32x32x16_bf16 v[144:159], a[72:75], v[12:15], v[144:159]
    v_mfma_f32_32x32x16_bf16 v[144:159], a[76:79], v[12:15], v[144:159]
    v_mfma_f32_32x32x16_bf16 v[144:159], a[80:83], v[12:15], v[144:159]
    v_mfma_f32_32x32x16_bf16 v[144:159], a[84:87], v[12:15], v[144:159]
    v_mfma_f32_32x32x16_bf16 v[144:159], a[88:91], v[12:15], v[144:159]
    v_mfma_f32_32x32x16_bf16 v[144:159], a[92:95], v[12:15], v[144:159]
    v_mfma_f32_32x32x16_bf16 v[144:159], a[96:99], v[12:15], v[144:159]
    v_mfma_f32_32x32x16_bf16 v[144:159], a[100:103], v[12:15], v[144:159]
    v_mfma_f32_32x32x16_bf16 v[144:159], a[104:107], v[12:15], v[144:159]
    v_mfma_f32_32x32x16_bf16 v[144:159], a[108:111], v[12:15], v[144:159]
    v_mfma_f32_32x32x16_bf16 v[144:159], a[112:115], v[12:15], v[144:159]
    v_mfma_f32_32x32x16_bf16 v[144:159], a[116:119], v[12:15], v[144:159]
    v_mfma_f32_32x32x16_bf16 v[144:159], a[120:123], v[12:15], v[144:159]
    v_mfma_f32_32x32x16_bf16 v[144:159], a[124:127], v[12:15], v[144:159]
    s_waitcnt vmcnt(27)
    s_barrier
    ds_read_b128 v[48:51], v128 offset:0
    ds_read_b128 v[52:55], v129 offset:0
    ds_read_b128 v[56:59], v130 offset:0
    ds_read_b128 v[60:63], v131 offset:0
    ds_read_b128 v[64:67], v132 offset:0
    ds_read_b128 v[68:71], v133 offset:0
    ds_read_b128 v[72:75], v134 offset:0
    s_waitcnt lgkmcnt(3)
    v_mfma_f32_32x32x16_bf16 v[16:31], a[0:3], v[48:51], 0
    ds_read_b128 v[76:79], v135 offset:0
    v_mfma_f32_32x32x16_bf16 v[16:31], a[4:7], v[52:55], v[16:31]
    ds_read_b128 v[80:83], v128 offset:256
    s_add_u32 m0, s58, 65536
    v_mfma_f32_32x32x16_bf16 v[16:31], a[8:11], v[56:59], v[16:31]
    ds_read_b128 v[84:87], v129 offset:256
    buffer_load_dwordx4 v120, s[24:27], s57 offen offset:0 lds
    s_waitcnt vmcnt(19)
    v_add_f32 v32, v32, v104
    v_add_f32 v33, v33, v105
    s_waitcnt vmcnt(18)
    v_add_f32_e64 v34, v34, v106
    v_mfma_f32_32x32x16_bf16 v[16:31], a[12:15], v[60:63], v[16:31]
    ds_read_b128 v[48:51], v130 offset:256
    s_waitcnt lgkmcnt(3)
    buffer_load_dwordx4 v121, s[24:27], s57 offen offset:1024 lds
    v_add_f32 v35, v35, v107
    s_waitcnt vmcnt(18)
    v_add_f32 v36, v36, v108
    v_mfma_f32_32x32x16_bf16 v[16:31], a[16:19], v[64:67], v[16:31]
    ds_read_b128 v[52:55], v131 offset:256
    buffer_load_dwordx4 v122, s[24:27], s57 offen offset:2048 lds
    v_add_f32 v37, v37, v109
    s_waitcnt vmcnt(18)
    v_add_f32 v38, v38, v110
    v_add_f32 v39, v39, v111
    v_mfma_f32_32x32x16_bf16 v[16:31], a[20:23], v[68:71], v[16:31]
    ds_read_b128 v[56:59], v132 offset:256
    buffer_load_dwordx4 v123, s[24:27], s57 offen offset:3072 lds
    s_waitcnt vmcnt(18)
    v_add_f32 v40, v40, v136
    v_add_f32 v41, v41, v137
    s_waitcnt vmcnt(17)
    v_add_f32_e64 v42, v42, v138
    v_mfma_f32_32x32x16_bf16 v[16:31], a[24:27], v[72:75], v[16:31]
    ds_read_b128 v[60:63], v133 offset:256
    s_add_u32 s57, s57, s60
    v_add_f32 v43, v43, v139
    s_waitcnt vmcnt(16)
    v_add_f32 v44, v44, v140
    v_add_f32 v45, v45, v141
    s_waitcnt vmcnt(15)
    v_add_f32_e64 v46, v46, v142
    v_mfma_f32_32x32x16_bf16 v[16:31], a[28:31], v[76:79], v[16:31]
    ds_read_b128 v[64:67], v134 offset:256
    s_waitcnt lgkmcnt(3)
    v_add_f32 v47, v47, v143
    v_add_f32 v32, v32, v40
    v_add_f32 v33, v33, v41
    v_add_f32_e64 v34, v34, v42
    v_mfma_f32_32x32x16_bf16 v[16:31], a[32:35], v[80:83], v[16:31]
    ds_read_b128 v[68:71], v135 offset:256
    s_add_u32 m0, s58, 69632
    v_add_f32 v35, v35, v43
    v_add_f32 v36, v36, v44
    v_add_f32_e64 v37, v37, v45
    v_mfma_f32_32x32x16_bf16 v[16:31], a[36:39], v[84:87], v[16:31]
    ds_read_b128 v[72:75], v128 offset:512
    buffer_load_dwordx4 v124, s[24:27], s57 offen offset:0 lds
    v_add_f32 v38, v38, v46
    v_add_f32 v39, v39, v47
    v_add_f32_e64 v32, v32, v36
    v_mfma_f32_32x32x16_bf16 v[16:31], a[40:43], v[48:51], v[16:31]
    ds_read_b128 v[76:79], v129 offset:512
    buffer_load_dwordx4 v125, s[24:27], s57 offen offset:1024 lds
    v_add_f32 v33, v33, v37
    v_add_f32 v34, v34, v38
    v_add_f32_e64 v35, v35, v39
    v_mfma_f32_32x32x16_bf16 v[16:31], a[44:47], v[52:55], v[16:31]
    ds_read_b128 v[80:83], v130 offset:512
    s_waitcnt lgkmcnt(3)
    buffer_load_dwordx4 v126, s[24:27], s57 offen offset:2048 lds
    v_add_f32 v32, v32, v34
    v_add_f32_e64 v33, v33, v35
    v_mfma_f32_32x32x16_bf16 v[16:31], a[48:51], v[56:59], v[16:31]
    ds_read_b128 v[84:87], v131 offset:512
    buffer_load_dwordx4 v127, s[24:27], s57 offen offset:3072 lds
    v_mul_f32 v32, 0xbb000000, v32
    v_mul_f32 v33, 0x3b000000, v33
    v_fma_f32 v34, -v32, v32, v33
    v_mfma_f32_32x32x16_bf16 v[16:31], a[52:55], v[60:63], v[16:31]
    ds_read_b128 v[48:51], v132 offset:512
    s_add_u32 s57, s57, s61
    v_add_f32 v34, 0x3727c5ac, v34
    v_rsq_f32_e64 v33, v34
    s_nop 0
    v_mul_f32 v33, 0xbfb8aa3b, v33
    ds_write_b128 v116, v[32:35]
    v_mfma_f32_32x32x16_bf16 v[16:31], a[56:59], v[64:67], v[16:31]
    ds_read_b128 v[52:55], v133 offset:512
    v_mfma_f32_32x32x16_bf16 v[16:31], a[60:63], v[68:71], v[16:31]
    ds_read_b128 v[56:59], v134 offset:512
    s_waitcnt lgkmcnt(4)
    s_waitcnt vmcnt(11)
    s_waitcnt lgkmcnt(0)
    s_barrier
    v_mfma_f32_32x32x16_bf16 v[16:31], a[64:67], v[72:75], v[16:31]
    ds_read_b128 v[60:63], v135 offset:512
    s_add_u32 m0, s58, 98304
    v_mfma_f32_32x32x16_bf16 v[16:31], a[68:71], v[76:79], v[16:31]
    ds_read_b128 v[64:67], v128 offset:768
    buffer_load_dwordx4 v120, s[24:27], s57 offen offset:0 lds
    v_mfma_f32_32x32x16_bf16 v[16:31], a[72:75], v[80:83], v[16:31]
    ds_read_b128 v[68:71], v129 offset:768
    buffer_load_dwordx4 v121, s[24:27], s57 offen offset:1024 lds
    v_mfma_f32_32x32x16_bf16 v[16:31], a[76:79], v[84:87], v[16:31]
    ds_read_b128 v[72:75], v130 offset:768
    s_waitcnt lgkmcnt(3)
    buffer_load_dwordx4 v122, s[24:27], s57 offen offset:2048 lds
    v_mfma_f32_32x32x16_bf16 v[16:31], a[80:83], v[48:51], v[16:31]
    ds_read_b128 v[76:79], v131 offset:768
    buffer_load_dwordx4 v123, s[24:27], s57 offen offset:3072 lds
    v_mfma_f32_32x32x16_bf16 v[16:31], a[84:87], v[52:55], v[16:31]
    ds_read_b128 v[80:83], v132 offset:768
    s_add_u32 s57, s57, s60
    v_mfma_f32_32x32x16_bf16 v[16:31], a[88:91], v[56:59], v[16:31]
    ds_read_b128 v[84:87], v133 offset:768
    v_mfma_f32_32x32x16_bf16 v[16:31], a[92:95], v[60:63], v[16:31]
    ds_read_b128 v[48:51], v134 offset:768
    s_waitcnt lgkmcnt(3)
    s_add_u32 m0, s58, 102400
    v_mfma_f32_32x32x16_bf16 v[16:31], a[96:99], v[64:67], v[16:31]
    ds_read_b128 v[52:55], v135 offset:768
    ds_read_b128 v[96:99], v115 offset:0
    buffer_load_dwordx4 v124, s[24:27], s57 offen offset:0 lds
    v_mfma_f32_32x32x16_bf16 v[16:31], a[100:103], v[68:71], v[16:31]
    ds_read_b128 v[56:59], v128 offset:32768
    buffer_load_dwordx4 v125, s[24:27], s57 offen offset:1024 lds
    v_mfma_f32_32x32x16_bf16 v[16:31], a[104:107], v[72:75], v[16:31]
    ds_read_b128 v[60:63], v129 offset:32768
    buffer_load_dwordx4 v126, s[24:27], s57 offen offset:2048 lds
    v_mfma_f32_32x32x16_bf16 v[16:31], a[108:111], v[76:79], v[16:31]
    ds_read_b128 v[64:67], v130 offset:32768
    s_waitcnt lgkmcnt(4)
    buffer_load_dwordx4 v127, s[24:27], s57 offen offset:3072 lds
    v_mfma_f32_32x32x16_bf16 v[16:31], a[112:115], v[80:83], v[16:31]
    ds_read_b128 v[68:71], v131 offset:32768
    s_add_u32 s57, s57, s61
    v_mfma_f32_32x32x16_bf16 v[16:31], a[116:119], v[84:87], v[16:31]
    ds_read_b128 v[72:75], v132 offset:32768
    v_mfma_f32_32x32x16_bf16 v[16:31], a[120:123], v[48:51], v[16:31]
    ds_read_b128 v[76:79], v133 offset:32768
    v_mfma_f32_32x32x16_bf16 v[16:31], a[124:127], v[52:55], v[16:31]
    ds_read_b128 v[80:83], v134 offset:32768
    s_waitcnt lgkmcnt(3)
    s_waitcnt vmcnt(18)
    buffer_load_dword v90, v114, s[24:27], s51 offen
    s_add_u32 s51, s51, s62
    v_mfma_f32_32x32x16_bf16 v[32:47], a[0:3], v[56:59], 0
    ds_read_b128 v[84:87], v135 offset:32768
    v_mfma_f32_32x32x16_bf16 v[32:47], a[4:7], v[60:63], v[32:47]
    ds_read_b128 v[48:51], v128 offset:33024
    v_mfma_f32_32x32x16_bf16 v[32:47], a[8:11], v[64:67], v[32:47]
    ds_read_b128 v[52:55], v129 offset:33024
    v_mfma_f32_32x32x16_bf16 v[32:47], a[12:15], v[68:71], v[32:47]
    ds_read_b128 v[56:59], v130 offset:33024
    s_waitcnt lgkmcnt(3)
    v_fmac_f32 v16, v96, v144
    v_fmac_f32 v17, v96, v145
    v_fmac_f32 v18, v96, v146
    v_fmac_f32_e64 v19, v96, v147
    v_mfma_f32_32x32x16_bf16 v[32:47], a[16:19], v[72:75], v[32:47]
    ds_read_b128 v[60:63], v131 offset:33024
    v_fmac_f32 v20, v96, v148
    v_fmac_f32 v21, v96, v149
    v_fmac_f32 v22, v96, v150
    v_fmac_f32 v23, v96, v151
    v_mul_f32_e64 v104, v16, v97
    v_mfma_f32_32x32x16_bf16 v[32:47], a[20:23], v[76:79], v[32:47]
    ds_read_b128 v[64:67], v132 offset:33024
    v_mul_f32 v105, v17, v97
    v_mul_f32 v106, v18, v97
    v_mul_f32 v107, v19, v97
    v_mul_f32 v108, v20, v97
    v_mfma_f32_32x32x16_bf16 v[32:47], a[24:27], v[80:83], v[32:47]
    ds_read_b128 v[68:71], v133 offset:33024
    v_mul_f32 v109, v21, v97
    v_mul_f32 v110, v22, v97
    v_mul_f32 v111, v23, v97
    v_fmac_f32 v24, v96, v152
    v_mfma_f32_32x32x16_bf16 v[32:47], a[28:31], v[84:87], v[32:47]
    ds_read_b128 v[72:75], v134 offset:33024
    s_waitcnt lgkmcnt(3)
    v_fmac_f32 v25, v96, v153
    v_fmac_f32 v26, v96, v154
    v_fmac_f32 v27, v96, v155
    v_fmac_f32_e64 v28, v96, v156
    v_mfma_f32_32x32x16_bf16 v[32:47], a[32:35], v[48:51], v[32:47]
    ds_read_b128 v[76:79], v135 offset:33024
    ds_read_b128 v[140:143], v115 offset:512
    v_fmac_f32 v29, v96, v157
    v_fmac_f32 v30, v96, v158
    v_fmac_f32_e64 v31, v96, v159
    v_mfma_f32_32x32x16_bf16 v[32:47], a[36:39], v[52:55], v[32:47]
    ds_read_b128 v[80:83], v128 offset:33280
    v_exp_f32 v104, v104
    v_mul_f32 v16, v16, v24
    v_mfma_f32_32x32x16_bf16 v[32:47], a[40:43], v[56:59], v[32:47]
    ds_read_b128 v[84:87], v129 offset:33280
    v_exp_f32 v105, v105
    v_mul_f32 v17, v17, v25
    v_exp_f32_e64 v106, v106
    v_mfma_f32_32x32x16_bf16 v[32:47], a[44:47], v[60:63], v[32:47]
    ds_read_b128 v[48:51], v130 offset:33280
    s_waitcnt lgkmcnt(4)
    v_mul_f32 v18, v18, v26
    v_exp_f32 v107, v107
    v_mul_f32 v19, v19, v27
    v_mfma_f32_32x32x16_bf16 v[32:47], a[48:51], v[64:67], v[32:47]
    ds_read_b128 v[52:55], v131 offset:33280
    v_exp_f32 v108, v108
    v_mul_f32 v20, v20, v28
    v_mfma_f32_32x32x16_bf16 v[32:47], a[52:55], v[68:71], v[32:47]
    ds_read_b128 v[56:59], v132 offset:33280
    v_exp_f32 v109, v109
    v_mul_f32 v21, v21, v29
    v_mfma_f32_32x32x16_bf16 v[32:47], a[56:59], v[72:75], v[32:47]
    ds_read_b128 v[60:63], v133 offset:33280
    v_exp_f32 v110, v110
    v_mul_f32 v22, v22, v30
    v_exp_f32_e64 v111, v111
    v_mfma_f32_32x32x16_bf16 v[32:47], a[60:63], v[76:79], v[32:47]
    ds_read_b128 v[64:67], v134 offset:33280
    s_waitcnt lgkmcnt(3)
    s_waitcnt vmcnt(9)
    s_barrier
    v_mul_f32 v23, v23, v31
    v_mfma_f32_32x32x16_bf16 v[32:47], a[64:67], v[80:83], v[32:47]
    ds_read_b128 v[68:71], v135 offset:33280
    s_add_u32 m0, s58, 0
    v_fma_f32 v104, v104, v98, v98
    v_fma_f32 v105, v105, v98, v98
    v_fma_f32 v106, v106, v98, v98
    v_fma_f32 v107, v107, v98, v98
    v_mfma_f32_32x32x16_bf16 v[32:47], a[68:71], v[84:87], v[32:47]
    ds_read_b128 v[72:75], v128 offset:33536
    buffer_load_dwordx4 v120, s[24:27], s57 offen offset:0 lds
    v_fma_f32 v108, v108, v98, v98
    v_fma_f32 v109, v109, v98, v98
    v_fma_f32 v110, v110, v98, v98
    v_mfma_f32_32x32x16_bf16 v[32:47], a[72:75], v[48:51], v[32:47]
    ds_read_b128 v[76:79], v129 offset:33536
    buffer_load_dwordx4 v121, s[24:27], s57 offen offset:1024 lds
    v_fma_f32 v111, v111, v98, v98
    v_rcp_f32 v104, v104
    v_mfma_f32_32x32x16_bf16 v[32:47], a[76:79], v[52:55], v[32:47]
    ds_read_b128 v[80:83], v130 offset:33536
    s_waitcnt lgkmcnt(3)
    buffer_load_dwordx4 v122, s[24:27], s57 offen offset:2048 lds
    v_rcp_f32 v105, v105
    v_mfma_f32_32x32x16_bf16 v[32:47], a[80:83], v[56:59], v[32:47]
    ds_read_b128 v[84:87], v131 offset:33536
    buffer_load_dwordx2 v[88:89], v118, s[24:27], 0 offen sc1
    buffer_load_dwordx4 v123, s[24:27], s57 offen offset:3072 lds
    v_mul_f32 v16, v16, v104
    v_rcp_f32 v106, v106
    v_mfma_f32_32x32x16_bf16 v[32:47], a[84:87], v[60:63], v[32:47]
    ds_read_b128 v[48:51], v132 offset:33536
    s_add_u32 s57, s57, s60
    v_mul_f32 v17, v17, v105
    v_rcp_f32_e64 v107, v107
    v_mfma_f32_32x32x16_bf16 v[32:47], a[88:91], v[64:67], v[32:47]
    ds_read_b128 v[52:55], v133 offset:33536
    v_mul_f32 v18, v18, v106
    v_rcp_f32 v108, v108
    v_mul_f32_e64 v19, v19, v107
    v_mfma_f32_32x32x16_bf16 v[32:47], a[92:95], v[68:71], v[32:47]
    ds_read_b128 v[56:59], v134 offset:33536
    s_waitcnt lgkmcnt(3)
    s_add_u32 m0, s58, 4096
    v_rcp_f32 v109, v109
    v_mfma_f32_32x32x16_bf16 v[32:47], a[96:99], v[72:75], v[32:47]
    ds_read_b128 v[60:63], v135 offset:33536
    buffer_load_dwordx4 v124, s[24:27], s57 offen offset:0 lds
    v_add_u32 v128, 65536, v128
    v_add_u32 v129, 65536, v129
    v_add_u32 v130, 65536, v130
    v_add_u32 v131, 65536, v131
    v_add_u32 v132, 65536, v132
    v_add_u32 v133, 65536, v133
    v_add_u32 v134, 65536, v134
    v_add_u32 v135, 65536, v135
    v_mfma_f32_32x32x16_bf16 v[32:47], a[100:103], v[76:79], v[32:47]
    ds_read_b128 v[64:67], v128 offset:0
    buffer_load_dwordx4 v125, s[24:27], s57 offen offset:1024 lds
    v_mul_f32_e64 v20, v20, v108
    v_mfma_f32_32x32x16_bf16 v[32:47], a[104:107], v[80:83], v[32:47]
    ds_read_b128 v[68:71], v129 offset:0
    buffer_load_dwordx4 v126, s[24:27], s57 offen offset:2048 lds
    v_rcp_f32 v110, v110
    v_mul_f32 v21, v21, v109
    v_mfma_f32_32x32x16_bf16 v[32:47], a[108:111], v[84:87], v[32:47]
    ds_read_b128 v[72:75], v130 offset:0
    s_waitcnt lgkmcnt(3)
    buffer_load_dwordx4 v127, s[24:27], s57 offen offset:3072 lds
    v_rcp_f32 v111, v111
    v_mfma_f32_32x32x16_bf16 v[32:47], a[112:115], v[48:51], v[32:47]
    ds_read_b128 v[76:79], v131 offset:0
    s_add_u32 s57, s57, s61
    v_mul_f32 v22, v22, v110
    v_mul_f32_e64 v23, v23, v111
    v_cvt_pk_bf16_f32 v100, v16, v17
    v_mfma_f32_32x32x16_bf16 v[32:47], a[116:119], v[52:55], v[32:47]
    ds_read_b128 v[80:83], v132 offset:0
    v_cvt_pk_bf16_f32 v101, v18, v19
    v_cvt_pk_bf16_f32 v102, v20, v21
    v_cvt_pk_bf16_f32 v103, v22, v23
    v_mfma_f32_32x32x16_bf16 v[32:47], a[120:123], v[56:59], v[32:47]
    ds_read_b128 v[84:87], v133 offset:0
    v_mfma_f32_32x32x16_bf16 v[32:47], a[124:127], v[60:63], v[32:47]
    ds_read_b128 v[48:51], v134 offset:0
    s_waitcnt lgkmcnt(3)
    buffer_load_dword v91, v114, s[24:27], s51 offen
    s_add_u32 s51, s51, s62
    s_waitcnt vmcnt(6)
    s_add_u32 s40, s32, 1
    v_subrev_u32 v2, s40, v88
    v_cmp_gt_u32 vcc, 64, v2
    v_cmp_eq_u32 s[42:43], s33, v89
    s_nop 0
    s_and_b64 vcc, vcc, s[42:43]
    s_and_b32 s42, vcc_lo, 0x1
    s_cmp_eq_u32 s42, 0x1
    s_nop 0
    s_cbranch_scc1 L_ac_22
    s_add_u32 s40, s32, 1
    s_mov_b32 exec_lo, 0x1
    s_mov_b32 exec_hi, 0
    s_mov_b32 s98, 0
    v_mov_b32 v2, 0
    v_mov_b32_e64 v3, 0
    s_nop 1
L_poll_23:
    buffer_load_dwordx2 v[2:3], v118, s[24:27], 0 offen sc1
    s_add_u32 s98, s98, 1
    s_cmp_gt_u32 s98, 0x40000
    s_cbranch_scc1 L_pd_24
    s_waitcnt vmcnt(0)
    v_subrev_u32_e64 v2, s40, v2
    v_cmp_gt_u32 vcc, 64, v2
    v_cmp_eq_u32 s[42:43], s33, v3
    s_nop 1
    s_and_b64 vcc, vcc, s[42:43]
    s_cmp_eq_u64 vcc, exec
    s_cbranch_scc1 L_pd_24
    s_sleep 2
    s_branch L_poll_23
L_pd_24:
    s_waitcnt vmcnt(0)
    s_mov_b64 exec, -1
L_ac_22:
    v_mfma_f32_32x32x16_bf16 v[16:31], a[0:3], v[64:67], 0
    ds_read_b128 v[52:55], v135 offset:0
    v_mfma_f32_32x32x16_bf16 v[16:31], a[4:7], v[68:71], v[16:31]
    ds_read_b128 v[56:59], v128 offset:256
    ds_write_b128 v112, v[100:103] offset:0
    v_mfma_f32_32x32x16_bf16 v[16:31], a[8:11], v[72:75], v[16:31]
    ds_read_b128 v[60:63], v129 offset:256
    v_mfma_f32_32x32x16_bf16 v[16:31], a[12:15], v[76:79], v[16:31]
    ds_read_b128 v[64:67], v130 offset:256
    s_waitcnt lgkmcnt(4)
    v_fmac_f32 v32, v140, v144
    v_fmac_f32 v33, v140, v145
    v_fmac_f32 v34, v140, v146
    v_fmac_f32_e64 v35, v140, v147
    v_mfma_f32_32x32x16_bf16 v[16:31], a[16:19], v[80:83], v[16:31]
    ds_read_b128 v[68:71], v131 offset:256
    v_fmac_f32 v36, v140, v148
    v_fmac_f32 v37, v140, v149
    v_fmac_f32 v38, v140, v150
    v_fmac_f32 v39, v140, v151
    v_mul_f32_e64 v104, v32, v141
    v_mfma_f32_32x32x16_bf16 v[16:31], a[20:23], v[84:87], v[16:31]
    ds_read_b128 v[72:75], v132 offset:256
    v_mul_f32 v105, v33, v141
    v_mul_f32 v106, v34, v141
    v_mul_f32 v107, v35, v141
    v_mul_f32 v108, v36, v141
    v_mul_f32_e64 v109, v37, v141
    v_mfma_f32_32x32x16_bf16 v[16:31], a[24:27], v[48:51], v[16:31]
    ds_read_b128 v[76:79], v133 offset:256
    v_mul_f32 v110, v38, v141
    v_mul_f32 v111, v39, v141
    v_fmac_f32 v40, v140, v152
    v_fmac_f32 v41, v140, v153
    v_fmac_f32_e64 v42, v140, v154
    v_mfma_f32_32x32x16_bf16 v[16:31], a[28:31], v[52:55], v[16:31]
    ds_read_b128 v[80:83], v134 offset:256
    s_waitcnt lgkmcnt(3)
    v_fmac_f32 v43, v140, v155
    v_fmac_f32 v44, v140, v156
    v_fmac_f32 v45, v140, v157
    v_fmac_f32_e64 v46, v140, v158
    v_mfma_f32_32x32x16_bf16 v[16:31], a[32:35], v[56:59], v[16:31]
    ds_read_b128 v[84:87], v135 offset:256
    ds_read_b128 v[96:99], v115 offset:1024
    v_fmac_f32 v47, v140, v159
    v_exp_f32 v104, v104
    v_mul_f32_e64 v32, v32, v40
    v_mfma_f32_32x32x16_bf16 v[16:31], a[36:39], v[60:63], v[16:31]
    ds_read_b128 v[48:51], v128 offset:512
    v_exp_f32 v105, v105
    v_mul_f32 v33, v33, v41
    v_exp_f32_e64 v106, v106
    v_mfma_f32_32x32x16_bf16 v[16:31], a[40:43], v[64:67], v[16:31]
    ds_read_b128 v[52:55], v129 offset:512
    v_mul_f32 v34, v34, v42
    v_exp_f32 v107, v107
    v_mul_f32_e64 v35, v35, v43
    v_mfma_f32_32x32x16_bf16 v[16:31], a[44:47], v[68:71], v[16:31]
    ds_read_b128 v[56:59], v130 offset:512
    s_waitcnt lgkmcnt(4)
    v_exp_f32 v108, v108
    v_mul_f32_e64 v36, v36, v44
    v_mfma_f32_32x32x16_bf16 v[16:31], a[48:51], v[72:75], v[16:31]
    ds_read_b128 v[60:63], v131 offset:512
    v_exp_f32 v109, v109
    v_mul_f32 v37, v37, v45
    v_exp_f32_e64 v110, v110
    v_mfma_f32_32x32x16_bf16 v[16:31], a[52:55], v[76:79], v[16:31]
    ds_read_b128 v[64:67], v132 offset:512
    v_mul_f32 v38, v38, v46
    v_exp_f32 v111, v111
    v_mul_f32_e64 v39, v39, v47
    v_fma_f32 v104, v104, v142, v142
    v_mfma_f32_32x32x16_bf16 v[16:31], a[56:59], v[80:83], v[16:31]
    ds_read_b128 v[68:71], v133 offset:512
    v_fma_f32 v105, v105, v142, v142
    v_fma_f32 v106, v106, v142, v142
    v_fma_f32 v107, v107, v142, v142
    v_fma_f32 v108, v108, v142, v142
    v_fma_f32 v109, v109, v142, v142
    v_mfma_f32_32x32x16_bf16 v[16:31], a[60:63], v[84:87], v[16:31]
    ds_read_b128 v[72:75], v134 offset:512
    s_waitcnt lgkmcnt(3)
    s_barrier
    ds_read_b128 v[92:95], v113 offset:0
    v_fma_f32 v110, v110, v142, v142
    v_mfma_f32_32x32x16_bf16 v[16:31], a[64:67], v[48:51], v[16:31]
    ds_read_b128 v[76:79], v135 offset:512
    s_add_u32 m0, s58, 32768
    s_nop 0
    buffer_load_dwordx4 v120, s[24:27], s57 offen offset:0 lds
    v_fma_f32 v111, v111, v142, v142
    v_mfma_f32_32x32x16_bf16 v[16:31], a[68:71], v[52:55], v[16:31]
    ds_read_b128 v[80:83], v128 offset:768
    buffer_load_dwordx4 v121, s[24:27], s57 offen offset:1024 lds
    buffer_load_dwordx4 v122, s[24:27], s57 offen offset:2048 lds
    v_mfma_f32_32x32x16_bf16 v[16:31], a[72:75], v[56:59], v[16:31]
    ds_read_b128 v[84:87], v129 offset:768
    buffer_load_dwordx4 v123, s[24:27], s57 offen offset:3072 lds
    s_add_u32 s57, s57, s60
    v_rcp_f32_e64 v104, v104
    v_mfma_f32_32x32x16_bf16 v[16:31], a[76:79], v[60:63], v[16:31]
    ds_read_b128 v[48:51], v130 offset:768
    s_waitcnt lgkmcnt(3)
    s_add_u32 m0, s58, 36864
    v_rcp_f32 v105, v105
    v_mul_f32_e64 v32, v32, v104
    v_mfma_f32_32x32x16_bf16 v[16:31], a[80:83], v[64:67], v[16:31]
    ds_read_b128 v[52:55], v131 offset:768
    buffer_load_dwordx4 v124, s[24:27], s57 offen offset:0 lds
    buffer_load_dwordx4 v125, s[24:27], s57 offen offset:1024 lds
    v_mfma_f32_32x32x16_bf16 v[16:31], a[84:87], v[68:71], v[16:31]
    ds_read_b128 v[56:59], v132 offset:768
    buffer_load_dwordx4 v126, s[24:27], s57 offen offset:2048 lds
    buffer_load_dwordx4 v127, s[24:27], s57 offen offset:3072 lds
    v_mfma_f32_32x32x16_bf16 v[16:31], a[88:91], v[72:75], v[16:31]
    ds_read_b128 v[60:63], v133 offset:768
    s_add_u32 s57, s57, s61
    v_rcp_f32 v106, v106
    v_mul_f32_e64 v33, v33, v105
    v_mfma_f32_32x32x16_bf16 v[16:31], a[92:95], v[76:79], v[16:31]
    ds_read_b128 v[64:67], v134 offset:768
    s_waitcnt lgkmcnt(3)
    buffer_load_dwordx4 a[128:131], v117, s[24:27], s63 offen offset:0
    buffer_load_dwordx4 a[132:135], v117, s[24:27], s63 offen offset:1024
    v_mfma_f32_32x32x16_bf16 v[16:31], a[96:99], v[80:83], v[16:31]
    ds_read_b128 v[68:71], v135 offset:768
    buffer_load_dwordx4 a[136:139], v117, s[24:27], s63 offen offset:2048
    buffer_load_dwordx4 a[140:143], v117, s[24:27], s63 offen offset:3072
    v_mfma_f32_32x32x16_bf16 v[16:31], a[100:103], v[84:87], v[16:31]
    ds_read_b128 v[72:75], v128 offset:32768
    s_add_u32 s63, s63, 4096
    buffer_load_dwordx4 a[144:147], v117, s[24:27], s63 offen offset:0
    v_rcp_f32 v107, v107
    v_mfma_f32_32x32x16_bf16 v[16:31], a[104:107], v[48:51], v[16:31]
    ds_read_b128 v[76:79], v129 offset:32768
    buffer_load_dwordx4 a[148:151], v117, s[24:27], s63 offen offset:1024
    v_mul_f32 v34, v34, v106
    v_rcp_f32 v108, v108
    v_mfma_f32_32x32x16_bf16 v[16:31], a[108:111], v[52:55], v[16:31]
    ds_read_b128 v[80:83], v130 offset:32768
    s_waitcnt lgkmcnt(3)
    buffer_load_dwordx4 a[152:155], v117, s[24:27], s63 offen offset:2048
    buffer_load_dwordx4 a[156:159], v117, s[24:27], s63 offen offset:3072
    v_mfma_f32_32x32x16_bf16 v[16:31], a[112:115], v[56:59], v[16:31]
    ds_read_b128 v[84:87], v131 offset:32768
    s_add_u32 s63, s63, 4096
    buffer_load_dwordx4 a[160:163], v117, s[24:27], s63 offen offset:0
    v_mul_f32 v35, v35, v107
    v_mfma_f32_32x32x16_bf16 v[16:31], a[116:119], v[60:63], v[16:31]
    ds_read_b128 v[48:51], v132 offset:32768
    buffer_load_dwordx4 a[164:167], v117, s[24:27], s63 offen offset:1024
    v_rcp_f32 v109, v109
    v_mul_f32 v36, v36, v108
    v_mfma_f32_32x32x16_bf16 v[16:31], a[120:123], v[64:67], v[16:31]
    ds_read_b128 v[52:55], v133 offset:32768
    buffer_store_dwordx4 v[92:95], v114, s[24:27], s59 offen
    s_add_u32 s59, s59, s62
    v_mfma_f32_32x32x16_bf16 v[16:31], a[124:127], v[68:71], v[16:31]
    ds_read_b128 v[56:59], v134 offset:32768
    s_waitcnt lgkmcnt(3)
    buffer_load_dword v90, v114, s[24:27], s51 offen
    s_add_u32 s51, s51, s62
    v_rcp_f32 v110, v110
    v_mul_f32 v37, v37, v109
    v_rcp_f32 v111, v111
    v_mul_f32 v38, v38, v110
    v_mul_f32 v39, v39, v111
    v_cvt_pk_bf16_f32 v100, v32, v33
    v_cvt_pk_bf16_f32 v101, v34, v35
    v_cvt_pk_bf16_f32 v102, v36, v37
    v_cvt_pk_bf16_f32 v103, v38, v39
    v_mfma_f32_32x32x16_bf16 v[32:47], a[0:3], v[72:75], 0
    ds_read_b128 v[60:63], v135 offset:32768
    v_mfma_f32_32x32x16_bf16 v[32:47], a[4:7], v[76:79], v[32:47]
    ds_read_b128 v[64:67], v128 offset:33024
    ds_write_b128 v112, v[100:103] offset:4096
    v_mfma_f32_32x32x16_bf16 v[32:47], a[8:11], v[80:83], v[32:47]
    ds_read_b128 v[68:71], v129 offset:33024
    v_mfma_f32_32x32x16_bf16 v[32:47], a[12:15], v[84:87], v[32:47]
    ds_read_b128 v[72:75], v130 offset:33024
    s_waitcnt lgkmcnt(4)
    v_fmac_f32 v16, v96, v144
    v_fmac_f32 v17, v96, v145
    v_fmac_f32 v18, v96, v146
    v_fmac_f32_e64 v19, v96, v147
    v_mfma_f32_32x32x16_bf16 v[32:47], a[16:19], v[48:51], v[32:47]
    ds_read_b128 v[76:79], v131 offset:33024
    v_fmac_f32 v20, v96, v148
    v_fmac_f32 v21, v96, v149
    v_fmac_f32 v22, v96, v150
    v_fmac_f32 v23, v96, v151
    v_mul_f32_e64 v104, v16, v97
    v_mfma_f32_32x32x16_bf16 v[32:47], a[20:23], v[52:55], v[32:47]
    ds_read_b128 v[80:83], v132 offset:33024
    v_mul_f32 v105, v17, v97
    v_mul_f32 v106, v18, v97
    v_mul_f32 v107, v19, v97
    v_mul_f32 v108, v20, v97
    v_mul_f32_e64 v109, v21, v97
    v_mfma_f32_32x32x16_bf16 v[32:47], a[24:27], v[56:59], v[32:47]
    ds_read_b128 v[84:87], v133 offset:33024
    v_mul_f32 v110, v22, v97
    v_mul_f32 v111, v23, v97
    v_fmac_f32 v24, v96, v152
    v_fmac_f32 v25, v96, v153
    v_fmac_f32_e64 v26, v96, v154
    v_mfma_f32_32x32x16_bf16 v[32:47], a[28:31], v[60:63], v[32:47]
    ds_read_b128 v[48:51], v134 offset:33024
    s_waitcnt lgkmcnt(3)
    v_fmac_f32 v27, v96, v155
    v_fmac_f32 v28, v96, v156
    v_fmac_f32 v29, v96, v157
    v_fmac_f32_e64 v30, v96, v158
    v_mfma_f32_32x32x16_bf16 v[32:47], a[32:35], v[64:67], v[32:47]
    ds_read_b128 v[52:55], v135 offset:33024
    ds_read_b128 v[140:143], v115 offset:1536
    v_fmac_f32 v31, v96, v159
    v_exp_f32 v104, v104
    v_mul_f32_e64 v16, v16, v24
    v_mfma_f32_32x32x16_bf16 v[32:47], a[36:39], v[68:71], v[32:47]
    ds_read_b128 v[56:59], v128 offset:33280
    v_exp_f32 v105, v105
    v_mul_f32 v17, v17, v25
    v_exp_f32_e64 v106, v106
    v_mfma_f32_32x32x16_bf16 v[32:47], a[40:43], v[72:75], v[32:47]
    ds_read_b128 v[60:63], v129 offset:33280
    v_mul_f32 v18, v18, v26
    v_exp_f32 v107, v107
    v_mul_f32_e64 v19, v19, v27
    v_mfma_f32_32x32x16_bf16 v[32:47], a[44:47], v[76:79], v[32:47]
    ds_read_b128 v[64:67], v130 offset:33280
    s_waitcnt lgkmcnt(4)
    v_exp_f32 v108, v108
    v_mul_f32_e64 v20, v20, v28
    v_mfma_f32_32x32x16_bf16 v[32:47], a[48:51], v[80:83], v[32:47]
    ds_read_b128 v[68:71], v131 offset:33280
    v_exp_f32 v109, v109
    v_mul_f32 v21, v21, v29
    v_exp_f32_e64 v110, v110
    v_mfma_f32_32x32x16_bf16 v[32:47], a[52:55], v[84:87], v[32:47]
    ds_read_b128 v[72:75], v132 offset:33280
    v_mul_f32 v22, v22, v30
    v_exp_f32 v111, v111
    v_mul_f32_e64 v23, v23, v31
    v_fma_f32 v104, v104, v98, v98
    v_mfma_f32_32x32x16_bf16 v[32:47], a[56:59], v[48:51], v[32:47]
    ds_read_b128 v[76:79], v133 offset:33280
    v_fma_f32 v105, v105, v98, v98
    v_fma_f32 v106, v106, v98, v98
    v_fma_f32 v107, v107, v98, v98
    v_fma_f32 v108, v108, v98, v98
    v_fma_f32 v109, v109, v98, v98
    v_mfma_f32_32x32x16_bf16 v[32:47], a[60:63], v[52:55], v[32:47]
    ds_read_b128 v[80:83], v134 offset:33280
    s_waitcnt lgkmcnt(3)
    s_waitcnt vmcnt(21)
    s_barrier
    ds_read_b128 v[92:95], v113 offset:4096
    v_fma_f32 v110, v110, v98, v98
    v_mfma_f32_32x32x16_bf16 v[32:47], a[64:67], v[56:59], v[32:47]
    ds_read_b128 v[84:87], v135 offset:33280
    s_add_u32 m0, s58, 65536
    s_nop 0
    buffer_load_dwordx4 v120, s[24:27], s57 offen offset:0 lds
    v_fma_f32 v111, v111, v98, v98
    v_mfma_f32_32x32x16_bf16 v[32:47], a[68:71], v[60:63], v[32:47]
    ds_read_b128 v[48:51], v128 offset:33536
    buffer_load_dwordx4 v121, s[24:27], s57 offen offset:1024 lds
    buffer_load_dwordx4 v122, s[24:27], s57 offen offset:2048 lds
    v_mfma_f32_32x32x16_bf16 v[32:47], a[72:75], v[64:67], v[32:47]
    ds_read_b128 v[52:55], v129 offset:33536
    buffer_load_dwordx4 v123, s[24:27], s57 offen offset:3072 lds
    s_add_u32 s57, s57, s60
    v_rcp_f32 v104, v104
    v_mfma_f32_32x32x16_bf16 v[32:47], a[76:79], v[68:71], v[32:47]
    ds_read_b128 v[56:59], v130 offset:33536
    s_waitcnt lgkmcnt(3)
    s_add_u32 m0, s58, 69632
    v_rcp_f32 v105, v105
    v_mul_f32_e64 v16, v16, v104
    v_mfma_f32_32x32x16_bf16 v[32:47], a[80:83], v[72:75], v[32:47]
    ds_read_b128 v[60:63], v131 offset:33536
    buffer_load_dwordx4 v124, s[24:27], s57 offen offset:0 lds
    buffer_load_dwordx4 v125, s[24:27], s57 offen offset:1024 lds
    v_mfma_f32_32x32x16_bf16 v[32:47], a[84:87], v[76:79], v[32:47]
    ds_read_b128 v[64:67], v132 offset:33536
    buffer_load_dwordx4 v126, s[24:27], s57 offen offset:2048 lds
    buffer_load_dwordx4 v127, s[24:27], s57 offen offset:3072 lds
    v_mfma_f32_32x32x16_bf16 v[32:47], a[88:91], v[80:83], v[32:47]
    ds_read_b128 v[68:71], v133 offset:33536
    s_add_u32 s57, s57, s61
    v_rcp_f32 v106, v106
    v_mul_f32_e64 v17, v17, v105
    v_mfma_f32_32x32x16_bf16 v[32:47], a[92:95], v[84:87], v[32:47]
    ds_read_b128 v[72:75], v134 offset:33536
    s_waitcnt lgkmcnt(3)
    buffer_load_dwordx4 a[168:171], v117, s[24:27], s63 offen offset:2048
    buffer_load_dwordx4 a[172:175], v117, s[24:27], s63 offen offset:3072
    v_mfma_f32_32x32x16_bf16 v[32:47], a[96:99], v[48:51], v[32:47]
    ds_read_b128 v[76:79], v135 offset:33536
    s_add_u32 s63, s63, 4096
    buffer_load_dwordx4 a[176:179], v117, s[24:27], s63 offen offset:0
    v_add_u32 v128, 4294901760, v128
    v_add_u32 v129, 4294901760, v129
    v_add_u32 v130, 4294901760, v130
    v_add_u32 v131, 4294901760, v131
    v_add_u32 v132, 4294901760, v132
    v_add_u32 v133, 4294901760, v133
    v_add_u32 v134, 4294901760, v134
    v_add_u32 v135, 4294901760, v135
    v_mfma_f32_32x32x16_bf16 v[32:47], a[100:103], v[52:55], v[32:47]
    ds_read_b128 v[80:83], v128 offset:0
    buffer_load_dwordx4 a[180:183], v117, s[24:27], s63 offen offset:1024
    buffer_load_dwordx4 a[184:187], v117, s[24:27], s63 offen offset:2048
    v_mfma_f32_32x32x16_bf16 v[32:47], a[104:107], v[56:59], v[32:47]
    ds_read_b128 v[84:87], v129 offset:0
    buffer_load_dwordx4 a[188:191], v117, s[24:27], s63 offen offset:3072
    v_rcp_f32 v107, v107
    v_mul_f32_e64 v18, v18, v106
    v_mfma_f32_32x32x16_bf16 v[32:47], a[108:111], v[60:63], v[32:47]
    ds_read_b128 v[48:51], v130 offset:0
    s_waitcnt lgkmcnt(3)
    s_add_u32 s63, s63, 4096
    buffer_load_dwordx4 a[192:195], v117, s[24:27], s63 offen offset:0
    v_mfma_f32_32x32x16_bf16 v[32:47], a[112:115], v[64:67], v[32:47]
    ds_read_b128 v[52:55], v131 offset:0
    buffer_load_dwordx4 a[196:199], v117, s[24:27], s63 offen offset:1024
    buffer_load_dwordx4 a[200:203], v117, s[24:27], s63 offen offset:2048
    v_mfma_f32_32x32x16_bf16 v[32:47], a[116:119], v[68:71], v[32:47]
    ds_read_b128 v[56:59], v132 offset:0
    buffer_load_dwordx4 a[204:207], v117, s[24:27], s63 offen offset:3072
    v_rcp_f32 v108, v108
    v_mul_f32_e64 v19, v19, v107
    v_mfma_f32_32x32x16_bf16 v[32:47], a[120:123], v[72:75], v[32:47]
    ds_read_b128 v[60:63], v133 offset:0
    buffer_store_dwordx4 v[92:95], v114, s[24:27], s59 offen
    s_add_u32 s59, s59, s62
    v_mfma_f32_32x32x16_bf16 v[32:47], a[124:127], v[76:79], v[32:47]
    ds_read_b128 v[64:67], v134 offset:0
    s_waitcnt lgkmcnt(3)
    s_waitcnt vmcnt(39)
    buffer_load_dword v91, v114, s[24:27], s51 offen
    s_add_u32 s51, s51, s62
    v_rcp_f32 v109, v109
    v_mul_f32 v20, v20, v108
    v_rcp_f32 v110, v110
    v_mul_f32 v21, v21, v109
    v_rcp_f32 v111, v111
    v_mul_f32 v22, v22, v110
    v_mul_f32_e64 v23, v23, v111
    v_cvt_pk_bf16_f32 v100, v16, v17
    v_cvt_pk_bf16_f32 v101, v18, v19
    v_cvt_pk_bf16_f32 v102, v20, v21
    v_cvt_pk_bf16_f32 v103, v22, v23
    v_mfma_f32_32x32x16_bf16 v[16:31], a[0:3], v[80:83], 0
    ds_read_b128 v[68:71], v135 offset:0
    v_mfma_f32_32x32x16_bf16 v[16:31], a[4:7], v[84:87], v[16:31]
    ds_read_b128 v[72:75], v128 offset:256
    ds_write_b128 v112, v[100:103] offset:0
    v_mfma_f32_32x32x16_bf16 v[16:31], a[8:11], v[48:51], v[16:31]
    ds_read_b128 v[76:79], v129 offset:256
    v_mfma_f32_32x32x16_bf16 v[16:31], a[12:15], v[52:55], v[16:31]
    ds_read_b128 v[80:83], v130 offset:256
    s_waitcnt lgkmcnt(4)
    v_fmac_f32 v32, v140, v144
    v_fmac_f32 v33, v140, v145
    v_fmac_f32 v34, v140, v146
    v_fmac_f32_e64 v35, v140, v147
    v_mfma_f32_32x32x16_bf16 v[16:31], a[16:19], v[56:59], v[16:31]
    ds_read_b128 v[84:87], v131 offset:256
    v_fmac_f32 v36, v140, v148
    v_fmac_f32 v37, v140, v149
    v_fmac_f32 v38, v140, v150
    v_fmac_f32 v39, v140, v151
    v_mul_f32_e64 v104, v32, v141
    v_mfma_f32_32x32x16_bf16 v[16:31], a[20:23], v[60:63], v[16:31]
    ds_read_b128 v[48:51], v132 offset:256
    v_mul_f32 v105, v33, v141
    v_mul_f32 v106, v34, v141
    v_mul_f32 v107, v35, v141
    v_mul_f32 v108, v36, v141
    v_mul_f32_e64 v109, v37, v141
    v_mfma_f32_32x32x16_bf16 v[16:31], a[24:27], v[64:67], v[16:31]
    ds_read_b128 v[52:55], v133 offset:256
    v_mul_f32 v110, v38, v141
    v_mul_f32 v111, v39, v141
    v_fmac_f32 v40, v140, v152
    v_fmac_f32 v41, v140, v153
    v_fmac_f32_e64 v42, v140, v154
    v_mfma_f32_32x32x16_bf16 v[16:31], a[28:31], v[68:71], v[16:31]
    ds_read_b128 v[56:59], v134 offset:256
    s_waitcnt lgkmcnt(3)
    v_fmac_f32 v43, v140, v155
    v_fmac_f32 v44, v140, v156
    v_fmac_f32 v45, v140, v157
    v_fmac_f32_e64 v46, v140, v158
    v_mfma_f32_32x32x16_bf16 v[16:31], a[32:35], v[72:75], v[16:31]
    ds_read_b128 v[60:63], v135 offset:256
    ds_read_b128 v[96:99], v115 offset:2048
    v_fmac_f32 v47, v140, v159
    v_exp_f32 v104, v104
    v_mul_f32_e64 v32, v32, v40
    v_mfma_f32_32x32x16_bf16 v[16:31], a[36:39], v[76:79], v[16:31]
    ds_read_b128 v[64:67], v128 offset:512
    v_exp_f32 v105, v105
    v_mul_f32 v33, v33, v41
    v_exp_f32_e64 v106, v106
    v_mfma_f32_32x32x16_bf16 v[16:31], a[40:43], v[80:83], v[16:31]
    ds_read_b128 v[68:71], v129 offset:512
    v_mul_f32 v34, v34, v42
    v_exp_f32 v107, v107
    v_mul_f32_e64 v35, v35, v43
    v_mfma_f32_32x32x16_bf16 v[16:31], a[44:47], v[84:87], v[16:31]
    ds_read_b128 v[72:75], v130 offset:512
    s_waitcnt lgkmcnt(4)
    v_exp_f32 v108, v108
    v_mul_f32_e64 v36, v36, v44
    v_mfma_f32_32x32x16_bf16 v[16:31], a[48:51], v[48:51], v[16:31]
    ds_read_b128 v[76:79], v131 offset:512
    v_exp_f32 v109, v109
    v_mul_f32 v37, v37, v45
    v_exp_f32_e64 v110, v110
    v_mfma_f32_32x32x16_bf16 v[16:31], a[52:55], v[52:55], v[16:31]
    ds_read_b128 v[80:83], v132 offset:512
    v_mul_f32 v38, v38, v46
    v_exp_f32 v111, v111
    v_mul_f32_e64 v39, v39, v47
    v_fma_f32 v104, v104, v142, v142
    v_mfma_f32_32x32x16_bf16 v[16:31], a[56:59], v[56:59], v[16:31]
    ds_read_b128 v[84:87], v133 offset:512
    v_fma_f32 v105, v105, v142, v142
    v_fma_f32 v106, v106, v142, v142
    v_fma_f32 v107, v107, v142, v142
    v_fma_f32 v108, v108, v142, v142
    v_fma_f32 v109, v109, v142, v142
    v_mfma_f32_32x32x16_bf16 v[16:31], a[60:63], v[60:63], v[16:31]
    ds_read_b128 v[48:51], v134 offset:512
    s_waitcnt lgkmcnt(3)
    s_waitcnt vmcnt(32)
    s_barrier
    ds_read_b128 v[92:95], v113 offset:0
    v_fma_f32 v110, v110, v142, v142
    v_mfma_f32_32x32x16_bf16 v[16:31], a[64:67], v[64:67], v[16:31]
    ds_read_b128 v[52:55], v135 offset:512
    s_add_u32 m0, s58, 98304
    s_nop 0
    buffer_load_dwordx4 v120, s[24:27], s57 offen offset:0 lds
    v_fma_f32 v111, v111, v142, v142
    v_mfma_f32_32x32x16_bf16 v[16:31], a[68:71], v[68:71], v[16:31]
    ds_read_b128 v[56:59], v128 offset:768
    buffer_load_dwordx4 v121, s[24:27], s57 offen offset:1024 lds
    buffer_load_dwordx4 v122, s[24:27], s57 offen offset:2048 lds
    v_mfma_f32_32x32x16_bf16 v[16:31], a[72:75], v[72:75], v[16:31]
    ds_read_b128 v[60:63], v129 offset:768
    buffer_load_dwordx4 v123, s[24:27], s57 offen offset:3072 lds
    s_add_u32 s57, s57, s60
    v_rcp_f32 v104, v104
    v_mfma_f32_32x32x16_bf16 v[16:31], a[76:79], v[76:79], v[16:31]
    ds_read_b128 v[64:67], v130 offset:768
    s_waitcnt lgkmcnt(3)
    s_add_u32 m0, s58, 102400
    v_rcp_f32 v105, v105
    v_mul_f32_e64 v32, v32, v104
    v_mfma_f32_32x32x16_bf16 v[16:31], a[80:83], v[80:83], v[16:31]
    ds_read_b128 v[68:71], v131 offset:768
    buffer_load_dwordx4 v124, s[24:27], s57 offen offset:0 lds
    buffer_load_dwordx4 v125, s[24:27], s57 offen offset:1024 lds
    v_mfma_f32_32x32x16_bf16 v[16:31], a[84:87], v[84:87], v[16:31]
    ds_read_b128 v[72:75], v132 offset:768
    buffer_load_dwordx4 v126, s[24:27], s57 offen offset:2048 lds
    buffer_load_dwordx4 v127, s[24:27], s57 offen offset:3072 lds
    v_mfma_f32_32x32x16_bf16 v[16:31], a[88:91], v[48:51], v[16:31]
    ds_read_b128 v[76:79], v133 offset:768
    s_add_u32 s57, s57, s61
    v_rcp_f32 v106, v106
    v_mul_f32_e64 v33, v33, v105
    v_mfma_f32_32x32x16_bf16 v[16:31], a[92:95], v[52:55], v[16:31]
    ds_read_b128 v[80:83], v134 offset:768
    s_waitcnt lgkmcnt(3)
    s_add_u32 s63, s63, 4096
    buffer_load_dwordx4 a[208:211], v117, s[24:27], s63 offen offset:0
    v_mfma_f32_32x32x16_bf16 v[16:31], a[96:99], v[56:59], v[16:31]
    ds_read_b128 v[84:87], v135 offset:768
    buffer_load_dwordx4 a[212:215], v117, s[24:27], s63 offen offset:1024
    buffer_load_dwordx4 a[216:219], v117, s[24:27], s63 offen offset:2048
    v_mfma_f32_32x32x16_bf16 v[16:31], a[100:103], v[60:63], v[16:31]
    ds_read_b128 v[48:51], v128 offset:32768
    buffer_load_dwordx4 a[220:223], v117, s[24:27], s63 offen offset:3072
    s_add_u32 s63, s63, 4096
    v_rcp_f32 v107, v107
    v_mfma_f32_32x32x16_bf16 v[16:31], a[104:107], v[64:67], v[16:31]
    ds_read_b128 v[52:55], v129 offset:32768
    buffer_load_dwordx4 a[224:227], v117, s[24:27], s63 offen offset:0
    v_mul_f32 v34, v34, v106
    v_rcp_f32 v108, v108
    v_mfma_f32_32x32x16_bf16 v[16:31], a[108:111], v[68:71], v[16:31]
    ds_read_b128 v[56:59], v130 offset:32768
    s_waitcnt lgkmcnt(3)
    buffer_load_dwordx4 a[228:231], v117, s[24:27], s63 offen offset:1024
    buffer_load_dwordx4 a[232:235], v117, s[24:27], s63 offen offset:2048
    v_mfma_f32_32x32x16_bf16 v[16:31], a[112:115], v[72:75], v[16:31]
    ds_read_b128 v[60:63], v131 offset:32768
    buffer_load_dwordx4 a[236:239], v117, s[24:27], s63 offen offset:3072
    s_add_u32 s63, s63, 4096
    v_mul_f32 v35, v35, v107
    v_mfma_f32_32x32x16_bf16 v[16:31], a[116:119], v[76:79], v[16:31]
    ds_read_b128 v[64:67], v132 offset:32768
    buffer_load_dwordx4 a[240:243], v117, s[24:27], s63 offen offset:0
    v_rcp_f32 v109, v109
    v_mul_f32 v36, v36, v108
    v_mfma_f32_32x32x16_bf16 v[16:31], a[120:123], v[80:83], v[16:31]
    ds_read_b128 v[68:71], v133 offset:32768
    buffer_store_dwordx4 v[92:95], v114, s[24:27], s59 offen
    s_add_u32 s59, s59, s62
    v_mfma_f32_32x32x16_bf16 v[16:31], a[124:127], v[84:87], v[16:31]
    ds_read_b128 v[72:75], v134 offset:32768
    s_waitcnt lgkmcnt(3)
    s_waitcnt vmcnt(38)
    buffer_load_dword v90, v114, s[24:27], s51 offen
    s_add_u32 s51, s51, s62
    v_rcp_f32 v110, v110
    v_mul_f32 v37, v37, v109
    v_rcp_f32 v111, v111
    v_mul_f32 v38, v38, v110
    v_mul_f32_e64 v39, v39, v111
    v_cvt_pk_bf16_f32 v100, v32, v33
    v_cvt_pk_bf16_f32 v101, v34, v35
    v_cvt_pk_bf16_f32 v102, v36, v37
    v_cvt_pk_bf16_f32 v103, v38, v39
    v_mfma_f32_32x32x16_bf16 v[32:47], a[0:3], v[48:51], 0
    ds_read_b128 v[76:79], v135 offset:32768
    v_mfma_f32_32x32x16_bf16 v[32:47], a[4:7], v[52:55], v[32:47]
    ds_read_b128 v[80:83], v128 offset:33024
    ds_write_b128 v112, v[100:103] offset:4096
    v_mfma_f32_32x32x16_bf16 v[32:47], a[8:11], v[56:59], v[32:47]
    ds_read_b128 v[84:87], v129 offset:33024
    buffer_load_dwordx4 a[244:247], v117, s[24:27], s63 offen offset:1024
    v_mfma_f32_32x32x16_bf16 v[32:47], a[12:15], v[60:63], v[32:47]
    ds_read_b128 v[48:51], v130 offset:33024
    s_waitcnt lgkmcnt(4)
    v_fmac_f32 v16, v96, v144
    v_fmac_f32 v17, v96, v145
    v_fmac_f32 v18, v96, v146
    v_fmac_f32_e64 v19, v96, v147
    v_mfma_f32_32x32x16_bf16 v[32:47], a[16:19], v[64:67], v[32:47]
    ds_read_b128 v[52:55], v131 offset:33024
    buffer_load_dwordx4 a[248:251], v117, s[24:27], s63 offen offset:2048
    v_fmac_f32 v20, v96, v148
    v_fmac_f32 v21, v96, v149
    v_fmac_f32_e64 v22, v96, v150
    v_mfma_f32_32x32x16_bf16 v[32:47], a[20:23], v[68:71], v[32:47]
    ds_read_b128 v[56:59], v132 offset:33024
    v_fmac_f32 v23, v96, v151
    v_mul_f32 v104, v16, v97
    v_mul_f32 v105, v17, v97
    v_mul_f32 v106, v18, v97
    v_mul_f32_e64 v107, v19, v97
    v_mfma_f32_32x32x16_bf16 v[32:47], a[24:27], v[72:75], v[32:47]
    ds_read_b128 v[60:63], v133 offset:33024
    buffer_load_dwordx4 a[252:255], v117, s[24:27], s63 offen offset:3072
    v_mul_f32 v108, v20, v97
    v_mul_f32 v109, v21, v97
    v_mul_f32_e64 v110, v22, v97
    v_mfma_f32_32x32x16_bf16 v[32:47], a[28:31], v[76:79], v[32:47]
    ds_read_b128 v[64:67], v134 offset:33024
    s_waitcnt lgkmcnt(3)
    v_mul_f32 v111, v23, v97
    v_fmac_f32 v24, v96, v152
    v_fmac_f32 v25, v96, v153
    v_fmac_f32_e64 v26, v96, v154
    v_mfma_f32_32x32x16_bf16 v[32:47], a[32:35], v[80:83], v[32:47]
    ds_read_b128 v[68:71], v135 offset:33024
    ds_read_b128 v[140:143], v115 offset:2560
    v_fmac_f32 v27, v96, v155
    v_fmac_f32 v28, v96, v156
    v_fmac_f32 v29, v96, v157
    v_fmac_f32 v30, v96, v158
    v_mfma_f32_32x32x16_bf16 v[32:47], a[36:39], v[84:87], v[32:47]
    ds_read_b128 v[72:75], v128 offset:33280
    s_add_u32 s63, s63, 4096
    v_fmac_f32 v31, v96, v159
    v_exp_f32 v104, v104
    v_mul_f32_e64 v16, v16, v24
    v_mfma_f32_32x32x16_bf16 v[32:47], a[40:43], v[48:51], v[32:47]
    ds_read_b128 v[76:79], v129 offset:33280
    v_exp_f32 v105, v105
    v_mul_f32 v17, v17, v25
    v_mfma_f32_32x32x16_bf16 v[32:47], a[44:47], v[52:55], v[32:47]
    ds_read_b128 v[80:83], v130 offset:33280
    s_waitcnt lgkmcnt(4)
    buffer_load_dwordx4 v[160:163], v117, s[24:27], s63 offen offset:0
    v_exp_f32 v106, v106
    v_mfma_f32_32x32x16_bf16 v[32:47], a[48:51], v[56:59], v[32:47]
    ds_read_b128 v[84:87], v131 offset:33280
    v_mul_f32 v18, v18, v26
    v_exp_f32 v107, v107
    v_mul_f32_e64 v19, v19, v27
    v_mfma_f32_32x32x16_bf16 v[32:47], a[52:55], v[60:63], v[32:47]
    ds_read_b128 v[48:51], v132 offset:33280
    buffer_load_dwordx4 v[164:167], v117, s[24:27], s63 offen offset:1024
    v_exp_f32 v108, v108
    v_mul_f32 v20, v20, v28
    v_mfma_f32_32x32x16_bf16 v[32:47], a[56:59], v[64:67], v[32:47]
    ds_read_b128 v[52:55], v133 offset:33280
    v_exp_f32 v109, v109
    v_mul_f32 v21, v21, v29
    v_mfma_f32_32x32x16_bf16 v[32:47], a[60:63], v[68:71], v[32:47]
    ds_read_b128 v[56:59], v134 offset:33280
    s_waitcnt lgkmcnt(3)
    s_waitcnt vmcnt(36)
    s_barrier
    ds_read_b128 v[92:95], v113 offset:4096
    v_mfma_f32_32x32x16_bf16 v[32:47], a[64:67], v[72:75], v[32:47]
    ds_read_b128 v[60:63], v135 offset:33280
    buffer_load_dwordx4 v[168:171], v117, s[24:27], s63 offen offset:2048
    v_exp_f32 v110, v110
    v_mul_f32_e64 v22, v22, v30
    v_mfma_f32_32x32x16_bf16 v[32:47], a[68:71], v[76:79], v[32:47]
    ds_read_b128 v[64:67], v128 offset:33536
    v_exp_f32 v111, v111
    v_mul_f32 v23, v23, v31
    v_fma_f32 v104, v104, v98, v98
    v_mfma_f32_32x32x16_bf16 v[32:47], a[72:75], v[80:83], v[32:47]
    ds_read_b128 v[68:71], v129 offset:33536
    buffer_load_dwordx4 v[172:175], v117, s[24:27], s63 offen offset:3072
    v_fma_f32 v105, v105, v98, v98
    v_fma_f32 v106, v106, v98, v98
    v_fma_f32 v107, v107, v98, v98
    v_mfma_f32_32x32x16_bf16 v[32:47], a[76:79], v[84:87], v[32:47]
    ds_read_b128 v[72:75], v130 offset:33536
    s_waitcnt lgkmcnt(3)
    v_fma_f32 v108, v108, v98, v98
    v_fma_f32 v109, v109, v98, v98
    v_fma_f32 v110, v110, v98, v98
    v_fma_f32 v111, v111, v98, v98
    v_mfma_f32_32x32x16_bf16 v[32:47], a[80:83], v[48:51], v[32:47]
    ds_read_b128 v[76:79], v131 offset:33536
    s_add_u32 s63, s63, 4096
    v_rcp_f32 v104, v104
    v_mfma_f32_32x32x16_bf16 v[32:47], a[84:87], v[52:55], v[32:47]
    ds_read_b128 v[80:83], v132 offset:33536
    v_rcp_f32 v105, v105
    v_mul_f32 v16, v16, v104
    v_mfma_f32_32x32x16_bf16 v[32:47], a[88:91], v[56:59], v[32:47]
    ds_read_b128 v[84:87], v133 offset:33536
    v_rcp_f32 v106, v106
    v_mul_f32 v17, v17, v105
    v_mfma_f32_32x32x16_bf16 v[32:47], a[92:95], v[60:63], v[32:47]
    ds_read_b128 v[48:51], v134 offset:33536
    s_waitcnt lgkmcnt(3)
    buffer_load_dwordx4 v[176:179], v117, s[24:27], s63 offen offset:0
    v_rcp_f32 v107, v107
    v_mfma_f32_32x32x16_bf16 v[32:47], a[96:99], v[64:67], v[32:47]
    ds_read_b128 v[52:55], v135 offset:33536
    v_add_u32 v128, 65536, v128
    v_add_u32 v129, 65536, v129
    v_add_u32 v130, 65536, v130
    v_add_u32 v131, 65536, v131
    v_add_u32 v132, 65536, v132
    v_add_u32 v133, 65536, v133
    v_add_u32 v134, 65536, v134
    v_add_u32 v135, 65536, v135
    v_mfma_f32_32x32x16_bf16 v[32:47], a[100:103], v[68:71], v[32:47]
    ds_read_b128 v[56:59], v128 offset:0
    buffer_load_dwordx4 v[180:183], v117, s[24:27], s63 offen offset:1024
    v_mul_f32 v18, v18, v106
    v_rcp_f32 v108, v108
    v_mfma_f32_32x32x16_bf16 v[32:47], a[104:107], v[72:75], v[32:47]
    ds_read_b128 v[60:63], v129 offset:0
    v_mul_f32 v19, v19, v107
    v_rcp_f32 v109, v109
    v_mul_f32_e64 v20, v20, v108
    v_mfma_f32_32x32x16_bf16 v[32:47], a[108:111], v[76:79], v[32:47]
    ds_read_b128 v[64:67], v130 offset:0
    s_waitcnt lgkmcnt(3)
    buffer_load_dwordx4 v[184:187], v117, s[24:27], s63 offen offset:2048
    v_rcp_f32 v110, v110
    v_mfma_f32_32x32x16_bf16 v[32:47], a[112:115], v[80:83], v[32:47]
    ds_read_b128 v[68:71], v131 offset:0
    v_mul_f32 v21, v21, v109
    v_rcp_f32 v111, v111
    v_mul_f32_e64 v22, v22, v110
    v_mfma_f32_32x32x16_bf16 v[32:47], a[116:119], v[84:87], v[32:47]
    ds_read_b128 v[72:75], v132 offset:0
    v_mul_f32_e64 v23, v23, v111
    v_cvt_pk_bf16_f32 v100, v16, v17
    v_cvt_pk_bf16_f32 v101, v18, v19
    v_cvt_pk_bf16_f32 v102, v20, v21
    v_mfma_f32_32x32x16_bf16 v[32:47], a[120:123], v[48:51], v[32:47]
    ds_read_b128 v[76:79], v133 offset:0
    buffer_store_dwordx4 v[92:95], v114, s[24:27], s59 offen
    s_add_u32 s59, s59, s62
    v_cvt_pk_bf16_f32 v103, v22, v23
    v_mfma_f32_32x32x16_bf16 v[32:47], a[124:127], v[52:55], v[32:47]
    ds_read_b128 v[80:83], v134 offset:0
    s_waitcnt lgkmcnt(3)
    s_waitcnt vmcnt(30)
    buffer_load_dword v91, v114, s[24:27], s51 offen
    s_add_u32 s51, s51, s62
    v_mfma_f32_32x32x16_bf16 v[16:31], a[0:3], v[56:59], 0
    ds_read_b128 v[84:87], v135 offset:0
    v_mfma_f32_32x32x16_bf16 v[16:31], a[4:7], v[60:63], v[16:31]
    ds_read_b128 v[48:51], v128 offset:256
    ds_write_b128 v112, v[100:103] offset:0
    v_mfma_f32_32x32x16_bf16 v[16:31], a[8:11], v[64:67], v[16:31]
    ds_read_b128 v[52:55], v129 offset:256
    buffer_load_dwordx4 v[188:191], v117, s[24:27], s63 offen offset:3072
    v_mfma_f32_32x32x16_bf16 v[16:31], a[12:15], v[68:71], v[16:31]
    ds_read_b128 v[56:59], v130 offset:256
    s_waitcnt lgkmcnt(4)
    v_fmac_f32 v32, v140, v144
    v_fmac_f32 v33, v140, v145
    v_fmac_f32 v34, v140, v146
    v_fmac_f32_e64 v35, v140, v147
    v_mfma_f32_32x32x16_bf16 v[16:31], a[16:19], v[72:75], v[16:31]
    ds_read_b128 v[60:63], v131 offset:256
    s_add_u32 s63, s63, 4096
    v_fmac_f32 v36, v140, v148
    v_fmac_f32 v37, v140, v149
    v_fmac_f32 v38, v140, v150
    v_fmac_f32 v39, v140, v151
    v_mfma_f32_32x32x16_bf16 v[16:31], a[20:23], v[76:79], v[16:31]
    ds_read_b128 v[64:67], v132 offset:256
    v_mul_f32 v104, v32, v141
    v_mul_f32 v105, v33, v141
    v_mul_f32 v106, v34, v141
    v_mul_f32 v107, v35, v141
    v_mfma_f32_32x32x16_bf16 v[16:31], a[24:27], v[80:83], v[16:31]
    ds_read_b128 v[68:71], v133 offset:256
    buffer_load_dwordx4 v[192:195], v117, s[24:27], s63 offen offset:0
    v_mul_f32 v108, v36, v141
    v_mul_f32 v109, v37, v141
    v_mul_f32_e64 v110, v38, v141
    v_mfma_f32_32x32x16_bf16 v[16:31], a[28:31], v[84:87], v[16:31]
    ds_read_b128 v[72:75], v134 offset:256
    s_waitcnt lgkmcnt(3)
    v_mul_f32 v111, v39, v141
    v_fmac_f32 v40, v140, v152
    v_fmac_f32 v41, v140, v153
    v_mfma_f32_32x32x16_bf16 v[16:31], a[32:35], v[48:51], v[16:31]
    ds_read_b128 v[76:79], v135 offset:256
    ds_read_b128 v[96:99], v115 offset:3072
    v_fmac_f32 v42, v140, v154
    v_fmac_f32 v43, v140, v155
    v_fmac_f32_e64 v44, v140, v156
    v_mfma_f32_32x32x16_bf16 v[16:31], a[36:39], v[52:55], v[16:31]
    ds_read_b128 v[80:83], v128 offset:512
    buffer_load_dwordx4 v[196:199], v117, s[24:27], s63 offen offset:1024
    v_fmac_f32 v45, v140, v157
    v_fmac_f32 v46, v140, v158
    v_fmac_f32_e64 v47, v140, v159
    v_mfma_f32_32x32x16_bf16 v[16:31], a[40:43], v[56:59], v[16:31]
    ds_read_b128 v[84:87], v129 offset:512
    v_exp_f32 v104, v104
    v_mul_f32 v32, v32, v40
    v_mfma_f32_32x32x16_bf16 v[16:31], a[44:47], v[60:63], v[16:31]
    ds_read_b128 v[48:51], v130 offset:512
    s_waitcnt lgkmcnt(4)
    buffer_load_dwordx4 v[200:203], v117, s[24:27], s63 offen offset:2048
    v_exp_f32 v105, v105
    v_mfma_f32_32x32x16_bf16 v[16:31], a[48:51], v[64:67], v[16:31]
    ds_read_b128 v[52:55], v131 offset:512
    v_mul_f32 v33, v33, v41
    v_exp_f32 v106, v106
    v_mul_f32_e64 v34, v34, v42
    v_mfma_f32_32x32x16_bf16 v[16:31], a[52:55], v[68:71], v[16:31]
    ds_read_b128 v[56:59], v132 offset:512
    buffer_load_dwordx4 v[204:207], v117, s[24:27], s63 offen offset:3072
    v_exp_f32 v107, v107
    v_mul_f32 v35, v35, v43
    v_mfma_f32_32x32x16_bf16 v[16:31], a[56:59], v[72:75], v[16:31]
    ds_read_b128 v[60:63], v133 offset:512
    v_exp_f32 v108, v108
    v_mul_f32 v36, v36, v44
    v_mfma_f32_32x32x16_bf16 v[16:31], a[60:63], v[76:79], v[16:31]
    ds_read_b128 v[64:67], v134 offset:512
    s_waitcnt lgkmcnt(3)
    s_waitcnt vmcnt(28)
    s_waitcnt vmcnt(6)
    s_barrier
    s_nop 6
    s_cmp_lg_u32 s30, 0
    s_cbranch_scc1 L_fs_26
    s_add_u32 s40, s32, 2
    v_mov_b32 v2, s40
    v_mov_b32_e64 v3, s33
    s_lshl_b32 s41, s2, 6
    s_add_u32 s41, s41, 98304
    v_mov_b32 v4, s41
    s_mov_b64 exec, 1
    buffer_store_dwordx2 v[2:3], v4, s[24:27], 0 offen
    s_mov_b64 exec, -1
L_fs_26:
    ds_read_b128 v[92:95], v113 offset:0
    v_mfma_f32_32x32x16_bf16 v[16:31], a[64:67], v[80:83], v[16:31]
    ds_read_b128 v[68:71], v135 offset:512
    s_add_u32 s63, s63, 4096
    v_exp_f32 v109, v109
    v_mul_f32_e64 v37, v37, v45
    v_mfma_f32_32x32x16_bf16 v[16:31], a[68:71], v[84:87], v[16:31]
    ds_read_b128 v[72:75], v128 offset:768
    v_exp_f32 v110, v110
    v_mul_f32 v38, v38, v46
    v_mfma_f32_32x32x16_bf16 v[16:31], a[72:75], v[48:51], v[16:31]
    ds_read_b128 v[76:79], v129 offset:768
    buffer_load_dwordx4 v[208:211], v117, s[24:27], s63 offen offset:0
    v_exp_f32 v111, v111
    v_mul_f32 v39, v39, v47
    v_mfma_f32_32x32x16_bf16 v[16:31], a[76:79], v[52:55], v[16:31]
    ds_read_b128 v[80:83], v130 offset:768
    s_waitcnt lgkmcnt(3)
    v_fma_f32 v104, v104, v142, v142
    v_fma_f32 v105, v105, v142, v142
    v_fma_f32 v106, v106, v142, v142
    v_mfma_f32_32x32x16_bf16 v[16:31], a[80:83], v[56:59], v[16:31]
    ds_read_b128 v[84:87], v131 offset:768
    buffer_load_dwordx4 v[212:215], v117, s[24:27], s63 offen offset:1024
    v_fma_f32 v107, v107, v142, v142
    v_fma_f32 v108, v108, v142, v142
    v_fma_f32 v109, v109, v142, v142
    v_mfma_f32_32x32x16_bf16 v[16:31], a[84:87], v[60:63], v[16:31]
    ds_read_b128 v[48:51], v132 offset:768
    v_fma_f32 v110, v110, v142, v142
    v_fma_f32 v111, v111, v142, v142
    v_rcp_f32 v104, v104
    v_mfma_f32_32x32x16_bf16 v[16:31], a[88:91], v[64:67], v[16:31]
    ds_read_b128 v[52:55], v133 offset:768
    v_rcp_f32 v105, v105
    v_mul_f32 v32, v32, v104
    v_mfma_f32_32x32x16_bf16 v[16:31], a[92:95], v[68:71], v[16:31]
    ds_read_b128 v[56:59], v134 offset:768
    s_waitcnt lgkmcnt(3)
    buffer_load_dwordx4 v[216:219], v117, s[24:27], s63 offen offset:2048
    v_rcp_f32 v106, v106
    v_mfma_f32_32x32x16_bf16 v[16:31], a[96:99], v[72:75], v[16:31]
    ds_read_b128 v[60:63], v135 offset:768
    v_mul_f32 v33, v33, v105
    v_rcp_f32 v107, v107
    v_mul_f32_e64 v34, v34, v106
    v_mfma_f32_32x32x16_bf16 v[16:31], a[100:103], v[76:79], v[16:31]
    ds_read_b128 v[64:67], v128 offset:32768
    buffer_load_dwordx4 v[220:223], v117, s[24:27], s63 offen offset:3072
    v_rcp_f32_e64 v108, v108
    v_mfma_f32_32x32x16_bf16 v[16:31], a[104:107], v[80:83], v[16:31]
    ds_read_b128 v[68:71], v129 offset:32768
    v_mul_f32 v35, v35, v107
    v_rcp_f32 v109, v109
    v_mul_f32_e64 v36, v36, v108
    v_mfma_f32_32x32x16_bf16 v[16:31], a[108:111], v[84:87], v[16:31]
    ds_read_b128 v[72:75], v130 offset:32768
    s_waitcnt lgkmcnt(3)
    s_add_u32 s63, s63, 4096
    v_rcp_f32 v110, v110
    v_mfma_f32_32x32x16_bf16 v[16:31], a[112:115], v[48:51], v[16:31]
    ds_read_b128 v[76:79], v131 offset:32768
    v_mul_f32 v37, v37, v109
    v_rcp_f32 v111, v111
    v_mfma_f32_32x32x16_bf16 v[16:31], a[116:119], v[52:55], v[16:31]
    ds_read_b128 v[80:83], v132 offset:32768
    v_mul_f32 v38, v38, v110
    v_mul_f32 v39, v39, v111
    v_cvt_pk_bf16_f32 v100, v32, v33
    v_mfma_f32_32x32x16_bf16 v[16:31], a[120:123], v[56:59], v[16:31]
    ds_read_b128 v[84:87], v133 offset:32768
    buffer_store_dwordx4 v[92:95], v114, s[24:27], s59 offen
    s_add_u32 s59, s59, s62
    v_cvt_pk_bf16_f32 v101, v34, v35
    v_mfma_f32_32x32x16_bf16 v[16:31], a[124:127], v[60:63], v[16:31]
    ds_read_b128 v[48:51], v134 offset:32768
    s_waitcnt lgkmcnt(3)
    v_cvt_pk_bf16_f32 v102, v36, v37
    v_cvt_pk_bf16_f32 v103, v38, v39
    v_mfma_f32_32x32x16_bf16 v[32:47], a[0:3], v[64:67], 0
    ds_read_b128 v[52:55], v135 offset:32768
    v_mfma_f32_32x32x16_bf16 v[32:47], a[4:7], v[68:71], v[32:47]
    ds_read_b128 v[56:59], v128 offset:33024
    ds_write_b128 v112, v[100:103] offset:4096
    v_mfma_f32_32x32x16_bf16 v[32:47], a[8:11], v[72:75], v[32:47]
    ds_read_b128 v[60:63], v129 offset:33024
    buffer_load_dwordx4 v[224:227], v117, s[24:27], s63 offen offset:0
    v_mfma_f32_32x32x16_bf16 v[32:47], a[12:15], v[76:79], v[32:47]
    ds_read_b128 v[64:67], v130 offset:33024
    s_waitcnt lgkmcnt(4)
    v_fmac_f32 v16, v96, v144
    v_fmac_f32 v17, v96, v145
    v_fmac_f32 v18, v96, v146
    v_fmac_f32_e64 v19, v96, v147
    v_mfma_f32_32x32x16_bf16 v[32:47], a[16:19], v[80:83], v[32:47]
    ds_read_b128 v[68:71], v131 offset:33024
    v_fmac_f32 v20, v96, v148
    v_fmac_f32 v21, v96, v149
    v_fmac_f32 v22, v96, v150
    v_fmac_f32 v23, v96, v151
    v_mfma_f32_32x32x16_bf16 v[32:47], a[20:23], v[84:87], v[32:47]
    ds_read_b128 v[72:75], v132 offset:33024
    buffer_load_dwordx4 v[228:231], v117, s[24:27], s63 offen offset:1024
    v_mul_f32 v104, v16, v97
    v_mul_f32 v105, v17, v97
    v_mul_f32_e64 v106, v18, v97
    v_mfma_f32_32x32x16_bf16 v[32:47], a[24:27], v[48:51], v[32:47]
    ds_read_b128 v[76:79], v133 offset:33024
    v_mul_f32 v107, v19, v97
    v_mul_f32 v108, v20, v97
    v_mul_f32 v109, v21, v97
    v_mul_f32 v110, v22, v97
    v_mfma_f32_32x32x16_bf16 v[32:47], a[28:31], v[52:55], v[32:47]
    ds_read_b128 v[80:83], v134 offset:33024
    s_waitcnt lgkmcnt(3)
    v_mul_f32 v111, v23, v97
    v_fmac_f32 v24, v96, v152
    v_fmac_f32 v25, v96, v153
    v_mfma_f32_32x32x16_bf16 v[32:47], a[32:35], v[56:59], v[32:47]
    ds_read_b128 v[84:87], v135 offset:33024
    ds_read_b128 v[140:143], v115 offset:3584
    buffer_load_dwordx4 v[232:235], v117, s[24:27], s63 offen offset:2048
    v_fmac_f32 v26, v96, v154
    v_fmac_f32 v27, v96, v155
    v_mfma_f32_32x32x16_bf16 v[32:47], a[36:39], v[60:63], v[32:47]
    ds_read_b128 v[48:51], v128 offset:33280
    v_fmac_f32 v28, v96, v156
    v_fmac_f32 v29, v96, v157
    v_fmac_f32 v30, v96, v158
    v_fmac_f32 v31, v96, v159
    v_mfma_f32_32x32x16_bf16 v[32:47], a[40:43], v[64:67], v[32:47]
    ds_read_b128 v[52:55], v129 offset:33280
    v_exp_f32 v104, v104
    v_mul_f32 v16, v16, v24
    v_mfma_f32_32x32x16_bf16 v[32:47], a[44:47], v[68:71], v[32:47]
    ds_read_b128 v[56:59], v130 offset:33280
    s_waitcnt lgkmcnt(4)
    buffer_load_dwordx4 v[236:239], v117, s[24:27], s63 offen offset:3072
    v_exp_f32 v105, v105
    v_mfma_f32_32x32x16_bf16 v[32:47], a[48:51], v[72:75], v[32:47]
    ds_read_b128 v[60:63], v131 offset:33280
    v_mul_f32 v17, v17, v25
    v_exp_f32 v106, v106
    v_mul_f32_e64 v18, v18, v26
    v_mfma_f32_32x32x16_bf16 v[32:47], a[52:55], v[76:79], v[32:47]
    ds_read_b128 v[64:67], v132 offset:33280
    v_exp_f32 v107, v107
    v_mul_f32 v19, v19, v27
    v_mfma_f32_32x32x16_bf16 v[32:47], a[56:59], v[80:83], v[32:47]
    ds_read_b128 v[68:71], v133 offset:33280
    s_add_u32 s63, s63, 4096
    v_exp_f32 v108, v108
    v_mul_f32 v20, v20, v28
    v_mfma_f32_32x32x16_bf16 v[32:47], a[60:63], v[84:87], v[32:47]
    ds_read_b128 v[72:75], v134 offset:33280
    s_waitcnt lgkmcnt(3)
    s_barrier
    ds_read_b128 v[92:95], v113 offset:4096
    v_mfma_f32_32x32x16_bf16 v[32:47], a[64:67], v[48:51], v[32:47]
    ds_read_b128 v[76:79], v135 offset:33280
    v_exp_f32 v109, v109
    v_mul_f32 v21, v21, v29
    v_mfma_f32_32x32x16_bf16 v[32:47], a[68:71], v[52:55], v[32:47]
    ds_read_b128 v[80:83], v128 offset:33536
    buffer_load_dwordx4 v[240:243], v117, s[24:27], s63 offen offset:0
    v_exp_f32 v110, v110
    v_mul_f32 v22, v22, v30
    v_mfma_f32_32x32x16_bf16 v[32:47], a[72:75], v[56:59], v[32:47]
    ds_read_b128 v[84:87], v129 offset:33536
    v_exp_f32 v111, v111
    v_mul_f32 v23, v23, v31
    v_fma_f32 v104, v104, v98, v98
    v_mfma_f32_32x32x16_bf16 v[32:47], a[76:79], v[60:63], v[32:47]
    ds_read_b128 v[48:51], v130 offset:33536
    s_waitcnt lgkmcnt(3)
    v_fma_f32 v105, v105, v98, v98
    v_fma_f32 v106, v106, v98, v98
    v_fma_f32 v107, v107, v98, v98
    v_fma_f32 v108, v108, v98, v98
    v_mfma_f32_32x32x16_bf16 v[32:47], a[80:83], v[64:67], v[32:47]
    ds_read_b128 v[52:55], v131 offset:33536
    buffer_load_dwordx4 v[244:247], v117, s[24:27], s63 offen offset:1024
    v_fma_f32 v109, v109, v98, v98
    v_fma_f32 v110, v110, v98, v98
    v_fma_f32 v111, v111, v98, v98
    v_mfma_f32_32x32x16_bf16 v[32:47], a[84:87], v[68:71], v[32:47]
    ds_read_b128 v[56:59], v132 offset:33536
    v_rcp_f32 v104, v104
    v_rcp_f32_e64 v105, v105
    v_mfma_f32_32x32x16_bf16 v[32:47], a[88:91], v[72:75], v[32:47]
    ds_read_b128 v[60:63], v133 offset:33536
    v_mul_f32 v16, v16, v104
    v_rcp_f32 v106, v106
    v_mul_f32_e64 v17, v17, v105
    v_mfma_f32_32x32x16_bf16 v[32:47], a[92:95], v[76:79], v[32:47]
    ds_read_b128 v[64:67], v134 offset:33536
    s_waitcnt lgkmcnt(3)
    buffer_load_dwordx4 v[248:251], v117, s[24:27], s63 offen offset:2048
    v_rcp_f32 v107, v107
    v_mfma_f32_32x32x16_bf16 v[32:47], a[96:99], v[80:83], v[32:47]
    ds_read_b128 v[68:71], v135 offset:33536
    v_mfma_f32_32x32x16_bf16 v[32:47], a[100:103], v[84:87], v[32:47]
    v_mul_f32 v18, v18, v106
    v_rcp_f32 v108, v108
    v_mul_f32_e64 v19, v19, v107
    v_mfma_f32_32x32x16_bf16 v[32:47], a[104:107], v[48:51], v[32:47]
    buffer_load_dwordx4 v[252:255], v117, s[24:27], s63 offen offset:3072
    v_rcp_f32_e64 v109, v109
    v_mfma_f32_32x32x16_bf16 v[32:47], a[108:111], v[52:55], v[32:47]
    s_waitcnt lgkmcnt(0)
    v_mul_f32 v20, v20, v108
    v_rcp_f32_e64 v110, v110
    v_mfma_f32_32x32x16_bf16 v[32:47], a[112:115], v[56:59], v[32:47]
    v_mul_f32 v21, v21, v109
    v_rcp_f32 v111, v111
    v_mfma_f32_32x32x16_bf16 v[32:47], a[116:119], v[60:63], v[32:47]
    v_mul_f32 v22, v22, v110
    v_mul_f32 v23, v23, v111
    v_cvt_pk_bf16_f32 v100, v16, v17
    v_mfma_f32_32x32x16_bf16 v[32:47], a[120:123], v[64:67], v[32:47]
    buffer_store_dwordx4 v[92:95], v114, s[24:27], s59 offen
    s_add_u32 s59, s59, s62
    v_cvt_pk_bf16_f32 v101, v18, v19
    v_mfma_f32_32x32x16_bf16 v[32:47], a[124:127], v[68:71], v[32:47]
    v_cvt_pk_bf16_f32 v102, v20, v21
    v_cvt_pk_bf16_f32 v103, v22, v23
    ds_write_b128 v112, v[100:103]
    s_nop 8
    v_fmac_f32 v32, v140, v144
    v_fmac_f32 v33, v140, v145
    v_fmac_f32 v34, v140, v146
    v_fmac_f32 v35, v140, v147
    v_fmac_f32 v36, v140, v148
    v_fmac_f32 v37, v140, v149
    v_fmac_f32 v38, v140, v150
    v_fmac_f32 v39, v140, v151
    v_mul_f32 v104, v32, v141
    v_mul_f32 v105, v33, v141
    v_mul_f32 v106, v34, v141
    v_mul_f32 v107, v35, v141
    v_mul_f32 v108, v36, v141
    v_mul_f32 v109, v37, v141
    v_mul_f32 v110, v38, v141
    v_mul_f32 v111, v39, v141
    v_fmac_f32 v40, v140, v152
    v_fmac_f32 v41, v140, v153
    v_fmac_f32 v42, v140, v154
    v_fmac_f32 v43, v140, v155
    v_fmac_f32 v44, v140, v156
    v_fmac_f32 v45, v140, v157
    v_fmac_f32 v46, v140, v158
    v_fmac_f32 v47, v140, v159
    v_exp_f32 v104, v104
    v_mul_f32 v32, v32, v40
    v_exp_f32 v105, v105
    v_mul_f32 v33, v33, v41
    v_exp_f32 v106, v106
    v_mul_f32 v34, v34, v42
    v_exp_f32 v107, v107
    v_mul_f32 v35, v35, v43
    v_exp_f32 v108, v108
    v_mul_f32 v36, v36, v44
    v_exp_f32 v109, v109
    v_mul_f32 v37, v37, v45
    v_exp_f32 v110, v110
    v_mul_f32 v38, v38, v46
    v_exp_f32 v111, v111
    v_mul_f32 v39, v39, v47
    v_fma_f32 v104, v104, v142, v142
    v_fma_f32 v105, v105, v142, v142
    v_fma_f32 v106, v106, v142, v142
    v_fma_f32 v107, v107, v142, v142
    v_fma_f32 v108, v108, v142, v142
    v_fma_f32 v109, v109, v142, v142
    v_fma_f32 v110, v110, v142, v142
    v_fma_f32 v111, v111, v142, v142
    v_rcp_f32 v104, v104
    v_rcp_f32 v105, v105
    v_mul_f32 v32, v32, v104
    v_rcp_f32 v106, v106
    v_mul_f32 v33, v33, v105
    v_rcp_f32 v107, v107
    v_mul_f32 v34, v34, v106
    v_rcp_f32 v108, v108
    v_mul_f32 v35, v35, v107
    v_rcp_f32 v109, v109
    v_mul_f32 v36, v36, v108
    v_rcp_f32 v110, v110
    v_mul_f32 v37, v37, v109
    v_rcp_f32 v111, v111
    v_mul_f32 v38, v38, v110
    v_mul_f32 v39, v39, v111
    v_cvt_pk_bf16_f32 v100, v32, v33
    v_cvt_pk_bf16_f32 v101, v34, v35
    v_cvt_pk_bf16_f32 v102, v36, v37
    v_cvt_pk_bf16_f32 v103, v38, v39
    ds_write_b128 v112, v[100:103] offset:4096
    s_waitcnt lgkmcnt(0)
    s_barrier
    ds_read_b128 v[92:95], v113
    s_waitcnt vmcnt(19)
    ds_read_b128 v[88:91], v113 offset:4096
    s_waitcnt lgkmcnt(1)
    buffer_store_dwordx4 v[92:95], v114, s[24:27], s59 offen
    s_add_u32 s59, s59, s62
    s_waitcnt lgkmcnt(0)
    buffer_store_dwordx4 v[88:91], v114, s[24:27], s59 offen
    s_waitcnt vmcnt(0)
    s_barrier
    s_cmp_lg_u32 s30, 0
    s_cbranch_scc1 L_fs_27
    s_add_u32 s40, s32, 3
    v_mov_b32 v2, s40
    v_mov_b32 v3, s33
    s_lshl_b32 s41, s2, 6
    s_add_u32 s41, s41, 98304
    v_mov_b32 v4, s41
    s_mov_b64 exec, 1
    buffer_store_dwordx2 v[2:3], v4, s[24:27], 0 offen
    s_mov_b64 exec, -1
L_fs_27:
    s_waitcnt vmcnt(0)
    s_branch L_gudone_15
L_idle_14:
    s_cmp_lg_u32 s30, 0
    s_cbranch_scc1 L_fs_28
    s_add_u32 s40, s32, 3
    v_mov_b32 v2, s40
    v_mov_b32_e64 v3, s33
    s_lshl_b32 s41, s2, 6
    s_add_u32 s41, s41, 98304
    v_mov_b32 v4, s41
    s_mov_b64 exec, 1
    buffer_store_dwordx2 v[2:3], v4, s[24:27], 0 offen
    s_mov_b64 exec, -1
L_fs_28:
    s_lshl_b32 s44, s28, 2
    s_add_u32 s44, s44, s29
    s_sub_u32 s44, s44, 28
    s_and_b32 s45, s44, 7
    s_lshr_b32 s46, s44, 3
    v_lshrrev_b32 v2, 3, v1
    v_and_b32 v3, 7, v1
    v_lshlrev_b32_e64 v4, 10, v2
    v_lshl_add_u32 v4, v3, 4, v4
    s_mul_i32 s47, s46, 448
    s_mul_i32 s40, s30, 112
    s_add_u32 s47, s47, s40
    s_lshl_b32 s47, s47, 10
    s_lshl_b32 s40, s45, 7
    s_add_u32 s47, s47, s40
    buffer_load_dwordx4 v[16:19], v4, s[16:19], s47 offen
    s_add_u32 s47, s47, 8192
    buffer_load_dwordx4 v[20:23], v4, s[16:19], s47 offen
    s_add_u32 s47, s47, 8192
    buffer_load_dwordx4 v[24:27], v4, s[16:19], s47 offen
    s_add_u32 s47, s47, 8192
    buffer_load_dwordx4 v[28:31], v4, s[16:19], s47 offen
    s_add_u32 s47, s47, 8192
    buffer_load_dwordx4 v[32:35], v4, s[16:19], s47 offen
    s_add_u32 s47, s47, 8192
    buffer_load_dwordx4 v[36:39], v4, s[16:19], s47 offen
    s_add_u32 s47, s47, 8192
    buffer_load_dwordx4 v[40:43], v4, s[16:19], s47 offen
    s_add_u32 s47, s47, 8192
    buffer_load_dwordx4 v[44:47], v4, s[16:19], s47 offen
    s_add_u32 s47, s47, 8192
    buffer_load_dwordx4 v[48:51], v4, s[16:19], s47 offen
    s_add_u32 s47, s47, 8192
    buffer_load_dwordx4 v[52:55], v4, s[16:19], s47 offen
    s_add_u32 s47, s47, 8192
    buffer_load_dwordx4 v[56:59], v4, s[16:19], s47 offen
    s_add_u32 s47, s47, 8192
    buffer_load_dwordx4 v[60:63], v4, s[16:19], s47 offen
    s_add_u32 s47, s47, 8192
    buffer_load_dwordx4 v[64:67], v4, s[16:19], s47 offen
    s_add_u32 s47, s47, 8192
    buffer_load_dwordx4 v[68:71], v4, s[16:19], s47 offen
    v_bfe_u32 v8, v2, 1, 1
    v_lshlrev_b32 v8, 2, v8
    v_xor_b32 v3, v3, v8
    v_lshlrev_b32_e64 v3, 4, v3
    v_lshl_add_u32 v5, v2, 7, v3
    v_and_b32 v6, 15, v1
    v_lshrrev_b32 v7, 4, v1
    v_lshrrev_b32 v8, 2, v6
    v_and_b32 v9, 3, v6
    v_and_b32 v10, 1, v7
    v_lshrrev_b32 v7, 1, v7
    v_and_b32_e64 v11, 1, v9
    v_lshl_add_u32 v11, v10, 1, v11
    v_bfe_u32 v6, v8, 1, 1
    v_lshlrev_b32 v6, 2, v6
    v_xor_b32 v11, v11, v6
    v_lshlrev_b32 v11, 4, v11
    v_lshrrev_b32 v9, 1, v9
    v_lshl_add_u32 v11, v9, 3, v11
    v_lshl_add_u32 v8, v7, 3, v8
    v_lshl_add_u32 v6, v8, 7, v11
    v_xor_b32_e64 v7, 64, v6
    s_mul_i32 s41, s30, 14336
    s_add_u32 s41, s41, 106496
    v_add_u32 v5, s41, v5
    v_add_u32 v6, s41, v6
    v_add_u32 v7, s41, v7
    s_waitcnt vmcnt(13)
    ds_write_b128 v5, v[16:19] offset:0
    s_waitcnt vmcnt(12)
    ds_write_b128 v5, v[20:23] offset:1024
    s_waitcnt vmcnt(11)
    ds_write_b128 v5, v[24:27] offset:2048
    s_waitcnt vmcnt(10)
    ds_write_b128 v5, v[28:31] offset:3072
    s_waitcnt vmcnt(9)
    ds_write_b128 v5, v[32:35] offset:4096
    s_waitcnt vmcnt(8)
    ds_write_b128 v5, v[36:39] offset:5120
    s_waitcnt vmcnt(7)
    ds_write_b128 v5, v[40:43] offset:6144
    s_waitcnt vmcnt(6)
    ds_write_b128 v5, v[44:47] offset:7168
    s_waitcnt vmcnt(5)
    ds_write_b128 v5, v[48:51] offset:8192
    s_waitcnt vmcnt(4)
    ds_write_b128 v5, v[52:55] offset:9216
    s_waitcnt vmcnt(3)
    ds_write_b128 v5, v[56:59] offset:10240
    s_waitcnt vmcnt(2)
    ds_write_b128 v5, v[60:63] offset:11264
    s_waitcnt vmcnt(1)
    ds_write_b128 v5, v[64:67] offset:12288
    s_waitcnt vmcnt(0)
    ds_write_b128 v5, v[68:71] offset:13312
    ds_read_b64_tr_b16 v[72:73], v6 offset:0
    ds_read_b64_tr_b16 v[74:75], v6 offset:512
    ds_read_b64_tr_b16 v[76:77], v7 offset:0
    ds_read_b64_tr_b16 v[78:79], v7 offset:512
    ds_read_b64_tr_b16 v[80:81], v6 offset:2048
    ds_read_b64_tr_b16 v[82:83], v6 offset:2560
    ds_read_b64_tr_b16 v[84:85], v7 offset:2048
    ds_read_b64_tr_b16 v[86:87], v7 offset:2560
    ds_read_b64_tr_b16 v[88:89], v6 offset:4096
    ds_read_b64_tr_b16 v[90:91], v6 offset:4608
    ds_read_b64_tr_b16 v[92:93], v7 offset:4096
    ds_read_b64_tr_b16 v[94:95], v7 offset:4608
    ds_read_b64_tr_b16 v[96:97], v6 offset:6144
    ds_read_b64_tr_b16 v[98:99], v6 offset:6656
    ds_read_b64_tr_b16 v[100:101], v7 offset:6144
    ds_read_b64_tr_b16 v[102:103], v7 offset:6656
    ds_read_b64_tr_b16 v[104:105], v6 offset:8192
    ds_read_b64_tr_b16 v[106:107], v6 offset:8704
    ds_read_b64_tr_b16 v[108:109], v7 offset:8192
    ds_read_b64_tr_b16 v[110:111], v7 offset:8704
    ds_read_b64_tr_b16 v[112:113], v6 offset:10240
    ds_read_b64_tr_b16 v[114:115], v6 offset:10752
    ds_read_b64_tr_b16 v[116:117], v7 offset:10240
    ds_read_b64_tr_b16 v[118:119], v7 offset:10752
    ds_read_b64_tr_b16 v[120:121], v6 offset:12288
    ds_read_b64_tr_b16 v[122:123], v6 offset:12800
    ds_read_b64_tr_b16 v[124:125], v7 offset:12288
    ds_read_b64_tr_b16 v[126:127], v7 offset:12800
    v_lshlrev_b32 v4, 4, v1
    s_lshl_b32 s47, s45, 2
    s_add_u32 s47, s47, s46
    s_mul_i32 s47, s47, 56
    s_mul_i32 s40, s30, 14
    s_add_u32 s47, s47, s40
    s_lshl_b32 s47, s47, 10
    s_add_u32 s47, s47, 29360128
    s_waitcnt lgkmcnt(15)
    buffer_store_dwordx4 v[72:75], v4, s[24:27], s47 offen offset:0 sc1
    s_waitcnt lgkmcnt(15)
    buffer_store_dwordx4 v[76:79], v4, s[24:27], s47 offen offset:1024 sc1
    s_waitcnt lgkmcnt(15)
    buffer_store_dwordx4 v[80:83], v4, s[24:27], s47 offen offset:2048 sc1
    s_waitcnt lgkmcnt(15)
    buffer_store_dwordx4 v[84:87], v4, s[24:27], s47 offen offset:3072 sc1
    s_add_u32 s47, s47, 4096
    s_waitcnt lgkmcnt(15)
    buffer_store_dwordx4 v[88:91], v4, s[24:27], s47 offen offset:0 sc1
    s_waitcnt lgkmcnt(15)
    buffer_store_dwordx4 v[92:95], v4, s[24:27], s47 offen offset:1024 sc1
    s_waitcnt lgkmcnt(14)
    buffer_store_dwordx4 v[96:99], v4, s[24:27], s47 offen offset:2048 sc1
    s_waitcnt lgkmcnt(12)
    buffer_store_dwordx4 v[100:103], v4, s[24:27], s47 offen offset:3072 sc1
    s_add_u32 s47, s47, 4096
    s_waitcnt lgkmcnt(10)
    buffer_store_dwordx4 v[104:107], v4, s[24:27], s47 offen offset:0 sc1
    s_waitcnt lgkmcnt(8)
    buffer_store_dwordx4 v[108:111], v4, s[24:27], s47 offen offset:1024 sc1
    s_waitcnt lgkmcnt(6)
    buffer_store_dwordx4 v[112:115], v4, s[24:27], s47 offen offset:2048 sc1
    s_waitcnt lgkmcnt(4)
    buffer_store_dwordx4 v[116:119], v4, s[24:27], s47 offen offset:3072 sc1
    s_add_u32 s47, s47, 4096
    s_waitcnt lgkmcnt(2)
    buffer_store_dwordx4 v[120:123], v4, s[24:27], s47 offen offset:0 sc1
    s_waitcnt lgkmcnt(0)
    buffer_store_dwordx4 v[124:127], v4, s[24:27], s47 offen offset:1024 sc1
    s_waitcnt vmcnt(0)
    s_barrier
    s_cmp_lg_u32 s30, 0
    s_cbranch_scc1 L_wf_29
    s_add_u32 s40, s32, 1
    v_mov_b32 v2, s40
    v_mov_b32 v3, s33
    s_lshl_b32 s41, s44, 6
    s_add_u32 s41, s41, 114688
    v_mov_b32 v4, s41
    s_mov_b64 exec, 1
    buffer_store_dwordx2 v[2:3], v4, s[24:27], 0 offen sc1
    s_mov_b64 exec, -1
L_wf_29:
    s_lshl_b32 s40, s30, 3
    s_add_u32 s40, s40, s35
    s_lshl_b32 s40, s40, 6
    s_add_u32 s40, s40, 114688
    v_mov_b32 v118, s40
    s_add_u32 s40, s32, 1
    s_mov_b32 exec_lo, 0x1
    s_mov_b32 exec_hi, 0
    s_mov_b32 s98, 0
    v_mov_b32 v2, 0
    v_mov_b32 v3, 0
    s_nop 1
L_poll_30:
    buffer_load_dwordx2 v[2:3], v118, s[24:27], 0 offen sc1
    s_add_u32 s98, s98, 1
    s_cmp_gt_u32 s98, 0x40000
    s_cbranch_scc1 L_pd_31
    s_waitcnt vmcnt(0)
    v_subrev_u32_e64 v2, s40, v2
    v_cmp_gt_u32 vcc, 64, v2
    v_cmp_eq_u32 s[42:43], s33, v3
    s_nop 1
    s_and_b64 vcc, vcc, s[42:43]
    s_cmp_eq_u64 vcc, exec
    s_cbranch_scc1 L_pd_31
    s_sleep 4
    s_branch L_poll_30
L_pd_31:
    s_waitcnt vmcnt(0)
    s_mov_b64 exec, -1
    v_lshlrev_b32_e64 v117, 4, v1
    s_lshl_b32 s63, s35, 2
    s_add_u32 s63, s63, s30
    s_mul_i32 s63, s63, 57344
    s_add_u32 s63, s63, 29360128
    buffer_load_dwordx4 a[128:131], v117, s[24:27], s63 offen offset:0
    buffer_load_dwordx4 a[132:135], v117, s[24:27], s63 offen offset:1024
    buffer_load_dwordx4 a[136:139], v117, s[24:27], s63 offen offset:2048
    buffer_load_dwordx4 a[140:143], v117, s[24:27], s63 offen offset:3072
    s_add_u32 s63, s63, 4096
    buffer_load_dwordx4 a[144:147], v117, s[24:27], s63 offen offset:0
    buffer_load_dwordx4 a[148:151], v117, s[24:27], s63 offen offset:1024
    buffer_load_dwordx4 a[152:155], v117, s[24:27], s63 offen offset:2048
    buffer_load_dwordx4 a[156:159], v117, s[24:27], s63 offen offset:3072
    s_add_u32 s63, s63, 4096
    buffer_load_dwordx4 a[160:163], v117, s[24:27], s63 offen offset:0
    buffer_load_dwordx4 a[164:167], v117, s[24:27], s63 offen offset:1024
    buffer_load_dwordx4 a[168:171], v117, s[24:27], s63 offen offset:2048
    buffer_load_dwordx4 a[172:175], v117, s[24:27], s63 offen offset:3072
    s_add_u32 s63, s63, 4096
    buffer_load_dwordx4 a[176:179], v117, s[24:27], s63 offen offset:0
    buffer_load_dwordx4 a[180:183], v117, s[24:27], s63 offen offset:1024
    buffer_load_dwordx4 a[184:187], v117, s[24:27], s63 offen offset:2048
    buffer_load_dwordx4 a[188:191], v117, s[24:27], s63 offen offset:3072
    s_add_u32 s63, s63, 4096
    buffer_load_dwordx4 a[192:195], v117, s[24:27], s63 offen offset:0
    buffer_load_dwordx4 a[196:199], v117, s[24:27], s63 offen offset:1024
    buffer_load_dwordx4 a[200:203], v117, s[24:27], s63 offen offset:2048
    buffer_load_dwordx4 a[204:207], v117, s[24:27], s63 offen offset:3072
    s_add_u32 s63, s63, 4096
    buffer_load_dwordx4 a[208:211], v117, s[24:27], s63 offen offset:0
    buffer_load_dwordx4 a[212:215], v117, s[24:27], s63 offen offset:1024
    buffer_load_dwordx4 a[216:219], v117, s[24:27], s63 offen offset:2048
    buffer_load_dwordx4 a[220:223], v117, s[24:27], s63 offen offset:3072
    s_add_u32 s63, s63, 4096
    buffer_load_dwordx4 a[224:227], v117, s[24:27], s63 offen offset:0
    buffer_load_dwordx4 a[228:231], v117, s[24:27], s63 offen offset:1024
    buffer_load_dwordx4 a[232:235], v117, s[24:27], s63 offen offset:2048
    buffer_load_dwordx4 a[236:239], v117, s[24:27], s63 offen offset:3072
    s_add_u32 s63, s63, 4096
    buffer_load_dwordx4 a[240:243], v117, s[24:27], s63 offen offset:0
    buffer_load_dwordx4 a[244:247], v117, s[24:27], s63 offen offset:1024
    buffer_load_dwordx4 a[248:251], v117, s[24:27], s63 offen offset:2048
    buffer_load_dwordx4 a[252:255], v117, s[24:27], s63 offen offset:3072
    s_add_u32 s63, s63, 4096
    buffer_load_dwordx4 v[160:163], v117, s[24:27], s63 offen offset:0
    buffer_load_dwordx4 v[164:167], v117, s[24:27], s63 offen offset:1024
    buffer_load_dwordx4 v[168:171], v117, s[24:27], s63 offen offset:2048
    buffer_load_dwordx4 v[172:175], v117, s[24:27], s63 offen offset:3072
    s_add_u32 s63, s63, 4096
    buffer_load_dwordx4 v[176:179], v117, s[24:27], s63 offen offset:0
    buffer_load_dwordx4 v[180:183], v117, s[24:27], s63 offen offset:1024
    buffer_load_dwordx4 v[184:187], v117, s[24:27], s63 offen offset:2048
    buffer_load_dwordx4 v[188:191], v117, s[24:27], s63 offen offset:3072
    s_add_u32 s63, s63, 4096
    buffer_load_dwordx4 v[192:195], v117, s[24:27], s63 offen offset:0
    buffer_load_dwordx4 v[196:199], v117, s[24:27], s63 offen offset:1024
    buffer_load_dwordx4 v[200:203], v117, s[24:27], s63 offen offset:2048
    buffer_load_dwordx4 v[204:207], v117, s[24:27], s63 offen offset:3072
    s_add_u32 s63, s63, 4096
    buffer_load_dwordx4 v[208:211], v117, s[24:27], s63 offen offset:0
    buffer_load_dwordx4 v[212:215], v117, s[24:27], s63 offen offset:1024
    buffer_load_dwordx4 v[216:219], v117, s[24:27], s63 offen offset:2048
    buffer_load_dwordx4 v[220:223], v117, s[24:27], s63 offen offset:3072
    s_add_u32 s63, s63, 4096
    buffer_load_dwordx4 v[224:227], v117, s[24:27], s63 offen offset:0
    buffer_load_dwordx4 v[228:231], v117, s[24:27], s63 offen offset:1024
    buffer_load_dwordx4 v[232:235], v117, s[24:27], s63 offen offset:2048
    buffer_load_dwordx4 v[236:239], v117, s[24:27], s63 offen offset:3072
    s_add_u32 s63, s63, 4096
    buffer_load_dwordx4 v[240:243], v117, s[24:27], s63 offen offset:0
    buffer_load_dwordx4 v[244:247], v117, s[24:27], s63 offen offset:1024
    buffer_load_dwordx4 v[248:251], v117, s[24:27], s63 offen offset:2048
    buffer_load_dwordx4 v[252:255], v117, s[24:27], s63 offen offset:3072
    s_waitcnt vmcnt(0)
L_gudone_15:
    s_lshr_b32 s44, s29, 3
    v_and_b32 v3, 31, v1
    v_lshrrev_b32 v4, 5, v1
    v_bfe_u32 v5, v3, 1, 3
    s_lshl_b32 s40, s30, 14
    v_add_u32 v6, 0, v4
    v_xor_b32 v6, v6, v5
    v_lshlrev_b32 v6, 4, v6
    v_lshl_add_u32 v6, v3, 7, v6
    v_add_u32 v104, s40, v6
    v_add_u32 v6, 2, v4
    v_xor_b32 v6, v6, v5
    v_lshlrev_b32 v6, 4, v6
    v_lshl_add_u32 v6, v3, 7, v6
    v_add_u32 v105, s40, v6
    v_add_u32 v6, 4, v4
    v_xor_b32 v6, v6, v5
    v_lshlrev_b32 v6, 4, v6
    v_lshl_add_u32 v6, v3, 7, v6
    v_add_u32 v106, s40, v6
    v_add_u32 v6, 6, v4
    v_xor_b32 v6, v6, v5
    v_lshlrev_b32 v6, 4, v6
    v_lshl_add_u32 v6, v3, 7, v6
    v_add_u32 v107, s40, v6
    v_lshrrev_b32 v6, 3, v1
    v_and_b32 v7, 7, v1
    s_movk_i32 s41, 3712
    v_add_u32_e64 v8, 0, v6
    v_bfe_u32 v9, v8, 1, 3
    v_xor_b32_e64 v9, v9, v7
    v_mul_lo_u32 v8, v8, s41
    v_lshl_add_u32 v108, v9, 4, v8
    v_add_u32_e64 v8, 8, v6
    v_bfe_u32 v9, v8, 1, 3
    v_xor_b32_e64 v9, v9, v7
    v_mul_lo_u32 v8, v8, s41
    v_lshl_add_u32 v109, v9, 4, v8
    v_add_u32_e64 v8, 16, v6
    v_bfe_u32 v9, v8, 1, 3
    v_xor_b32_e64 v9, v9, v7
    v_mul_lo_u32 v8, v8, s41
    v_lshl_add_u32 v110, v9, 4, v8
    v_add_u32_e64 v8, 24, v6
    v_bfe_u32 v9, v8, 1, 3
    v_xor_b32_e64 v9, v9, v7
    v_mul_lo_u32 v8, v8, s41
    v_lshl_add_u32 v111, v9, 4, v8
    s_lshl_b32 s57, s28, 8
    s_lshl_b32 s41, s44, 5
    s_add_u32 s57, s57, s41
    s_mul_i32 s57, s57, 3712
    s_mul_i32 s41, s30, 896
    s_add_u32 s57, s57, s41
    s_add_u32 s57, s57, 13631488
    s_lshl_b32 s58, s30, 14
    s_lshl_b32 s41, s35, 7
    s_lshr_b32 s42, s30, 1
    s_lshl_b32 s42, s42, 6
    s_add_u32 s41, s41, s42
    s_and_b32 s42, s30, 1
    s_lshl_b32 s42, s42, 5
    s_add_u32 s41, s41, s42
    v_lshlrev_b32 v12, 4, v4
    v_add_u32 v12, s41, v12
    s_lshl_b32 s42, s28, 8
    s_lshl_b32 s43, s44, 5
    s_add_u32 s42, s42, s43
    v_add_u32_e64 v13, s42, v3
    s_movk_i32 s43, 1152
    v_mul_lo_u32 v13, v13, s43
    v_add_u32 v13, v13, v12
    v_mov_b32 v14, v13
    v_add_u32 v15, 147456, v13
    v_lshlrev_b32 v2, 3, v1
    v_add_u32 v2, s28, v2
    v_lshlrev_b32_e64 v2, 6, v2
    v_add_u32 v115, 98304, v2
    s_add_u32 s40, s32, 2
    s_mov_b32 exec_lo, -1
    s_mov_b32 exec_hi, 0
    s_mov_b32 s98, 0
    v_mov_b32 v2, 0
    v_mov_b32_e64 v3, 0
    s_nop 1
L_poll_33:
    buffer_load_dwordx2 v[2:3], v115, s[24:27], 0 offen sc1
    s_add_u32 s98, s98, 1
    s_cmp_gt_u32 s98, 0x40000
    s_cbranch_scc1 L_pd_34
    s_waitcnt vmcnt(0)
    v_subrev_u32_e64 v2, s40, v2
    v_cmp_gt_u32 vcc, 64, v2
    v_cmp_eq_u32 s[42:43], s33, v3
    s_nop 1
    s_and_b64 vcc, vcc, s[42:43]
    s_cmp_eq_u64 vcc, exec
    s_cbranch_scc1 L_pd_34
    s_sleep 8
    s_branch L_poll_33
L_pd_34:
    s_waitcnt vmcnt(0)
    s_mov_b64 exec, -1
    s_add_u32 m0, s58, 0
    s_nop 0
    buffer_load_dwordx4 v108, s[24:27], s57 offen lds
    s_add_u32 m0, s58, 1024
    s_nop 0
    buffer_load_dwordx4 v109, s[24:27], s57 offen lds
    s_add_u32 m0, s58, 2048
    s_nop 0
    buffer_load_dwordx4 v110, s[24:27], s57 offen lds
    s_add_u32 m0, s58, 3072
    s_nop 0
    buffer_load_dwordx4 v111, s[24:27], s57 offen lds
    s_add_u32 s57, s57, 128
    s_add_u32 m0, s58, 4096
    s_nop 0
    buffer_load_dwordx4 v108, s[24:27], s57 offen lds
    s_add_u32 m0, s58, 5120
    s_nop 0
    buffer_load_dwordx4 v109, s[24:27], s57 offen lds
    s_add_u32 m0, s58, 6144
    s_nop 0
    buffer_load_dwordx4 v110, s[24:27], s57 offen lds
    s_add_u32 m0, s58, 7168
    s_nop 0
    buffer_load_dwordx4 v111, s[24:27], s57 offen lds
    s_add_u32 s57, s57, 128
    s_add_u32 m0, s58, 8192
    s_nop 0
    buffer_load_dwordx4 v108, s[24:27], s57 offen lds
    s_add_u32 m0, s58, 9216
    s_nop 0
    buffer_load_dwordx4 v109, s[24:27], s57 offen lds
    s_add_u32 m0, s58, 10240
    s_nop 0
    buffer_load_dwordx4 v110, s[24:27], s57 offen lds
    s_add_u32 m0, s58, 11264
    s_nop 0
    buffer_load_dwordx4 v111, s[24:27], s57 offen lds
    s_add_u32 s57, s57, 128
    s_mov_b32 s47, 5242880
    buffer_load_dwordx4 v[96:99], v13, s[24:27], s47 offen
    v_add_u32 v13, 147456, v13
    buffer_load_dwordx4 v[100:103], v13, s[24:27], s47 offen
    s_mov_b32 s46, 7864320
    buffer_load_dword v116, v14, s[24:27], s46 offen
    buffer_load_dword v117, v15, s[24:27], s46 offen
    s_getpc_b64 s[42:43]
L_pc_36:
    s_lshl_b32 s40, s29, 2
    s_add_u32 s40, s40, s30
    s_lshl_b32 s40, s40, 10
    v_lshlrev_b32 v2, 4, v1
    v_add_u32_e64 v2, s40, v2
    v_min_u32 v2, 24560, v2
    v_add_u32 v2, 4096, v2
    v_min_u32 v2, L_code_end-L_pc_36-16, v2
    global_load_dwordx4 v[120:123], v2, s[42:43]
    s_waitcnt vmcnt(13)
    ds_read_b128 v[80:83], v104 offset:0
    ds_read_b128 v[84:87], v105 offset:0
    s_waitcnt lgkmcnt(1)
    v_mfma_f32_32x32x16_bf16 v[16:31], a[128:131], v[80:83], 0
    ds_read_b128 v[88:91], v106 offset:0
    v_mfma_f32_32x32x16_bf16 v[32:47], a[132:135], v[80:83], 0
    s_add_u32 m0, s58, 12288
    s_nop 0
    buffer_load_dwordx4 v108, s[24:27], s57 offen lds
    s_waitcnt lgkmcnt(1)
    v_mfma_f32_32x32x16_bf16 v[16:31], a[136:139], v[84:87], v[16:31]
    ds_read_b128 v[92:95], v107 offset:0
    v_mfma_f32_32x32x16_bf16 v[32:47], a[140:143], v[84:87], v[32:47]
    s_add_u32 m0, s58, 13312
    s_nop 0
    buffer_load_dwordx4 v109, s[24:27], s57 offen lds
    s_waitcnt vmcnt(11)
    s_waitcnt lgkmcnt(1)
    v_mfma_f32_32x32x16_bf16 v[16:31], a[144:147], v[88:91], v[16:31]
    ds_read_b128 v[80:83], v104 offset:4096
    v_mfma_f32_32x32x16_bf16 v[32:47], a[148:151], v[88:91], v[32:47]
    s_add_u32 m0, s58, 14336
    s_nop 0
    buffer_load_dwordx4 v110, s[24:27], s57 offen lds
    s_waitcnt lgkmcnt(1)
    v_mfma_f32_32x32x16_bf16 v[16:31], a[152:155], v[92:95], v[16:31]
    ds_read_b128 v[84:87], v105 offset:4096
    v_mfma_f32_32x32x16_bf16 v[32:47], a[156:159], v[92:95], v[32:47]
    s_add_u32 m0, s58, 15360
    s_nop 0
    buffer_load_dwordx4 v111, s[24:27], s57 offen lds
    s_add_u32 s57, s57, 128
    s_waitcnt lgkmcnt(1)
    v_mfma_f32_32x32x16_bf16 v[16:31], a[160:163], v[80:83], v[16:31]
    ds_read_b128 v[88:91], v106 offset:4096
    v_mfma_f32_32x32x16_bf16 v[32:47], a[164:167], v[80:83], v[32:47]
    s_add_u32 m0, s58, 0
    s_nop 0
    buffer_load_dwordx4 v108, s[24:27], s57 offen lds
    s_waitcnt lgkmcnt(1)
    v_mfma_f32_32x32x16_bf16 v[16:31], a[168:171], v[84:87], v[16:31]
    ds_read_b128 v[92:95], v107 offset:4096
    v_mfma_f32_32x32x16_bf16 v[32:47], a[172:175], v[84:87], v[32:47]
    s_add_u32 m0, s58, 1024
    s_nop 0
    buffer_load_dwordx4 v109, s[24:27], s57 offen lds
    s_waitcnt vmcnt(11)
    s_waitcnt lgkmcnt(1)
    v_mfma_f32_32x32x16_bf16 v[16:31], a[176:179], v[88:91], v[16:31]
    ds_read_b128 v[80:83], v104 offset:8192
    v_mfma_f32_32x32x16_bf16 v[32:47], a[180:183], v[88:91], v[32:47]
    s_add_u32 m0, s58, 2048
    s_nop 0
    buffer_load_dwordx4 v110, s[24:27], s57 offen lds
    s_waitcnt lgkmcnt(1)
    v_mfma_f32_32x32x16_bf16 v[16:31], a[184:187], v[92:95], v[16:31]
    ds_read_b128 v[84:87], v105 offset:8192
    v_mfma_f32_32x32x16_bf16 v[32:47], a[188:191], v[92:95], v[32:47]
    s_add_u32 m0, s58, 3072
    s_nop 0
    buffer_load_dwordx4 v111, s[24:27], s57 offen lds
    s_add_u32 s57, s57, 128
    s_waitcnt lgkmcnt(1)
    v_mfma_f32_32x32x16_bf16 v[16:31], a[192:195], v[80:83], v[16:31]
    ds_read_b128 v[88:91], v106 offset:8192
    v_mfma_f32_32x32x16_bf16 v[32:47], a[196:199], v[80:83], v[32:47]
    s_add_u32 m0, s58, 4096
    s_nop 0
    buffer_load_dwordx4 v108, s[24:27], s57 offen lds
    s_waitcnt lgkmcnt(1)
    v_mfma_f32_32x32x16_bf16 v[16:31], a[200:203], v[84:87], v[16:31]
    ds_read_b128 v[92:95], v107 offset:8192
    v_mfma_f32_32x32x16_bf16 v[32:47], a[204:207], v[84:87], v[32:47]
    s_add_u32 m0, s58, 5120
    s_nop 0
    buffer_load_dwordx4 v109, s[24:27], s57 offen lds
    s_waitcnt vmcnt(6)
    s_waitcnt lgkmcnt(1)
    v_mfma_f32_32x32x16_bf16 v[16:31], a[208:211], v[88:91], v[16:31]
    ds_read_b128 v[80:83], v104 offset:12288
    v_mfma_f32_32x32x16_bf16 v[32:47], a[212:215], v[88:91], v[32:47]
    s_add_u32 m0, s58, 6144
    s_nop 0
    buffer_load_dwordx4 v110, s[24:27], s57 offen lds
    s_waitcnt lgkmcnt(1)
    v_mfma_f32_32x32x16_bf16 v[16:31], a[216:219], v[92:95], v[16:31]
    ds_read_b128 v[84:87], v105 offset:12288
    v_mfma_f32_32x32x16_bf16 v[32:47], a[220:223], v[92:95], v[32:47]
    s_add_u32 m0, s58, 7168
    s_nop 0
    buffer_load_dwordx4 v111, s[24:27], s57 offen lds
    s_add_u32 s57, s57, 128
    s_waitcnt lgkmcnt(1)
    v_mfma_f32_32x32x16_bf16 v[16:31], a[224:227], v[80:83], v[16:31]
    ds_read_b128 v[88:91], v106 offset:12288
    v_mfma_f32_32x32x16_bf16 v[32:47], a[228:231], v[80:83], v[32:47]
    s_add_u32 m0, s58, 8192
    s_nop 0
    buffer_load_dwordx4 v108, s[24:27], s57 offen lds
    s_waitcnt lgkmcnt(1)
    v_mfma_f32_32x32x16_bf16 v[16:31], a[232:235], v[84:87], v[16:31]
    ds_read_b128 v[92:95], v107 offset:12288
    v_mfma_f32_32x32x16_bf16 v[32:47], a[236:239], v[84:87], v[32:47]
    s_add_u32 m0, s58, 9216
    s_nop 0
    buffer_load_dwordx4 v109, s[24:27], s57 offen lds
    s_waitcnt vmcnt(6)
    s_waitcnt lgkmcnt(1)
    v_mfma_f32_32x32x16_bf16 v[16:31], a[240:243], v[88:91], v[16:31]
    ds_read_b128 v[80:83], v104 offset:0
    v_mfma_f32_32x32x16_bf16 v[32:47], a[244:247], v[88:91], v[32:47]
    s_add_u32 m0, s58, 10240
    s_nop 0
    buffer_load_dwordx4 v110, s[24:27], s57 offen lds
    s_waitcnt lgkmcnt(1)
    v_mfma_f32_32x32x16_bf16 v[16:31], a[248:251], v[92:95], v[16:31]
    ds_read_b128 v[84:87], v105 offset:0
    v_mfma_f32_32x32x16_bf16 v[32:47], a[252:255], v[92:95], v[32:47]
    s_add_u32 m0, s58, 11264
    s_nop 0
    buffer_load_dwordx4 v111, s[24:27], s57 offen lds
    s_add_u32 s57, s57, 474368
    s_waitcnt lgkmcnt(1)
    v_mfma_f32_32x32x16_bf16 v[16:31], v[160:163], v[80:83], v[16:31]
    ds_read_b128 v[88:91], v106 offset:0
    v_mfma_f32_32x32x16_bf16 v[32:47], v[164:167], v[80:83], v[32:47]
    s_add_u32 s40, s32, 3
    s_mov_b32 exec_lo, -1
    s_mov_b32 exec_hi, 0
    s_mov_b32 s98, 0
    v_mov_b32 v2, 0
    v_mov_b32 v3, 0
    s_nop 5
L_poll_37:
    buffer_load_dwordx2 v[2:3], v115, s[24:27], 0 offen sc1
    s_add_u32 s98, s98, 1
    s_cmp_gt_u32 s98, 0x40000
    s_cbranch_scc1 L_pd_38
    s_waitcnt vmcnt(0)
    v_subrev_u32_e64 v2, s40, v2
    v_cmp_gt_u32 vcc, 64, v2
    v_cmp_eq_u32 s[42:43], s33, v3
    s_nop 1
    s_and_b64 vcc, vcc, s[42:43]
    s_cmp_eq_u64 vcc, exec
    s_cbranch_scc0 L_poll_37
L_pd_38:
    s_waitcnt vmcnt(0)
    s_mov_b64 exec, -1
    s_add_u32 m0, s58, 12288
    s_nop 0
    buffer_load_dwordx4 v108, s[24:27], s57 offen lds
    s_waitcnt lgkmcnt(1)
    v_mfma_f32_32x32x16_bf16 v[16:31], v[168:171], v[84:87], v[16:31]
    ds_read_b128 v[92:95], v107 offset:0
    v_mfma_f32_32x32x16_bf16 v[32:47], v[172:175], v[84:87], v[32:47]
    s_add_u32 m0, s58, 13312
    s_nop 0
    buffer_load_dwordx4 v109, s[24:27], s57 offen lds
    s_waitcnt lgkmcnt(1)
    v_mfma_f32_32x32x16_bf16 v[16:31], v[176:179], v[88:91], v[16:31]
    ds_read_b128 v[80:83], v104 offset:4096
    v_mfma_f32_32x32x16_bf16 v[32:47], v[180:183], v[88:91], v[32:47]
    s_add_u32 m0, s58, 14336
    s_nop 0
    buffer_load_dwordx4 v110, s[24:27], s57 offen lds
    s_waitcnt lgkmcnt(1)
    v_mfma_f32_32x32x16_bf16 v[16:31], v[184:187], v[92:95], v[16:31]
    ds_read_b128 v[84:87], v105 offset:4096
    v_mfma_f32_32x32x16_bf16 v[32:47], v[188:191], v[92:95], v[32:47]
    s_add_u32 m0, s58, 15360
    s_nop 0
    buffer_load_dwordx4 v111, s[24:27], s57 offen lds
    s_add_u32 s57, s57, 128
    s_waitcnt lgkmcnt(1)
    v_mfma_f32_32x32x16_bf16 v[16:31], v[192:195], v[80:83], v[16:31]
    ds_read_b128 v[88:91], v106 offset:4096
    v_mfma_f32_32x32x16_bf16 v[32:47], v[196:199], v[80:83], v[32:47]
    s_add_u32 m0, s58, 0
    s_nop 0
    buffer_load_dwordx4 v108, s[24:27], s57 offen lds
    s_waitcnt lgkmcnt(1)
    v_mfma_f32_32x32x16_bf16 v[16:31], v[200:203], v[84:87], v[16:31]
    ds_read_b128 v[92:95], v107 offset:4096
    v_mfma_f32_32x32x16_bf16 v[32:47], v[204:207], v[84:87], v[32:47]
    s_add_u32 m0, s58, 1024
    s_nop 0
    buffer_load_dwordx4 v109, s[24:27], s57 offen lds
    s_waitcnt lgkmcnt(1)
    v_mfma_f32_32x32x16_bf16 v[16:31], v[208:211], v[88:91], v[16:31]
    ds_read_b128 v[80:83], v104 offset:8192
    v_mfma_f32_32x32x16_bf16 v[32:47], v[212:215], v[88:91], v[32:47]
    s_add_u32 m0, s58, 2048
    s_nop 0
    buffer_load_dwordx4 v110, s[24:27], s57 offen lds
    s_waitcnt lgkmcnt(1)
    v_mfma_f32_32x32x16_bf16 v[16:31], v[216:219], v[92:95], v[16:31]
    ds_read_b128 v[84:87], v105 offset:8192
    v_mfma_f32_32x32x16_bf16 v[32:47], v[220:223], v[92:95], v[32:47]
    s_add_u32 m0, s58, 3072
    s_nop 0
    buffer_load_dwordx4 v111, s[24:27], s57 offen lds
    s_add_u32 s57, s57, 128
    s_waitcnt lgkmcnt(1)
    v_mfma_f32_32x32x16_bf16 v[16:31], v[224:227], v[80:83], v[16:31]
    ds_read_b128 v[88:91], v106 offset:8192
    v_mfma_f32_32x32x16_bf16 v[32:47], v[228:231], v[80:83], v[32:47]
    s_add_u32 m0, s58, 4096
    s_nop 0
    buffer_load_dwordx4 v108, s[24:27], s57 offen lds
    s_waitcnt lgkmcnt(1)
    v_mfma_f32_32x32x16_bf16 v[16:31], v[232:235], v[84:87], v[16:31]
    ds_read_b128 v[92:95], v107 offset:8192
    v_mfma_f32_32x32x16_bf16 v[32:47], v[236:239], v[84:87], v[32:47]
    s_add_u32 m0, s58, 5120
    s_nop 0
    buffer_load_dwordx4 v109, s[24:27], s57 offen lds
    s_waitcnt vmcnt(6)
    s_waitcnt lgkmcnt(1)
    v_mfma_f32_32x32x16_bf16 v[16:31], v[240:243], v[88:91], v[16:31]
    ds_read_b128 v[80:83], v104 offset:12288
    v_mfma_f32_32x32x16_bf16 v[32:47], v[244:247], v[88:91], v[32:47]
    s_add_u32 m0, s58, 6144
    s_nop 0
    buffer_load_dwordx4 v110, s[24:27], s57 offen lds
    s_waitcnt lgkmcnt(1)
    v_mfma_f32_32x32x16_bf16 v[16:31], v[248:251], v[92:95], v[16:31]
    ds_read_b128 v[84:87], v105 offset:12288
    v_mfma_f32_32x32x16_bf16 v[32:47], v[252:255], v[92:95], v[32:47]
    s_add_u32 m0, s58, 7168
    s_nop 0
    buffer_load_dwordx4 v111, s[24:27], s57 offen lds
    s_add_u32 s57, s57, 128
    s_waitcnt lgkmcnt(1)
    v_mfma_f32_32x32x16_bf16 v[48:63], a[128:131], v[80:83], 0
    ds_read_b128 v[88:91], v106 offset:12288
    v_mfma_f32_32x32x16_bf16 v[64:79], a[132:135], v[80:83], 0
    s_add_u32 m0, s58, 8192
    s_nop 0
    buffer_load_dwordx4 v108, s[24:27], s57 offen lds
    s_waitcnt lgkmcnt(1)
    v_mfma_f32_32x32x16_bf16 v[48:63], a[136:139], v[84:87], v[48:63]
    ds_read_b128 v[92:95], v107 offset:12288
    v_mfma_f32_32x32x16_bf16 v[64:79], a[140:143], v[84:87], v[64:79]
    s_add_u32 m0, s58, 9216
    s_nop 0
    buffer_load_dwordx4 v109, s[24:27], s57 offen lds
    s_waitcnt vmcnt(6)
    s_waitcnt lgkmcnt(1)
    v_mfma_f32_32x32x16_bf16 v[48:63], a[144:147], v[88:91], v[48:63]
    ds_read_b128 v[80:83], v104 offset:0
    v_mfma_f32_32x32x16_bf16 v[64:79], a[148:151], v[88:91], v[64:79]
    s_add_u32 m0, s58, 10240
    s_nop 0
    buffer_load_dwordx4 v110, s[24:27], s57 offen lds
    s_waitcnt lgkmcnt(1)
    v_mfma_f32_32x32x16_bf16 v[48:63], a[152:155], v[92:95], v[48:63]
    ds_read_b128 v[84:87], v105 offset:0
    v_mfma_f32_32x32x16_bf16 v[64:79], a[156:159], v[92:95], v[64:79]
    s_add_u32 m0, s58, 11264
    s_nop 0
    buffer_load_dwordx4 v111, s[24:27], s57 offen lds
    s_add_u32 s57, s57, 128
    s_waitcnt lgkmcnt(1)
    v_mfma_f32_32x32x16_bf16 v[48:63], a[160:163], v[80:83], v[48:63]
    ds_read_b128 v[88:91], v106 offset:0
    v_mfma_f32_32x32x16_bf16 v[64:79], a[164:167], v[80:83], v[64:79]
    s_add_u32 m0, s58, 12288
    s_nop 0
    buffer_load_dwordx4 v108, s[24:27], s57 offen lds
    s_waitcnt lgkmcnt(1)
    v_mfma_f32_32x32x16_bf16 v[48:63], a[168:171], v[84:87], v[48:63]
    ds_read_b128 v[92:95], v107 offset:0
    v_mfma_f32_32x32x16_bf16 v[64:79], a[172:175], v[84:87], v[64:79]
    s_add_u32 m0, s58, 13312
    s_nop 0
    buffer_load_dwordx4 v109, s[24:27], s57 offen lds
    s_waitcnt vmcnt(6)
    s_waitcnt lgkmcnt(1)
    v_mfma_f32_32x32x16_bf16 v[48:63], a[176:179], v[88:91], v[48:63]
    ds_read_b128 v[80:83], v104 offset:4096
    v_mfma_f32_32x32x16_bf16 v[64:79], a[180:183], v[88:91], v[64:79]
    s_add_u32 m0, s58, 14336
    s_nop 0
    buffer_load_dwordx4 v110, s[24:27], s57 offen lds
    s_waitcnt lgkmcnt(1)
    v_mfma_f32_32x32x16_bf16 v[48:63], a[184:187], v[92:95], v[48:63]
    ds_read_b128 v[84:87], v105 offset:4096
    v_mfma_f32_32x32x16_bf16 v[64:79], a[188:191], v[92:95], v[64:79]
    s_add_u32 m0, s58, 15360
    s_nop 0
    buffer_load_dwordx4 v111, s[24:27], s57 offen lds
    s_add_u32 s57, s57, 128
    s_waitcnt lgkmcnt(1)
    v_mfma_f32_32x32x16_bf16 v[48:63], a[192:195], v[80:83], v[48:63]
    ds_read_b128 v[88:91], v106 offset:4096
    v_mfma_f32_32x32x16_bf16 v[64:79], a[196:199], v[80:83], v[64:79]
    s_add_u32 m0, s58, 0
    s_nop 0
    buffer_load_dwordx4 v108, s[24:27], s57 offen lds
    s_waitcnt lgkmcnt(1)
    v_mfma_f32_32x32x16_bf16 v[48:63], a[200:203], v[84:87], v[48:63]
    ds_read_b128 v[92:95], v107 offset:4096
    v_mfma_f32_32x32x16_bf16 v[64:79], a[204:207], v[84:87], v[64:79]
    s_add_u32 m0, s58, 1024
    s_nop 0
    buffer_load_dwordx4 v109, s[24:27], s57 offen lds
    s_waitcnt vmcnt(6)
    s_waitcnt lgkmcnt(1)
    v_mfma_f32_32x32x16_bf16 v[48:63], a[208:211], v[88:91], v[48:63]
    ds_read_b128 v[80:83], v104 offset:8192
    v_mfma_f32_32x32x16_bf16 v[64:79], a[212:215], v[88:91], v[64:79]
    s_add_u32 m0, s58, 2048
    s_nop 0
    buffer_load_dwordx4 v110, s[24:27], s57 offen lds
    s_waitcnt lgkmcnt(1)
    v_mfma_f32_32x32x16_bf16 v[48:63], a[216:219], v[92:95], v[48:63]
    ds_read_b128 v[84:87], v105 offset:8192
    v_mfma_f32_32x32x16_bf16 v[64:79], a[220:223], v[92:95], v[64:79]
    s_add_u32 m0, s58, 3072
    s_nop 0
    buffer_load_dwordx4 v111, s[24:27], s57 offen lds
    s_add_u32 s57, s57, 128
    s_waitcnt lgkmcnt(1)
    v_mfma_f32_32x32x16_bf16 v[48:63], a[224:227], v[80:83], v[48:63]
    ds_read_b128 v[88:91], v106 offset:8192
    v_mfma_f32_32x32x16_bf16 v[64:79], a[228:231], v[80:83], v[64:79]
    s_add_u32 m0, s58, 4096
    s_nop 0
    buffer_load_dwordx4 v108, s[24:27], s57 offen lds
    s_waitcnt lgkmcnt(1)
    v_mfma_f32_32x32x16_bf16 v[48:63], a[232:235], v[84:87], v[48:63]
    ds_read_b128 v[92:95], v107 offset:8192
    v_mfma_f32_32x32x16_bf16 v[64:79], a[236:239], v[84:87], v[64:79]
    s_add_u32 m0, s58, 5120
    s_nop 0
    buffer_load_dwordx4 v109, s[24:27], s57 offen lds
    s_waitcnt vmcnt(6)
    s_waitcnt lgkmcnt(1)
    v_mfma_f32_32x32x16_bf16 v[48:63], a[240:243], v[88:91], v[48:63]
    ds_read_b128 v[80:83], v104 offset:12288
    v_mfma_f32_32x32x16_bf16 v[64:79], a[244:247], v[88:91], v[64:79]
    s_add_u32 m0, s58, 6144
    s_nop 0
    buffer_load_dwordx4 v110, s[24:27], s57 offen lds
    s_waitcnt lgkmcnt(1)
    v_mfma_f32_32x32x16_bf16 v[48:63], a[248:251], v[92:95], v[48:63]
    ds_read_b128 v[84:87], v105 offset:12288
    v_mfma_f32_32x32x16_bf16 v[64:79], a[252:255], v[92:95], v[64:79]
    s_add_u32 m0, s58, 7168
    s_nop 0
    buffer_load_dwordx4 v111, s[24:27], s57 offen lds
    s_add_u32 s57, s57, 128
    s_waitcnt lgkmcnt(1)
    v_mfma_f32_32x32x16_bf16 v[48:63], v[160:163], v[80:83], v[48:63]
    ds_read_b128 v[88:91], v106 offset:12288
    v_mfma_f32_32x32x16_bf16 v[64:79], v[164:167], v[80:83], v[64:79]
    s_waitcnt lgkmcnt(1)
    v_mfma_f32_32x32x16_bf16 v[48:63], v[168:171], v[84:87], v[48:63]
    ds_read_b128 v[92:95], v107 offset:12288
    v_mfma_f32_32x32x16_bf16 v[64:79], v[172:175], v[84:87], v[64:79]
    s_waitcnt vmcnt(4)
    s_waitcnt lgkmcnt(1)
    v_mfma_f32_32x32x16_bf16 v[48:63], v[176:179], v[88:91], v[48:63]
    ds_read_b128 v[80:83], v104 offset:0
    v_mfma_f32_32x32x16_bf16 v[64:79], v[180:183], v[88:91], v[64:79]
    s_waitcnt lgkmcnt(1)
    v_mfma_f32_32x32x16_bf16 v[48:63], v[184:187], v[92:95], v[48:63]
    ds_read_b128 v[84:87], v105 offset:0
    v_mfma_f32_32x32x16_bf16 v[64:79], v[188:191], v[92:95], v[64:79]
    s_waitcnt lgkmcnt(1)
    v_mfma_f32_32x32x16_bf16 v[48:63], v[192:195], v[80:83], v[48:63]
    ds_read_b128 v[88:91], v106 offset:0
    v_mfma_f32_32x32x16_bf16 v[64:79], v[196:199], v[80:83], v[64:79]
    s_waitcnt lgkmcnt(1)
    v_mfma_f32_32x32x16_bf16 v[48:63], v[200:203], v[84:87], v[48:63]
    ds_read_b128 v[92:95], v107 offset:0
    v_mfma_f32_32x32x16_bf16 v[64:79], v[204:207], v[84:87], v[64:79]
    s_waitcnt vmcnt(0)
    s_waitcnt lgkmcnt(1)
    v_mfma_f32_32x32x16_bf16 v[48:63], v[208:211], v[88:91], v[48:63]
    ds_read_b128 v[80:83], v104 offset:4096
    v_mfma_f32_32x32x16_bf16 v[64:79], v[212:215], v[88:91], v[64:79]
    s_waitcnt lgkmcnt(1)
    v_mfma_f32_32x32x16_bf16 v[48:63], v[216:219], v[92:95], v[48:63]
    ds_read_b128 v[84:87], v105 offset:4096
    v_mfma_f32_32x32x16_bf16 v[64:79], v[220:223], v[92:95], v[64:79]
    s_waitcnt lgkmcnt(1)
    v_mfma_f32_32x32x16_bf16 v[48:63], v[224:227], v[80:83], v[48:63]
    ds_read_b128 v[88:91], v106 offset:4096
    v_mfma_f32_32x32x16_bf16 v[64:79], v[228:231], v[80:83], v[64:79]
    s_waitcnt lgkmcnt(1)
    v_mfma_f32_32x32x16_bf16 v[48:63], v[232:235], v[84:87], v[48:63]
    ds_read_b128 v[92:95], v107 offset:4096
    v_mfma_f32_32x32x16_bf16 v[64:79], v[236:239], v[84:87], v[64:79]
    s_waitcnt lgkmcnt(1)
    v_mfma_f32_32x32x16_bf16 v[48:63], v[240:243], v[88:91], v[48:63]
    v_mfma_f32_32x32x16_bf16 v[64:79], v[244:247], v[88:91], v[64:79]
    s_waitcnt lgkmcnt(0)
    v_mfma_f32_32x32x16_bf16 v[48:63], v[248:251], v[92:95], v[48:63]
    v_mfma_f32_32x32x16_bf16 v[64:79], v[252:255], v[92:95], v[64:79]
    v_lshlrev_b32 v2, 4, v1
    s_lshl_b32 s40, s35, 15
    s_lshl_b32 s41, s30, 13
    s_add_u32 s40, s40, s41
    s_add_u32 s40, s40, 524288
    s_add_u32 s41, s41, 131072
    s_add_u32 m0, s41, 0
    s_nop 0
    buffer_load_dwordx4 v2, s[24:27], s40 offen offset:0 lds
    buffer_load_dwordx4 v2, s[24:27], s40 offen offset:1024 lds
    buffer_load_dwordx4 v2, s[24:27], s40 offen offset:2048 lds
    buffer_load_dwordx4 v2, s[24:27], s40 offen offset:3072 lds
    s_add_u32 m0, s41, 4096
    s_add_u32 s40, s40, 4096
    buffer_load_dwordx4 v2, s[24:27], s40 offen offset:0 lds
    buffer_load_dwordx4 v2, s[24:27], s40 offen offset:1024 lds
    buffer_load_dwordx4 v2, s[24:27], s40 offen offset:2048 lds
    buffer_load_dwordx4 v2, s[24:27], s40 offen offset:3072 lds
    v_lshlrev_b32 v2, 4, v1
    s_lshl_b32 s40, s30, 14
    v_add_u32_e64 v3, s40, v2
    ds_write_b128 v3, v[16:19] offset:0
    ds_write_b128 v3, v[20:23] offset:1024
    ds_write_b128 v3, v[24:27] offset:2048
    ds_write_b128 v3, v[28:31] offset:3072
    ds_write_b128 v3, v[32:35] offset:4096
    ds_write_b128 v3, v[36:39] offset:5120
    ds_write_b128 v3, v[40:43] offset:6144
    ds_write_b128 v3, v[44:47] offset:7168
    ds_write_b128 v3, v[48:51] offset:8192
    ds_write_b128 v3, v[52:55] offset:9216
    ds_write_b128 v3, v[56:59] offset:10240
    ds_write_b128 v3, v[60:63] offset:11264
    ds_write_b128 v3, v[64:67] offset:12288
    ds_write_b128 v3, v[68:71] offset:13312
    ds_write_b128 v3, v[72:75] offset:14336
    ds_write_b128 v3, v[76:79] offset:15360
    s_waitcnt lgkmcnt(0)
    s_barrier
    s_lshl_b32 s40, s30, 11
    v_add_u32 v3, s40, v2
    ds_read_b128 v[16:19], v3 offset:0
    ds_read_b128 v[20:23], v3 offset:1024
    ds_read_b128 v[24:27], v3 offset:16384
    ds_read_b128 v[28:31], v3 offset:17408
    ds_read_b128 v[32:35], v3 offset:32768
    ds_read_b128 v[36:39], v3 offset:33792
    ds_read_b128 v[40:43], v3 offset:49152
    ds_read_b128 v[44:47], v3 offset:50176
    ds_read_b128 v[48:51], v3 offset:8192
    ds_read_b128 v[52:55], v3 offset:9216
    ds_read_b128 v[56:59], v3 offset:24576
    ds_read_b128 v[60:63], v3 offset:25600
    ds_read_b128 v[64:67], v3 offset:40960
    ds_read_b128 v[68:71], v3 offset:41984
    ds_read_b128 v[72:75], v3 offset:57344
    ds_read_b128 v[76:79], v3 offset:58368
    s_mov_b32 s54, 0xffff0000
    s_waitcnt lgkmcnt(13)
    v_add_f32 v16, v16, v24
    v_add_f32 v17, v17, v25
    v_add_f32 v18, v18, v26
    v_add_f32 v19, v19, v27
    s_waitcnt lgkmcnt(12)
    v_add_f32 v20, v20, v28
    v_add_f32 v21, v21, v29
    v_add_f32 v22, v22, v30
    v_add_f32 v23, v23, v31
    s_waitcnt lgkmcnt(9)
    v_add_f32 v32, v32, v40
    v_add_f32 v33, v33, v41
    v_add_f32 v34, v34, v42
    v_add_f32 v35, v35, v43
    s_waitcnt lgkmcnt(8)
    v_add_f32 v36, v36, v44
    v_add_f32 v37, v37, v45
    v_add_f32 v38, v38, v46
    v_add_f32 v39, v39, v47
    v_add_f32 v16, v16, v32
    v_add_f32 v17, v17, v33
    v_add_f32 v18, v18, v34
    v_add_f32 v19, v19, v35
    v_add_f32 v20, v20, v36
    v_add_f32 v21, v21, v37
    v_add_f32 v22, v22, v38
    v_add_f32 v23, v23, v39
    v_lshlrev_b32 v24, 16, v96
    v_and_b32 v25, s54, v96
    v_lshlrev_b32 v26, 16, v97
    v_and_b32 v27, s54, v97
    v_lshlrev_b32 v28, 16, v98
    v_and_b32 v29, s54, v98
    v_lshlrev_b32 v30, 16, v99
    v_and_b32 v31, s54, v99
    v_add_f32 v16, v16, v24
    v_add_f32 v17, v17, v25
    v_add_f32 v18, v18, v26
    v_add_f32 v19, v19, v27
    v_add_f32 v20, v20, v28
    v_add_f32 v21, v21, v29
    v_add_f32 v22, v22, v30
    v_add_f32 v23, v23, v31
    v_cvt_pk_bf16_f32 v32, v16, v17
    v_cvt_pk_bf16_f32 v33, v18, v19
    v_cvt_pk_bf16_f32 v34, v20, v21
    v_cvt_pk_bf16_f32 v35, v22, v23
    s_mov_b32 s46, 7864320
    buffer_store_dwordx4 v[32:35], v14, s[24:27], s46 offen
    s_waitcnt lgkmcnt(5)
    v_add_f32 v48, v48, v56
    v_add_f32 v49, v49, v57
    v_add_f32 v50, v50, v58
    v_add_f32 v51, v51, v59
    s_waitcnt lgkmcnt(4)
    v_add_f32 v52, v52, v60
    v_add_f32 v53, v53, v61
    v_add_f32 v54, v54, v62
    v_add_f32 v55, v55, v63
    s_waitcnt lgkmcnt(1)
    v_add_f32 v64, v64, v72
    v_add_f32 v65, v65, v73
    v_add_f32 v66, v66, v74
    v_add_f32 v67, v67, v75
    s_waitcnt lgkmcnt(0)
    v_add_f32 v68, v68, v76
    v_add_f32 v69, v69, v77
    v_add_f32 v70, v70, v78
    v_add_f32 v71, v71, v79
    v_add_f32 v48, v48, v64
    v_add_f32 v49, v49, v65
    v_add_f32 v50, v50, v66
    v_add_f32 v51, v51, v67
    v_add_f32 v52, v52, v68
    v_add_f32 v53, v53, v69
    v_add_f32 v54, v54, v70
    v_add_f32 v55, v55, v71
    v_lshlrev_b32 v56, 16, v100
    v_and_b32 v57, s54, v100
    v_lshlrev_b32 v58, 16, v101
    v_and_b32 v59, s54, v101
    v_lshlrev_b32 v60, 16, v102
    v_and_b32 v61, s54, v102
    v_lshlrev_b32 v62, 16, v103
    v_and_b32 v63, s54, v103
    v_add_f32 v48, v48, v56
    v_add_f32 v49, v49, v57
    v_add_f32 v50, v50, v58
    v_add_f32 v51, v51, v59
    v_add_f32 v52, v52, v60
    v_add_f32 v53, v53, v61
    v_add_f32 v54, v54, v62
    v_add_f32 v55, v55, v63
    v_cvt_pk_bf16_f32 v64, v48, v49
    v_cvt_pk_bf16_f32 v65, v50, v51
    v_cvt_pk_bf16_f32 v66, v52, v53
    v_cvt_pk_bf16_f32 v67, v54, v55
    s_mov_b32 s46, 7864320
    buffer_store_dwordx4 v[64:67], v15, s[24:27], s46 offen
    s_waitcnt vmcnt(0)
    s_barrier
    s_cmp_lg_u32 s30, 0
    s_cbranch_scc1 L_fs_40
    s_add_u32 s40, s32, 4
    v_mov_b32 v2, s40
    v_mov_b32 v3, s33
    s_lshl_b32 s41, s2, 6
    s_add_u32 s41, s41, 98304
    v_mov_b32 v4, s41
    s_mov_b64 exec, 1
    buffer_store_dwordx2 v[2:3], v4, s[24:27], 0 offen
    s_mov_b64 exec, -1
L_fs_40:
    v_and_b32 v2, 15, v1
    v_lshrrev_b32 v3, 4, v1
    v_cvt_f32_u32 v2, v2
    s_lshl_b32 s40, s36, 2
    s_add_u32 s40, s40, s30
    s_lshl_b32 s40, s40, 4
    s_add_u32 s40, s40, s37
    v_lshlrev_b32 v3, 9, v3
    v_add_u32 v3, s40, v3
    v_cvt_f32_u32_e64 v3, v3
    v_mul_f32 v3, 0x3a000000, v3
    v_mul_f32_e64 v4, v2, v3
    v_mul_f32 v5, 0x3d800000, v2
    v_fract_f32 v8, v4
    v_add_f32 v4, v4, v5
    v_fract_f32 v9, v4
    v_add_f32 v4, v4, v5
    v_fract_f32 v10, v4
    v_add_f32 v4, v4, v5
    v_fract_f32 v11, v4
    v_cos_f32 v12, v8
    v_cos_f32 v13, v9
    v_cos_f32 v14, v10
    v_cos_f32 v15, v11
    v_sin_f32 v8, v8
    v_sin_f32 v9, v9
    v_sin_f32 v10, v10
    v_sin_f32_e64 v11, v11
    v_cvt_pk_bf16_f32 v136, v12, v13
    v_cvt_pk_bf16_f32 v137, v14, v15
    v_cvt_pk_bf16_f32 v138, v8, v9
    v_cvt_pk_bf16_f32 v139, v10, v11
    v_xor_b32 v140, 0x80008000, v138
    v_xor_b32 v141, 0x80008000, v139
    v_mov_b32 v142, v136
    v_mov_b32 v143, v137
    v_lshlrev_b32 v2, 3, v1
    v_add_u32 v2, s28, v2
    v_lshlrev_b32_e64 v2, 6, v2
    v_add_u32 v4, 98304, v2
    s_nop 1
    s_cmp_lg_u32 s30, 0
    s_cbranch_scc1 L_ps_43
    s_add_u32 s40, s32, 4
    s_mov_b32 exec_lo, -1
    s_mov_b32 exec_hi, 0
    s_mov_b32 s98, 0
    v_mov_b32 v2, 0
    v_mov_b32 v3, 0
    s_nop 1
L_poll_41:
    buffer_load_dwordx2 v[2:3], v4, s[24:27], 0 offen sc1
    s_add_u32 s98, s98, 1
    s_cmp_gt_u32 s98, 0x40000
    s_cbranch_scc1 L_pd_42
    s_waitcnt vmcnt(0)
    v_subrev_u32_e64 v2, s40, v2
    v_cmp_gt_u32 vcc, 64, v2
    v_cmp_eq_u32 s[42:43], s33, v3
    s_nop 1
    s_and_b64 vcc, vcc, s[42:43]
    s_cmp_eq_u64 vcc, exec
    s_cbranch_scc0 L_poll_41
L_pd_42:
    s_waitcnt vmcnt(0)
    s_mov_b64 exec, -1
L_ps_43:
    s_waitcnt vmcnt(0)
    s_barrier
    v_lshlrev_b32 v14, 4, v1
    s_lshl_b32 s50, s34, 7
    s_lshl_b32 s41, s36, 6
    s_add_u32 s50, s50, s41
    s_lshl_b32 s41, s30, 4
    s_add_u32 s50, s50, s41
    s_lshl_b32 s41, s28, 8
    s_add_u32 s50, s50, s41
    s_mul_i32 s50, s50, 1152
    s_add_u32 s50, s50, 7864320
    s_lshl_b32 s51, s30, 14
    s_add_u32 s51, s51, 0
    v_xor_b32_e64 v15, 0, v14
    s_mov_b32 m0, s51
    s_nop 0
    buffer_load_dwordx4 v15, s[24:27], s50 offen lds
    s_add_u32 s50, s50, 1152
    s_add_u32 s51, s51, 1024
    v_xor_b32_e64 v15, 16, v14
    s_mov_b32 m0, s51
    s_nop 0
    buffer_load_dwordx4 v15, s[24:27], s50 offen lds
    s_add_u32 s50, s50, 1152
    s_add_u32 s51, s51, 1024
    v_xor_b32_e64 v15, 32, v14
    s_mov_b32 m0, s51
    s_nop 0
    buffer_load_dwordx4 v15, s[24:27], s50 offen lds
    s_add_u32 s50, s50, 1152
    s_add_u32 s51, s51, 1024
    v_xor_b32_e64 v15, 48, v14
    s_mov_b32 m0, s51
    s_nop 0
    buffer_load_dwordx4 v15, s[24:27], s50 offen lds
    s_add_u32 s50, s50, 1152
    s_add_u32 s51, s51, 1024
    v_xor_b32_e64 v15, 64, v14
    s_mov_b32 m0, s51
    s_nop 0
    buffer_load_dwordx4 v15, s[24:27], s50 offen lds
    s_add_u32 s50, s50, 1152
    s_add_u32 s51, s51, 1024
    v_xor_b32 v15, 80, v14
    s_mov_b32 m0, s51
    s_nop 0
    buffer_load_dwordx4 v15, s[24:27], s50 offen lds
    s_add_u32 s50, s50, 1152
    s_add_u32 s51, s51, 1024
    v_xor_b32 v15, 96, v14
    s_mov_b32 m0, s51
    s_nop 0
    buffer_load_dwordx4 v15, s[24:27], s50 offen lds
    s_add_u32 s50, s50, 1152
    s_add_u32 s51, s51, 1024
    v_xor_b32 v15, 112, v14
    s_mov_b32 m0, s51
    s_nop 0
    buffer_load_dwordx4 v15, s[24:27], s50 offen lds
    s_add_u32 s50, s50, 1152
    s_add_u32 s51, s51, 1024
    v_xor_b32 v15, 128, v14
    s_mov_b32 m0, s51
    s_nop 0
    buffer_load_dwordx4 v15, s[24:27], s50 offen lds
    s_add_u32 s50, s50, 1152
    s_add_u32 s51, s51, 1024
    v_xor_b32 v15, 144, v14
    s_mov_b32 m0, s51
    s_nop 0
    buffer_load_dwordx4 v15, s[24:27], s50 offen lds
    s_add_u32 s50, s50, 1152
    s_add_u32 s51, s51, 1024
    v_xor_b32 v15, 160, v14
    s_mov_b32 m0, s51
    s_nop 0
    buffer_load_dwordx4 v15, s[24:27], s50 offen lds
    s_add_u32 s50, s50, 1152
    s_add_u32 s51, s51, 1024
    v_xor_b32 v15, 176, v14
    s_mov_b32 m0, s51
    s_nop 0
    buffer_load_dwordx4 v15, s[24:27], s50 offen lds
    s_add_u32 s50, s50, 1152
    s_add_u32 s51, s51, 1024
    v_xor_b32 v15, 192, v14
    s_mov_b32 m0, s51
    s_nop 0
    buffer_load_dwordx4 v15, s[24:27], s50 offen lds
    s_add_u32 s50, s50, 1152
    s_add_u32 s51, s51, 1024
    v_xor_b32 v15, 208, v14
    s_mov_b32 m0, s51
    s_nop 0
    buffer_load_dwordx4 v15, s[24:27], s50 offen lds
    s_add_u32 s50, s50, 1152
    s_add_u32 s51, s51, 1024
    v_xor_b32 v15, 224, v14
    s_mov_b32 m0, s51
    s_nop 0
    buffer_load_dwordx4 v15, s[24:27], s50 offen lds
    s_add_u32 s50, s50, 1152
    s_add_u32 s51, s51, 1024
    v_xor_b32 v15, 240, v14
    s_mov_b32 m0, s51
    s_nop 0
    buffer_load_dwordx4 v15, s[24:27], s50 offen lds
    v_and_b32 v2, 15, v1
    v_lshrrev_b32 v3, 4, v1
    v_and_b32 v8, 3, v2
    v_xor_b32 v8, v8, v3
    v_lshlrev_b32 v8, 4, v8
    v_lshrrev_b32 v9, 2, v2
    v_lshl_add_u32 v11, v2, 10, v8
    s_lshl_b32 s40, s30, 14
    s_add_u32 s40, s40, 0
    v_add_u32_e64 v11, s40, v11
    v_lshl_add_u32 v8, v2, 9, v8
    v_add_u32 v8, 0x20000, v8
    v_xor_b32_e64 v10, 0, v9
    v_lshl_add_u32 v4, v10, 6, v8
    v_lshl_add_u32 v16, v10, 6, v11
    v_xor_b32_e64 v10, 1, v9
    v_lshl_add_u32 v5, v10, 6, v8
    v_lshl_add_u32 v17, v10, 6, v11
    v_xor_b32_e64 v10, 2, v9
    v_lshl_add_u32 v6, v10, 6, v8
    v_lshl_add_u32 v18, v10, 6, v11
    v_xor_b32_e64 v10, 3, v9
    v_lshl_add_u32 v7, v10, 6, v8
    v_lshl_add_u32 v19, v10, 6, v11
    v_mov_b32 v12, 0x3f803f80
    v_mov_b32 v13, 0x3f803f80
    v_mov_b32 v14, 0x3f803f80
    v_mov_b32 v15, 0x3f803f80
    ds_read_b128 v[104:107], v4 offset:0
    ds_read_b128 v[108:111], v4 offset:8192
    ds_read_b128 v[112:115], v4 offset:16384
    ds_read_b128 v[116:119], v4 offset:24576
    s_waitcnt vmcnt(0)
    ds_read_b128 v[24:27], v16 offset:0
    ds_read_b128 v[28:31], v17 offset:0
    ds_read_b128 v[32:35], v18 offset:0
    ds_read_b128 v[36:39], v19 offset:0
    ds_read_b128 v[40:43], v16 offset:256
    ds_read_b128 v[44:47], v17 offset:256
    ds_read_b128 v[48:51], v18 offset:256
    s_waitcnt lgkmcnt(6)
    v_mfma_f32_16x16x32_bf16 v[96:99], v[24:27], v[12:15], 0
    v_mfma_f32_16x16x32_bf16 v[100:103], v[24:27], v[24:27], 0
    ds_read_b128 v[52:55], v19 offset:256
    s_waitcnt lgkmcnt(6)
    v_mfma_f32_16x16x32_bf16 v[96:99], v[28:31], v[12:15], v[96:99]
    v_mfma_f32_16x16x32_bf16 v[100:103], v[28:31], v[28:31], v[100:103]
    ds_read_b128 v[24:27], v16 offset:512
    s_waitcnt lgkmcnt(6)
    v_mfma_f32_16x16x32_bf16 v[96:99], v[32:35], v[12:15], v[96:99]
    v_mfma_f32_16x16x32_bf16 v[100:103], v[32:35], v[32:35], v[100:103]
    ds_read_b128 v[28:31], v17 offset:512
    s_waitcnt lgkmcnt(6)
    v_mfma_f32_16x16x32_bf16 v[96:99], v[36:39], v[12:15], v[96:99]
    v_mfma_f32_16x16x32_bf16 v[100:103], v[36:39], v[36:39], v[100:103]
    ds_read_b128 v[32:35], v18 offset:512
    s_waitcnt lgkmcnt(6)
    v_mfma_f32_16x16x32_bf16 v[96:99], v[40:43], v[12:15], v[96:99]
    v_mfma_f32_16x16x32_bf16 v[100:103], v[40:43], v[40:43], v[100:103]
    ds_read_b128 v[36:39], v19 offset:512
    s_waitcnt lgkmcnt(6)
    v_mfma_f32_16x16x32_bf16 v[96:99], v[44:47], v[12:15], v[96:99]
    v_mfma_f32_16x16x32_bf16 v[100:103], v[44:47], v[44:47], v[100:103]
    ds_read_b128 v[40:43], v16 offset:768
    s_waitcnt lgkmcnt(6)
    v_mfma_f32_16x16x32_bf16 v[96:99], v[48:51], v[12:15], v[96:99]
    v_mfma_f32_16x16x32_bf16 v[100:103], v[48:51], v[48:51], v[100:103]
    ds_read_b128 v[44:47], v17 offset:768
    s_waitcnt lgkmcnt(6)
    v_mfma_f32_16x16x32_bf16 v[96:99], v[52:55], v[12:15], v[96:99]
    v_mfma_f32_16x16x32_bf16 v[100:103], v[52:55], v[52:55], v[100:103]
    ds_read_b128 v[48:51], v18 offset:768
    s_waitcnt lgkmcnt(6)
    v_mfma_f32_16x16x32_bf16 v[96:99], v[24:27], v[12:15], v[96:99]
    v_mfma_f32_16x16x32_bf16 v[100:103], v[24:27], v[24:27], v[100:103]
    ds_read_b128 v[52:55], v19 offset:768
    s_waitcnt lgkmcnt(6)
    v_mfma_f32_16x16x32_bf16 v[96:99], v[28:31], v[12:15], v[96:99]
    v_mfma_f32_16x16x32_bf16 v[100:103], v[28:31], v[28:31], v[100:103]
    s_waitcnt lgkmcnt(5)
    v_mfma_f32_16x16x32_bf16 v[96:99], v[32:35], v[12:15], v[96:99]
    v_mfma_f32_16x16x32_bf16 v[100:103], v[32:35], v[32:35], v[100:103]
    s_waitcnt lgkmcnt(4)
    v_mfma_f32_16x16x32_bf16 v[96:99], v[36:39], v[12:15], v[96:99]
    v_mfma_f32_16x16x32_bf16 v[100:103], v[36:39], v[36:39], v[100:103]
    s_waitcnt lgkmcnt(3)
    v_mfma_f32_16x16x32_bf16 v[96:99], v[40:43], v[12:15], v[96:99]
    v_mfma_f32_16x16x32_bf16 v[100:103], v[40:43], v[40:43], v[100:103]
    s_waitcnt lgkmcnt(2)
    v_mfma_f32_16x16x32_bf16 v[96:99], v[44:47], v[12:15], v[96:99]
    v_mfma_f32_16x16x32_bf16 v[100:103], v[44:47], v[44:47], v[100:103]
    s_waitcnt lgkmcnt(1)
    v_mfma_f32_16x16x32_bf16 v[96:99], v[48:51], v[12:15], v[96:99]
    v_mfma_f32_16x16x32_bf16 v[100:103], v[48:51], v[48:51], v[100:103]
    s_waitcnt lgkmcnt(0)
    v_mfma_f32_16x16x32_bf16 v[96:99], v[52:55], v[12:15], v[96:99]
    v_mfma_f32_16x16x32_bf16 v[100:103], v[52:55], v[52:55], v[100:103]
    ds_read_b128 v[24:27], v16 offset:0
    ds_read_b128 v[28:31], v16 offset:512
    ds_read_b128 v[32:35], v17 offset:0
    ds_read_b128 v[36:39], v17 offset:512
    s_waitcnt lgkmcnt(3)
    v_mfma_f32_16x16x32_bf16 v[80:83], v[24:27], v[104:107], 0
    s_waitcnt lgkmcnt(2)
    v_mfma_f32_16x16x32_bf16 v[120:123], v[28:31], v[104:107], 0
    ds_read_b128 v[104:107], v5 offset:0
    v_mfma_f32_16x16x32_bf16 v[84:87], v[24:27], v[108:111], 0
    v_mfma_f32_16x16x32_bf16 v[124:127], v[28:31], v[108:111], 0
    ds_read_b128 v[108:111], v5 offset:8192
    v_mfma_f32_16x16x32_bf16 v[88:91], v[24:27], v[112:115], 0
    v_mfma_f32_16x16x32_bf16 v[128:131], v[28:31], v[112:115], 0
    ds_read_b128 v[112:115], v5 offset:16384
    v_mfma_f32_16x16x32_bf16 v[92:95], v[24:27], v[116:119], 0
    v_mfma_f32_16x16x32_bf16 v[132:135], v[28:31], v[116:119], 0
    ds_read_b128 v[116:119], v5 offset:24576
    ds_read_b128 v[40:43], v18 offset:0
    ds_read_b128 v[44:47], v18 offset:512
    s_waitcnt lgkmcnt(5)
    v_mfma_f32_16x16x32_bf16 v[80:83], v[32:35], v[104:107], v[80:83]
    v_mfma_f32_16x16x32_bf16 v[120:123], v[36:39], v[104:107], v[120:123]
    ds_read_b128 v[104:107], v6 offset:0
    v_lshrrev_b32_e64 v3, 4, v1
    v_mul_u32_u24 v3, 80, v3
    s_waitcnt lgkmcnt(5)
    v_mfma_f32_16x16x32_bf16 v[84:87], v[32:35], v[108:111], v[84:87]
    v_mfma_f32_16x16x32_bf16 v[124:127], v[36:39], v[108:111], v[124:127]
    ds_read_b128 v[108:111], v6 offset:8192
    v_add_u32 v2, 0, v3
    ds_bpermute_b32 v8, v2, v100
    s_waitcnt lgkmcnt(6)
    v_mfma_f32_16x16x32_bf16 v[88:91], v[32:35], v[112:115], v[88:91]
    v_mfma_f32_16x16x32_bf16 v[128:131], v[36:39], v[112:115], v[128:131]
    ds_read_b128 v[112:115], v6 offset:16384
    v_add_u32 v2, 4, v3
    ds_bpermute_b32 v9, v2, v101
    s_waitcnt lgkmcnt(7)
    v_mfma_f32_16x16x32_bf16 v[92:95], v[32:35], v[116:119], v[92:95]
    v_mfma_f32_16x16x32_bf16 v[132:135], v[36:39], v[116:119], v[132:135]
    ds_read_b128 v[116:119], v6 offset:24576
    v_add_u32 v2, 8, v3
    ds_bpermute_b32 v10, v2, v102
    ds_read_b128 v[48:51], v19 offset:0
    ds_read_b128 v[52:55], v19 offset:512
    s_waitcnt lgkmcnt(8)
    v_mfma_f32_16x16x32_bf16 v[80:83], v[40:43], v[104:107], v[80:83]
    v_mfma_f32_16x16x32_bf16 v[120:123], v[44:47], v[104:107], v[120:123]
    ds_read_b128 v[104:107], v7 offset:0
    v_add_u32 v2, 12, v3
    ds_bpermute_b32 v11, v2, v103
    s_waitcnt lgkmcnt(9)
    v_mfma_f32_16x16x32_bf16 v[84:87], v[40:43], v[108:111], v[84:87]
    v_mfma_f32_16x16x32_bf16 v[124:127], v[44:47], v[108:111], v[124:127]
    ds_read_b128 v[108:111], v7 offset:8192
    v_mul_f32 v96, 0x3b000000, v96
    v_mul_f32 v97, 0x3b000000, v97
    s_waitcnt lgkmcnt(8)
    v_mfma_f32_16x16x32_bf16 v[88:91], v[40:43], v[112:115], v[88:91]
    v_mfma_f32_16x16x32_bf16 v[128:131], v[44:47], v[112:115], v[128:131]
    ds_read_b128 v[112:115], v7 offset:16384
    v_mul_f32 v98, 0x3b000000, v98
    v_mul_f32 v99, 0x3b000000, v99
    s_waitcnt lgkmcnt(7)
    v_mfma_f32_16x16x32_bf16 v[92:95], v[40:43], v[116:119], v[92:95]
    v_mfma_f32_16x16x32_bf16 v[132:135], v[44:47], v[116:119], v[132:135]
    ds_read_b128 v[116:119], v7 offset:24576
    v_mul_f32 v8, 0x3b000000, v8
    v_mul_f32 v9, 0x3b000000, v9
    ds_read_b128 v[24:27], v16 offset:256
    ds_read_b128 v[28:31], v16 offset:768
    s_waitcnt lgkmcnt(6)
    v_mfma_f32_16x16x32_bf16 v[80:83], v[48:51], v[104:107], v[80:83]
    v_mfma_f32_16x16x32_bf16 v[120:123], v[52:55], v[104:107], v[120:123]
    ds_read_b128 v[104:107], v4 offset:256
    v_mul_f32 v10, 0x3b000000, v10
    s_waitcnt lgkmcnt(6)
    v_mul_f32 v11, 0x3b000000, v11
    s_waitcnt lgkmcnt(5)
    v_mfma_f32_16x16x32_bf16 v[84:87], v[48:51], v[108:111], v[84:87]
    v_mfma_f32_16x16x32_bf16 v[124:127], v[52:55], v[108:111], v[124:127]
    ds_read_b128 v[108:111], v4 offset:8448
    v_fma_f32 v8, -v96, v96, v8
    v_fma_f32 v9, -v97, v97, v9
    s_waitcnt lgkmcnt(5)
    v_mfma_f32_16x16x32_bf16 v[88:91], v[48:51], v[112:115], v[88:91]
    v_mfma_f32_16x16x32_bf16 v[128:131], v[52:55], v[112:115], v[128:131]
    ds_read_b128 v[112:115], v4 offset:16640
    v_fma_f32 v10, -v98, v98, v10
    v_fma_f32 v11, -v99, v99, v11
    s_waitcnt lgkmcnt(5)
    v_mfma_f32_16x16x32_bf16 v[92:95], v[48:51], v[116:119], v[92:95]
    v_mfma_f32_16x16x32_bf16 v[132:135], v[52:55], v[116:119], v[132:135]
    ds_read_b128 v[116:119], v4 offset:24832
    v_add_f32 v8, 0x3727c5ac, v8
    v_add_f32 v9, 0x3727c5ac, v9
    ds_read_b128 v[32:35], v17 offset:256
    ds_read_b128 v[36:39], v17 offset:768
    s_waitcnt lgkmcnt(5)
    v_mfma_f32_16x16x32_bf16 v[80:83], v[24:27], v[104:107], v[80:83]
    v_mfma_f32_16x16x32_bf16 v[120:123], v[28:31], v[104:107], v[120:123]
    ds_read_b128 v[104:107], v5 offset:256
    v_add_f32 v10, 0x3727c5ac, v10
    v_add_f32 v11, 0x3727c5ac, v11
    s_waitcnt lgkmcnt(5)
    v_mfma_f32_16x16x32_bf16 v[84:87], v[24:27], v[108:111], v[84:87]
    v_mfma_f32_16x16x32_bf16 v[124:127], v[28:31], v[108:111], v[124:127]
    ds_read_b128 v[108:111], v5 offset:8448
    v_rsq_f32 v8, v8
    v_rsq_f32_e64 v9, v9
    s_waitcnt lgkmcnt(5)
    v_mfma_f32_16x16x32_bf16 v[88:91], v[24:27], v[112:115], v[88:91]
    v_mfma_f32_16x16x32_bf16 v[128:131], v[28:31], v[112:115], v[128:131]
    ds_read_b128 v[112:115], v5 offset:16640
    v_rsq_f32 v10, v10
    v_rsq_f32_e64 v11, v11
    s_waitcnt lgkmcnt(5)
    v_mfma_f32_16x16x32_bf16 v[92:95], v[24:27], v[116:119], v[92:95]
    v_mfma_f32_16x16x32_bf16 v[132:135], v[28:31], v[116:119], v[132:135]
    ds_read_b128 v[116:119], v5 offset:24832
    v_and_b32 v2, 1, v1
    v_lshlrev_b32 v2, 31, v2
    ds_read_b128 v[40:43], v18 offset:256
    ds_read_b128 v[44:47], v18 offset:768
    s_waitcnt lgkmcnt(5)
    v_mfma_f32_16x16x32_bf16 v[80:83], v[32:35], v[104:107], v[80:83]
    v_mfma_f32_16x16x32_bf16 v[120:123], v[36:39], v[104:107], v[120:123]
    ds_read_b128 v[104:107], v6 offset:256
    v_or_b32_e64 v2, 1.0, v2
    s_waitcnt lgkmcnt(5)
    v_mfma_f32_16x16x32_bf16 v[84:87], v[32:35], v[108:111], v[84:87]
    v_mfma_f32_16x16x32_bf16 v[124:127], v[36:39], v[108:111], v[124:127]
    ds_read_b128 v[108:111], v6 offset:8448
    s_waitcnt lgkmcnt(5)
    v_mfma_f32_16x16x32_bf16 v[88:91], v[32:35], v[112:115], v[88:91]
    v_mfma_f32_16x16x32_bf16 v[128:131], v[36:39], v[112:115], v[128:131]
    ds_read_b128 v[112:115], v6 offset:16640
    s_waitcnt lgkmcnt(5)
    v_mfma_f32_16x16x32_bf16 v[92:95], v[32:35], v[116:119], v[92:95]
    v_mfma_f32_16x16x32_bf16 v[132:135], v[36:39], v[116:119], v[132:135]
    ds_read_b128 v[116:119], v6 offset:24832
    ds_read_b128 v[48:51], v19 offset:256
    ds_read_b128 v[52:55], v19 offset:768
    s_waitcnt lgkmcnt(5)
    v_mfma_f32_16x16x32_bf16 v[80:83], v[40:43], v[104:107], v[80:83]
    v_mfma_f32_16x16x32_bf16 v[120:123], v[44:47], v[104:107], v[120:123]
    ds_read_b128 v[104:107], v7 offset:256
    s_waitcnt lgkmcnt(5)
    v_mfma_f32_16x16x32_bf16 v[84:87], v[40:43], v[108:111], v[84:87]
    v_mfma_f32_16x16x32_bf16 v[124:127], v[44:47], v[108:111], v[124:127]
    ds_read_b128 v[108:111], v7 offset:8448
    s_waitcnt lgkmcnt(5)
    v_mfma_f32_16x16x32_bf16 v[88:91], v[40:43], v[112:115], v[88:91]
    v_mfma_f32_16x16x32_bf16 v[128:131], v[44:47], v[112:115], v[128:131]
    ds_read_b128 v[112:115], v7 offset:16640
    s_waitcnt lgkmcnt(5)
    v_mfma_f32_16x16x32_bf16 v[92:95], v[40:43], v[116:119], v[92:95]
    v_mfma_f32_16x16x32_bf16 v[132:135], v[44:47], v[116:119], v[132:135]
    ds_read_b128 v[116:119], v7 offset:24832
    s_waitcnt lgkmcnt(3)
    v_mfma_f32_16x16x32_bf16 v[80:83], v[48:51], v[104:107], v[80:83]
    v_mfma_f32_16x16x32_bf16 v[120:123], v[52:55], v[104:107], v[120:123]
    s_waitcnt lgkmcnt(2)
    v_mfma_f32_16x16x32_bf16 v[84:87], v[48:51], v[108:111], v[84:87]
    v_mfma_f32_16x16x32_bf16 v[124:127], v[52:55], v[108:111], v[124:127]
    s_waitcnt lgkmcnt(1)
    v_mfma_f32_16x16x32_bf16 v[88:91], v[48:51], v[112:115], v[88:91]
    v_mfma_f32_16x16x32_bf16 v[128:131], v[52:55], v[112:115], v[128:131]
    s_waitcnt lgkmcnt(0)
    v_mfma_f32_16x16x32_bf16 v[92:95], v[48:51], v[116:119], v[92:95]
    v_mfma_f32_16x16x32_bf16 v[132:135], v[52:55], v[116:119], v[132:135]
    v_fmac_f32 v80, v2, v120
    v_fmac_f32 v81, v2, v121
    v_fmac_f32 v82, v2, v122
    v_fmac_f32 v83, v2, v123
    v_fmac_f32 v84, v2, v124
    v_fmac_f32 v85, v2, v125
    v_fmac_f32 v86, v2, v126
    v_fmac_f32 v87, v2, v127
    v_fmac_f32 v88, v2, v128
    v_fmac_f32 v89, v2, v129
    v_fmac_f32 v90, v2, v130
    v_fmac_f32 v91, v2, v131
    v_fmac_f32 v92, v2, v132
    v_fmac_f32 v93, v2, v133
    v_fmac_f32 v94, v2, v134
    v_fmac_f32 v95, v2, v135
    v_mul_f32 v80, v80, v8
    v_mul_f32 v81, v81, v9
    v_mul_f32 v82, v82, v10
    v_mul_f32 v83, v83, v11
    v_mul_f32 v84, v84, v8
    v_mul_f32 v85, v85, v9
    v_mul_f32 v86, v86, v10
    v_mul_f32 v87, v87, v11
    v_mul_f32 v88, v88, v8
    v_mul_f32 v89, v89, v9
    v_mul_f32 v90, v90, v10
    v_mul_f32 v91, v91, v11
    v_mul_f32 v92, v92, v8
    v_mul_f32 v93, v93, v9
    v_mul_f32 v94, v94, v10
    v_mul_f32 v95, v95, v11
    v_cvt_pk_bf16_f32 v16, v80, v81
    v_cvt_pk_bf16_f32 v17, v82, v83
    v_cvt_pk_bf16_f32 v18, v88, v89
    v_cvt_pk_bf16_f32 v19, v90, v91
    v_cvt_pk_bf16_f32 v20, v84, v85
    v_cvt_pk_bf16_f32 v21, v86, v87
    v_cvt_pk_bf16_f32 v22, v92, v93
    v_cvt_pk_bf16_f32 v23, v94, v95
    v_mfma_f32_16x16x32_bf16 v[24:27], v[136:139], v[16:19], 0
    v_mfma_f32_16x16x32_bf16 v[28:31], v[140:143], v[16:19], 0
    v_mfma_f32_16x16x32_bf16 v[32:35], v[136:139], v[20:23], 0
    v_mfma_f32_16x16x32_bf16 v[36:39], v[140:143], v[20:23], 0
    v_and_b32 v2, 15, v1
    v_lshrrev_b32 v3, 4, v1
    v_lshlrev_b32_e64 v2, 4, v2
    v_lshl_add_u32 v2, v3, 11, v2
    s_lshl_b32 s40, s30, 2
    s_add_u32 s40, s40, 65536
    v_add_u32 v2, s40, v2
    v_cvt_pk_bf16_f32 v40, v24, v28
    ds_write_b32 v2, v40 offset:0
    v_cvt_pk_bf16_f32 v41, v25, v29
    ds_write_b32 v2, v41 offset:512
    v_cvt_pk_bf16_f32 v42, v26, v30
    ds_write_b32 v2, v42 offset:1024
    v_cvt_pk_bf16_f32 v43, v27, v31
    ds_write_b32 v2, v43 offset:1536
    v_cvt_pk_bf16_f32 v44, v32, v36
    ds_write_b32 v2, v44 offset:256
    v_cvt_pk_bf16_f32 v45, v33, v37
    ds_write_b32 v2, v45 offset:768
    v_cvt_pk_bf16_f32 v46, v34, v38
    ds_write_b32 v2, v46 offset:1280
    v_cvt_pk_bf16_f32 v47, v35, v39
    ds_write_b32 v2, v47 offset:1792
    s_waitcnt lgkmcnt(0)
    s_barrier
    v_lshlrev_b32_e64 v2, 4, v0
    v_add_u32 v3, 65536, v2
    ds_read_b128 v[16:19], v3
    ds_read_b128 v[20:23], v3 offset:4096
    v_lshrrev_b32 v4, 5, v0
    v_and_b32 v5, 31, v0
    v_lshlrev_b32_e64 v4, 17, v4
    v_lshl_add_u32 v4, v5, 4, v4
    s_lshl_b32 s40, s28, 1
    s_add_u32 s40, s40, s34
    s_lshl_b32 s40, s40, 13
    s_lshl_b32 s41, s36, 12
    s_add_u32 s40, s40, s41
    s_lshl_b32 s41, s35, 9
    s_add_u32 s40, s40, s41
    s_add_u32 s40, s40, 3145728
    s_add_u32 s41, s40, 0x100000
    s_waitcnt lgkmcnt(1)
    buffer_store_dwordx4 v[16:19], v4, s[24:27], s40 offen sc1
    s_waitcnt lgkmcnt(0)
    buffer_store_dwordx4 v[20:23], v4, s[24:27], s41 offen sc1
    v_and_b32 v2, 15, v1
    v_lshrrev_b32 v3, 4, v1
    v_and_b32 v4, 7, v2
    v_lshrrev_b32_e64 v2, 3, v2
    v_lshl_add_u32 v2, v4, 3, v2
    s_lshl_b32 s40, s36, 6
    s_lshl_b32 s41, s30, 1
    s_add_u32 s40, s40, s41
    v_add_u32 v2, s40, v2
    v_cvt_f32_u32_e64 v4, v2
    v_mul_f32 v4, 0x3c000000, v4
    v_and_b32 v5, 1, v3
    v_lshrrev_b32 v6, 1, v3
    v_cvt_f32_u32 v5, v5
    v_cvt_f32_u32 v6, v6
    v_mul_f32 v6, v4, v6
    v_mul_f32 v5, v4, v5
    v_mul_f32 v5, 0x42800000, v5
    v_mul_f32 v7, 0x41000000, v6
    v_add_f32_e64 v5, v5, v7
    v_mul_f32 v7, 0x40c00000, v6
    v_add_f32 v7, v4, v7
    v_add_f32 v8, v6, v6
    v_sub_f32_e64 v8, v4, v8
    v_mul_f32 v9, 0x41800000, v4
    v_add_f32 v10, v9, v9
    v_add_f32 v49, v5, v9
    v_add_f32 v50, v5, v10
    v_fract_f32 v48, v5
    v_add_f32 v51, v49, v10
    v_fract_f32 v49, v49
    v_fract_f32 v50, v50
    v_fract_f32 v51, v51
    v_cos_f32 v52, v48
    v_cos_f32 v53, v49
    v_cos_f32 v54, v50
    v_cos_f32 v55, v51
    v_sin_f32 v56, v48
    v_sin_f32 v57, v49
    v_sin_f32 v58, v50
    v_sin_f32 v59, v51
    v_cvt_pk_bf16_f32 v16, v52, v56
    v_cvt_pk_bf16_f32 v17, v53, v57
    v_cvt_pk_bf16_f32 v18, v54, v58
    v_cvt_pk_bf16_f32 v19, v55, v59
    v_add_f32 v5, v5, v7
    v_add_f32 v49, v5, v9
    v_add_f32 v50, v5, v10
    v_fract_f32 v48, v5
    v_add_f32 v51, v49, v10
    v_fract_f32 v49, v49
    v_fract_f32 v50, v50
    v_fract_f32 v51, v51
    v_cos_f32 v52, v48
    v_cos_f32 v53, v49
    v_cos_f32 v54, v50
    v_cos_f32 v55, v51
    v_sin_f32 v56, v48
    v_sin_f32 v57, v49
    v_sin_f32 v58, v50
    v_sin_f32 v59, v51
    v_cvt_pk_bf16_f32 v20, v52, v56
    v_cvt_pk_bf16_f32 v21, v53, v57
    v_cvt_pk_bf16_f32 v22, v54, v58
    v_cvt_pk_bf16_f32 v23, v55, v59
    v_add_f32 v5, v5, v8
    v_add_f32 v49, v5, v9
    v_add_f32 v50, v5, v10
    v_fract_f32 v48, v5
    v_add_f32 v51, v49, v10
    v_fract_f32 v49, v49
    v_fract_f32 v50, v50
    v_fract_f32 v51, v51
    v_cos_f32 v52, v48
    v_cos_f32 v53, v49
    v_cos_f32 v54, v50
    v_cos_f32 v55, v51
    v_sin_f32 v56, v48
    v_sin_f32 v57, v49
    v_sin_f32 v58, v50
    v_sin_f32 v59, v51
    v_cvt_pk_bf16_f32 v24, v52, v56
    v_cvt_pk_bf16_f32 v25, v53, v57
    v_cvt_pk_bf16_f32 v26, v54, v58
    v_cvt_pk_bf16_f32 v27, v55, v59
    v_add_f32 v5, v5, v8
    v_add_f32 v49, v5, v9
    v_add_f32 v50, v5, v10
    v_fract_f32 v48, v5
    v_add_f32 v51, v49, v10
    v_fract_f32 v49, v49
    v_fract_f32 v50, v50
    v_fract_f32 v51, v51
    v_cos_f32 v52, v48
    v_cos_f32 v53, v49
    v_cos_f32 v54, v50
    v_cos_f32 v55, v51
    v_sin_f32 v56, v48
    v_sin_f32 v57, v49
    v_sin_f32 v58, v50
    v_sin_f32 v59, v51
    v_cvt_pk_bf16_f32 v28, v52, v56
    v_cvt_pk_bf16_f32 v29, v53, v57
    v_cvt_pk_bf16_f32 v30, v54, v58
    v_cvt_pk_bf16_f32 v31, v55, v59
    v_add_f32 v5, v5, v8
    v_add_f32 v49, v5, v9
    v_add_f32 v50, v5, v10
    v_fract_f32 v48, v5
    v_add_f32 v51, v49, v10
    v_fract_f32 v49, v49
    v_fract_f32 v50, v50
    v_fract_f32 v51, v51
    v_cos_f32 v52, v48
    v_cos_f32 v53, v49
    v_cos_f32 v54, v50
    v_cos_f32 v55, v51
    v_sin_f32 v56, v48
    v_sin_f32 v57, v49
    v_sin_f32 v58, v50
    v_sin_f32 v59, v51
    v_cvt_pk_bf16_f32 v32, v52, v56
    v_cvt_pk_bf16_f32 v33, v53, v57
    v_cvt_pk_bf16_f32 v34, v54, v58
    v_cvt_pk_bf16_f32 v35, v55, v59
    v_add_f32 v5, v5, v8
    v_add_f32 v49, v5, v9
    v_add_f32 v50, v5, v10
    v_fract_f32 v48, v5
    v_add_f32 v51, v49, v10
    v_fract_f32 v49, v49
    v_fract_f32 v50, v50
    v_fract_f32 v51, v51
    v_cos_f32 v52, v48
    v_cos_f32 v53, v49
    v_cos_f32 v54, v50
    v_cos_f32 v55, v51
    v_sin_f32 v56, v48
    v_sin_f32 v57, v49
    v_sin_f32 v58, v50
    v_sin_f32 v59, v51
    v_cvt_pk_bf16_f32 v36, v52, v56
    v_cvt_pk_bf16_f32 v37, v53, v57
    v_cvt_pk_bf16_f32 v38, v54, v58
    v_cvt_pk_bf16_f32 v39, v55, v59
    v_add_f32 v5, v5, v8
    v_add_f32 v49, v5, v9
    v_add_f32 v50, v5, v10
    v_fract_f32 v48, v5
    v_add_f32 v51, v49, v10
    v_fract_f32 v49, v49
    v_fract_f32 v50, v50
    v_fract_f32 v51, v51
    v_cos_f32 v52, v48
    v_cos_f32 v53, v49
    v_cos_f32 v54, v50
    v_cos_f32 v55, v51
    v_sin_f32 v56, v48
    v_sin_f32 v57, v49
    v_sin_f32 v58, v50
    v_sin_f32 v59, v51
    v_cvt_pk_bf16_f32 v40, v52, v56
    v_cvt_pk_bf16_f32 v41, v53, v57
    v_cvt_pk_bf16_f32 v42, v54, v58
    v_cvt_pk_bf16_f32 v43, v55, v59
    v_add_f32 v5, v5, v8
    v_add_f32 v49, v5, v9
    v_add_f32 v50, v5, v10
    v_fract_f32 v48, v5
    v_add_f32 v51, v49, v10
    v_fract_f32 v49, v49
    v_fract_f32 v50, v50
    v_fract_f32 v51, v51
    v_cos_f32 v52, v48
    v_cos_f32 v53, v49
    v_cos_f32 v54, v50
    v_cos_f32 v55, v51
    v_sin_f32 v56, v48
    v_sin_f32 v57, v49
    v_sin_f32 v58, v50
    v_sin_f32 v59, v51
    v_cvt_pk_bf16_f32 v44, v52, v56
    v_cvt_pk_bf16_f32 v45, v53, v57
    v_cvt_pk_bf16_f32 v46, v54, v58
    v_cvt_pk_bf16_f32 v47, v55, v59
    s_waitcnt vmcnt(0)
    s_barrier
    s_cmp_lg_u32 s30, 0
    s_cbranch_scc1 L_fs_44
    s_add_u32 s40, s32, 2
    v_mov_b32 v2, s40
    v_mov_b32 v3, s33
    s_lshl_b32 s41, s2, 6
    s_add_u32 s41, s41, 81920
    v_mov_b32 v4, s41
    s_mov_b64 exec, 1
    buffer_store_dwordx2 v[2:3], v4, s[24:27], 0 offen sc1
    s_mov_b64 exec, -1
L_fs_44:
    v_lshrrev_b32 v2, 2, v1
    v_and_b32 v3, 3, v1
    v_and_b32 v4, 7, v2
    v_lshrrev_b32_e64 v2, 3, v2
    v_lshl_add_u32 v2, v4, 3, v2
    s_lshl_b32 s40, s36, 6
    s_lshl_b32 s41, s30, 1
    s_add_u32 s40, s40, s41
    v_add_u32 v2, s40, v2
    s_cmp_eq_u32 s37, 0
    s_cselect_b32 s43, 1, 0
    s_add_u32 s43, s43, 127
    v_sub_u32_e64 v4, s43, v2
    v_and_b32 v4, 127, v4
    s_sub_u32 s44, 1, s34
    s_cmp_eq_u32 s28, 0
    s_cselect_b32 s44, s34, s44
    v_bfe_u32 v60, v2, 1, 2
    v_lshlrev_b32 v60, 5, v60
    v_and_b32_e64 v61, 1, v2
    v_lshl_add_u32 v60, v61, 4, v60
    v_lshrrev_b32 v61, 3, v2
    v_add_u32 v60, v60, v61
    s_lshl_b32 s42, s34, 7
    v_add_u32 v5, s42, v60
    v_bfe_u32 v60, v4, 1, 2
    v_lshlrev_b32 v60, 5, v60
    v_and_b32 v61, 1, v4
    v_lshl_add_u32 v60, v61, 4, v60
    v_lshrrev_b32 v61, 3, v4
    v_add_u32 v60, v60, v61
    s_lshl_b32 s42, s44, 7
    v_add_u32 v6, s42, v60
    s_lshl_b32 s45, s28, 4
    s_add_u32 s45, s45, s35
    s_lshl_b32 s45, s45, 11
    v_lshlrev_b32 v10, 3, v5
    v_add_u32_e64 v10, s45, v10
    s_add_u32 s45, s45, 16384
    v_lshlrev_b32 v11, 3, v6
    v_add_u32 v11, s45, v11
    s_lshl_b32 s45, s28, 8
    v_add_u32 v5, s45, v5
    v_add_u32 v6, s45, v6
    s_lshl_b32 s46, s35, 6
    v_lshlrev_b32 v7, 4, v3
    v_add_u32 v7, s46, v7
    v_sub_u32 v12, 1010, v7
    s_movk_i32 s46, 1152
    v_mul_lo_u32 v5, v5, s46
    v_mul_lo_u32 v6, v6, s46
    v_add_u32 v8, v5, v7
    v_add_u32 v9, v6, v12
    s_cmp_eq_u32 s35, 0
    s_cselect_b32 s52, 0x11111111, 0
    s_mov_b32 s53, s52
    v_mov_b32 v13, v8
    v_mov_b32_e64 v14, v9
    v_add_u32 v15, 512, v6
    s_mov_b32 s47, 7864320
    v_subrev_u32_e64 v12, 2, v14
    v_cndmask_b32 v12, v14, v12, s[52:53]
    buffer_load_dwordx4 v[88:91], v13, s[24:27], s47 offen
    buffer_load_dwordx4 v[92:95], v12, s[24:27], s47 offen
    buffer_load_ushort v96, v15, s[24:27], s47 offen
    s_mov_b32 s46, 10485760
    s_mov_b32 s45, 13369344
    v_and_b32_e64 v12, 0xfffffffc, v9
    buffer_load_dword v97, v8, s[24:27], s46 offen
    buffer_load_dword v98, v12, s[24:27], s46 offen offset:4
    buffer_load_dword v100, v10, s[24:27], s45 offen
    buffer_load_dword v101, v11, s[24:27], s45 offen
    s_getpc_b64 s[42:43]
L_pc_45:
    s_lshl_b32 s40, s29, 2
    s_add_u32 s40, s40, s30
    s_lshl_b32 s40, s40, 10
    v_lshlrev_b32 v2, 4, v1
    v_add_u32 v2, s40, v2
    v_min_u32 v2, 24560, v2
    v_add_u32_e64 v2, 0, v2
    v_min_u32 v2, L_code_end-L_pc_45-16, v2
    global_load_dwordx4 v[128:131], v2, s[42:43]
    s_nop 1
    s_cmp_eq_u32 s30, 0
    s_cbranch_scc1 L_w0_46
    s_branch L_wj_47
L_w0_46:
    v_and_b32 v2, 7, v1
    v_lshrrev_b32 v3, 3, v1
    v_lshlrev_b32 v3, 6, v3
    v_add_u32 v2, v2, v3
    s_lshl_b32 s40, s35, 3
    v_add_u32 v2, s40, v2
    v_lshlrev_b32_e64 v2, 6, v2
    v_add_u32 v4, 81920, v2
    s_add_u32 s40, s32, 2
    s_mov_b32 exec_lo, -1
    s_mov_b32 exec_hi, 0
    s_mov_b32 s98, 0
    v_mov_b32 v2, 0
    v_mov_b32_e64 v3, 0
    s_nop 1
L_poll_48:
    buffer_load_dwordx2 v[2:3], v4, s[24:27], 0 offen sc1
    s_add_u32 s98, s98, 1
    s_cmp_gt_u32 s98, 0x40000
    s_cbranch_scc1 L_pd_49
    s_waitcnt vmcnt(0)
    v_subrev_u32_e64 v2, s40, v2
    v_cmp_gt_u32 vcc, 64, v2
    v_cmp_eq_u32 s[42:43], s33, v3
    s_nop 1
    s_and_b64 vcc, vcc, s[42:43]
    s_cmp_eq_u64 vcc, exec
    s_cbranch_scc0 L_poll_48
L_pd_49:
    s_waitcnt vmcnt(0)
    s_mov_b64 exec, -1
    v_and_b32 v2, 15, v1
    v_lshrrev_b32 v3, 4, v1
    v_lshlrev_b32_e64 v2, 4, v2
    v_lshl_add_u32 v2, v3, 12, v2
    s_lshl_b32 s40, s37, 17
    s_lshl_b32 s41, s35, 9
    s_add_u32 s40, s40, s41
    s_add_u32 s40, s40, 3145728
    s_mov_b32 m0, 0
    s_add_u32 s41, s40, 0
    buffer_load_dwordx4 v2, s[24:27], s41 offen lds
    s_mov_b32 m0, 1024
    s_add_u32 s41, s40, 16384
    buffer_load_dwordx4 v2, s[24:27], s41 offen lds
    s_mov_b32 m0, 2048
    s_add_u32 s41, s40, 32768
    buffer_load_dwordx4 v2, s[24:27], s41 offen lds
    s_mov_b32 m0, 3072
    s_add_u32 s41, s40, 49152
    buffer_load_dwordx4 v2, s[24:27], s41 offen lds
    s_mov_b32 m0, 4096
    s_add_u32 s41, s40, 65536
    buffer_load_dwordx4 v2, s[24:27], s41 offen lds
    s_mov_b32 m0, 5120
    s_add_u32 s41, s40, 81920
    buffer_load_dwordx4 v2, s[24:27], s41 offen lds
    s_mov_b32 m0, 6144
    s_add_u32 s41, s40, 98304
    buffer_load_dwordx4 v2, s[24:27], s41 offen lds
    s_mov_b32 m0, 7168
    s_add_u32 s41, s40, 114688
    buffer_load_dwordx4 v2, s[24:27], s41 offen lds
    s_mov_b32 m0, 8192
    s_add_u32 s41, s40, 256
    buffer_load_dwordx4 v2, s[24:27], s41 offen lds
    s_mov_b32 m0, 9216
    s_add_u32 s41, s40, 16640
    buffer_load_dwordx4 v2, s[24:27], s41 offen lds
    s_mov_b32 m0, 10240
    s_add_u32 s41, s40, 33024
    buffer_load_dwordx4 v2, s[24:27], s41 offen lds
    s_mov_b32 m0, 11264
    s_add_u32 s41, s40, 49408
    buffer_load_dwordx4 v2, s[24:27], s41 offen lds
    s_mov_b32 m0, 12288
    s_add_u32 s41, s40, 65792
    buffer_load_dwordx4 v2, s[24:27], s41 offen lds
    s_mov_b32 m0, 13312
    s_add_u32 s41, s40, 82176
    buffer_load_dwordx4 v2, s[24:27], s41 offen lds
    s_mov_b32 m0, 14336
    s_add_u32 s41, s40, 98560
    buffer_load_dwordx4 v2, s[24:27], s41 offen lds
    s_mov_b32 m0, 15360
    s_add_u32 s41, s40, 114944
    buffer_load_dwordx4 v2, s[24:27], s41 offen lds
    s_waitcnt vmcnt(0)
L_wj_47:
    s_barrier
    v_lshlrev_b32 v2, 4, v1
    v_add_u32_e64 v2, 0, v2
    ds_read_b128 v[48:51], v2 offset:0
    ds_read_b128 v[52:55], v2 offset:8192
    ds_read_b128 v[56:59], v2 offset:1024
    ds_read_b128 v[60:63], v2 offset:9216
    ds_read_b128 v[64:67], v2 offset:2048
    ds_read_b128 v[68:71], v2 offset:10240
    ds_read_b128 v[72:75], v2 offset:3072
    s_waitcnt lgkmcnt(6)
    v_mfma_f32_16x16x32_bf16 v[80:83], v[48:51], v[16:19], 0
    ds_read_b128 v[76:79], v2 offset:11264
    s_waitcnt lgkmcnt(6)
    v_mfma_f32_16x16x32_bf16 v[84:87], v[52:55], v[16:19], 0
    ds_read_b128 v[48:51], v2 offset:4096
    s_waitcnt lgkmcnt(6)
    v_mfma_f32_16x16x32_bf16 v[80:83], v[56:59], v[20:23], v[80:83]
    ds_read_b128 v[52:55], v2 offset:12288
    s_waitcnt lgkmcnt(6)
    v_mfma_f32_16x16x32_bf16 v[84:87], v[60:63], v[20:23], v[84:87]
    ds_read_b128 v[56:59], v2 offset:5120
    s_waitcnt lgkmcnt(6)
    v_mfma_f32_16x16x32_bf16 v[80:83], v[64:67], v[24:27], v[80:83]
    ds_read_b128 v[60:63], v2 offset:13312
    s_waitcnt lgkmcnt(6)
    v_mfma_f32_16x16x32_bf16 v[84:87], v[68:71], v[24:27], v[84:87]
    ds_read_b128 v[64:67], v2 offset:6144
    s_waitcnt lgkmcnt(6)
    v_mfma_f32_16x16x32_bf16 v[80:83], v[72:75], v[28:31], v[80:83]
    ds_read_b128 v[68:71], v2 offset:14336
    s_waitcnt lgkmcnt(6)
    v_mfma_f32_16x16x32_bf16 v[84:87], v[76:79], v[28:31], v[84:87]
    ds_read_b128 v[72:75], v2 offset:7168
    s_waitcnt lgkmcnt(6)
    v_mfma_f32_16x16x32_bf16 v[80:83], v[48:51], v[32:35], v[80:83]
    ds_read_b128 v[76:79], v2 offset:15360
    s_waitcnt lgkmcnt(6)
    v_mfma_f32_16x16x32_bf16 v[84:87], v[52:55], v[32:35], v[84:87]
    s_waitcnt lgkmcnt(5)
    v_mfma_f32_16x16x32_bf16 v[80:83], v[56:59], v[36:39], v[80:83]
    s_waitcnt lgkmcnt(4)
    v_mfma_f32_16x16x32_bf16 v[84:87], v[60:63], v[36:39], v[84:87]
    s_waitcnt lgkmcnt(3)
    v_mfma_f32_16x16x32_bf16 v[80:83], v[64:67], v[40:43], v[80:83]
    s_waitcnt lgkmcnt(2)
    v_mfma_f32_16x16x32_bf16 v[84:87], v[68:71], v[40:43], v[84:87]
    s_waitcnt lgkmcnt(1)
    v_mfma_f32_16x16x32_bf16 v[80:83], v[72:75], v[44:47], v[80:83]
    s_waitcnt lgkmcnt(0)
    v_mfma_f32_16x16x32_bf16 v[84:87], v[76:79], v[44:47], v[84:87]
    v_and_b32 v2, 15, v1
    v_lshrrev_b32 v3, 4, v1
    v_and_b32 v4, 7, v2
    v_xor_b32 v3, v3, v4
    v_lshlrev_b32_e64 v5, 4, v3
    v_lshl_add_u32 v5, v2, 7, v5
    s_lshl_b32 s40, s30, 11
    s_add_u32 s40, s40, 16384
    v_add_u32 v5, s40, v5
    v_xor_b32_e64 v6, 64, v5
    ds_write_b128 v5, v[80:83]
    ds_write_b128 v6, v[84:87]
    v_lshrrev_b32 v2, 2, v1
    v_and_b32 v3, 3, v1
    v_lshlrev_b32 v3, 1, v3
    v_and_b32 v4, 7, v2
    v_xor_b32 v3, v3, v4
    v_lshlrev_b32 v7, 4, v3
    v_lshl_add_u32 v7, v2, 7, v7
    v_add_u32 v7, s40, v7
    v_xor_b32 v6, 16, v7
    ds_read_b128 v[80:83], v7
    ds_read_b128 v[84:87], v6
    s_waitcnt vmcnt(0)
    v_alignbit_b32 v104, v93, v92, 16
    v_alignbit_b32 v105, v94, v93, 16
    v_alignbit_b32 v106, v95, v94, 16
    v_lshrrev_b32 v107, 16, v95
    v_lshl_or_b32 v107, v96, 16, v107
    v_cndmask_b32 v92, v92, v104, s[52:53]
    v_cndmask_b32 v93, v93, v105, s[52:53]
    v_cndmask_b32 v94, v94, v106, s[52:53]
    v_cndmask_b32 v95, v95, v107, s[52:53]
    s_mov_b32 s54, 0xffff0000
    v_lshlrev_b32 v104, 16, v88
    v_and_b32 v105, s54, v88
    v_lshlrev_b32 v119, 16, v92
    v_and_b32 v118, s54, v92
    v_lshlrev_b32 v106, 16, v89
    v_and_b32 v107, s54, v89
    v_lshlrev_b32 v117, 16, v93
    v_and_b32 v116, s54, v93
    v_lshlrev_b32 v108, 16, v90
    v_and_b32 v109, s54, v90
    v_lshlrev_b32 v115, 16, v94
    v_and_b32 v114, s54, v94
    v_lshlrev_b32 v110, 16, v91
    v_and_b32 v111, s54, v91
    v_lshlrev_b32 v113, 16, v95
    v_and_b32 v112, s54, v95
    s_waitcnt lgkmcnt(1)
    v_add_f32 v112, v112, v80
    v_add_f32 v113, v113, v81
    v_add_f32 v114, v114, v82
    v_add_f32 v115, v115, v83
    s_waitcnt lgkmcnt(0)
    v_add_f32 v116, v116, v84
    v_add_f32 v117, v117, v85
    v_add_f32 v118, v118, v86
    v_add_f32 v119, v119, v87
    v_mov_b32_e64 v99, 0
    v_cndmask_b32 v80, v80, v99, s[52:53]
    v_add_f32 v104, v104, v80
    v_add_f32 v105, v105, v81
    v_add_f32 v106, v106, v82
    v_add_f32 v107, v107, v83
    v_add_f32 v108, v108, v84
    v_add_f32 v109, v109, v85
    v_add_f32 v110, v110, v86
    v_add_f32 v111, v111, v87
    v_cvt_pk_bf16_f32 v120, v104, v105
    v_cvt_pk_bf16_f32 v121, v106, v107
    v_cvt_pk_bf16_f32 v122, v108, v109
    v_cvt_pk_bf16_f32 v123, v110, v111
    v_cvt_pk_bf16_f32 v124, v119, v118
    v_cvt_pk_bf16_f32 v125, v117, v116
    v_cvt_pk_bf16_f32 v126, v115, v114
    v_cvt_pk_bf16_f32 v127, v113, v112
    s_mov_b32 s46, 10485760
    s_mov_b32 s47, 13369344
    buffer_store_dwordx4 v[120:123], v8, s[24:27], s46 offen
    s_not_b64 exec, s[52:53]
    buffer_store_dwordx4 v[124:127], v9, s[24:27], s46 offen
    s_mov_b64 exec, -1
    s_nop 0
    s_cmp_lg_u32 s35, 0
    s_cbranch_scc1 L_qsp_51
    v_subrev_u32 v13, 498, v9
    s_mov_b64 exec, s[52:53]
    buffer_store_dwordx3 v[124:126], v9, s[24:27], s46 offen
    buffer_store_short v127, v9, s[24:27], s46 offen offset:12
    buffer_store_short_d16_hi v127, v13, s[24:27], s46 offen
    s_mov_b64 exec, -1
L_qsp_51:
    v_add_f32 v128, v104, v105
    v_mul_f32 v129, v104, v104
    v_fmac_f32 v129, v105, v105
    v_add_f32 v128, v128, v106
    v_fmac_f32 v129, v106, v106
    v_add_f32 v128, v128, v107
    v_fmac_f32 v129, v107, v107
    v_add_f32 v128, v128, v108
    v_fmac_f32 v129, v108, v108
    v_add_f32 v128, v128, v109
    v_fmac_f32 v129, v109, v109
    v_add_f32 v128, v128, v110
    v_fmac_f32 v129, v110, v110
    v_add_f32 v128, v128, v111
    v_fmac_f32 v129, v111, v111
    v_add_f32 v130, v112, v113
    v_mul_f32 v131, v112, v112
    v_fmac_f32 v131, v113, v113
    v_add_f32 v130, v130, v114
    v_fmac_f32 v131, v114, v114
    v_add_f32 v130, v130, v115
    v_fmac_f32 v131, v115, v115
    v_add_f32 v130, v130, v116
    v_fmac_f32 v131, v116, v116
    v_add_f32 v130, v130, v117
    v_fmac_f32 v131, v117, v117
    v_add_f32 v130, v130, v118
    v_fmac_f32 v131, v118, v118
    v_add_f32 v130, v130, v119
    v_fmac_f32_e64 v131, v119, v119
    v_add_f32_dpp v128, v128, v128 quad_perm:[1,0,3,2] row_mask:0xf bank_mask:0xf
    v_add_f32_dpp v129, v129, v129 quad_perm:[1,0,3,2] row_mask:0xf bank_mask:0xf
    v_add_f32_dpp v130, v130, v130 quad_perm:[1,0,3,2] row_mask:0xf bank_mask:0xf
    v_add_f32_dpp v131, v131, v131 quad_perm:[1,0,3,2] row_mask:0xf bank_mask:0xf
    v_add_f32_dpp v128, v128, v128 quad_perm:[2,3,0,1] row_mask:0xf bank_mask:0xf
    v_add_f32_dpp v129, v129, v129 quad_perm:[2,3,0,1] row_mask:0xf bank_mask:0xf
    v_add_f32_dpp v130, v130, v130 quad_perm:[2,3,0,1] row_mask:0xf bank_mask:0xf
    v_add_f32_dpp v131, v131, v131 quad_perm:[2,3,0,1] row_mask:0xf bank_mask:0xf
    s_mov_b32 exec_lo, 0x11111111
    s_mov_b32 exec_hi, 0x11111111
    buffer_store_dwordx2 v[128:129], v10, s[24:27], s47 offen
    buffer_store_dwordx2 v[130:131], v11, s[24:27], s47 offen
    s_mov_b64 exec, -1
    s_waitcnt vmcnt(0)
    s_barrier
    s_cmp_lg_u32 s30, 0
    s_cbranch_scc1 L_fs_52
    s_add_u32 s40, s32, 6
    v_mov_b32 v2, s40
    v_mov_b32_e64 v3, s33
    s_lshl_b32 s41, s2, 6
    s_add_u32 s41, s41, 98304
    v_mov_b32 v4, s41
    s_mov_b64 exec, 1
    buffer_store_dwordx2 v[2:3], v4, s[24:27], 0 offen
    s_mov_b64 exec, -1
L_fs_52:
    s_cmp_ge_u32 s29, 28
    s_cbranch_scc1 L_idle_53
    s_and_b32 s40, s30, 1
    s_lshl_b32 s40, s40, 3
    s_or_b32 s41, s40, 0
    v_xor_b32 v2, s41, v1
    v_lshlrev_b32 v2, 4, v2
    v_add_u32 v120, 0, v2
    s_or_b32 s41, s40, 1
    v_xor_b32 v2, s41, v1
    v_lshlrev_b32 v2, 4, v2
    v_add_u32 v121, 128, v2
    s_or_b32 s41, s40, 2
    v_xor_b32 v2, s41, v1
    v_lshlrev_b32_e64 v2, 4, v2
    v_add_u32 v122, 256, v2
    s_or_b32 s41, s40, 3
    v_xor_b32 v2, s41, v1
    v_lshlrev_b32_e64 v2, 4, v2
    v_add_u32 v123, 384, v2
    s_or_b32 s41, s40, 4
    v_xor_b32 v2, s41, v1
    v_lshlrev_b32 v2, 4, v2
    v_add_u32 v124, 0, v2
    s_or_b32 s41, s40, 5
    v_xor_b32 v2, s41, v1
    v_lshlrev_b32_e64 v2, 4, v2
    v_add_u32 v125, 128, v2
    s_or_b32 s41, s40, 6
    v_xor_b32 v2, s41, v1
    v_lshlrev_b32_e64 v2, 4, v2
    v_add_u32 v126, 256, v2
    s_or_b32 s41, s40, 7
    v_xor_b32 v2, s41, v1
    v_lshlrev_b32_e64 v2, 4, v2
    v_add_u32 v127, 384, v2
    v_and_b32 v3, 31, v1
    v_lshrrev_b32 v4, 5, v1
    v_and_b32 v5, 15, v3
    v_add_u32 v6, 0, v4
    v_xor_b32 v6, v6, v5
    v_lshlrev_b32 v6, 4, v6
    v_lshl_add_u32 v128, v3, 10, v6
    v_add_u32 v6, 2, v4
    v_xor_b32 v6, v6, v5
    v_lshlrev_b32_e64 v6, 4, v6
    v_lshl_add_u32 v129, v3, 10, v6
    v_add_u32 v6, 4, v4
    v_xor_b32 v6, v6, v5
    v_lshlrev_b32_e64 v6, 4, v6
    v_lshl_add_u32 v130, v3, 10, v6
    v_add_u32 v6, 6, v4
    v_xor_b32 v6, v6, v5
    v_lshlrev_b32_e64 v6, 4, v6
    v_lshl_add_u32 v131, v3, 10, v6
    v_add_u32 v6, 8, v4
    v_xor_b32 v6, v6, v5
    v_lshlrev_b32_e64 v6, 4, v6
    v_lshl_add_u32 v132, v3, 10, v6
    v_add_u32 v6, 10, v4
    v_xor_b32 v6, v6, v5
    v_lshlrev_b32_e64 v6, 4, v6
    v_lshl_add_u32 v133, v3, 10, v6
    v_add_u32 v6, 12, v4
    v_xor_b32 v6, v6, v5
    v_lshlrev_b32_e64 v6, 4, v6
    v_lshl_add_u32 v134, v3, 10, v6
    v_add_u32 v6, 14, v4
    v_xor_b32 v6, v6, v5
    v_lshlrev_b32_e64 v6, 4, v6
    v_lshl_add_u32 v135, v3, 10, v6
    v_lshlrev_b32_e64 v115, 4, v3
    v_add_u32 v115, 0x20000, v115
    s_lshl_b32 s40, s30, 1
    v_add_u32 v6, s40, v4
    v_and_b32 v7, 7, v3
    v_xor_b32 v6, v6, v7
    v_lshlrev_b32_e64 v6, 4, v6
    v_lshl_add_u32 v6, v3, 7, v6
    v_add_u32 v112, 0x21000, v6
    v_lshrrev_b32 v6, 3, v1
    v_and_b32 v7, 7, v1
    v_xor_b32 v8, v6, v7
    v_lshlrev_b32 v8, 4, v8
    s_lshl_b32 s40, s30, 3
    v_add_u32 v6, s40, v6
    v_lshl_add_u32 v8, v6, 7, v8
    v_add_u32 v113, 0x21000, v8
    s_movk_i32 s40, 3712
    v_mul_lo_u32 v6, v6, s40
    v_lshl_add_u32 v114, v7, 4, v6
    s_lshl_b32 s57, s28, 8
    s_lshl_b32 s40, s30, 3
    s_add_u32 s57, s57, s40
    s_mul_i32 s57, s57, 1152
    s_add_u32 s57, s57, 10485760
    s_lshl_b32 s58, s30, 13
    s_mul_i32 s59, s28, 950272
    s_lshl_b32 s40, s29, 7
    s_add_u32 s59, s59, s40
    s_add_u32 s59, s59, 21495808
    s_movk_i32 s60, 4608
    s_mov_b32 s61, 32256
    s_mov_b32 s62, 118784
    v_lshlrev_b32 v2, 3, v1
    v_add_u32 v2, s28, v2
    v_lshlrev_b32_e64 v2, 6, v2
    v_add_u32 v4, 98304, v2
    s_nop 1
    s_cmp_lg_u32 s30, 0
    s_cbranch_scc1 L_ps_57
    s_add_u32 s40, s32, 6
    s_mov_b32 exec_lo, -1
    s_mov_b32 exec_hi, 0
    s_mov_b32 s98, 0
    v_mov_b32 v2, 0
    v_mov_b32 v3, 0
    s_nop 1
L_poll_55:
    buffer_load_dwordx2 v[2:3], v4, s[24:27], 0 offen sc1
    s_add_u32 s98, s98, 1
    s_cmp_gt_u32 s98, 0x40000
    s_cbranch_scc1 L_pd_56
    s_waitcnt vmcnt(0)
    v_subrev_u32_e64 v2, s40, v2
    v_cmp_gt_u32 vcc, 64, v2
    v_cmp_eq_u32 s[42:43], s33, v3
    s_nop 1
    s_and_b64 vcc, vcc, s[42:43]
    s_cmp_eq_u64 vcc, exec
    s_cbranch_scc0 L_poll_55
L_pd_56:
    s_waitcnt vmcnt(0)
    s_mov_b64 exec, -1
L_ps_57:
    s_barrier
    s_add_u32 m0, s58, 0
    s_nop 0
    buffer_load_dwordx4 v120, s[24:27], s57 offen offset:0 lds
    buffer_load_dwordx4 v121, s[24:27], s57 offen offset:1024 lds
    buffer_load_dwordx4 v122, s[24:27], s57 offen offset:2048 lds
    buffer_load_dwordx4 v123, s[24:27], s57 offen offset:3072 lds
    s_add_u32 s57, s57, s60
    s_add_u32 m0, s58, 4096
    s_nop 0
    buffer_load_dwordx4 v124, s[24:27], s57 offen offset:0 lds
    buffer_load_dwordx4 v125, s[24:27], s57 offen offset:1024 lds
    buffer_load_dwordx4 v126, s[24:27], s57 offen offset:2048 lds
    buffer_load_dwordx4 v127, s[24:27], s57 offen offset:3072 lds
    s_add_u32 s57, s57, s61
    s_lshl_b32 s41, s30, 6
    v_add_u32 v2, s41, v1
    v_lshlrev_b32_e64 v116, 4, v2
    v_add_u32 v116, 0x20000, v116
    v_lshlrev_b32 v2, 3, v2
    s_lshl_b32 s40, s28, 15
    s_add_u32 s40, s40, 13369344
    buffer_load_dwordx2 v[32:33], v2, s[24:27], s40 offen offset:0
    buffer_load_dwordx2 v[34:35], v2, s[24:27], s40 offen offset:2048
    s_add_u32 s40, s40, 4096
    buffer_load_dwordx2 v[36:37], v2, s[24:27], s40 offen offset:0
    buffer_load_dwordx2 v[38:39], v2, s[24:27], s40 offen offset:2048
    s_add_u32 s40, s40, 4096
    buffer_load_dwordx2 v[40:41], v2, s[24:27], s40 offen offset:0
    buffer_load_dwordx2 v[42:43], v2, s[24:27], s40 offen offset:2048
    s_add_u32 s40, s40, 4096
    buffer_load_dwordx2 v[44:45], v2, s[24:27], s40 offen offset:0
    buffer_load_dwordx2 v[46:47], v2, s[24:27], s40 offen offset:2048
    s_add_u32 s40, s40, 4096
    buffer_load_dwordx2 v[104:105], v2, s[24:27], s40 offen offset:0
    buffer_load_dwordx2 v[106:107], v2, s[24:27], s40 offen offset:2048
    s_add_u32 s40, s40, 4096
    buffer_load_dwordx2 v[108:109], v2, s[24:27], s40 offen offset:0
    buffer_load_dwordx2 v[110:111], v2, s[24:27], s40 offen offset:2048
    s_add_u32 s40, s40, 4096
    buffer_load_dwordx2 v[136:137], v2, s[24:27], s40 offen offset:0
    buffer_load_dwordx2 v[138:139], v2, s[24:27], s40 offen offset:2048
    s_add_u32 s40, s40, 4096
    buffer_load_dwordx2 v[140:141], v2, s[24:27], s40 offen offset:0
    buffer_load_dwordx2 v[142:143], v2, s[24:27], s40 offen offset:2048
    s_add_u32 m0, s58, 32768
    s_nop 0
    buffer_load_dwordx4 v120, s[24:27], s57 offen offset:0 lds
    buffer_load_dwordx4 v121, s[24:27], s57 offen offset:1024 lds
    buffer_load_dwordx4 v122, s[24:27], s57 offen offset:2048 lds
    buffer_load_dwordx4 v123, s[24:27], s57 offen offset:3072 lds
    s_add_u32 s57, s57, s60
    s_add_u32 m0, s58, 36864
    s_nop 0
    buffer_load_dwordx4 v124, s[24:27], s57 offen offset:0 lds
    buffer_load_dwordx4 v125, s[24:27], s57 offen offset:1024 lds
    buffer_load_dwordx4 v126, s[24:27], s57 offen offset:2048 lds
    buffer_load_dwordx4 v127, s[24:27], s57 offen offset:3072 lds
    s_add_u32 s57, s57, s61
    s_mov_b32 s51, s59
    buffer_load_dword v90, v114, s[24:27], s51 offen
    s_add_u32 s51, s51, s62
    buffer_load_dword v91, v114, s[24:27], s51 offen
    s_add_u32 s51, s51, s62
    s_getpc_b64 s[42:43]
L_pc_58:
    s_lshl_b32 s40, s29, 2
    s_add_u32 s40, s40, s30
    s_lshl_b32 s40, s40, 10
    v_lshlrev_b32 v2, 4, v1
    v_add_u32_e64 v2, s40, v2
    v_min_u32 v2, 24560, v2
    v_add_u32 v2, 12288, v2
    v_min_u32 v2, L_code_end-L_pc_58-16, v2
    global_load_dwordx4 v[92:95], v2, s[42:43]
    s_waitcnt vmcnt(27)
    s_barrier
    ds_read_b128 v[48:51], v128 offset:0
    ds_read_b128 v[52:55], v129 offset:0
    ds_read_b128 v[56:59], v130 offset:0
    ds_read_b128 v[60:63], v131 offset:0
    ds_read_b128 v[64:67], v132 offset:0
    ds_read_b128 v[68:71], v133 offset:0
    ds_read_b128 v[72:75], v134 offset:0
    s_waitcnt lgkmcnt(3)
    v_mfma_f32_32x32x16_bf16 v[16:31], a[0:3], v[48:51], 0
    ds_read_b128 v[76:79], v135 offset:0
    v_mfma_f32_32x32x16_bf16 v[16:31], a[4:7], v[52:55], v[16:31]
    ds_read_b128 v[80:83], v128 offset:256
    s_add_u32 m0, s58, 65536
    v_mfma_f32_32x32x16_bf16 v[16:31], a[8:11], v[56:59], v[16:31]
    ds_read_b128 v[84:87], v129 offset:256
    buffer_load_dwordx4 v120, s[24:27], s57 offen offset:0 lds
    s_waitcnt vmcnt(19)
    v_add_f32 v32, v32, v104
    v_add_f32 v33, v33, v105
    s_waitcnt vmcnt(18)
    v_add_f32 v34, v34, v106
    v_mfma_f32_32x32x16_bf16 v[16:31], a[12:15], v[60:63], v[16:31]
    ds_read_b128 v[48:51], v130 offset:256
    s_waitcnt lgkmcnt(3)
    buffer_load_dwordx4 v121, s[24:27], s57 offen offset:1024 lds
    v_add_f32 v35, v35, v107
    s_waitcnt vmcnt(18)
    v_add_f32 v36, v36, v108
    v_mfma_f32_32x32x16_bf16 v[16:31], a[16:19], v[64:67], v[16:31]
    ds_read_b128 v[52:55], v131 offset:256
    buffer_load_dwordx4 v122, s[24:27], s57 offen offset:2048 lds
    v_add_f32 v37, v37, v109
    s_waitcnt vmcnt(18)
    v_add_f32 v38, v38, v110
    v_add_f32 v39, v39, v111
    v_mfma_f32_32x32x16_bf16 v[16:31], a[20:23], v[68:71], v[16:31]
    ds_read_b128 v[56:59], v132 offset:256
    buffer_load_dwordx4 v123, s[24:27], s57 offen offset:3072 lds
    s_waitcnt vmcnt(18)
    v_add_f32 v40, v40, v136
    v_add_f32 v41, v41, v137
    s_waitcnt vmcnt(17)
    v_add_f32_e64 v42, v42, v138
    v_mfma_f32_32x32x16_bf16 v[16:31], a[24:27], v[72:75], v[16:31]
    ds_read_b128 v[60:63], v133 offset:256
    s_add_u32 s57, s57, s60
    v_add_f32 v43, v43, v139
    s_waitcnt vmcnt(16)
    v_add_f32 v44, v44, v140
    v_add_f32 v45, v45, v141
    s_waitcnt vmcnt(15)
    v_add_f32_e64 v46, v46, v142
    v_mfma_f32_32x32x16_bf16 v[16:31], a[28:31], v[76:79], v[16:31]
    ds_read_b128 v[64:67], v134 offset:256
    s_waitcnt lgkmcnt(3)
    v_add_f32 v47, v47, v143
    v_add_f32 v32, v32, v40
    v_add_f32 v33, v33, v41
    v_add_f32_e64 v34, v34, v42
    v_mfma_f32_32x32x16_bf16 v[16:31], a[32:35], v[80:83], v[16:31]
    ds_read_b128 v[68:71], v135 offset:256
    s_add_u32 m0, s58, 69632
    v_add_f32 v35, v35, v43
    v_add_f32 v36, v36, v44
    v_add_f32_e64 v37, v37, v45
    v_mfma_f32_32x32x16_bf16 v[16:31], a[36:39], v[84:87], v[16:31]
    ds_read_b128 v[72:75], v128 offset:512
    buffer_load_dwordx4 v124, s[24:27], s57 offen offset:0 lds
    v_add_f32 v38, v38, v46
    v_add_f32 v39, v39, v47
    v_add_f32_e64 v32, v32, v36
    v_mfma_f32_32x32x16_bf16 v[16:31], a[40:43], v[48:51], v[16:31]
    ds_read_b128 v[76:79], v129 offset:512
    buffer_load_dwordx4 v125, s[24:27], s57 offen offset:1024 lds
    v_add_f32 v33, v33, v37
    v_add_f32 v34, v34, v38
    v_add_f32_e64 v35, v35, v39
    v_mfma_f32_32x32x16_bf16 v[16:31], a[44:47], v[52:55], v[16:31]
    ds_read_b128 v[80:83], v130 offset:512
    s_waitcnt lgkmcnt(3)
    buffer_load_dwordx4 v126, s[24:27], s57 offen offset:2048 lds
    v_add_f32 v32, v32, v34
    v_add_f32_e64 v33, v33, v35
    v_mfma_f32_32x32x16_bf16 v[16:31], a[48:51], v[56:59], v[16:31]
    ds_read_b128 v[84:87], v131 offset:512
    buffer_load_dwordx4 v127, s[24:27], s57 offen offset:3072 lds
    v_mul_f32 v32, 0xbb000000, v32
    v_mul_f32 v33, 0x3b000000, v33
    v_fma_f32 v34, -v32, v32, v33
    v_mfma_f32_32x32x16_bf16 v[16:31], a[52:55], v[60:63], v[16:31]
    ds_read_b128 v[48:51], v132 offset:512
    s_add_u32 s57, s57, s61
    v_add_f32 v34, 0x3727c5ac, v34
    v_rsq_f32_e64 v33, v34
    s_nop 0
    v_mul_f32 v33, 0xbfb8aa3b, v33
    ds_write_b128 v116, v[32:35]
    v_mfma_f32_32x32x16_bf16 v[16:31], a[56:59], v[64:67], v[16:31]
    ds_read_b128 v[52:55], v133 offset:512
    v_mfma_f32_32x32x16_bf16 v[16:31], a[60:63], v[68:71], v[16:31]
    ds_read_b128 v[56:59], v134 offset:512
    s_waitcnt lgkmcnt(4)
    s_waitcnt vmcnt(11)
    s_waitcnt lgkmcnt(0)
    s_barrier
    v_mfma_f32_32x32x16_bf16 v[16:31], a[64:67], v[72:75], v[16:31]
    ds_read_b128 v[60:63], v135 offset:512
    s_add_u32 m0, s58, 98304
    v_mfma_f32_32x32x16_bf16 v[16:31], a[68:71], v[76:79], v[16:31]
    ds_read_b128 v[64:67], v128 offset:768
    buffer_load_dwordx4 v120, s[24:27], s57 offen offset:0 lds
    v_mfma_f32_32x32x16_bf16 v[16:31], a[72:75], v[80:83], v[16:31]
    ds_read_b128 v[68:71], v129 offset:768
    buffer_load_dwordx4 v121, s[24:27], s57 offen offset:1024 lds
    v_mfma_f32_32x32x16_bf16 v[16:31], a[76:79], v[84:87], v[16:31]
    ds_read_b128 v[72:75], v130 offset:768
    s_waitcnt lgkmcnt(3)
    buffer_load_dwordx4 v122, s[24:27], s57 offen offset:2048 lds
    v_mfma_f32_32x32x16_bf16 v[16:31], a[80:83], v[48:51], v[16:31]
    ds_read_b128 v[76:79], v131 offset:768
    buffer_load_dwordx4 v123, s[24:27], s57 offen offset:3072 lds
    v_mfma_f32_32x32x16_bf16 v[16:31], a[84:87], v[52:55], v[16:31]
    ds_read_b128 v[80:83], v132 offset:768
    s_add_u32 s57, s57, s60
    v_mfma_f32_32x32x16_bf16 v[16:31], a[88:91], v[56:59], v[16:31]
    ds_read_b128 v[84:87], v133 offset:768
    v_mfma_f32_32x32x16_bf16 v[16:31], a[92:95], v[60:63], v[16:31]
    ds_read_b128 v[48:51], v134 offset:768
    s_waitcnt lgkmcnt(3)
    s_add_u32 m0, s58, 102400
    v_mfma_f32_32x32x16_bf16 v[16:31], a[96:99], v[64:67], v[16:31]
    ds_read_b128 v[52:55], v135 offset:768
    ds_read_b128 v[96:99], v115 offset:0
    buffer_load_dwordx4 v124, s[24:27], s57 offen offset:0 lds
    v_mfma_f32_32x32x16_bf16 v[16:31], a[100:103], v[68:71], v[16:31]
    ds_read_b128 v[56:59], v128 offset:32768
    buffer_load_dwordx4 v125, s[24:27], s57 offen offset:1024 lds
    v_mfma_f32_32x32x16_bf16 v[16:31], a[104:107], v[72:75], v[16:31]
    ds_read_b128 v[60:63], v129 offset:32768
    buffer_load_dwordx4 v126, s[24:27], s57 offen offset:2048 lds
    v_mfma_f32_32x32x16_bf16 v[16:31], a[108:111], v[76:79], v[16:31]
    ds_read_b128 v[64:67], v130 offset:32768
    s_waitcnt lgkmcnt(4)
    buffer_load_dwordx4 v127, s[24:27], s57 offen offset:3072 lds
    v_mfma_f32_32x32x16_bf16 v[16:31], a[112:115], v[80:83], v[16:31]
    ds_read_b128 v[68:71], v131 offset:32768
    s_add_u32 s57, s57, s61
    v_mfma_f32_32x32x16_bf16 v[16:31], a[116:119], v[84:87], v[16:31]
    ds_read_b128 v[72:75], v132 offset:32768
    v_mfma_f32_32x32x16_bf16 v[16:31], a[120:123], v[48:51], v[16:31]
    ds_read_b128 v[76:79], v133 offset:32768
    v_mfma_f32_32x32x16_bf16 v[16:31], a[124:127], v[52:55], v[16:31]
    ds_read_b128 v[80:83], v134 offset:32768
    s_waitcnt lgkmcnt(3)
    s_waitcnt vmcnt(18)
    buffer_load_dword v90, v114, s[24:27], s51 offen
    s_add_u32 s51, s51, s62
    v_mfma_f32_32x32x16_bf16 v[32:47], a[0:3], v[56:59], 0
    ds_read_b128 v[84:87], v135 offset:32768
    v_mfma_f32_32x32x16_bf16 v[32:47], a[4:7], v[60:63], v[32:47]
    ds_read_b128 v[48:51], v128 offset:33024
    v_mfma_f32_32x32x16_bf16 v[32:47], a[8:11], v[64:67], v[32:47]
    ds_read_b128 v[52:55], v129 offset:33024
    v_mfma_f32_32x32x16_bf16 v[32:47], a[12:15], v[68:71], v[32:47]
    ds_read_b128 v[56:59], v130 offset:33024
    s_waitcnt lgkmcnt(3)
    v_fmac_f32 v16, v96, v144
    v_fmac_f32 v17, v96, v145
    v_fmac_f32 v18, v96, v146
    v_fmac_f32_e64 v19, v96, v147
    v_mfma_f32_32x32x16_bf16 v[32:47], a[16:19], v[72:75], v[32:47]
    ds_read_b128 v[60:63], v131 offset:33024
    v_fmac_f32 v20, v96, v148
    v_fmac_f32 v21, v96, v149
    v_fmac_f32 v22, v96, v150
    v_fmac_f32 v23, v96, v151
    v_mul_f32_e64 v104, v16, v97
    v_mfma_f32_32x32x16_bf16 v[32:47], a[20:23], v[76:79], v[32:47]
    ds_read_b128 v[64:67], v132 offset:33024
    v_mul_f32 v105, v17, v97
    v_mul_f32 v106, v18, v97
    v_mul_f32 v107, v19, v97
    v_mul_f32 v108, v20, v97
    v_mfma_f32_32x32x16_bf16 v[32:47], a[24:27], v[80:83], v[32:47]
    ds_read_b128 v[68:71], v133 offset:33024
    v_mul_f32 v109, v21, v97
    v_mul_f32 v110, v22, v97
    v_mul_f32 v111, v23, v97
    v_fmac_f32 v24, v96, v152
    v_mfma_f32_32x32x16_bf16 v[32:47], a[28:31], v[84:87], v[32:47]
    ds_read_b128 v[72:75], v134 offset:33024
    s_waitcnt lgkmcnt(3)
    v_fmac_f32 v25, v96, v153
    v_fmac_f32 v26, v96, v154
    v_fmac_f32 v27, v96, v155
    v_fmac_f32_e64 v28, v96, v156
    v_mfma_f32_32x32x16_bf16 v[32:47], a[32:35], v[48:51], v[32:47]
    ds_read_b128 v[76:79], v135 offset:33024
    ds_read_b128 v[140:143], v115 offset:512
    v_fmac_f32 v29, v96, v157
    v_fmac_f32 v30, v96, v158
    v_fmac_f32_e64 v31, v96, v159
    v_mfma_f32_32x32x16_bf16 v[32:47], a[36:39], v[52:55], v[32:47]
    ds_read_b128 v[80:83], v128 offset:33280
    v_exp_f32 v104, v104
    v_mul_f32 v16, v16, v24
    v_mfma_f32_32x32x16_bf16 v[32:47], a[40:43], v[56:59], v[32:47]
    ds_read_b128 v[84:87], v129 offset:33280
    v_exp_f32 v105, v105
    v_mul_f32 v17, v17, v25
    v_exp_f32_e64 v106, v106
    v_mfma_f32_32x32x16_bf16 v[32:47], a[44:47], v[60:63], v[32:47]
    ds_read_b128 v[48:51], v130 offset:33280
    s_waitcnt lgkmcnt(4)
    v_mul_f32 v18, v18, v26
    v_exp_f32 v107, v107
    v_mul_f32 v19, v19, v27
    v_mfma_f32_32x32x16_bf16 v[32:47], a[48:51], v[64:67], v[32:47]
    ds_read_b128 v[52:55], v131 offset:33280
    v_exp_f32 v108, v108
    v_mul_f32 v20, v20, v28
    v_mfma_f32_32x32x16_bf16 v[32:47], a[52:55], v[68:71], v[32:47]
    ds_read_b128 v[56:59], v132 offset:33280
    v_exp_f32 v109, v109
    v_mul_f32 v21, v21, v29
    v_mfma_f32_32x32x16_bf16 v[32:47], a[56:59], v[72:75], v[32:47]
    ds_read_b128 v[60:63], v133 offset:33280
    v_exp_f32 v110, v110
    v_mul_f32 v22, v22, v30
    v_exp_f32_e64 v111, v111
    v_mfma_f32_32x32x16_bf16 v[32:47], a[60:63], v[76:79], v[32:47]
    ds_read_b128 v[64:67], v134 offset:33280
    s_waitcnt lgkmcnt(3)
    s_waitcnt vmcnt(9)
    s_barrier
    v_mul_f32 v23, v23, v31
    v_mfma_f32_32x32x16_bf16 v[32:47], a[64:67], v[80:83], v[32:47]
    ds_read_b128 v[68:71], v135 offset:33280
    s_add_u32 m0, s58, 0
    v_fma_f32 v104, v104, v98, v98
    v_fma_f32 v105, v105, v98, v98
    v_fma_f32 v106, v106, v98, v98
    v_fma_f32 v107, v107, v98, v98
    v_mfma_f32_32x32x16_bf16 v[32:47], a[68:71], v[84:87], v[32:47]
    ds_read_b128 v[72:75], v128 offset:33536
    buffer_load_dwordx4 v120, s[24:27], s57 offen offset:0 lds
    v_fma_f32 v108, v108, v98, v98
    v_fma_f32 v109, v109, v98, v98
    v_fma_f32 v110, v110, v98, v98
    v_mfma_f32_32x32x16_bf16 v[32:47], a[72:75], v[48:51], v[32:47]
    ds_read_b128 v[76:79], v129 offset:33536
    buffer_load_dwordx4 v121, s[24:27], s57 offen offset:1024 lds
    v_fma_f32 v111, v111, v98, v98
    v_rcp_f32 v104, v104
    v_mfma_f32_32x32x16_bf16 v[32:47], a[76:79], v[52:55], v[32:47]
    ds_read_b128 v[80:83], v130 offset:33536
    s_waitcnt lgkmcnt(3)
    buffer_load_dwordx4 v122, s[24:27], s57 offen offset:2048 lds
    v_rcp_f32 v105, v105
    v_mfma_f32_32x32x16_bf16 v[32:47], a[80:83], v[56:59], v[32:47]
    ds_read_b128 v[84:87], v131 offset:33536
    buffer_load_dwordx4 v123, s[24:27], s57 offen offset:3072 lds
    v_mul_f32 v16, v16, v104
    v_rcp_f32 v106, v106
    v_mfma_f32_32x32x16_bf16 v[32:47], a[84:87], v[60:63], v[32:47]
    ds_read_b128 v[48:51], v132 offset:33536
    s_add_u32 s57, s57, s60
    v_mul_f32 v17, v17, v105
    v_rcp_f32_e64 v107, v107
    v_mfma_f32_32x32x16_bf16 v[32:47], a[88:91], v[64:67], v[32:47]
    ds_read_b128 v[52:55], v133 offset:33536
    v_mul_f32 v18, v18, v106
    v_rcp_f32 v108, v108
    v_mul_f32_e64 v19, v19, v107
    v_mfma_f32_32x32x16_bf16 v[32:47], a[92:95], v[68:71], v[32:47]
    ds_read_b128 v[56:59], v134 offset:33536
    s_waitcnt lgkmcnt(3)
    s_add_u32 m0, s58, 4096
    v_rcp_f32 v109, v109
    v_mfma_f32_32x32x16_bf16 v[32:47], a[96:99], v[72:75], v[32:47]
    ds_read_b128 v[60:63], v135 offset:33536
    buffer_load_dwordx4 v124, s[24:27], s57 offen offset:0 lds
    v_add_u32 v128, 65536, v128
    v_add_u32 v129, 65536, v129
    v_add_u32 v130, 65536, v130
    v_add_u32 v131, 65536, v131
    v_add_u32 v132, 65536, v132
    v_add_u32 v133, 65536, v133
    v_add_u32 v134, 65536, v134
    v_add_u32 v135, 65536, v135
    v_mfma_f32_32x32x16_bf16 v[32:47], a[100:103], v[76:79], v[32:47]
    ds_read_b128 v[64:67], v128 offset:0
    buffer_load_dwordx4 v125, s[24:27], s57 offen offset:1024 lds
    v_mul_f32_e64 v20, v20, v108
    v_mfma_f32_32x32x16_bf16 v[32:47], a[104:107], v[80:83], v[32:47]
    ds_read_b128 v[68:71], v129 offset:0
    buffer_load_dwordx4 v126, s[24:27], s57 offen offset:2048 lds
    v_rcp_f32 v110, v110
    v_mul_f32 v21, v21, v109
    v_mfma_f32_32x32x16_bf16 v[32:47], a[108:111], v[84:87], v[32:47]
    ds_read_b128 v[72:75], v130 offset:0
    s_waitcnt lgkmcnt(3)
    buffer_load_dwordx4 v127, s[24:27], s57 offen offset:3072 lds
    v_rcp_f32 v111, v111
    v_mfma_f32_32x32x16_bf16 v[32:47], a[112:115], v[48:51], v[32:47]
    ds_read_b128 v[76:79], v131 offset:0
    s_add_u32 s57, s57, s61
    v_mul_f32 v22, v22, v110
    v_mul_f32_e64 v23, v23, v111
    v_cvt_pk_bf16_f32 v100, v16, v17
    v_mfma_f32_32x32x16_bf16 v[32:47], a[116:119], v[52:55], v[32:47]
    ds_read_b128 v[80:83], v132 offset:0
    v_cvt_pk_bf16_f32 v101, v18, v19
    v_cvt_pk_bf16_f32 v102, v20, v21
    v_cvt_pk_bf16_f32 v103, v22, v23
    v_mfma_f32_32x32x16_bf16 v[32:47], a[120:123], v[56:59], v[32:47]
    ds_read_b128 v[84:87], v133 offset:0
    v_mfma_f32_32x32x16_bf16 v[32:47], a[124:127], v[60:63], v[32:47]
    ds_read_b128 v[48:51], v134 offset:0
    s_waitcnt lgkmcnt(3)
    buffer_load_dword v91, v114, s[24:27], s51 offen
    s_add_u32 s51, s51, s62
    v_mfma_f32_32x32x16_bf16 v[16:31], a[0:3], v[64:67], 0
    ds_read_b128 v[52:55], v135 offset:0
    v_mfma_f32_32x32x16_bf16 v[16:31], a[4:7], v[68:71], v[16:31]
    ds_read_b128 v[56:59], v128 offset:256
    ds_write_b128 v112, v[100:103] offset:0
    v_mfma_f32_32x32x16_bf16 v[16:31], a[8:11], v[72:75], v[16:31]
    ds_read_b128 v[60:63], v129 offset:256
    v_mfma_f32_32x32x16_bf16 v[16:31], a[12:15], v[76:79], v[16:31]
    ds_read_b128 v[64:67], v130 offset:256
    s_waitcnt lgkmcnt(4)
    v_fmac_f32 v32, v140, v144
    v_fmac_f32 v33, v140, v145
    v_fmac_f32 v34, v140, v146
    v_fmac_f32_e64 v35, v140, v147
    v_mfma_f32_32x32x16_bf16 v[16:31], a[16:19], v[80:83], v[16:31]
    ds_read_b128 v[68:71], v131 offset:256
    v_fmac_f32 v36, v140, v148
    v_fmac_f32 v37, v140, v149
    v_fmac_f32 v38, v140, v150
    v_fmac_f32 v39, v140, v151
    v_mfma_f32_32x32x16_bf16 v[16:31], a[20:23], v[84:87], v[16:31]
    ds_read_b128 v[72:75], v132 offset:256
    v_mul_f32 v104, v32, v141
    v_mul_f32 v105, v33, v141
    v_mul_f32 v106, v34, v141
    v_mul_f32 v107, v35, v141
    v_mfma_f32_32x32x16_bf16 v[16:31], a[24:27], v[48:51], v[16:31]
    ds_read_b128 v[76:79], v133 offset:256
    v_mul_f32 v108, v36, v141
    v_mul_f32 v109, v37, v141
    v_mul_f32 v110, v38, v141
    v_mul_f32 v111, v39, v141
    v_mfma_f32_32x32x16_bf16 v[16:31], a[28:31], v[52:55], v[16:31]
    ds_read_b128 v[80:83], v134 offset:256
    s_waitcnt lgkmcnt(3)
    v_fmac_f32 v40, v140, v152
    v_fmac_f32 v41, v140, v153
    v_fmac_f32 v42, v140, v154
    v_fmac_f32_e64 v43, v140, v155
    v_mfma_f32_32x32x16_bf16 v[16:31], a[32:35], v[56:59], v[16:31]
    ds_read_b128 v[84:87], v135 offset:256
    ds_read_b128 v[96:99], v115 offset:1024
    v_fmac_f32 v44, v140, v156
    v_fmac_f32 v45, v140, v157
    v_fmac_f32 v46, v140, v158
    v_fmac_f32 v47, v140, v159
    v_mfma_f32_32x32x16_bf16 v[16:31], a[36:39], v[60:63], v[16:31]
    ds_read_b128 v[48:51], v128 offset:512
    v_exp_f32 v104, v104
    v_mul_f32 v32, v32, v40
    v_mfma_f32_32x32x16_bf16 v[16:31], a[40:43], v[64:67], v[16:31]
    ds_read_b128 v[52:55], v129 offset:512
    v_exp_f32 v105, v105
    v_mul_f32 v33, v33, v41
    v_mfma_f32_32x32x16_bf16 v[16:31], a[44:47], v[68:71], v[16:31]
    ds_read_b128 v[56:59], v130 offset:512
    s_waitcnt lgkmcnt(4)
    v_exp_f32 v106, v106
    v_mul_f32_e64 v34, v34, v42
    v_mfma_f32_32x32x16_bf16 v[16:31], a[48:51], v[72:75], v[16:31]
    ds_read_b128 v[60:63], v131 offset:512
    v_exp_f32 v107, v107
    v_mul_f32 v35, v35, v43
    v_mfma_f32_32x32x16_bf16 v[16:31], a[52:55], v[76:79], v[16:31]
    ds_read_b128 v[64:67], v132 offset:512
    v_exp_f32 v108, v108
    v_mul_f32 v36, v36, v44
    v_mfma_f32_32x32x16_bf16 v[16:31], a[56:59], v[80:83], v[16:31]
    ds_read_b128 v[68:71], v133 offset:512
    v_exp_f32 v109, v109
    v_mul_f32 v37, v37, v45
    v_exp_f32_e64 v110, v110
    v_mfma_f32_32x32x16_bf16 v[16:31], a[60:63], v[84:87], v[16:31]
    ds_read_b128 v[72:75], v134 offset:512
    s_waitcnt lgkmcnt(3)
    s_waitcnt vmcnt(10)
    s_barrier
    ds_read_b128 v[92:95], v113 offset:0
    v_mul_f32 v38, v38, v46
    v_mfma_f32_32x32x16_bf16 v[16:31], a[64:67], v[48:51], v[16:31]
    ds_read_b128 v[76:79], v135 offset:512
    s_add_u32 m0, s58, 32768
    v_exp_f32 v111, v111
    v_mul_f32 v39, v39, v47
    v_fma_f32 v104, v104, v142, v142
    v_mfma_f32_32x32x16_bf16 v[16:31], a[68:71], v[52:55], v[16:31]
    ds_read_b128 v[80:83], v128 offset:768
    buffer_load_dwordx4 v120, s[24:27], s57 offen offset:0 lds
    v_fma_f32 v105, v105, v142, v142
    v_fma_f32 v106, v106, v142, v142
    v_fma_f32 v107, v107, v142, v142
    v_mfma_f32_32x32x16_bf16 v[16:31], a[72:75], v[56:59], v[16:31]
    ds_read_b128 v[84:87], v129 offset:768
    buffer_load_dwordx4 v121, s[24:27], s57 offen offset:1024 lds
    v_fma_f32 v108, v108, v142, v142
    v_fma_f32 v109, v109, v142, v142
    v_fma_f32 v110, v110, v142, v142
    v_mfma_f32_32x32x16_bf16 v[16:31], a[76:79], v[60:63], v[16:31]
    ds_read_b128 v[48:51], v130 offset:768
    s_waitcnt lgkmcnt(3)
    buffer_load_dwordx4 v122, s[24:27], s57 offen offset:2048 lds
    v_fma_f32 v111, v111, v142, v142
    v_mfma_f32_32x32x16_bf16 v[16:31], a[80:83], v[64:67], v[16:31]
    ds_read_b128 v[52:55], v131 offset:768
    buffer_load_dwordx4 v123, s[24:27], s57 offen offset:3072 lds
    v_rcp_f32 v104, v104
    v_mfma_f32_32x32x16_bf16 v[16:31], a[84:87], v[68:71], v[16:31]
    ds_read_b128 v[56:59], v132 offset:768
    s_add_u32 s57, s57, s60
    v_rcp_f32 v105, v105
    v_mul_f32_e64 v32, v32, v104
    v_mfma_f32_32x32x16_bf16 v[16:31], a[88:91], v[72:75], v[16:31]
    ds_read_b128 v[60:63], v133 offset:768
    v_rcp_f32 v106, v106
    v_mul_f32 v33, v33, v105
    v_mfma_f32_32x32x16_bf16 v[16:31], a[92:95], v[76:79], v[16:31]
    ds_read_b128 v[64:67], v134 offset:768
    s_waitcnt lgkmcnt(3)
    s_add_u32 m0, s58, 36864
    v_rcp_f32 v107, v107
    v_mul_f32_e64 v34, v34, v106
    v_mfma_f32_32x32x16_bf16 v[16:31], a[96:99], v[80:83], v[16:31]
    ds_read_b128 v[68:71], v135 offset:768
    buffer_load_dwordx4 v124, s[24:27], s57 offen offset:0 lds
    v_rcp_f32 v108, v108
    v_mul_f32 v35, v35, v107
    v_mfma_f32_32x32x16_bf16 v[16:31], a[100:103], v[84:87], v[16:31]
    ds_read_b128 v[72:75], v128 offset:32768
    buffer_load_dwordx4 v125, s[24:27], s57 offen offset:1024 lds
    v_rcp_f32 v109, v109
    v_mul_f32 v36, v36, v108
    v_mfma_f32_32x32x16_bf16 v[16:31], a[104:107], v[48:51], v[16:31]
    ds_read_b128 v[76:79], v129 offset:32768
    buffer_load_dwordx4 v126, s[24:27], s57 offen offset:2048 lds
    v_rcp_f32 v110, v110
    v_mul_f32 v37, v37, v109
    v_mfma_f32_32x32x16_bf16 v[16:31], a[108:111], v[52:55], v[16:31]
    ds_read_b128 v[80:83], v130 offset:32768
    s_waitcnt lgkmcnt(3)
    buffer_load_dwordx4 v127, s[24:27], s57 offen offset:3072 lds
    v_rcp_f32 v111, v111
    v_mfma_f32_32x32x16_bf16 v[16:31], a[112:115], v[56:59], v[16:31]
    ds_read_b128 v[84:87], v131 offset:32768
    s_add_u32 s57, s57, s61
    v_mul_f32 v38, v38, v110
    v_mul_f32_e64 v39, v39, v111
    v_cvt_pk_bf16_f32 v100, v32, v33
    v_mfma_f32_32x32x16_bf16 v[16:31], a[116:119], v[60:63], v[16:31]
    ds_read_b128 v[48:51], v132 offset:32768
    v_cvt_pk_bf16_f32 v101, v34, v35
    v_cvt_pk_bf16_f32 v102, v36, v37
    v_cvt_pk_bf16_f32 v103, v38, v39
    v_mfma_f32_32x32x16_bf16 v[16:31], a[120:123], v[64:67], v[16:31]
    ds_read_b128 v[52:55], v133 offset:32768
    buffer_store_dwordx4 v[92:95], v114, s[24:27], s59 offen
    s_add_u32 s59, s59, s62
    v_mfma_f32_32x32x16_bf16 v[16:31], a[124:127], v[68:71], v[16:31]
    ds_read_b128 v[56:59], v134 offset:32768
    s_waitcnt lgkmcnt(3)
    s_waitcnt vmcnt(18)
    buffer_load_dword v90, v114, s[24:27], s51 offen
    s_add_u32 s51, s51, s62
    v_mfma_f32_32x32x16_bf16 v[32:47], a[0:3], v[72:75], 0
    ds_read_b128 v[60:63], v135 offset:32768
    v_mfma_f32_32x32x16_bf16 v[32:47], a[4:7], v[76:79], v[32:47]
    ds_read_b128 v[64:67], v128 offset:33024
    ds_write_b128 v112, v[100:103] offset:4096
    v_mfma_f32_32x32x16_bf16 v[32:47], a[8:11], v[80:83], v[32:47]
    ds_read_b128 v[68:71], v129 offset:33024
    v_mfma_f32_32x32x16_bf16 v[32:47], a[12:15], v[84:87], v[32:47]
    ds_read_b128 v[72:75], v130 offset:33024
    s_waitcnt lgkmcnt(4)
    v_fmac_f32 v16, v96, v144
    v_fmac_f32 v17, v96, v145
    v_fmac_f32 v18, v96, v146
    v_fmac_f32_e64 v19, v96, v147
    v_mfma_f32_32x32x16_bf16 v[32:47], a[16:19], v[48:51], v[32:47]
    ds_read_b128 v[76:79], v131 offset:33024
    v_fmac_f32 v20, v96, v148
    v_fmac_f32 v21, v96, v149
    v_fmac_f32 v22, v96, v150
    v_fmac_f32 v23, v96, v151
    v_mul_f32_e64 v104, v16, v97
    v_mfma_f32_32x32x16_bf16 v[32:47], a[20:23], v[52:55], v[32:47]
    ds_read_b128 v[80:83], v132 offset:33024
    v_mul_f32 v105, v17, v97
    v_mul_f32 v106, v18, v97
    v_mul_f32 v107, v19, v97
    v_mul_f32 v108, v20, v97
    v_mfma_f32_32x32x16_bf16 v[32:47], a[24:27], v[56:59], v[32:47]
    ds_read_b128 v[84:87], v133 offset:33024
    v_mul_f32 v109, v21, v97
    v_mul_f32 v110, v22, v97
    v_mul_f32 v111, v23, v97
    v_fmac_f32 v24, v96, v152
    v_mfma_f32_32x32x16_bf16 v[32:47], a[28:31], v[60:63], v[32:47]
    ds_read_b128 v[48:51], v134 offset:33024
    s_waitcnt lgkmcnt(3)
    v_fmac_f32 v25, v96, v153
    v_fmac_f32 v26, v96, v154
    v_fmac_f32 v27, v96, v155
    v_fmac_f32_e64 v28, v96, v156
    v_mfma_f32_32x32x16_bf16 v[32:47], a[32:35], v[64:67], v[32:47]
    ds_read_b128 v[52:55], v135 offset:33024
    ds_read_b128 v[140:143], v115 offset:1536
    v_fmac_f32 v29, v96, v157
    v_fmac_f32 v30, v96, v158
    v_fmac_f32_e64 v31, v96, v159
    v_mfma_f32_32x32x16_bf16 v[32:47], a[36:39], v[68:71], v[32:47]
    ds_read_b128 v[56:59], v128 offset:33280
    v_exp_f32 v104, v104
    v_mul_f32 v16, v16, v24
    v_mfma_f32_32x32x16_bf16 v[32:47], a[40:43], v[72:75], v[32:47]
    ds_read_b128 v[60:63], v129 offset:33280
    v_exp_f32 v105, v105
    v_mul_f32 v17, v17, v25
    v_exp_f32_e64 v106, v106
    v_mfma_f32_32x32x16_bf16 v[32:47], a[44:47], v[76:79], v[32:47]
    ds_read_b128 v[64:67], v130 offset:33280
    s_waitcnt lgkmcnt(4)
    v_mul_f32 v18, v18, v26
    v_exp_f32 v107, v107
    v_mul_f32 v19, v19, v27
    v_mfma_f32_32x32x16_bf16 v[32:47], a[48:51], v[80:83], v[32:47]
    ds_read_b128 v[68:71], v131 offset:33280
    v_exp_f32 v108, v108
    v_mul_f32 v20, v20, v28
    v_mfma_f32_32x32x16_bf16 v[32:47], a[52:55], v[84:87], v[32:47]
    ds_read_b128 v[72:75], v132 offset:33280
    v_exp_f32 v109, v109
    v_mul_f32 v21, v21, v29
    v_mfma_f32_32x32x16_bf16 v[32:47], a[56:59], v[48:51], v[32:47]
    ds_read_b128 v[76:79], v133 offset:33280
    v_exp_f32 v110, v110
    v_mul_f32 v22, v22, v30
    v_exp_f32_e64 v111, v111
    v_mfma_f32_32x32x16_bf16 v[32:47], a[60:63], v[52:55], v[32:47]
    ds_read_b128 v[80:83], v134 offset:33280
    s_waitcnt lgkmcnt(3)
    s_waitcnt vmcnt(11)
    s_barrier
    ds_read_b128 v[92:95], v113 offset:4096
    v_mul_f32 v23, v23, v31
    v_mfma_f32_32x32x16_bf16 v[32:47], a[64:67], v[56:59], v[32:47]
    ds_read_b128 v[84:87], v135 offset:33280
    s_add_u32 m0, s58, 65536
    v_fma_f32 v104, v104, v98, v98
    v_fma_f32 v105, v105, v98, v98
    v_fma_f32 v106, v106, v98, v98
    v_fma_f32 v107, v107, v98, v98
    v_mfma_f32_32x32x16_bf16 v[32:47], a[68:71], v[60:63], v[32:47]
    ds_read_b128 v[48:51], v128 offset:33536
    buffer_load_dwordx4 v120, s[24:27], s57 offen offset:0 lds
    v_fma_f32 v108, v108, v98, v98
    v_fma_f32 v109, v109, v98, v98
    v_fma_f32 v110, v110, v98, v98
    v_mfma_f32_32x32x16_bf16 v[32:47], a[72:75], v[64:67], v[32:47]
    ds_read_b128 v[52:55], v129 offset:33536
    buffer_load_dwordx4 v121, s[24:27], s57 offen offset:1024 lds
    v_fma_f32 v111, v111, v98, v98
    v_rcp_f32_e64 v104, v104
    v_mfma_f32_32x32x16_bf16 v[32:47], a[76:79], v[68:71], v[32:47]
    ds_read_b128 v[56:59], v130 offset:33536
    s_waitcnt lgkmcnt(3)
    buffer_load_dwordx4 v122, s[24:27], s57 offen offset:2048 lds
    v_rcp_f32 v105, v105
    v_mfma_f32_32x32x16_bf16 v[32:47], a[80:83], v[72:75], v[32:47]
    ds_read_b128 v[60:63], v131 offset:33536
    buffer_load_dwordx4 v123, s[24:27], s57 offen offset:3072 lds
    v_mul_f32 v16, v16, v104
    v_rcp_f32 v106, v106
    v_mfma_f32_32x32x16_bf16 v[32:47], a[84:87], v[76:79], v[32:47]
    ds_read_b128 v[64:67], v132 offset:33536
    s_add_u32 s57, s57, s60
    v_mul_f32 v17, v17, v105
    v_rcp_f32_e64 v107, v107
    v_mfma_f32_32x32x16_bf16 v[32:47], a[88:91], v[80:83], v[32:47]
    ds_read_b128 v[68:71], v133 offset:33536
    v_mul_f32 v18, v18, v106
    v_rcp_f32 v108, v108
    v_mul_f32_e64 v19, v19, v107
    v_mfma_f32_32x32x16_bf16 v[32:47], a[92:95], v[84:87], v[32:47]
    ds_read_b128 v[72:75], v134 offset:33536
    s_waitcnt lgkmcnt(3)
    s_add_u32 m0, s58, 69632
    v_rcp_f32 v109, v109
    v_mfma_f32_32x32x16_bf16 v[32:47], a[96:99], v[48:51], v[32:47]
    ds_read_b128 v[76:79], v135 offset:33536
    buffer_load_dwordx4 v124, s[24:27], s57 offen offset:0 lds
    v_add_u32 v128, 4294901760, v128
    v_add_u32 v129, 4294901760, v129
    v_add_u32 v130, 4294901760, v130
    v_add_u32 v131, 4294901760, v131
    v_add_u32 v132, 4294901760, v132
    v_add_u32 v133, 4294901760, v133
    v_add_u32 v134, 4294901760, v134
    v_add_u32 v135, 4294901760, v135
    v_mfma_f32_32x32x16_bf16 v[32:47], a[100:103], v[52:55], v[32:47]
    ds_read_b128 v[80:83], v128 offset:0
    buffer_load_dwordx4 v125, s[24:27], s57 offen offset:1024 lds
    v_mul_f32_e64 v20, v20, v108
    v_mfma_f32_32x32x16_bf16 v[32:47], a[104:107], v[56:59], v[32:47]
    ds_read_b128 v[84:87], v129 offset:0
    buffer_load_dwordx4 v126, s[24:27], s57 offen offset:2048 lds
    v_rcp_f32 v110, v110
    v_mul_f32 v21, v21, v109
    v_mfma_f32_32x32x16_bf16 v[32:47], a[108:111], v[60:63], v[32:47]
    ds_read_b128 v[48:51], v130 offset:0
    s_waitcnt lgkmcnt(3)
    buffer_load_dwordx4 v127, s[24:27], s57 offen offset:3072 lds
    v_rcp_f32 v111, v111
    v_mfma_f32_32x32x16_bf16 v[32:47], a[112:115], v[64:67], v[32:47]
    ds_read_b128 v[52:55], v131 offset:0
    s_add_u32 s57, s57, s61
    v_mul_f32 v22, v22, v110
    v_mul_f32_e64 v23, v23, v111
    v_cvt_pk_bf16_f32 v100, v16, v17
    v_mfma_f32_32x32x16_bf16 v[32:47], a[116:119], v[68:71], v[32:47]
    ds_read_b128 v[56:59], v132 offset:0
    v_cvt_pk_bf16_f32 v101, v18, v19
    v_cvt_pk_bf16_f32 v102, v20, v21
    v_cvt_pk_bf16_f32 v103, v22, v23
    v_mfma_f32_32x32x16_bf16 v[32:47], a[120:123], v[72:75], v[32:47]
    ds_read_b128 v[60:63], v133 offset:0
    buffer_store_dwordx4 v[92:95], v114, s[24:27], s59 offen
    s_add_u32 s59, s59, s62
    v_mfma_f32_32x32x16_bf16 v[32:47], a[124:127], v[76:79], v[32:47]
    ds_read_b128 v[64:67], v134 offset:0
    s_waitcnt lgkmcnt(3)
    s_waitcnt vmcnt(19)
    buffer_load_dword v91, v114, s[24:27], s51 offen
    s_add_u32 s51, s51, s62
    v_mfma_f32_32x32x16_bf16 v[16:31], a[0:3], v[80:83], 0
    ds_read_b128 v[68:71], v135 offset:0
    v_mfma_f32_32x32x16_bf16 v[16:31], a[4:7], v[84:87], v[16:31]
    ds_read_b128 v[72:75], v128 offset:256
    ds_write_b128 v112, v[100:103] offset:0
    v_mfma_f32_32x32x16_bf16 v[16:31], a[8:11], v[48:51], v[16:31]
    ds_read_b128 v[76:79], v129 offset:256
    v_mfma_f32_32x32x16_bf16 v[16:31], a[12:15], v[52:55], v[16:31]
    ds_read_b128 v[80:83], v130 offset:256
    s_waitcnt lgkmcnt(4)
    v_fmac_f32 v32, v140, v144
    v_fmac_f32 v33, v140, v145
    v_fmac_f32 v34, v140, v146
    v_fmac_f32_e64 v35, v140, v147
    v_mfma_f32_32x32x16_bf16 v[16:31], a[16:19], v[56:59], v[16:31]
    ds_read_b128 v[84:87], v131 offset:256
    v_fmac_f32 v36, v140, v148
    v_fmac_f32 v37, v140, v149
    v_fmac_f32 v38, v140, v150
    v_fmac_f32 v39, v140, v151
    v_mfma_f32_32x32x16_bf16 v[16:31], a[20:23], v[60:63], v[16:31]
    ds_read_b128 v[48:51], v132 offset:256
    v_mul_f32 v104, v32, v141
    v_mul_f32 v105, v33, v141
    v_mul_f32 v106, v34, v141
    v_mul_f32 v107, v35, v141
    v_mfma_f32_32x32x16_bf16 v[16:31], a[24:27], v[64:67], v[16:31]
    ds_read_b128 v[52:55], v133 offset:256
    v_mul_f32 v108, v36, v141
    v_mul_f32 v109, v37, v141
    v_mul_f32 v110, v38, v141
    v_mul_f32 v111, v39, v141
    v_mfma_f32_32x32x16_bf16 v[16:31], a[28:31], v[68:71], v[16:31]
    ds_read_b128 v[56:59], v134 offset:256
    s_waitcnt lgkmcnt(3)
    v_fmac_f32 v40, v140, v152
    v_fmac_f32 v41, v140, v153
    v_fmac_f32 v42, v140, v154
    v_fmac_f32_e64 v43, v140, v155
    v_mfma_f32_32x32x16_bf16 v[16:31], a[32:35], v[72:75], v[16:31]
    ds_read_b128 v[60:63], v135 offset:256
    ds_read_b128 v[96:99], v115 offset:2048
    v_fmac_f32 v44, v140, v156
    v_fmac_f32 v45, v140, v157
    v_fmac_f32 v46, v140, v158
    v_fmac_f32 v47, v140, v159
    v_mfma_f32_32x32x16_bf16 v[16:31], a[36:39], v[76:79], v[16:31]
    ds_read_b128 v[64:67], v128 offset:512
    v_exp_f32 v104, v104
    v_mul_f32 v32, v32, v40
    v_mfma_f32_32x32x16_bf16 v[16:31], a[40:43], v[80:83], v[16:31]
    ds_read_b128 v[68:71], v129 offset:512
    v_exp_f32 v105, v105
    v_mul_f32 v33, v33, v41
    v_mfma_f32_32x32x16_bf16 v[16:31], a[44:47], v[84:87], v[16:31]
    ds_read_b128 v[72:75], v130 offset:512
    s_waitcnt lgkmcnt(4)
    v_exp_f32 v106, v106
    v_mul_f32_e64 v34, v34, v42
    v_mfma_f32_32x32x16_bf16 v[16:31], a[48:51], v[48:51], v[16:31]
    ds_read_b128 v[76:79], v131 offset:512
    v_exp_f32 v107, v107
    v_mul_f32 v35, v35, v43
    v_mfma_f32_32x32x16_bf16 v[16:31], a[52:55], v[52:55], v[16:31]
    ds_read_b128 v[80:83], v132 offset:512
    v_exp_f32 v108, v108
    v_mul_f32 v36, v36, v44
    v_mfma_f32_32x32x16_bf16 v[16:31], a[56:59], v[56:59], v[16:31]
    ds_read_b128 v[84:87], v133 offset:512
    v_exp_f32 v109, v109
    v_mul_f32 v37, v37, v45
    v_exp_f32_e64 v110, v110
    v_mfma_f32_32x32x16_bf16 v[16:31], a[60:63], v[60:63], v[16:31]
    ds_read_b128 v[48:51], v134 offset:512
    s_waitcnt lgkmcnt(3)
    s_waitcnt vmcnt(12)
    s_barrier
    ds_read_b128 v[92:95], v113 offset:0
    v_mul_f32 v38, v38, v46
    v_mfma_f32_32x32x16_bf16 v[16:31], a[64:67], v[64:67], v[16:31]
    ds_read_b128 v[52:55], v135 offset:512
    s_add_u32 m0, s58, 98304
    v_exp_f32 v111, v111
    v_mul_f32 v39, v39, v47
    v_fma_f32 v104, v104, v142, v142
    v_mfma_f32_32x32x16_bf16 v[16:31], a[68:71], v[68:71], v[16:31]
    ds_read_b128 v[56:59], v128 offset:768
    buffer_load_dwordx4 v120, s[24:27], s57 offen offset:0 lds
    v_fma_f32 v105, v105, v142, v142
    v_fma_f32 v106, v106, v142, v142
    v_fma_f32 v107, v107, v142, v142
    v_mfma_f32_32x32x16_bf16 v[16:31], a[72:75], v[72:75], v[16:31]
    ds_read_b128 v[60:63], v129 offset:768
    buffer_load_dwordx4 v121, s[24:27], s57 offen offset:1024 lds
    v_fma_f32 v108, v108, v142, v142
    v_fma_f32 v109, v109, v142, v142
    v_fma_f32 v110, v110, v142, v142
    v_mfma_f32_32x32x16_bf16 v[16:31], a[76:79], v[76:79], v[16:31]
    ds_read_b128 v[64:67], v130 offset:768
    s_waitcnt lgkmcnt(3)
    buffer_load_dwordx4 v122, s[24:27], s57 offen offset:2048 lds
    v_fma_f32 v111, v111, v142, v142
    v_mfma_f32_32x32x16_bf16 v[16:31], a[80:83], v[80:83], v[16:31]
    ds_read_b128 v[68:71], v131 offset:768
    buffer_load_dwordx4 v123, s[24:27], s57 offen offset:3072 lds
    v_rcp_f32 v104, v104
    v_mfma_f32_32x32x16_bf16 v[16:31], a[84:87], v[84:87], v[16:31]
    ds_read_b128 v[72:75], v132 offset:768
    s_add_u32 s57, s57, s60
    v_rcp_f32 v105, v105
    v_mul_f32_e64 v32, v32, v104
    v_mfma_f32_32x32x16_bf16 v[16:31], a[88:91], v[48:51], v[16:31]
    ds_read_b128 v[76:79], v133 offset:768
    v_rcp_f32 v106, v106
    v_mul_f32 v33, v33, v105
    v_mfma_f32_32x32x16_bf16 v[16:31], a[92:95], v[52:55], v[16:31]
    ds_read_b128 v[80:83], v134 offset:768
    s_waitcnt lgkmcnt(3)
    s_add_u32 m0, s58, 102400
    v_rcp_f32 v107, v107
    v_mul_f32_e64 v34, v34, v106
    v_mfma_f32_32x32x16_bf16 v[16:31], a[96:99], v[56:59], v[16:31]
    ds_read_b128 v[84:87], v135 offset:768
    buffer_load_dwordx4 v124, s[24:27], s57 offen offset:0 lds
    v_rcp_f32 v108, v108
    v_mul_f32 v35, v35, v107
    v_mfma_f32_32x32x16_bf16 v[16:31], a[100:103], v[60:63], v[16:31]
    ds_read_b128 v[48:51], v128 offset:32768
    buffer_load_dwordx4 v125, s[24:27], s57 offen offset:1024 lds
    v_rcp_f32 v109, v109
    v_mul_f32 v36, v36, v108
    v_mfma_f32_32x32x16_bf16 v[16:31], a[104:107], v[64:67], v[16:31]
    ds_read_b128 v[52:55], v129 offset:32768
    buffer_load_dwordx4 v126, s[24:27], s57 offen offset:2048 lds
    v_rcp_f32 v110, v110
    v_mul_f32 v37, v37, v109
    v_mfma_f32_32x32x16_bf16 v[16:31], a[108:111], v[68:71], v[16:31]
    ds_read_b128 v[56:59], v130 offset:32768
    s_waitcnt lgkmcnt(3)
    buffer_load_dwordx4 v127, s[24:27], s57 offen offset:3072 lds
    v_rcp_f32 v111, v111
    v_mfma_f32_32x32x16_bf16 v[16:31], a[112:115], v[72:75], v[16:31]
    ds_read_b128 v[60:63], v131 offset:32768
    s_add_u32 s57, s57, s61
    v_mul_f32 v38, v38, v110
    v_mul_f32_e64 v39, v39, v111
    v_cvt_pk_bf16_f32 v100, v32, v33
    v_mfma_f32_32x32x16_bf16 v[16:31], a[116:119], v[76:79], v[16:31]
    ds_read_b128 v[64:67], v132 offset:32768
    v_cvt_pk_bf16_f32 v101, v34, v35
    v_cvt_pk_bf16_f32 v102, v36, v37
    v_cvt_pk_bf16_f32 v103, v38, v39
    v_mfma_f32_32x32x16_bf16 v[16:31], a[120:123], v[80:83], v[16:31]
    ds_read_b128 v[68:71], v133 offset:32768
    buffer_store_dwordx4 v[92:95], v114, s[24:27], s59 offen
    s_add_u32 s59, s59, s62
    v_mfma_f32_32x32x16_bf16 v[16:31], a[124:127], v[84:87], v[16:31]
    ds_read_b128 v[72:75], v134 offset:32768
    s_waitcnt lgkmcnt(3)
    s_waitcnt vmcnt(19)
    buffer_load_dword v90, v114, s[24:27], s51 offen
    s_add_u32 s51, s51, s62
    v_mfma_f32_32x32x16_bf16 v[32:47], a[0:3], v[48:51], 0
    ds_read_b128 v[76:79], v135 offset:32768
    v_mfma_f32_32x32x16_bf16 v[32:47], a[4:7], v[52:55], v[32:47]
    ds_read_b128 v[80:83], v128 offset:33024
    ds_write_b128 v112, v[100:103] offset:4096
    v_mfma_f32_32x32x16_bf16 v[32:47], a[8:11], v[56:59], v[32:47]
    ds_read_b128 v[84:87], v129 offset:33024
    v_mfma_f32_32x32x16_bf16 v[32:47], a[12:15], v[60:63], v[32:47]
    ds_read_b128 v[48:51], v130 offset:33024
    s_waitcnt lgkmcnt(4)
    v_fmac_f32 v16, v96, v144
    v_fmac_f32 v17, v96, v145
    v_fmac_f32 v18, v96, v146
    v_mfma_f32_32x32x16_bf16 v[32:47], a[16:19], v[64:67], v[32:47]
    ds_read_b128 v[52:55], v131 offset:33024
    v_fmac_f32 v19, v96, v147
    v_fmac_f32 v20, v96, v148
    v_fmac_f32 v21, v96, v149
    v_fmac_f32 v22, v96, v150
    v_mfma_f32_32x32x16_bf16 v[32:47], a[20:23], v[68:71], v[32:47]
    ds_read_b128 v[56:59], v132 offset:33024
    v_fmac_f32 v23, v96, v151
    v_mul_f32 v104, v16, v97
    v_mul_f32 v105, v17, v97
    v_mul_f32 v106, v18, v97
    v_mfma_f32_32x32x16_bf16 v[32:47], a[24:27], v[72:75], v[32:47]
    ds_read_b128 v[60:63], v133 offset:33024
    v_mul_f32 v107, v19, v97
    v_mul_f32 v108, v20, v97
    v_mul_f32 v109, v21, v97
    v_mul_f32 v110, v22, v97
    v_mfma_f32_32x32x16_bf16 v[32:47], a[28:31], v[76:79], v[32:47]
    ds_read_b128 v[64:67], v134 offset:33024
    s_waitcnt lgkmcnt(3)
    v_mul_f32 v111, v23, v97
    v_fmac_f32 v24, v96, v152
    v_fmac_f32 v25, v96, v153
    v_mfma_f32_32x32x16_bf16 v[32:47], a[32:35], v[80:83], v[32:47]
    ds_read_b128 v[68:71], v135 offset:33024
    ds_read_b128 v[140:143], v115 offset:2560
    v_fmac_f32 v26, v96, v154
    v_fmac_f32 v27, v96, v155
    v_fmac_f32_e64 v28, v96, v156
    v_mfma_f32_32x32x16_bf16 v[32:47], a[36:39], v[84:87], v[32:47]
    ds_read_b128 v[72:75], v128 offset:33280
    v_fmac_f32 v29, v96, v157
    v_fmac_f32 v30, v96, v158
    v_fmac_f32_e64 v31, v96, v159
    v_mfma_f32_32x32x16_bf16 v[32:47], a[40:43], v[48:51], v[32:47]
    ds_read_b128 v[76:79], v129 offset:33280
    v_exp_f32 v104, v104
    v_mul_f32 v16, v16, v24
    v_mfma_f32_32x32x16_bf16 v[32:47], a[44:47], v[52:55], v[32:47]
    ds_read_b128 v[80:83], v130 offset:33280
    s_waitcnt lgkmcnt(4)
    v_exp_f32 v105, v105
    v_mul_f32_e64 v17, v17, v25
    v_mfma_f32_32x32x16_bf16 v[32:47], a[48:51], v[56:59], v[32:47]
    ds_read_b128 v[84:87], v131 offset:33280
    v_exp_f32 v106, v106
    v_mul_f32 v18, v18, v26
    v_mfma_f32_32x32x16_bf16 v[32:47], a[52:55], v[60:63], v[32:47]
    ds_read_b128 v[48:51], v132 offset:33280
    v_exp_f32 v107, v107
    v_mul_f32 v19, v19, v27
    v_mfma_f32_32x32x16_bf16 v[32:47], a[56:59], v[64:67], v[32:47]
    ds_read_b128 v[52:55], v133 offset:33280
    v_exp_f32 v108, v108
    v_mul_f32 v20, v20, v28
    v_mfma_f32_32x32x16_bf16 v[32:47], a[60:63], v[68:71], v[32:47]
    ds_read_b128 v[56:59], v134 offset:33280
    s_waitcnt lgkmcnt(3)
    s_waitcnt vmcnt(12)
    s_barrier
    ds_read_b128 v[92:95], v113 offset:4096
    v_mfma_f32_32x32x16_bf16 v[32:47], a[64:67], v[72:75], v[32:47]
    ds_read_b128 v[60:63], v135 offset:33280
    v_exp_f32 v109, v109
    v_mul_f32_e64 v21, v21, v29
    v_mfma_f32_32x32x16_bf16 v[32:47], a[68:71], v[76:79], v[32:47]
    ds_read_b128 v[64:67], v128 offset:33536
    v_exp_f32 v110, v110
    v_mul_f32 v22, v22, v30
    v_mfma_f32_32x32x16_bf16 v[32:47], a[72:75], v[80:83], v[32:47]
    ds_read_b128 v[68:71], v129 offset:33536
    v_exp_f32 v111, v111
    v_mul_f32 v23, v23, v31
    v_fma_f32 v104, v104, v98, v98
    v_mfma_f32_32x32x16_bf16 v[32:47], a[76:79], v[84:87], v[32:47]
    ds_read_b128 v[72:75], v130 offset:33536
    s_waitcnt lgkmcnt(3)
    v_fma_f32 v105, v105, v98, v98
    v_fma_f32 v106, v106, v98, v98
    v_fma_f32 v107, v107, v98, v98
    v_mfma_f32_32x32x16_bf16 v[32:47], a[80:83], v[48:51], v[32:47]
    ds_read_b128 v[76:79], v131 offset:33536
    v_fma_f32 v108, v108, v98, v98
    v_fma_f32 v109, v109, v98, v98
    v_fma_f32 v110, v110, v98, v98
    v_fma_f32 v111, v111, v98, v98
    v_mfma_f32_32x32x16_bf16 v[32:47], a[84:87], v[52:55], v[32:47]
    ds_read_b128 v[80:83], v132 offset:33536
    v_rcp_f32 v104, v104
    v_rcp_f32_e64 v105, v105
    v_mfma_f32_32x32x16_bf16 v[32:47], a[88:91], v[56:59], v[32:47]
    ds_read_b128 v[84:87], v133 offset:33536
    v_mul_f32 v16, v16, v104
    v_rcp_f32 v106, v106
    v_mul_f32_e64 v17, v17, v105
    v_mfma_f32_32x32x16_bf16 v[32:47], a[92:95], v[60:63], v[32:47]
    ds_read_b128 v[48:51], v134 offset:33536
    s_waitcnt lgkmcnt(3)
    v_rcp_f32 v107, v107
    v_mul_f32_e64 v18, v18, v106
    v_mfma_f32_32x32x16_bf16 v[32:47], a[96:99], v[64:67], v[32:47]
    ds_read_b128 v[52:55], v135 offset:33536
    v_add_u32 v128, 65536, v128
    v_add_u32 v129, 65536, v129
    v_add_u32 v130, 65536, v130
    v_add_u32 v131, 65536, v131
    v_add_u32 v132, 65536, v132
    v_add_u32 v133, 65536, v133
    v_add_u32 v134, 65536, v134
    v_add_u32 v135, 65536, v135
    v_mfma_f32_32x32x16_bf16 v[32:47], a[100:103], v[68:71], v[32:47]
    ds_read_b128 v[56:59], v128 offset:0
    v_rcp_f32 v108, v108
    v_mul_f32 v19, v19, v107
    v_mfma_f32_32x32x16_bf16 v[32:47], a[104:107], v[72:75], v[32:47]
    ds_read_b128 v[60:63], v129 offset:0
    v_rcp_f32 v109, v109
    v_mul_f32 v20, v20, v108
    v_mfma_f32_32x32x16_bf16 v[32:47], a[108:111], v[76:79], v[32:47]
    ds_read_b128 v[64:67], v130 offset:0
    s_waitcnt lgkmcnt(3)
    v_rcp_f32 v110, v110
    v_mul_f32_e64 v21, v21, v109
    v_mfma_f32_32x32x16_bf16 v[32:47], a[112:115], v[80:83], v[32:47]
    ds_read_b128 v[68:71], v131 offset:0
    v_rcp_f32 v111, v111
    v_mul_f32 v22, v22, v110
    v_mul_f32_e64 v23, v23, v111
    v_mfma_f32_32x32x16_bf16 v[32:47], a[116:119], v[84:87], v[32:47]
    ds_read_b128 v[72:75], v132 offset:0
    v_cvt_pk_bf16_f32 v100, v16, v17
    v_cvt_pk_bf16_f32 v101, v18, v19
    v_cvt_pk_bf16_f32 v102, v20, v21
    v_mfma_f32_32x32x16_bf16 v[32:47], a[120:123], v[48:51], v[32:47]
    ds_read_b128 v[76:79], v133 offset:0
    buffer_store_dwordx4 v[92:95], v114, s[24:27], s59 offen
    s_add_u32 s59, s59, s62
    v_cvt_pk_bf16_f32 v103, v22, v23
    v_mfma_f32_32x32x16_bf16 v[32:47], a[124:127], v[52:55], v[32:47]
    ds_read_b128 v[80:83], v134 offset:0
    s_waitcnt lgkmcnt(3)
    s_waitcnt vmcnt(11)
    buffer_load_dword v91, v114, s[24:27], s51 offen
    s_add_u32 s51, s51, s62
    v_mfma_f32_32x32x16_bf16 v[16:31], a[0:3], v[56:59], 0
    ds_read_b128 v[84:87], v135 offset:0
    v_mfma_f32_32x32x16_bf16 v[16:31], a[4:7], v[60:63], v[16:31]
    ds_read_b128 v[48:51], v128 offset:256
    ds_write_b128 v112, v[100:103] offset:0
    v_mfma_f32_32x32x16_bf16 v[16:31], a[8:11], v[64:67], v[16:31]
    ds_read_b128 v[52:55], v129 offset:256
    v_mfma_f32_32x32x16_bf16 v[16:31], a[12:15], v[68:71], v[16:31]
    ds_read_b128 v[56:59], v130 offset:256
    s_waitcnt lgkmcnt(4)
    v_fmac_f32 v32, v140, v144
    v_fmac_f32 v33, v140, v145
    v_fmac_f32 v34, v140, v146
    v_mfma_f32_32x32x16_bf16 v[16:31], a[16:19], v[72:75], v[16:31]
    ds_read_b128 v[60:63], v131 offset:256
    v_fmac_f32 v35, v140, v147
    v_fmac_f32 v36, v140, v148
    v_fmac_f32 v37, v140, v149
    v_fmac_f32 v38, v140, v150
    v_mfma_f32_32x32x16_bf16 v[16:31], a[20:23], v[76:79], v[16:31]
    ds_read_b128 v[64:67], v132 offset:256
    v_fmac_f32 v39, v140, v151
    v_mul_f32 v104, v32, v141
    v_mul_f32 v105, v33, v141
    v_mul_f32 v106, v34, v141
    v_mfma_f32_32x32x16_bf16 v[16:31], a[24:27], v[80:83], v[16:31]
    ds_read_b128 v[68:71], v133 offset:256
    v_mul_f32 v107, v35, v141
    v_mul_f32 v108, v36, v141
    v_mul_f32 v109, v37, v141
    v_mul_f32 v110, v38, v141
    v_mfma_f32_32x32x16_bf16 v[16:31], a[28:31], v[84:87], v[16:31]
    ds_read_b128 v[72:75], v134 offset:256
    s_waitcnt lgkmcnt(3)
    v_mul_f32 v111, v39, v141
    v_fmac_f32 v40, v140, v152
    v_fmac_f32 v41, v140, v153
    v_mfma_f32_32x32x16_bf16 v[16:31], a[32:35], v[48:51], v[16:31]
    ds_read_b128 v[76:79], v135 offset:256
    ds_read_b128 v[96:99], v115 offset:3072
    v_fmac_f32 v42, v140, v154
    v_fmac_f32 v43, v140, v155
    v_fmac_f32_e64 v44, v140, v156
    v_mfma_f32_32x32x16_bf16 v[16:31], a[36:39], v[52:55], v[16:31]
    ds_read_b128 v[80:83], v128 offset:512
    v_fmac_f32 v45, v140, v157
    v_fmac_f32 v46, v140, v158
    v_fmac_f32_e64 v47, v140, v159
    v_mfma_f32_32x32x16_bf16 v[16:31], a[40:43], v[56:59], v[16:31]
    ds_read_b128 v[84:87], v129 offset:512
    v_exp_f32 v104, v104
    v_mul_f32 v32, v32, v40
    v_mfma_f32_32x32x16_bf16 v[16:31], a[44:47], v[60:63], v[16:31]
    ds_read_b128 v[48:51], v130 offset:512
    s_waitcnt lgkmcnt(4)
    v_exp_f32 v105, v105
    v_mul_f32_e64 v33, v33, v41
    v_mfma_f32_32x32x16_bf16 v[16:31], a[48:51], v[64:67], v[16:31]
    ds_read_b128 v[52:55], v131 offset:512
    v_exp_f32 v106, v106
    v_mul_f32 v34, v34, v42
    v_mfma_f32_32x32x16_bf16 v[16:31], a[52:55], v[68:71], v[16:31]
    ds_read_b128 v[56:59], v132 offset:512
    v_exp_f32 v107, v107
    v_mul_f32 v35, v35, v43
    v_mfma_f32_32x32x16_bf16 v[16:31], a[56:59], v[72:75], v[16:31]
    ds_read_b128 v[60:63], v133 offset:512
    v_exp_f32 v108, v108
    v_mul_f32 v36, v36, v44
    v_mfma_f32_32x32x16_bf16 v[16:31], a[60:63], v[76:79], v[16:31]
    ds_read_b128 v[64:67], v134 offset:512
    s_waitcnt lgkmcnt(3)
    s_waitcnt vmcnt(4)
    s_waitcnt vmcnt(1)
    s_barrier
    s_nop 6
    s_cmp_lg_u32 s30, 0
    s_cbranch_scc1 L_fs_59
    s_add_u32 s40, s32, 7
    v_mov_b32 v2, s40
    v_mov_b32_e64 v3, s33
    s_lshl_b32 s41, s2, 6
    s_add_u32 s41, s41, 98304
    v_mov_b32 v4, s41
    s_mov_b64 exec, 1
    buffer_store_dwordx2 v[2:3], v4, s[24:27], 0 offen
    s_mov_b64 exec, -1
L_fs_59:
    ds_read_b128 v[92:95], v113 offset:0
    v_mfma_f32_32x32x16_bf16 v[16:31], a[64:67], v[80:83], v[16:31]
    ds_read_b128 v[68:71], v135 offset:512
    v_exp_f32 v109, v109
    v_mul_f32_e64 v37, v37, v45
    v_mfma_f32_32x32x16_bf16 v[16:31], a[68:71], v[84:87], v[16:31]
    ds_read_b128 v[72:75], v128 offset:768
    v_exp_f32 v110, v110
    v_mul_f32 v38, v38, v46
    v_mfma_f32_32x32x16_bf16 v[16:31], a[72:75], v[48:51], v[16:31]
    ds_read_b128 v[76:79], v129 offset:768
    v_exp_f32 v111, v111
    v_mul_f32 v39, v39, v47
    v_fma_f32 v104, v104, v142, v142
    v_mfma_f32_32x32x16_bf16 v[16:31], a[76:79], v[52:55], v[16:31]
    ds_read_b128 v[80:83], v130 offset:768
    s_waitcnt lgkmcnt(3)
    v_fma_f32 v105, v105, v142, v142
    v_fma_f32 v106, v106, v142, v142
    v_fma_f32 v107, v107, v142, v142
    v_mfma_f32_32x32x16_bf16 v[16:31], a[80:83], v[56:59], v[16:31]
    ds_read_b128 v[84:87], v131 offset:768
    v_fma_f32 v108, v108, v142, v142
    v_fma_f32 v109, v109, v142, v142
    v_fma_f32 v110, v110, v142, v142
    v_fma_f32 v111, v111, v142, v142
    v_mfma_f32_32x32x16_bf16 v[16:31], a[84:87], v[60:63], v[16:31]
    ds_read_b128 v[48:51], v132 offset:768
    v_rcp_f32 v104, v104
    v_mfma_f32_32x32x16_bf16 v[16:31], a[88:91], v[64:67], v[16:31]
    ds_read_b128 v[52:55], v133 offset:768
    v_rcp_f32 v105, v105
    v_mul_f32 v32, v32, v104
    v_mfma_f32_32x32x16_bf16 v[16:31], a[92:95], v[68:71], v[16:31]
    ds_read_b128 v[56:59], v134 offset:768
    s_waitcnt lgkmcnt(3)
    v_rcp_f32 v106, v106
    v_mul_f32_e64 v33, v33, v105
    v_mfma_f32_32x32x16_bf16 v[16:31], a[96:99], v[72:75], v[16:31]
    ds_read_b128 v[60:63], v135 offset:768
    v_rcp_f32 v107, v107
    v_mul_f32 v34, v34, v106
    v_mfma_f32_32x32x16_bf16 v[16:31], a[100:103], v[76:79], v[16:31]
    ds_read_b128 v[64:67], v128 offset:32768
    v_rcp_f32 v108, v108
    v_mul_f32 v35, v35, v107
    v_mfma_f32_32x32x16_bf16 v[16:31], a[104:107], v[80:83], v[16:31]
    ds_read_b128 v[68:71], v129 offset:32768
    v_rcp_f32 v109, v109
    v_mul_f32 v36, v36, v108
    v_mfma_f32_32x32x16_bf16 v[16:31], a[108:111], v[84:87], v[16:31]
    ds_read_b128 v[72:75], v130 offset:32768
    s_waitcnt lgkmcnt(3)
    v_rcp_f32 v110, v110
    v_mul_f32_e64 v37, v37, v109
    v_mfma_f32_32x32x16_bf16 v[16:31], a[112:115], v[48:51], v[16:31]
    ds_read_b128 v[76:79], v131 offset:32768
    v_rcp_f32 v111, v111
    v_mul_f32 v38, v38, v110
    v_mfma_f32_32x32x16_bf16 v[16:31], a[116:119], v[52:55], v[16:31]
    ds_read_b128 v[80:83], v132 offset:32768
    v_mul_f32_e64 v39, v39, v111
    v_cvt_pk_bf16_f32 v100, v32, v33
    v_cvt_pk_bf16_f32 v101, v34, v35
    v_mfma_f32_32x32x16_bf16 v[16:31], a[120:123], v[56:59], v[16:31]
    ds_read_b128 v[84:87], v133 offset:32768
    buffer_store_dwordx4 v[92:95], v114, s[24:27], s59 offen
    s_add_u32 s59, s59, s62
    v_cvt_pk_bf16_f32 v102, v36, v37
    v_mfma_f32_32x32x16_bf16 v[16:31], a[124:127], v[60:63], v[16:31]
    ds_read_b128 v[48:51], v134 offset:32768
    s_waitcnt lgkmcnt(3)
    v_cvt_pk_bf16_f32 v103, v38, v39
    v_mfma_f32_32x32x16_bf16 v[32:47], a[0:3], v[64:67], 0
    ds_read_b128 v[52:55], v135 offset:32768
    v_mfma_f32_32x32x16_bf16 v[32:47], a[4:7], v[68:71], v[32:47]
    ds_read_b128 v[56:59], v128 offset:33024
    ds_write_b128 v112, v[100:103] offset:4096
    v_mfma_f32_32x32x16_bf16 v[32:47], a[8:11], v[72:75], v[32:47]
    ds_read_b128 v[60:63], v129 offset:33024
    v_mfma_f32_32x32x16_bf16 v[32:47], a[12:15], v[76:79], v[32:47]
    ds_read_b128 v[64:67], v130 offset:33024
    s_waitcnt lgkmcnt(4)
    v_fmac_f32 v16, v96, v144
    v_fmac_f32 v17, v96, v145
    v_fmac_f32 v18, v96, v146
    v_mfma_f32_32x32x16_bf16 v[32:47], a[16:19], v[80:83], v[32:47]
    ds_read_b128 v[68:71], v131 offset:33024
    v_fmac_f32 v19, v96, v147
    v_fmac_f32 v20, v96, v148
    v_fmac_f32 v21, v96, v149
    v_fmac_f32 v22, v96, v150
    v_mfma_f32_32x32x16_bf16 v[32:47], a[20:23], v[84:87], v[32:47]
    ds_read_b128 v[72:75], v132 offset:33024
    v_fmac_f32 v23, v96, v151
    v_mul_f32 v104, v16, v97
    v_mul_f32 v105, v17, v97
    v_mul_f32 v106, v18, v97
    v_mfma_f32_32x32x16_bf16 v[32:47], a[24:27], v[48:51], v[32:47]
    ds_read_b128 v[76:79], v133 offset:33024
    v_mul_f32 v107, v19, v97
    v_mul_f32 v108, v20, v97
    v_mul_f32 v109, v21, v97
    v_mul_f32 v110, v22, v97
    v_mfma_f32_32x32x16_bf16 v[32:47], a[28:31], v[52:55], v[32:47]
    ds_read_b128 v[80:83], v134 offset:33024
    s_waitcnt lgkmcnt(3)
    v_mul_f32 v111, v23, v97
    v_fmac_f32 v24, v96, v152
    v_fmac_f32 v25, v96, v153
    v_mfma_f32_32x32x16_bf16 v[32:47], a[32:35], v[56:59], v[32:47]
    ds_read_b128 v[84:87], v135 offset:33024
    ds_read_b128 v[140:143], v115 offset:3584
    v_fmac_f32 v26, v96, v154
    v_fmac_f32 v27, v96, v155
    v_fmac_f32_e64 v28, v96, v156
    v_mfma_f32_32x32x16_bf16 v[32:47], a[36:39], v[60:63], v[32:47]
    ds_read_b128 v[48:51], v128 offset:33280
    v_fmac_f32 v29, v96, v157
    v_fmac_f32 v30, v96, v158
    v_fmac_f32_e64 v31, v96, v159
    v_mfma_f32_32x32x16_bf16 v[32:47], a[40:43], v[64:67], v[32:47]
    ds_read_b128 v[52:55], v129 offset:33280
    v_exp_f32 v104, v104
    v_mul_f32 v16, v16, v24
    v_mfma_f32_32x32x16_bf16 v[32:47], a[44:47], v[68:71], v[32:47]
    ds_read_b128 v[56:59], v130 offset:33280
    s_waitcnt lgkmcnt(4)
    v_exp_f32 v105, v105
    v_mul_f32_e64 v17, v17, v25
    v_mfma_f32_32x32x16_bf16 v[32:47], a[48:51], v[72:75], v[32:47]
    ds_read_b128 v[60:63], v131 offset:33280
    v_exp_f32 v106, v106
    v_mul_f32 v18, v18, v26
    v_mfma_f32_32x32x16_bf16 v[32:47], a[52:55], v[76:79], v[32:47]
    ds_read_b128 v[64:67], v132 offset:33280
    v_exp_f32 v107, v107
    v_mul_f32 v19, v19, v27
    v_mfma_f32_32x32x16_bf16 v[32:47], a[56:59], v[80:83], v[32:47]
    ds_read_b128 v[68:71], v133 offset:33280
    v_exp_f32 v108, v108
    v_mul_f32 v20, v20, v28
    v_mfma_f32_32x32x16_bf16 v[32:47], a[60:63], v[84:87], v[32:47]
    ds_read_b128 v[72:75], v134 offset:33280
    s_waitcnt lgkmcnt(3)
    s_barrier
    ds_read_b128 v[92:95], v113 offset:4096
    v_mfma_f32_32x32x16_bf16 v[32:47], a[64:67], v[48:51], v[32:47]
    ds_read_b128 v[76:79], v135 offset:33280
    v_exp_f32 v109, v109
    v_mul_f32 v21, v21, v29
    v_mfma_f32_32x32x16_bf16 v[32:47], a[68:71], v[52:55], v[32:47]
    ds_read_b128 v[80:83], v128 offset:33536
    v_exp_f32 v110, v110
    v_mul_f32 v22, v22, v30
    v_mfma_f32_32x32x16_bf16 v[32:47], a[72:75], v[56:59], v[32:47]
    ds_read_b128 v[84:87], v129 offset:33536
    v_exp_f32 v111, v111
    v_mul_f32 v23, v23, v31
    v_fma_f32 v104, v104, v98, v98
    v_mfma_f32_32x32x16_bf16 v[32:47], a[76:79], v[60:63], v[32:47]
    ds_read_b128 v[48:51], v130 offset:33536
    s_waitcnt lgkmcnt(3)
    v_fma_f32 v105, v105, v98, v98
    v_fma_f32 v106, v106, v98, v98
    v_fma_f32 v107, v107, v98, v98
    v_mfma_f32_32x32x16_bf16 v[32:47], a[80:83], v[64:67], v[32:47]
    ds_read_b128 v[52:55], v131 offset:33536
    v_fma_f32 v108, v108, v98, v98
    v_fma_f32 v109, v109, v98, v98
    v_fma_f32 v110, v110, v98, v98
    v_fma_f32 v111, v111, v98, v98
    v_mfma_f32_32x32x16_bf16 v[32:47], a[84:87], v[68:71], v[32:47]
    ds_read_b128 v[56:59], v132 offset:33536
    v_rcp_f32 v104, v104
    v_rcp_f32_e64 v105, v105
    v_mfma_f32_32x32x16_bf16 v[32:47], a[88:91], v[72:75], v[32:47]
    ds_read_b128 v[60:63], v133 offset:33536
    v_mul_f32 v16, v16, v104
    v_rcp_f32 v106, v106
    v_mul_f32_e64 v17, v17, v105
    v_mfma_f32_32x32x16_bf16 v[32:47], a[92:95], v[76:79], v[32:47]
    ds_read_b128 v[64:67], v134 offset:33536
    s_waitcnt lgkmcnt(3)
    v_rcp_f32 v107, v107
    v_mul_f32_e64 v18, v18, v106
    v_mfma_f32_32x32x16_bf16 v[32:47], a[96:99], v[80:83], v[32:47]
    ds_read_b128 v[68:71], v135 offset:33536
    v_mfma_f32_32x32x16_bf16 v[32:47], a[100:103], v[84:87], v[32:47]
    v_rcp_f32 v108, v108
    v_mul_f32 v19, v19, v107
    v_mfma_f32_32x32x16_bf16 v[32:47], a[104:107], v[48:51], v[32:47]
    v_rcp_f32 v109, v109
    v_mul_f32 v20, v20, v108
    v_mfma_f32_32x32x16_bf16 v[32:47], a[108:111], v[52:55], v[32:47]
    s_waitcnt lgkmcnt(0)
    v_rcp_f32 v110, v110
    v_mul_f32_e64 v21, v21, v109
    v_mfma_f32_32x32x16_bf16 v[32:47], a[112:115], v[56:59], v[32:47]
    v_rcp_f32 v111, v111
    v_mul_f32 v22, v22, v110
    v_mfma_f32_32x32x16_bf16 v[32:47], a[116:119], v[60:63], v[32:47]
    v_mul_f32_e64 v23, v23, v111
    v_cvt_pk_bf16_f32 v100, v16, v17
    v_cvt_pk_bf16_f32 v101, v18, v19
    v_mfma_f32_32x32x16_bf16 v[32:47], a[120:123], v[64:67], v[32:47]
    buffer_store_dwordx4 v[92:95], v114, s[24:27], s59 offen
    s_add_u32 s59, s59, s62
    v_cvt_pk_bf16_f32 v102, v20, v21
    v_mfma_f32_32x32x16_bf16 v[32:47], a[124:127], v[68:71], v[32:47]
    v_cvt_pk_bf16_f32 v103, v22, v23
    ds_write_b128 v112, v[100:103]
    s_nop 9
    v_fmac_f32 v32, v140, v144
    v_fmac_f32 v33, v140, v145
    v_fmac_f32 v34, v140, v146
    v_fmac_f32 v35, v140, v147
    v_fmac_f32 v36, v140, v148
    v_fmac_f32 v37, v140, v149
    v_fmac_f32 v38, v140, v150
    v_fmac_f32 v39, v140, v151
    v_mul_f32 v104, v32, v141
    v_mul_f32 v105, v33, v141
    v_mul_f32 v106, v34, v141
    v_mul_f32 v107, v35, v141
    v_mul_f32 v108, v36, v141
    v_mul_f32 v109, v37, v141
    v_mul_f32 v110, v38, v141
    v_mul_f32 v111, v39, v141
    v_fmac_f32 v40, v140, v152
    v_fmac_f32 v41, v140, v153
    v_fmac_f32 v42, v140, v154
    v_fmac_f32 v43, v140, v155
    v_fmac_f32 v44, v140, v156
    v_fmac_f32 v45, v140, v157
    v_fmac_f32 v46, v140, v158
    v_fmac_f32 v47, v140, v159
    v_exp_f32 v104, v104
    v_mul_f32 v32, v32, v40
    v_exp_f32 v105, v105
    v_mul_f32 v33, v33, v41
    v_exp_f32 v106, v106
    v_mul_f32 v34, v34, v42
    v_exp_f32 v107, v107
    v_mul_f32 v35, v35, v43
    v_exp_f32 v108, v108
    v_mul_f32 v36, v36, v44
    v_exp_f32 v109, v109
    v_mul_f32 v37, v37, v45
    v_exp_f32 v110, v110
    v_mul_f32 v38, v38, v46
    v_exp_f32 v111, v111
    v_mul_f32 v39, v39, v47
    v_fma_f32 v104, v104, v142, v142
    v_fma_f32 v105, v105, v142, v142
    v_fma_f32 v106, v106, v142, v142
    v_fma_f32 v107, v107, v142, v142
    v_fma_f32 v108, v108, v142, v142
    v_fma_f32 v109, v109, v142, v142
    v_fma_f32 v110, v110, v142, v142
    v_fma_f32 v111, v111, v142, v142
    v_rcp_f32 v104, v104
    v_rcp_f32 v105, v105
    v_mul_f32 v32, v32, v104
    v_rcp_f32 v106, v106
    v_mul_f32 v33, v33, v105
    v_rcp_f32 v107, v107
    v_mul_f32 v34, v34, v106
    v_rcp_f32 v108, v108
    v_mul_f32 v35, v35, v107
    v_rcp_f32 v109, v109
    v_mul_f32 v36, v36, v108
    v_rcp_f32 v110, v110
    v_mul_f32 v37, v37, v109
    v_rcp_f32 v111, v111
    v_mul_f32 v38, v38, v110
    v_mul_f32 v39, v39, v111
    v_cvt_pk_bf16_f32 v100, v32, v33
    v_cvt_pk_bf16_f32 v101, v34, v35
    v_cvt_pk_bf16_f32 v102, v36, v37
    v_cvt_pk_bf16_f32 v103, v38, v39
    ds_write_b128 v112, v[100:103] offset:4096
    s_waitcnt lgkmcnt(0)
    s_barrier
    ds_read_b128 v[92:95], v113
    s_waitcnt vmcnt(2)
    ds_read_b128 v[88:91], v113 offset:4096
    s_waitcnt lgkmcnt(1)
    buffer_store_dwordx4 v[92:95], v114, s[24:27], s59 offen
    s_add_u32 s59, s59, s62
    s_waitcnt lgkmcnt(0)
    buffer_store_dwordx4 v[88:91], v114, s[24:27], s59 offen
    s_waitcnt vmcnt(0)
    s_barrier
    s_cmp_lg_u32 s30, 0
    s_cbranch_scc1 L_fs_60
    s_add_u32 s40, s32, 8
    v_mov_b32 v2, s40
    v_mov_b32 v3, s33
    s_lshl_b32 s41, s2, 6
    s_add_u32 s41, s41, 98304
    v_mov_b32 v4, s41
    s_mov_b64 exec, 1
    buffer_store_dwordx2 v[2:3], v4, s[24:27], 0 offen
    s_mov_b64 exec, -1
L_fs_60:
    s_waitcnt vmcnt(0)
    s_branch L_gudone_54
L_idle_53:
    s_cmp_lg_u32 s30, 0
    s_cbranch_scc1 L_fs_61
    s_add_u32 s40, s32, 8
    v_mov_b32 v2, s40
    v_mov_b32_e64 v3, s33
    s_lshl_b32 s41, s2, 6
    s_add_u32 s41, s41, 98304
    v_mov_b32 v4, s41
    s_mov_b64 exec, 1
    buffer_store_dwordx2 v[2:3], v4, s[24:27], 0 offen
    s_mov_b64 exec, -1
L_fs_61:
    s_waitcnt vmcnt(0)
L_gudone_54:
    s_lshr_b32 s44, s29, 3
    v_and_b32 v3, 31, v1
    v_lshrrev_b32_e64 v4, 5, v1
    v_bfe_u32 v5, v3, 1, 3
    s_lshl_b32 s40, s30, 14
    v_add_u32 v6, 0, v4
    v_xor_b32 v6, v6, v5
    v_lshlrev_b32 v6, 4, v6
    v_lshl_add_u32 v6, v3, 7, v6
    v_add_u32 v104, s40, v6
    v_add_u32 v6, 2, v4
    v_xor_b32 v6, v6, v5
    v_lshlrev_b32 v6, 4, v6
    v_lshl_add_u32 v6, v3, 7, v6
    v_add_u32 v105, s40, v6
    v_add_u32 v6, 4, v4
    v_xor_b32 v6, v6, v5
    v_lshlrev_b32 v6, 4, v6
    v_lshl_add_u32 v6, v3, 7, v6
    v_add_u32 v106, s40, v6
    v_add_u32 v6, 6, v4
    v_xor_b32 v6, v6, v5
    v_lshlrev_b32 v6, 4, v6
    v_lshl_add_u32 v6, v3, 7, v6
    v_add_u32 v107, s40, v6
    v_lshrrev_b32 v6, 3, v1
    v_and_b32 v7, 7, v1
    s_movk_i32 s41, 3712
    v_add_u32_e64 v8, 0, v6
    v_bfe_u32 v9, v8, 1, 3
    v_xor_b32_e64 v9, v9, v7
    v_mul_lo_u32 v8, v8, s41
    v_lshl_add_u32 v108, v9, 4, v8
    v_add_u32_e64 v8, 8, v6
    v_bfe_u32 v9, v8, 1, 3
    v_xor_b32_e64 v9, v9, v7
    v_mul_lo_u32 v8, v8, s41
    v_lshl_add_u32 v109, v9, 4, v8
    v_add_u32_e64 v8, 16, v6
    v_bfe_u32 v9, v8, 1, 3
    v_xor_b32_e64 v9, v9, v7
    v_mul_lo_u32 v8, v8, s41
    v_lshl_add_u32 v110, v9, 4, v8
    v_add_u32_e64 v8, 24, v6
    v_bfe_u32 v9, v8, 1, 3
    v_xor_b32_e64 v9, v9, v7
    v_mul_lo_u32 v8, v8, s41
    v_lshl_add_u32 v111, v9, 4, v8
    s_lshl_b32 s57, s28, 8
    s_lshl_b32 s41, s44, 5
    s_add_u32 s57, s57, s41
    s_mul_i32 s57, s57, 3712
    s_mul_i32 s41, s30, 896
    s_add_u32 s57, s57, s41
    s_add_u32 s57, s57, 21495808
    s_lshl_b32 s58, s30, 14
    s_lshl_b32 s41, s35, 7
    s_lshr_b32 s42, s30, 1
    s_lshl_b32 s42, s42, 6
    s_add_u32 s41, s41, s42
    s_and_b32 s42, s30, 1
    s_lshl_b32 s42, s42, 5
    s_add_u32 s41, s41, s42
    v_lshlrev_b32 v12, 4, v4
    v_add_u32 v12, s41, v12
    s_lshl_b32 s42, s28, 8
    s_lshl_b32 s43, s44, 5
    s_add_u32 s42, s42, s43
    v_add_u32_e64 v13, s42, v3
    s_movk_i32 s43, 1152
    v_mul_lo_u32 v13, v13, s43
    v_add_u32 v13, v13, v12
    v_and_b32 v8, 15, v3
    v_lshrrev_b32 v9, 4, v3
    v_lshlrev_b32 v8, 7, v8
    v_lshl_add_u32 v8, v9, 4, v8
    s_lshl_b32 s42, s44, 5
    v_add_u32 v8, s42, v8
    v_add_u32_e64 v9, s38, v8
    v_lshl_add_u32 v14, v9, 10, v12
    v_add_u32_e64 v9, s39, v8
    v_lshl_add_u32 v15, v9, 10, v12
    v_lshlrev_b32 v2, 3, v1
    v_add_u32 v2, s28, v2
    v_lshlrev_b32_e64 v2, 6, v2
    v_add_u32 v115, 98304, v2
    s_add_u32 s40, s32, 7
    s_mov_b32 exec_lo, -1
    s_mov_b32 exec_hi, 0
    s_mov_b32 s98, 0
    v_mov_b32 v2, 0
    v_mov_b32_e64 v3, 0
    s_nop 1
L_poll_62:
    buffer_load_dwordx2 v[2:3], v115, s[24:27], 0 offen sc1
    s_add_u32 s98, s98, 1
    s_cmp_gt_u32 s98, 0x40000
    s_cbranch_scc1 L_pd_63
    s_waitcnt vmcnt(0)
    v_subrev_u32_e64 v2, s40, v2
    v_cmp_gt_u32 vcc, 64, v2
    v_cmp_eq_u32 s[42:43], s33, v3
    s_nop 1
    s_and_b64 vcc, vcc, s[42:43]
    s_cmp_eq_u64 vcc, exec
    s_cbranch_scc1 L_pd_63
    s_sleep 8
    s_branch L_poll_62
L_pd_63:
    s_waitcnt vmcnt(0)
    s_mov_b64 exec, -1
    s_add_u32 m0, s58, 0
    s_nop 0
    buffer_load_dwordx4 v108, s[24:27], s57 offen lds
    s_add_u32 m0, s58, 1024
    s_nop 0
    buffer_load_dwordx4 v109, s[24:27], s57 offen lds
    s_add_u32 m0, s58, 2048
    s_nop 0
    buffer_load_dwordx4 v110, s[24:27], s57 offen lds
    s_add_u32 m0, s58, 3072
    s_nop 0
    buffer_load_dwordx4 v111, s[24:27], s57 offen lds
    s_add_u32 s57, s57, 128
    s_add_u32 m0, s58, 4096
    s_nop 0
    buffer_load_dwordx4 v108, s[24:27], s57 offen lds
    s_add_u32 m0, s58, 5120
    s_nop 0
    buffer_load_dwordx4 v109, s[24:27], s57 offen lds
    s_add_u32 m0, s58, 6144
    s_nop 0
    buffer_load_dwordx4 v110, s[24:27], s57 offen lds
    s_add_u32 m0, s58, 7168
    s_nop 0
    buffer_load_dwordx4 v111, s[24:27], s57 offen lds
    s_add_u32 s57, s57, 128
    s_add_u32 m0, s58, 8192
    s_nop 0
    buffer_load_dwordx4 v108, s[24:27], s57 offen lds
    s_add_u32 m0, s58, 9216
    s_nop 0
    buffer_load_dwordx4 v109, s[24:27], s57 offen lds
    s_add_u32 m0, s58, 10240
    s_nop 0
    buffer_load_dwordx4 v110, s[24:27], s57 offen lds
    s_add_u32 m0, s58, 11264
    s_nop 0
    buffer_load_dwordx4 v111, s[24:27], s57 offen lds
    s_add_u32 s57, s57, 128
    s_mov_b32 s47, 10485760
    buffer_load_dwordx4 v[96:99], v13, s[24:27], s47 offen
    v_add_u32 v13, 147456, v13
    buffer_load_dwordx4 v[100:103], v13, s[24:27], s47 offen
    s_waitcnt vmcnt(10)
    ds_read_b128 v[80:83], v104 offset:0
    ds_read_b128 v[84:87], v105 offset:0
    s_waitcnt lgkmcnt(1)
    v_mfma_f32_32x32x16_bf16 v[16:31], a[128:131], v[80:83], 0
    ds_read_b128 v[88:91], v106 offset:0
    v_mfma_f32_32x32x16_bf16 v[32:47], a[132:135], v[80:83], 0
    s_add_u32 m0, s58, 12288
    s_nop 0
    buffer_load_dwordx4 v108, s[24:27], s57 offen lds
    s_waitcnt lgkmcnt(1)
    v_mfma_f32_32x32x16_bf16 v[16:31], a[136:139], v[84:87], v[16:31]
    ds_read_b128 v[92:95], v107 offset:0
    v_mfma_f32_32x32x16_bf16 v[32:47], a[140:143], v[84:87], v[32:47]
    s_add_u32 m0, s58, 13312
    s_nop 0
    buffer_load_dwordx4 v109, s[24:27], s57 offen lds
    s_waitcnt vmcnt(8)
    s_waitcnt lgkmcnt(1)
    v_mfma_f32_32x32x16_bf16 v[16:31], a[144:147], v[88:91], v[16:31]
    ds_read_b128 v[80:83], v104 offset:4096
    v_mfma_f32_32x32x16_bf16 v[32:47], a[148:151], v[88:91], v[32:47]
    s_add_u32 m0, s58, 14336
    s_nop 0
    buffer_load_dwordx4 v110, s[24:27], s57 offen lds
    s_waitcnt lgkmcnt(1)
    v_mfma_f32_32x32x16_bf16 v[16:31], a[152:155], v[92:95], v[16:31]
    ds_read_b128 v[84:87], v105 offset:4096
    v_mfma_f32_32x32x16_bf16 v[32:47], a[156:159], v[92:95], v[32:47]
    s_add_u32 m0, s58, 15360
    s_nop 0
    buffer_load_dwordx4 v111, s[24:27], s57 offen lds
    s_add_u32 s57, s57, 128
    s_waitcnt lgkmcnt(1)
    v_mfma_f32_32x32x16_bf16 v[16:31], a[160:163], v[80:83], v[16:31]
    ds_read_b128 v[88:91], v106 offset:4096
    v_mfma_f32_32x32x16_bf16 v[32:47], a[164:167], v[80:83], v[32:47]
    s_add_u32 m0, s58, 0
    s_nop 0
    buffer_load_dwordx4 v108, s[24:27], s57 offen lds
    s_waitcnt lgkmcnt(1)
    v_mfma_f32_32x32x16_bf16 v[16:31], a[168:171], v[84:87], v[16:31]
    ds_read_b128 v[92:95], v107 offset:4096
    v_mfma_f32_32x32x16_bf16 v[32:47], a[172:175], v[84:87], v[32:47]
    s_add_u32 m0, s58, 1024
    s_nop 0
    buffer_load_dwordx4 v109, s[24:27], s57 offen lds
    s_waitcnt vmcnt(8)
    s_waitcnt lgkmcnt(1)
    v_mfma_f32_32x32x16_bf16 v[16:31], a[176:179], v[88:91], v[16:31]
    ds_read_b128 v[80:83], v104 offset:8192
    v_mfma_f32_32x32x16_bf16 v[32:47], a[180:183], v[88:91], v[32:47]
    s_add_u32 m0, s58, 2048
    s_nop 0
    buffer_load_dwordx4 v110, s[24:27], s57 offen lds
    s_waitcnt lgkmcnt(1)
    v_mfma_f32_32x32x16_bf16 v[16:31], a[184:187], v[92:95], v[16:31]
    ds_read_b128 v[84:87], v105 offset:8192
    v_mfma_f32_32x32x16_bf16 v[32:47], a[188:191], v[92:95], v[32:47]
    s_add_u32 m0, s58, 3072
    s_nop 0
    buffer_load_dwordx4 v111, s[24:27], s57 offen lds
    s_add_u32 s57, s57, 128
    s_waitcnt lgkmcnt(1)
    v_mfma_f32_32x32x16_bf16 v[16:31], a[192:195], v[80:83], v[16:31]
    ds_read_b128 v[88:91], v106 offset:8192
    v_mfma_f32_32x32x16_bf16 v[32:47], a[196:199], v[80:83], v[32:47]
    s_add_u32 m0, s58, 4096
    s_nop 0
    buffer_load_dwordx4 v108, s[24:27], s57 offen lds
    s_waitcnt lgkmcnt(1)
    v_mfma_f32_32x32x16_bf16 v[16:31], a[200:203], v[84:87], v[16:31]
    ds_read_b128 v[92:95], v107 offset:8192
    v_mfma_f32_32x32x16_bf16 v[32:47], a[204:207], v[84:87], v[32:47]
    s_add_u32 m0, s58, 5120
    s_nop 0
    buffer_load_dwordx4 v109, s[24:27], s57 offen lds
    s_waitcnt vmcnt(6)
    s_waitcnt lgkmcnt(1)
    v_mfma_f32_32x32x16_bf16 v[16:31], a[208:211], v[88:91], v[16:31]
    ds_read_b128 v[80:83], v104 offset:12288
    v_mfma_f32_32x32x16_bf16 v[32:47], a[212:215], v[88:91], v[32:47]
    s_add_u32 m0, s58, 6144
    s_nop 0
    buffer_load_dwordx4 v110, s[24:27], s57 offen lds
    s_waitcnt lgkmcnt(1)
    v_mfma_f32_32x32x16_bf16 v[16:31], a[216:219], v[92:95], v[16:31]
    ds_read_b128 v[84:87], v105 offset:12288
    v_mfma_f32_32x32x16_bf16 v[32:47], a[220:223], v[92:95], v[32:47]
    s_add_u32 m0, s58, 7168
    s_nop 0
    buffer_load_dwordx4 v111, s[24:27], s57 offen lds
    s_add_u32 s57, s57, 128
    s_waitcnt lgkmcnt(1)
    v_mfma_f32_32x32x16_bf16 v[16:31], a[224:227], v[80:83], v[16:31]
    ds_read_b128 v[88:91], v106 offset:12288
    v_mfma_f32_32x32x16_bf16 v[32:47], a[228:231], v[80:83], v[32:47]
    s_add_u32 m0, s58, 8192
    s_nop 0
    buffer_load_dwordx4 v108, s[24:27], s57 offen lds
    s_waitcnt lgkmcnt(1)
    v_mfma_f32_32x32x16_bf16 v[16:31], a[232:235], v[84:87], v[16:31]
    ds_read_b128 v[92:95], v107 offset:12288
    v_mfma_f32_32x32x16_bf16 v[32:47], a[236:239], v[84:87], v[32:47]
    s_add_u32 m0, s58, 9216
    s_nop 0
    buffer_load_dwordx4 v109, s[24:27], s57 offen lds
    s_waitcnt vmcnt(6)
    s_waitcnt lgkmcnt(1)
    v_mfma_f32_32x32x16_bf16 v[16:31], a[240:243], v[88:91], v[16:31]
    ds_read_b128 v[80:83], v104 offset:0
    v_mfma_f32_32x32x16_bf16 v[32:47], a[244:247], v[88:91], v[32:47]
    s_add_u32 m0, s58, 10240
    s_nop 0
    buffer_load_dwordx4 v110, s[24:27], s57 offen lds
    s_waitcnt lgkmcnt(1)
    v_mfma_f32_32x32x16_bf16 v[16:31], a[248:251], v[92:95], v[16:31]
    ds_read_b128 v[84:87], v105 offset:0
    v_mfma_f32_32x32x16_bf16 v[32:47], a[252:255], v[92:95], v[32:47]
    s_add_u32 m0, s58, 11264
    s_nop 0
    buffer_load_dwordx4 v111, s[24:27], s57 offen lds
    s_add_u32 s57, s57, 474368
    s_waitcnt lgkmcnt(1)
    v_mfma_f32_32x32x16_bf16 v[16:31], v[160:163], v[80:83], v[16:31]
    ds_read_b128 v[88:91], v106 offset:0
    v_mfma_f32_32x32x16_bf16 v[32:47], v[164:167], v[80:83], v[32:47]
    s_add_u32 s40, s32, 8
    s_mov_b32 exec_lo, -1
    s_mov_b32 exec_hi, 0
    s_mov_b32 s98, 0
    v_mov_b32 v2, 0
    v_mov_b32_e64 v3, 0
    s_nop 5
L_poll_65:
    buffer_load_dwordx2 v[2:3], v115, s[24:27], 0 offen sc1
    s_add_u32 s98, s98, 1
    s_cmp_gt_u32 s98, 0x40000
    s_cbranch_scc1 L_pd_66
    s_waitcnt vmcnt(0)
    v_subrev_u32_e64 v2, s40, v2
    v_cmp_gt_u32 vcc, 64, v2
    v_cmp_eq_u32 s[42:43], s33, v3
    s_nop 1
    s_and_b64 vcc, vcc, s[42:43]
    s_cmp_eq_u64 vcc, exec
    s_cbranch_scc0 L_poll_65
L_pd_66:
    s_waitcnt vmcnt(0)
    s_mov_b64 exec, -1
    s_add_u32 m0, s58, 12288
    s_nop 0
    buffer_load_dwordx4 v108, s[24:27], s57 offen lds
    s_waitcnt lgkmcnt(1)
    v_mfma_f32_32x32x16_bf16 v[16:31], v[168:171], v[84:87], v[16:31]
    ds_read_b128 v[92:95], v107 offset:0
    v_mfma_f32_32x32x16_bf16 v[32:47], v[172:175], v[84:87], v[32:47]
    s_add_u32 m0, s58, 13312
    s_nop 0
    buffer_load_dwordx4 v109, s[24:27], s57 offen lds
    s_waitcnt lgkmcnt(1)
    v_mfma_f32_32x32x16_bf16 v[16:31], v[176:179], v[88:91], v[16:31]
    ds_read_b128 v[80:83], v104 offset:4096
    v_mfma_f32_32x32x16_bf16 v[32:47], v[180:183], v[88:91], v[32:47]
    s_add_u32 m0, s58, 14336
    s_nop 0
    buffer_load_dwordx4 v110, s[24:27], s57 offen lds
    s_waitcnt lgkmcnt(1)
    v_mfma_f32_32x32x16_bf16 v[16:31], v[184:187], v[92:95], v[16:31]
    ds_read_b128 v[84:87], v105 offset:4096
    v_mfma_f32_32x32x16_bf16 v[32:47], v[188:191], v[92:95], v[32:47]
    s_add_u32 m0, s58, 15360
    s_nop 0
    buffer_load_dwordx4 v111, s[24:27], s57 offen lds
    s_add_u32 s57, s57, 128
    s_waitcnt lgkmcnt(1)
    v_mfma_f32_32x32x16_bf16 v[16:31], v[192:195], v[80:83], v[16:31]
    ds_read_b128 v[88:91], v106 offset:4096
    v_mfma_f32_32x32x16_bf16 v[32:47], v[196:199], v[80:83], v[32:47]
    s_add_u32 m0, s58, 0
    s_nop 0
    buffer_load_dwordx4 v108, s[24:27], s57 offen lds
    s_waitcnt lgkmcnt(1)
    v_mfma_f32_32x32x16_bf16 v[16:31], v[200:203], v[84:87], v[16:31]
    ds_read_b128 v[92:95], v107 offset:4096
    v_mfma_f32_32x32x16_bf16 v[32:47], v[204:207], v[84:87], v[32:47]
    s_add_u32 m0, s58, 1024
    s_nop 0
    buffer_load_dwordx4 v109, s[24:27], s57 offen lds
    s_waitcnt lgkmcnt(1)
    v_mfma_f32_32x32x16_bf16 v[16:31], v[208:211], v[88:91], v[16:31]
    ds_read_b128 v[80:83], v104 offset:8192
    v_mfma_f32_32x32x16_bf16 v[32:47], v[212:215], v[88:91], v[32:47]
    s_add_u32 m0, s58, 2048
    s_nop 0
    buffer_load_dwordx4 v110, s[24:27], s57 offen lds
    s_waitcnt lgkmcnt(1)
    v_mfma_f32_32x32x16_bf16 v[16:31], v[216:219], v[92:95], v[16:31]
    ds_read_b128 v[84:87], v105 offset:8192
    v_mfma_f32_32x32x16_bf16 v[32:47], v[220:223], v[92:95], v[32:47]
    s_add_u32 m0, s58, 3072
    s_nop 0
    buffer_load_dwordx4 v111, s[24:27], s57 offen lds
    s_add_u32 s57, s57, 128
    s_waitcnt lgkmcnt(1)
    v_mfma_f32_32x32x16_bf16 v[16:31], v[224:227], v[80:83], v[16:31]
    ds_read_b128 v[88:91], v106 offset:8192
    v_mfma_f32_32x32x16_bf16 v[32:47], v[228:231], v[80:83], v[32:47]
    s_add_u32 m0, s58, 4096
    s_nop 0
    buffer_load_dwordx4 v108, s[24:27], s57 offen lds
    s_waitcnt lgkmcnt(1)
    v_mfma_f32_32x32x16_bf16 v[16:31], v[232:235], v[84:87], v[16:31]
    ds_read_b128 v[92:95], v107 offset:8192
    v_mfma_f32_32x32x16_bf16 v[32:47], v[236:239], v[84:87], v[32:47]
    s_add_u32 m0, s58, 5120
    s_nop 0
    buffer_load_dwordx4 v109, s[24:27], s57 offen lds
    s_waitcnt vmcnt(6)
    s_waitcnt lgkmcnt(1)
    v_mfma_f32_32x32x16_bf16 v[16:31], v[240:243], v[88:91], v[16:31]
    ds_read_b128 v[80:83], v104 offset:12288
    v_mfma_f32_32x32x16_bf16 v[32:47], v[244:247], v[88:91], v[32:47]
    s_add_u32 m0, s58, 6144
    s_nop 0
    buffer_load_dwordx4 v110, s[24:27], s57 offen lds
    s_waitcnt lgkmcnt(1)
    v_mfma_f32_32x32x16_bf16 v[16:31], v[248:251], v[92:95], v[16:31]
    ds_read_b128 v[84:87], v105 offset:12288
    v_mfma_f32_32x32x16_bf16 v[32:47], v[252:255], v[92:95], v[32:47]
    s_add_u32 m0, s58, 7168
    s_nop 0
    buffer_load_dwordx4 v111, s[24:27], s57 offen lds
    s_add_u32 s57, s57, 128
    s_waitcnt lgkmcnt(1)
    v_mfma_f32_32x32x16_bf16 v[48:63], a[128:131], v[80:83], 0
    ds_read_b128 v[88:91], v106 offset:12288
    v_mfma_f32_32x32x16_bf16 v[64:79], a[132:135], v[80:83], 0
    s_add_u32 m0, s58, 8192
    s_nop 0
    buffer_load_dwordx4 v108, s[24:27], s57 offen lds
    s_waitcnt lgkmcnt(1)
    v_mfma_f32_32x32x16_bf16 v[48:63], a[136:139], v[84:87], v[48:63]
    ds_read_b128 v[92:95], v107 offset:12288
    v_mfma_f32_32x32x16_bf16 v[64:79], a[140:143], v[84:87], v[64:79]
    s_add_u32 m0, s58, 9216
    s_nop 0
    buffer_load_dwordx4 v109, s[24:27], s57 offen lds
    s_waitcnt vmcnt(6)
    s_waitcnt lgkmcnt(1)
    v_mfma_f32_32x32x16_bf16 v[48:63], a[144:147], v[88:91], v[48:63]
    ds_read_b128 v[80:83], v104 offset:0
    v_mfma_f32_32x32x16_bf16 v[64:79], a[148:151], v[88:91], v[64:79]
    s_add_u32 m0, s58, 10240
    s_nop 0
    buffer_load_dwordx4 v110, s[24:27], s57 offen lds
    s_waitcnt lgkmcnt(1)
    v_mfma_f32_32x32x16_bf16 v[48:63], a[152:155], v[92:95], v[48:63]
    ds_read_b128 v[84:87], v105 offset:0
    v_mfma_f32_32x32x16_bf16 v[64:79], a[156:159], v[92:95], v[64:79]
    s_add_u32 m0, s58, 11264
    s_nop 0
    buffer_load_dwordx4 v111, s[24:27], s57 offen lds
    s_add_u32 s57, s57, 128
    s_waitcnt lgkmcnt(1)
    v_mfma_f32_32x32x16_bf16 v[48:63], a[160:163], v[80:83], v[48:63]
    ds_read_b128 v[88:91], v106 offset:0
    v_mfma_f32_32x32x16_bf16 v[64:79], a[164:167], v[80:83], v[64:79]
    s_add_u32 m0, s58, 12288
    s_nop 0
    buffer_load_dwordx4 v108, s[24:27], s57 offen lds
    s_waitcnt lgkmcnt(1)
    v_mfma_f32_32x32x16_bf16 v[48:63], a[168:171], v[84:87], v[48:63]
    ds_read_b128 v[92:95], v107 offset:0
    v_mfma_f32_32x32x16_bf16 v[64:79], a[172:175], v[84:87], v[64:79]
    s_add_u32 m0, s58, 13312
    s_nop 0
    buffer_load_dwordx4 v109, s[24:27], s57 offen lds
    s_waitcnt vmcnt(6)
    s_waitcnt lgkmcnt(1)
    v_mfma_f32_32x32x16_bf16 v[48:63], a[176:179], v[88:91], v[48:63]
    ds_read_b128 v[80:83], v104 offset:4096
    v_mfma_f32_32x32x16_bf16 v[64:79], a[180:183], v[88:91], v[64:79]
    s_add_u32 m0, s58, 14336
    s_nop 0
    buffer_load_dwordx4 v110, s[24:27], s57 offen lds
    s_waitcnt lgkmcnt(1)
    v_mfma_f32_32x32x16_bf16 v[48:63], a[184:187], v[92:95], v[48:63]
    ds_read_b128 v[84:87], v105 offset:4096
    v_mfma_f32_32x32x16_bf16 v[64:79], a[188:191], v[92:95], v[64:79]
    s_add_u32 m0, s58, 15360
    s_nop 0
    buffer_load_dwordx4 v111, s[24:27], s57 offen lds
    s_add_u32 s57, s57, 128
    s_waitcnt lgkmcnt(1)
    v_mfma_f32_32x32x16_bf16 v[48:63], a[192:195], v[80:83], v[48:63]
    ds_read_b128 v[88:91], v106 offset:4096
    v_mfma_f32_32x32x16_bf16 v[64:79], a[196:199], v[80:83], v[64:79]
    s_add_u32 m0, s58, 0
    s_nop 0
    buffer_load_dwordx4 v108, s[24:27], s57 offen lds
    s_waitcnt lgkmcnt(1)
    v_mfma_f32_32x32x16_bf16 v[48:63], a[200:203], v[84:87], v[48:63]
    ds_read_b128 v[92:95], v107 offset:4096
    v_mfma_f32_32x32x16_bf16 v[64:79], a[204:207], v[84:87], v[64:79]
    s_add_u32 m0, s58, 1024
    s_nop 0
    buffer_load_dwordx4 v109, s[24:27], s57 offen lds
    s_waitcnt vmcnt(6)
    s_waitcnt lgkmcnt(1)
    v_mfma_f32_32x32x16_bf16 v[48:63], a[208:211], v[88:91], v[48:63]
    ds_read_b128 v[80:83], v104 offset:8192
    v_mfma_f32_32x32x16_bf16 v[64:79], a[212:215], v[88:91], v[64:79]
    s_add_u32 m0, s58, 2048
    s_nop 0
    buffer_load_dwordx4 v110, s[24:27], s57 offen lds
    s_waitcnt lgkmcnt(1)
    v_mfma_f32_32x32x16_bf16 v[48:63], a[216:219], v[92:95], v[48:63]
    ds_read_b128 v[84:87], v105 offset:8192
    v_mfma_f32_32x32x16_bf16 v[64:79], a[220:223], v[92:95], v[64:79]
    s_add_u32 m0, s58, 3072
    s_nop 0
    buffer_load_dwordx4 v111, s[24:27], s57 offen lds
    s_add_u32 s57, s57, 128
    s_waitcnt lgkmcnt(1)
    v_mfma_f32_32x32x16_bf16 v[48:63], a[224:227], v[80:83], v[48:63]
    ds_read_b128 v[88:91], v106 offset:8192
    v_mfma_f32_32x32x16_bf16 v[64:79], a[228:231], v[80:83], v[64:79]
    s_add_u32 m0, s58, 4096
    s_nop 0
    buffer_load_dwordx4 v108, s[24:27], s57 offen lds
    s_waitcnt lgkmcnt(1)
    v_mfma_f32_32x32x16_bf16 v[48:63], a[232:235], v[84:87], v[48:63]
    ds_read_b128 v[92:95], v107 offset:8192
    v_mfma_f32_32x32x16_bf16 v[64:79], a[236:239], v[84:87], v[64:79]
    s_add_u32 m0, s58, 5120
    s_nop 0
    buffer_load_dwordx4 v109, s[24:27], s57 offen lds
    s_waitcnt vmcnt(6)
    s_waitcnt lgkmcnt(1)
    v_mfma_f32_32x32x16_bf16 v[48:63], a[240:243], v[88:91], v[48:63]
    ds_read_b128 v[80:83], v104 offset:12288
    v_mfma_f32_32x32x16_bf16 v[64:79], a[244:247], v[88:91], v[64:79]
    s_add_u32 m0, s58, 6144
    s_nop 0
    buffer_load_dwordx4 v110, s[24:27], s57 offen lds
    s_waitcnt lgkmcnt(1)
    v_mfma_f32_32x32x16_bf16 v[48:63], a[248:251], v[92:95], v[48:63]
    ds_read_b128 v[84:87], v105 offset:12288
    v_mfma_f32_32x32x16_bf16 v[64:79], a[252:255], v[92:95], v[64:79]
    s_add_u32 m0, s58, 7168
    s_nop 0
    buffer_load_dwordx4 v111, s[24:27], s57 offen lds
    s_add_u32 s57, s57, 128
    s_waitcnt lgkmcnt(1)
    v_mfma_f32_32x32x16_bf16 v[48:63], v[160:163], v[80:83], v[48:63]
    ds_read_b128 v[88:91], v106 offset:12288
    v_mfma_f32_32x32x16_bf16 v[64:79], v[164:167], v[80:83], v[64:79]
    s_waitcnt lgkmcnt(1)
    v_mfma_f32_32x32x16_bf16 v[48:63], v[168:171], v[84:87], v[48:63]
    ds_read_b128 v[92:95], v107 offset:12288
    v_mfma_f32_32x32x16_bf16 v[64:79], v[172:175], v[84:87], v[64:79]
    s_waitcnt vmcnt(4)
    s_waitcnt lgkmcnt(1)
    v_mfma_f32_32x32x16_bf16 v[48:63], v[176:179], v[88:91], v[48:63]
    ds_read_b128 v[80:83], v104 offset:0
    v_mfma_f32_32x32x16_bf16 v[64:79], v[180:183], v[88:91], v[64:79]
    s_waitcnt lgkmcnt(1)
    v_mfma_f32_32x32x16_bf16 v[48:63], v[184:187], v[92:95], v[48:63]
    ds_read_b128 v[84:87], v105 offset:0
    v_mfma_f32_32x32x16_bf16 v[64:79], v[188:191], v[92:95], v[64:79]
    s_waitcnt lgkmcnt(1)
    v_mfma_f32_32x32x16_bf16 v[48:63], v[192:195], v[80:83], v[48:63]
    ds_read_b128 v[88:91], v106 offset:0
    v_mfma_f32_32x32x16_bf16 v[64:79], v[196:199], v[80:83], v[64:79]
    s_waitcnt lgkmcnt(1)
    v_mfma_f32_32x32x16_bf16 v[48:63], v[200:203], v[84:87], v[48:63]
    ds_read_b128 v[92:95], v107 offset:0
    v_mfma_f32_32x32x16_bf16 v[64:79], v[204:207], v[84:87], v[64:79]
    s_waitcnt vmcnt(0)
    s_waitcnt lgkmcnt(1)
    v_mfma_f32_32x32x16_bf16 v[48:63], v[208:211], v[88:91], v[48:63]
    ds_read_b128 v[80:83], v104 offset:4096
    v_mfma_f32_32x32x16_bf16 v[64:79], v[212:215], v[88:91], v[64:79]
    s_waitcnt lgkmcnt(1)
    v_mfma_f32_32x32x16_bf16 v[48:63], v[216:219], v[92:95], v[48:63]
    ds_read_b128 v[84:87], v105 offset:4096
    v_mfma_f32_32x32x16_bf16 v[64:79], v[220:223], v[92:95], v[64:79]
    s_waitcnt lgkmcnt(1)
    v_mfma_f32_32x32x16_bf16 v[48:63], v[224:227], v[80:83], v[48:63]
    ds_read_b128 v[88:91], v106 offset:4096
    v_mfma_f32_32x32x16_bf16 v[64:79], v[228:231], v[80:83], v[64:79]
    s_waitcnt lgkmcnt(1)
    v_mfma_f32_32x32x16_bf16 v[48:63], v[232:235], v[84:87], v[48:63]
    ds_read_b128 v[92:95], v107 offset:4096
    v_mfma_f32_32x32x16_bf16 v[64:79], v[236:239], v[84:87], v[64:79]
    s_waitcnt lgkmcnt(1)
    v_mfma_f32_32x32x16_bf16 v[48:63], v[240:243], v[88:91], v[48:63]
    v_mfma_f32_32x32x16_bf16 v[64:79], v[244:247], v[88:91], v[64:79]
    s_waitcnt lgkmcnt(0)
    v_mfma_f32_32x32x16_bf16 v[48:63], v[248:251], v[92:95], v[48:63]
    v_mfma_f32_32x32x16_bf16 v[64:79], v[252:255], v[92:95], v[64:79]
    v_lshlrev_b32 v2, 4, v1
    s_lshl_b32 s40, s30, 14
    v_add_u32_e64 v3, s40, v2
    ds_write_b128 v3, v[16:19] offset:0
    ds_write_b128 v3, v[20:23] offset:1024
    ds_write_b128 v3, v[24:27] offset:2048
    ds_write_b128 v3, v[28:31] offset:3072
    ds_write_b128 v3, v[32:35] offset:4096
    ds_write_b128 v3, v[36:39] offset:5120
    ds_write_b128 v3, v[40:43] offset:6144
    ds_write_b128 v3, v[44:47] offset:7168
    ds_write_b128 v3, v[48:51] offset:8192
    ds_write_b128 v3, v[52:55] offset:9216
    ds_write_b128 v3, v[56:59] offset:10240
    ds_write_b128 v3, v[60:63] offset:11264
    ds_write_b128 v3, v[64:67] offset:12288
    ds_write_b128 v3, v[68:71] offset:13312
    ds_write_b128 v3, v[72:75] offset:14336
    ds_write_b128 v3, v[76:79] offset:15360
    s_waitcnt lgkmcnt(0)
    s_barrier
    s_lshl_b32 s40, s30, 11
    v_add_u32 v3, s40, v2
    ds_read_b128 v[16:19], v3 offset:0
    ds_read_b128 v[20:23], v3 offset:1024
    ds_read_b128 v[24:27], v3 offset:16384
    ds_read_b128 v[28:31], v3 offset:17408
    ds_read_b128 v[32:35], v3 offset:32768
    ds_read_b128 v[36:39], v3 offset:33792
    ds_read_b128 v[40:43], v3 offset:49152
    ds_read_b128 v[44:47], v3 offset:50176
    ds_read_b128 v[48:51], v3 offset:8192
    ds_read_b128 v[52:55], v3 offset:9216
    ds_read_b128 v[56:59], v3 offset:24576
    ds_read_b128 v[60:63], v3 offset:25600
    ds_read_b128 v[64:67], v3 offset:40960
    ds_read_b128 v[68:71], v3 offset:41984
    ds_read_b128 v[72:75], v3 offset:57344
    ds_read_b128 v[76:79], v3 offset:58368
    s_mov_b32 s54, 0xffff0000
    s_waitcnt lgkmcnt(13)
    v_add_f32 v16, v16, v24
    v_add_f32 v17, v17, v25
    v_add_f32 v18, v18, v26
    v_add_f32 v19, v19, v27
    s_waitcnt lgkmcnt(12)
    v_add_f32 v20, v20, v28
    v_add_f32 v21, v21, v29
    v_add_f32 v22, v22, v30
    v_add_f32 v23, v23, v31
    s_waitcnt lgkmcnt(9)
    v_add_f32 v32, v32, v40
    v_add_f32 v33, v33, v41
    v_add_f32 v34, v34, v42
    v_add_f32 v35, v35, v43
    s_waitcnt lgkmcnt(8)
    v_add_f32 v36, v36, v44
    v_add_f32 v37, v37, v45
    v_add_f32 v38, v38, v46
    v_add_f32 v39, v39, v47
    v_add_f32 v16, v16, v32
    v_add_f32 v17, v17, v33
    v_add_f32 v18, v18, v34
    v_add_f32 v19, v19, v35
    v_add_f32 v20, v20, v36
    v_add_f32 v21, v21, v37
    v_add_f32 v22, v22, v38
    v_add_f32 v23, v23, v39
    v_lshlrev_b32 v24, 16, v96
    v_and_b32 v25, s54, v96
    v_lshlrev_b32 v26, 16, v97
    v_and_b32 v27, s54, v97
    v_lshlrev_b32 v28, 16, v98
    v_and_b32 v29, s54, v98
    v_lshlrev_b32 v30, 16, v99
    v_and_b32 v31, s54, v99
    v_add_f32 v16, v16, v24
    v_add_f32 v17, v17, v25
    v_add_f32 v18, v18, v26
    v_add_f32 v19, v19, v27
    v_add_f32 v20, v20, v28
    v_add_f32 v21, v21, v29
    v_add_f32 v22, v22, v30
    v_add_f32 v23, v23, v31
    v_cvt_pk_bf16_f32 v32, v16, v17
    v_cvt_pk_bf16_f32 v33, v18, v19
    v_cvt_pk_bf16_f32 v34, v20, v21
    v_cvt_pk_bf16_f32 v35, v22, v23
    buffer_store_dwordx4 v[32:35], v14, s[20:23], 0 offen
    s_waitcnt lgkmcnt(5)
    v_add_f32 v48, v48, v56
    v_add_f32 v49, v49, v57
    v_add_f32 v50, v50, v58
    v_add_f32 v51, v51, v59
    s_waitcnt lgkmcnt(4)
    v_add_f32 v52, v52, v60
    v_add_f32 v53, v53, v61
    v_add_f32 v54, v54, v62
    v_add_f32 v55, v55, v63
    s_waitcnt lgkmcnt(1)
    v_add_f32 v64, v64, v72
    v_add_f32 v65, v65, v73
    v_add_f32 v66, v66, v74
    v_add_f32 v67, v67, v75
    s_waitcnt lgkmcnt(0)
    v_add_f32 v68, v68, v76
    v_add_f32 v69, v69, v77
    v_add_f32 v70, v70, v78
    v_add_f32 v71, v71, v79
    v_add_f32 v48, v48, v64
    v_add_f32 v49, v49, v65
    v_add_f32 v50, v50, v66
    v_add_f32 v51, v51, v67
    v_add_f32 v52, v52, v68
    v_add_f32 v53, v53, v69
    v_add_f32 v54, v54, v70
    v_add_f32 v55, v55, v71
    v_lshlrev_b32 v56, 16, v100
    v_and_b32 v57, s54, v100
    v_lshlrev_b32 v58, 16, v101
    v_and_b32 v59, s54, v101
    v_lshlrev_b32 v60, 16, v102
    v_and_b32 v61, s54, v102
    v_lshlrev_b32 v62, 16, v103
    v_and_b32 v63, s54, v103
    v_add_f32 v48, v48, v56
    v_add_f32 v49, v49, v57
    v_add_f32 v50, v50, v58
    v_add_f32 v51, v51, v59
    v_add_f32 v52, v52, v60
    v_add_f32 v53, v53, v61
    v_add_f32 v54, v54, v62
    v_add_f32 v55, v55, v63
    v_cvt_pk_bf16_f32 v64, v48, v49
    v_cvt_pk_bf16_f32 v65, v50, v51
    v_cvt_pk_bf16_f32 v66, v52, v53
    v_cvt_pk_bf16_f32 v67, v54, v55
    buffer_store_dwordx4 v[64:67], v15, s[20:23], 0 offen
    s_waitcnt vmcnt(0)
    s_nop 0
    s_branch L_fin
L_safe:
    v_lshlrev_b32 v2, 4, v1
    v_add_u32_e64 v2, 0, v2
    ds_read_b128 v[48:51], v2 offset:0
    ds_read_b128 v[52:55], v2 offset:8192
    ds_read_b128 v[56:59], v2 offset:1024
    ds_read_b128 v[60:63], v2 offset:9216
    ds_read_b128 v[64:67], v2 offset:2048
    ds_read_b128 v[68:71], v2 offset:10240
    ds_read_b128 v[72:75], v2 offset:3072
    s_waitcnt lgkmcnt(6)
    v_mfma_f32_16x16x32_bf16 v[80:83], v[48:51], v[16:19], 0
    ds_read_b128 v[76:79], v2 offset:11264
    s_waitcnt lgkmcnt(6)
    v_mfma_f32_16x16x32_bf16 v[84:87], v[52:55], v[16:19], 0
    ds_read_b128 v[48:51], v2 offset:4096
    s_waitcnt lgkmcnt(6)
    v_mfma_f32_16x16x32_bf16 v[80:83], v[56:59], v[20:23], v[80:83]
    ds_read_b128 v[52:55], v2 offset:12288
    s_waitcnt lgkmcnt(6)
    v_mfma_f32_16x16x32_bf16 v[84:87], v[60:63], v[20:23], v[84:87]
    ds_read_b128 v[56:59], v2 offset:5120
    s_waitcnt lgkmcnt(6)
    v_mfma_f32_16x16x32_bf16 v[80:83], v[64:67], v[24:27], v[80:83]
    ds_read_b128 v[60:63], v2 offset:13312
    s_waitcnt lgkmcnt(6)
    v_mfma_f32_16x16x32_bf16 v[84:87], v[68:71], v[24:27], v[84:87]
    ds_read_b128 v[64:67], v2 offset:6144
    s_waitcnt lgkmcnt(6)
    v_mfma_f32_16x16x32_bf16 v[80:83], v[72:75], v[28:31], v[80:83]
    ds_read_b128 v[68:71], v2 offset:14336
    s_waitcnt lgkmcnt(6)
    v_mfma_f32_16x16x32_bf16 v[84:87], v[76:79], v[28:31], v[84:87]
    ds_read_b128 v[72:75], v2 offset:7168
    s_waitcnt lgkmcnt(6)
    v_mfma_f32_16x16x32_bf16 v[80:83], v[48:51], v[32:35], v[80:83]
    ds_read_b128 v[76:79], v2 offset:15360
    s_waitcnt lgkmcnt(6)
    v_mfma_f32_16x16x32_bf16 v[84:87], v[52:55], v[32:35], v[84:87]
    s_waitcnt lgkmcnt(5)
    v_mfma_f32_16x16x32_bf16 v[80:83], v[56:59], v[36:39], v[80:83]
    s_waitcnt lgkmcnt(4)
    v_mfma_f32_16x16x32_bf16 v[84:87], v[60:63], v[36:39], v[84:87]
    s_waitcnt lgkmcnt(3)
    v_mfma_f32_16x16x32_bf16 v[80:83], v[64:67], v[40:43], v[80:83]
    s_waitcnt lgkmcnt(2)
    v_mfma_f32_16x16x32_bf16 v[84:87], v[68:71], v[40:43], v[84:87]
    s_waitcnt lgkmcnt(1)
    v_mfma_f32_16x16x32_bf16 v[80:83], v[72:75], v[44:47], v[80:83]
    s_waitcnt lgkmcnt(0)
    v_mfma_f32_16x16x32_bf16 v[84:87], v[76:79], v[44:47], v[84:87]
    v_and_b32 v2, 15, v1
    v_lshrrev_b32 v3, 4, v1
    v_and_b32 v4, 7, v2
    v_xor_b32 v3, v3, v4
    v_lshlrev_b32_e64 v5, 4, v3
    v_lshl_add_u32 v5, v2, 7, v5
    s_lshl_b32 s40, s30, 11
    s_add_u32 s40, s40, 16384
    v_add_u32 v5, s40, v5
    v_xor_b32_e64 v6, 64, v5
    ds_write_b128 v5, v[80:83]
    ds_write_b128 v6, v[84:87]
    v_lshrrev_b32 v2, 2, v1
    v_and_b32 v3, 3, v1
    v_lshlrev_b32 v3, 1, v3
    v_and_b32 v4, 7, v2
    v_xor_b32 v3, v3, v4
    v_lshlrev_b32 v7, 4, v3
    v_lshl_add_u32 v7, v2, 7, v7
    v_add_u32 v7, s40, v7
    v_xor_b32 v6, 16, v7
    ds_read_b128 v[80:83], v7
    ds_read_b128 v[84:87], v6
    s_waitcnt vmcnt(0)
    v_alignbit_b32 v104, v93, v92, 16
    v_alignbit_b32 v105, v94, v93, 16
    v_alignbit_b32 v106, v95, v94, 16
    v_lshrrev_b32 v107, 16, v95
    v_lshl_or_b32 v107, v96, 16, v107
    v_cndmask_b32 v92, v92, v104, s[52:53]
    v_cndmask_b32 v93, v93, v105, s[52:53]
    v_cndmask_b32 v94, v94, v106, s[52:53]
    v_cndmask_b32 v95, v95, v107, s[52:53]
    s_mov_b32 s54, 0xffff0000
    v_lshlrev_b32 v104, 16, v88
    v_and_b32 v105, s54, v88
    v_lshlrev_b32 v119, 16, v92
    v_and_b32 v118, s54, v92
    v_lshlrev_b32 v106, 16, v89
    v_and_b32 v107, s54, v89
    v_lshlrev_b32 v117, 16, v93
    v_and_b32 v116, s54, v93
    v_lshlrev_b32 v108, 16, v90
    v_and_b32 v109, s54, v90
    v_lshlrev_b32 v115, 16, v94
    v_and_b32 v114, s54, v94
    v_lshlrev_b32 v110, 16, v91
    v_and_b32 v111, s54, v91
    v_lshlrev_b32 v113, 16, v95
    v_and_b32 v112, s54, v95
    s_waitcnt lgkmcnt(1)
    v_add_f32 v112, v112, v80
    v_add_f32 v113, v113, v81
    v_add_f32 v114, v114, v82
    v_add_f32 v115, v115, v83
    s_waitcnt lgkmcnt(0)
    v_add_f32 v116, v116, v84
    v_add_f32 v117, v117, v85
    v_add_f32 v118, v118, v86
    v_add_f32 v119, v119, v87
    v_mov_b32_e64 v99, 0
    v_cndmask_b32 v80, v80, v99, s[52:53]
    v_add_f32 v104, v104, v80
    v_add_f32 v105, v105, v81
    v_add_f32 v106, v106, v82
    v_add_f32 v107, v107, v83
    v_add_f32 v108, v108, v84
    v_add_f32 v109, v109, v85
    v_add_f32 v110, v110, v86
    v_add_f32 v111, v111, v87
    v_cvt_pk_bf16_f32 v120, v104, v105
    v_cvt_pk_bf16_f32 v121, v106, v107
    v_cvt_pk_bf16_f32 v122, v108, v109
    v_cvt_pk_bf16_f32 v123, v110, v111
    v_cvt_pk_bf16_f32 v124, v119, v118
    v_cvt_pk_bf16_f32 v125, v117, v116
    v_cvt_pk_bf16_f32 v126, v115, v114
    v_cvt_pk_bf16_f32 v127, v113, v112
    s_mov_b32 s46, 5242880
    s_mov_b32 s47, 13107200
    buffer_store_dwordx4 v[120:123], v8, s[24:27], s46 offen sc1
    s_not_b64 exec, s[52:53]
    buffer_store_dwordx4 v[124:127], v9, s[24:27], s46 offen sc1
    s_mov_b64 exec, -1
    s_nop 0
    s_cmp_lg_u32 s35, 0
    s_cbranch_scc1 L_qsp_68
    v_subrev_u32 v13, 498, v9
    s_mov_b64 exec, s[52:53]
    buffer_store_dwordx3 v[124:126], v9, s[24:27], s46 offen sc1
    buffer_store_short v127, v9, s[24:27], s46 offen offset:12 sc1
    buffer_store_short_d16_hi v127, v13, s[24:27], s46 offen sc1
    s_mov_b64 exec, -1
L_qsp_68:
    v_add_f32 v128, v104, v105
    v_mul_f32 v129, v104, v104
    v_fmac_f32 v129, v105, v105
    v_add_f32 v128, v128, v106
    v_fmac_f32 v129, v106, v106
    v_add_f32 v128, v128, v107
    v_fmac_f32 v129, v107, v107
    v_add_f32 v128, v128, v108
    v_fmac_f32 v129, v108, v108
    v_add_f32 v128, v128, v109
    v_fmac_f32 v129, v109, v109
    v_add_f32 v128, v128, v110
    v_fmac_f32 v129, v110, v110
    v_add_f32 v128, v128, v111
    v_fmac_f32 v129, v111, v111
    v_add_f32 v130, v112, v113
    v_mul_f32 v131, v112, v112
    v_fmac_f32 v131, v113, v113
    v_add_f32 v130, v130, v114
    v_fmac_f32 v131, v114, v114
    v_add_f32 v130, v130, v115
    v_fmac_f32 v131, v115, v115
    v_add_f32 v130, v130, v116
    v_fmac_f32 v131, v116, v116
    v_add_f32 v130, v130, v117
    v_fmac_f32 v131, v117, v117
    v_add_f32 v130, v130, v118
    v_fmac_f32 v131, v118, v118
    v_add_f32 v130, v130, v119
    v_fmac_f32_e64 v131, v119, v119
    v_add_f32_dpp v128, v128, v128 quad_perm:[1,0,3,2] row_mask:0xf bank_mask:0xf
    v_add_f32_dpp v129, v129, v129 quad_perm:[1,0,3,2] row_mask:0xf bank_mask:0xf
    v_add_f32_dpp v130, v130, v130 quad_perm:[1,0,3,2] row_mask:0xf bank_mask:0xf
    v_add_f32_dpp v131, v131, v131 quad_perm:[1,0,3,2] row_mask:0xf bank_mask:0xf
    v_add_f32_dpp v128, v128, v128 quad_perm:[2,3,0,1] row_mask:0xf bank_mask:0xf
    v_add_f32_dpp v129, v129, v129 quad_perm:[2,3,0,1] row_mask:0xf bank_mask:0xf
    v_add_f32_dpp v130, v130, v130 quad_perm:[2,3,0,1] row_mask:0xf bank_mask:0xf
    v_add_f32_dpp v131, v131, v131 quad_perm:[2,3,0,1] row_mask:0xf bank_mask:0xf
    s_mov_b32 exec_lo, 0x11111111
    s_mov_b32 exec_hi, 0x11111111
    buffer_store_dwordx2 v[128:129], v10, s[24:27], s47 offen sc1
    buffer_store_dwordx2 v[130:131], v11, s[24:27], s47 offen sc1
    s_mov_b64 exec, -1
    s_cmp_eq_u32 s30, 0
    s_cbranch_scc1 L_w0_69
    v_lshrrev_b32 v2, 3, v1
    v_and_b32_e64 v3, 7, v1
    v_bfe_u32 v4, v2, 1, 1
    v_lshlrev_b32 v4, 1, v4
    v_xor_b32 v3, v3, v4
    v_mul_u32_u24 v2, 3584, v2
    v_lshl_add_u32 v112, v3, 4, v2
    v_xor_b32_e64 v3, 4, v3
    v_lshl_add_u32 v113, v3, 4, v2
    s_waitcnt vmcnt(0)
    s_barrier
    s_branch L_wj_70
L_w0_69:
    v_lshrrev_b32 v2, 3, v1
    v_and_b32_e64 v3, 7, v1
    v_bfe_u32 v4, v2, 1, 1
    v_lshlrev_b32 v4, 1, v4
    v_xor_b32 v3, v3, v4
    v_mul_u32_u24 v2, 3584, v2
    v_lshl_add_u32 v112, v3, 4, v2
    v_xor_b32_e64 v3, 4, v3
    v_lshl_add_u32 v113, v3, 4, v2
    s_waitcnt vmcnt(0)
    s_barrier
    s_add_u32 s40, s32, 1
    v_mov_b32 v2, s40
    v_mov_b32 v3, s33
    s_lshl_b32 s41, s2, 6
    s_add_u32 s41, s41, 98304
    v_mov_b32 v4, s41
    s_mov_b64 exec, 1
    buffer_store_dwordx2 v[2:3], v4, s[24:27], 0 offen sc1
    s_mov_b64 exec, -1
L_wj_70:
    s_cmp_ge_u32 s29, 28
    s_cbranch_scc1 L_idle_71
    s_cmp_eq_u32 s30, 0
    s_cbranch_scc1 L_w0_73
    s_add_u32 s40, s30, 41
    s_mul_i32 s41, s40, 28672
    s_min_u32 s42, s29, 27
    s_lshl_b32 s42, s42, 7
    s_add_u32 s41, s41, s42
    s_lshr_b32 s42, s40, 1
    s_lshl_b32 s42, s42, 12
    s_and_b32 s43, s40, 1
    s_lshl_b32 s43, s43, 10
    s_add_u32 s42, s42, s43
    s_add_u32 s42, s42, 4294950912
    s_mov_b32 m0, s42
    s_nop 0
    buffer_load_dwordx4 v112, s[8:11], s41 offen lds
    s_add_u32 m0, s42, 2048
    s_nop 0
    buffer_load_dwordx4 v113, s[12:15], s41 offen lds
    s_add_u32 s40, s30, 44
    s_mul_i32 s41, s40, 28672
    s_min_u32 s42, s29, 27
    s_lshl_b32 s42, s42, 7
    s_add_u32 s41, s41, s42
    s_lshr_b32 s42, s40, 1
    s_lshl_b32 s42, s42, 12
    s_and_b32 s43, s40, 1
    s_lshl_b32 s43, s43, 10
    s_add_u32 s42, s42, s43
    s_add_u32 s42, s42, 4294950912
    s_mov_b32 m0, s42
    s_nop 0
    buffer_load_dwordx4 v112, s[8:11], s41 offen lds
    s_add_u32 m0, s42, 2048
    s_nop 0
    buffer_load_dwordx4 v113, s[12:15], s41 offen lds
    s_add_u32 s40, s30, 47
    s_mul_i32 s41, s40, 28672
    s_min_u32 s42, s29, 27
    s_lshl_b32 s42, s42, 7
    s_add_u32 s41, s41, s42
    s_lshr_b32 s42, s40, 1
    s_lshl_b32 s42, s42, 12
    s_and_b32 s43, s40, 1
    s_lshl_b32 s43, s43, 10
    s_add_u32 s42, s42, s43
    s_add_u32 s42, s42, 4294950912
    s_mov_b32 m0, s42
    s_nop 0
    buffer_load_dwordx4 v112, s[8:11], s41 offen lds
    s_add_u32 m0, s42, 2048
    s_nop 0
    buffer_load_dwordx4 v113, s[12:15], s41 offen lds
    s_add_u32 s40, s30, 50
    s_mul_i32 s41, s40, 28672
    s_min_u32 s42, s29, 27
    s_lshl_b32 s42, s42, 7
    s_add_u32 s41, s41, s42
    s_lshr_b32 s42, s40, 1
    s_lshl_b32 s42, s42, 12
    s_and_b32 s43, s40, 1
    s_lshl_b32 s43, s43, 10
    s_add_u32 s42, s42, s43
    s_add_u32 s42, s42, 4294950912
    s_mov_b32 m0, s42
    s_nop 0
    buffer_load_dwordx4 v112, s[8:11], s41 offen lds
    s_add_u32 m0, s42, 2048
    s_nop 0
    buffer_load_dwordx4 v113, s[12:15], s41 offen lds
    s_add_u32 s40, s30, 53
    s_mul_i32 s41, s40, 28672
    s_min_u32 s42, s29, 27
    s_lshl_b32 s42, s42, 7
    s_add_u32 s41, s41, s42
    s_lshr_b32 s42, s40, 1
    s_lshl_b32 s42, s42, 12
    s_and_b32 s43, s40, 1
    s_lshl_b32 s43, s43, 10
    s_add_u32 s42, s42, s43
    s_add_u32 s42, s42, 4294950912
    s_mov_b32 m0, s42
    s_nop 0
    buffer_load_dwordx4 v112, s[8:11], s41 offen lds
    s_add_u32 m0, s42, 2048
    s_nop 0
    buffer_load_dwordx4 v113, s[12:15], s41 offen lds
    s_add_u32 s40, s30, 56
    s_mul_i32 s41, s40, 28672
    s_min_u32 s42, s29, 27
    s_lshl_b32 s42, s42, 7
    s_add_u32 s41, s41, s42
    s_lshr_b32 s42, s40, 1
    s_lshl_b32 s42, s42, 12
    s_and_b32 s43, s40, 1
    s_lshl_b32 s43, s43, 10
    s_add_u32 s42, s42, s43
    s_add_u32 s42, s42, 4294950912
    s_mov_b32 m0, s42
    s_nop 0
    buffer_load_dwordx4 v112, s[8:11], s41 offen lds
    s_add_u32 m0, s42, 2048
    s_nop 0
    buffer_load_dwordx4 v113, s[12:15], s41 offen lds
    s_branch L_wj_74
L_w0_73:
L_wj_74:
    s_add_u32 s40, s30, 60
    s_mul_i32 s41, s40, 28672
    s_min_u32 s42, s29, 27
    s_lshl_b32 s42, s42, 7
    s_add_u32 s41, s41, s42
    s_lshr_b32 s42, s30, 1
    s_lshl_b32 s42, s42, 12
    s_and_b32 s40, s30, 1
    s_lshl_b32 s40, s40, 10
    s_add_u32 s42, s42, s40
    s_add_u32 m0, s42, 16384
    s_nop 0
    buffer_load_dwordx4 v112, s[8:11], s41 offen lds
    s_add_u32 m0, s42, 18432
    s_nop 0
    buffer_load_dwordx4 v113, s[12:15], s41 offen lds
    s_and_b32 s40, s30, 1
    s_lshl_b32 s40, s40, 3
    s_or_b32 s41, s40, 0
    v_xor_b32 v2, s41, v1
    v_lshlrev_b32 v2, 4, v2
    v_add_u32 v120, 0, v2
    s_or_b32 s41, s40, 1
    v_xor_b32 v2, s41, v1
    v_lshlrev_b32 v2, 4, v2
    v_add_u32 v121, 128, v2
    s_or_b32 s41, s40, 2
    v_xor_b32 v2, s41, v1
    v_lshlrev_b32_e64 v2, 4, v2
    v_add_u32 v122, 256, v2
    s_or_b32 s41, s40, 3
    v_xor_b32 v2, s41, v1
    v_lshlrev_b32_e64 v2, 4, v2
    v_add_u32 v123, 384, v2
    s_or_b32 s41, s40, 4
    v_xor_b32 v2, s41, v1
    v_lshlrev_b32 v2, 4, v2
    v_add_u32 v124, 0, v2
    s_or_b32 s41, s40, 5
    v_xor_b32 v2, s41, v1
    v_lshlrev_b32_e64 v2, 4, v2
    v_add_u32 v125, 128, v2
    s_or_b32 s41, s40, 6
    v_xor_b32 v2, s41, v1
    v_lshlrev_b32_e64 v2, 4, v2
    v_add_u32 v126, 256, v2
    s_or_b32 s41, s40, 7
    v_xor_b32 v2, s41, v1
    v_lshlrev_b32_e64 v2, 4, v2
    v_add_u32 v127, 384, v2
    v_and_b32 v3, 31, v1
    v_lshrrev_b32 v4, 5, v1
    v_and_b32 v5, 15, v3
    v_add_u32 v6, 0, v4
    v_xor_b32 v6, v6, v5
    v_lshlrev_b32 v6, 4, v6
    v_lshl_add_u32 v128, v3, 10, v6
    v_add_u32 v6, 2, v4
    v_xor_b32 v6, v6, v5
    v_lshlrev_b32_e64 v6, 4, v6
    v_lshl_add_u32 v129, v3, 10, v6
    v_add_u32 v6, 4, v4
    v_xor_b32 v6, v6, v5
    v_lshlrev_b32_e64 v6, 4, v6
    v_lshl_add_u32 v130, v3, 10, v6
    v_add_u32 v6, 6, v4
    v_xor_b32 v6, v6, v5
    v_lshlrev_b32_e64 v6, 4, v6
    v_lshl_add_u32 v131, v3, 10, v6
    v_add_u32 v6, 8, v4
    v_xor_b32 v6, v6, v5
    v_lshlrev_b32_e64 v6, 4, v6
    v_lshl_add_u32 v132, v3, 10, v6
    v_add_u32 v6, 10, v4
    v_xor_b32 v6, v6, v5
    v_lshlrev_b32_e64 v6, 4, v6
    v_lshl_add_u32 v133, v3, 10, v6
    v_add_u32 v6, 12, v4
    v_xor_b32 v6, v6, v5
    v_lshlrev_b32_e64 v6, 4, v6
    v_lshl_add_u32 v134, v3, 10, v6
    v_add_u32 v6, 14, v4
    v_xor_b32 v6, v6, v5
    v_lshlrev_b32_e64 v6, 4, v6
    v_lshl_add_u32 v135, v3, 10, v6
    v_lshlrev_b32_e64 v115, 4, v3
    v_add_u32 v115, 0x20000, v115
    s_lshl_b32 s40, s30, 1
    v_add_u32 v6, s40, v4
    v_and_b32 v7, 7, v3
    v_xor_b32 v6, v6, v7
    v_lshlrev_b32_e64 v6, 4, v6
    v_lshl_add_u32 v6, v3, 7, v6
    v_add_u32 v112, 0x21000, v6
    v_lshrrev_b32 v6, 3, v1
    v_and_b32 v7, 7, v1
    v_xor_b32 v8, v6, v7
    v_lshlrev_b32 v8, 4, v8
    s_lshl_b32 s40, s30, 3
    v_add_u32 v6, s40, v6
    v_lshl_add_u32 v8, v6, 7, v8
    v_add_u32 v113, 0x21000, v8
    s_movk_i32 s40, 3712
    v_mul_lo_u32 v6, v6, s40
    v_lshl_add_u32 v114, v7, 4, v6
    s_lshl_b32 s57, s28, 8
    s_lshl_b32 s40, s30, 3
    s_add_u32 s57, s57, s40
    s_mul_i32 s57, s57, 1152
    s_add_u32 s57, s57, 5242880
    s_lshl_b32 s58, s30, 13
    s_mul_i32 s59, s28, 950272
    s_lshl_b32 s40, s29, 7
    s_add_u32 s59, s59, s40
    s_add_u32 s59, s59, 13631488
    s_movk_i32 s60, 4608
    s_mov_b32 s61, 32256
    s_mov_b32 s62, 118784
    s_waitcnt vmcnt(0)
    s_barrier
    v_and_b32 v2, 15, v1
    v_lshrrev_b32 v3, 4, v1
    v_lshrrev_b32 v4, 2, v2
    v_and_b32 v5, 3, v2
    v_and_b32 v6, 1, v3
    v_lshrrev_b32 v7, 1, v3
    v_and_b32 v8, 1, v5
    s_lshl_b32 s40, s30, 1
    v_add_u32 v8, s40, v8
    v_lshlrev_b32 v9, 2, v6
    v_and_b32 v10, 2, v4
    v_or_b32 v9, v9, v10
    v_xor_b32 v8, v8, v9
    v_lshlrev_b32 v8, 4, v8
    v_lshrrev_b32_e64 v5, 1, v5
    v_lshl_add_u32 v8, v5, 3, v8
    v_lshl_add_u32 v8, v6, 11, v8
    v_lshl_add_u32 v4, v7, 3, v4
    v_lshl_add_u32 v8, v4, 7, v8
    v_add_u32 v9, 106496, v8
    v_add_u32 v10, 40960, v8
    ds_read_b64_tr_b16 a[0:1], v9 offset:0
    ds_read_b64_tr_b16 a[2:3], v9 offset:512
    ds_read_b64_tr_b16 a[4:5], v9 offset:4096
    ds_read_b64_tr_b16 a[6:7], v9 offset:4608
    ds_read_b64_tr_b16 a[8:9], v9 offset:8192
    ds_read_b64_tr_b16 a[10:11], v9 offset:8704
    ds_read_b64_tr_b16 a[12:13], v9 offset:12288
    ds_read_b64_tr_b16 a[14:15], v9 offset:12800
    ds_read_b64_tr_b16 a[16:17], v9 offset:16384
    ds_read_b64_tr_b16 a[18:19], v9 offset:16896
    ds_read_b64_tr_b16 a[20:21], v9 offset:20480
    ds_read_b64_tr_b16 a[22:23], v9 offset:20992
    ds_read_b64_tr_b16 a[24:25], v9 offset:24576
    ds_read_b64_tr_b16 a[26:27], v9 offset:25088
    ds_read_b64_tr_b16 a[28:29], v9 offset:28672
    ds_read_b64_tr_b16 a[30:31], v9 offset:29184
    ds_read_b64_tr_b16 a[32:33], v9 offset:32768
    ds_read_b64_tr_b16 a[34:35], v9 offset:33280
    ds_read_b64_tr_b16 a[36:37], v9 offset:36864
    ds_read_b64_tr_b16 a[38:39], v9 offset:37376
    ds_read_b64_tr_b16 a[40:41], v9 offset:40960
    ds_read_b64_tr_b16 a[42:43], v9 offset:41472
    ds_read_b64_tr_b16 a[44:45], v9 offset:45056
    ds_read_b64_tr_b16 a[46:47], v9 offset:45568
    ds_read_b64_tr_b16 a[48:49], v9 offset:49152
    ds_read_b64_tr_b16 a[50:51], v9 offset:49664
    ds_read_b64_tr_b16 a[52:53], v9 offset:53248
    ds_read_b64_tr_b16 a[54:55], v9 offset:53760
    ds_read_b64_tr_b16 a[56:57], v10 offset:0
    ds_read_b64_tr_b16 a[58:59], v10 offset:512
    ds_read_b64_tr_b16 a[60:61], v10 offset:4096
    ds_read_b64_tr_b16 a[62:63], v10 offset:4608
    ds_read_b64_tr_b16 a[64:65], v10 offset:8192
    ds_read_b64_tr_b16 a[66:67], v10 offset:8704
    ds_read_b64_tr_b16 a[68:69], v10 offset:12288
    ds_read_b64_tr_b16 a[70:71], v10 offset:12800
    ds_read_b64_tr_b16 a[72:73], v10 offset:16384
    ds_read_b64_tr_b16 a[74:75], v10 offset:16896
    ds_read_b64_tr_b16 a[76:77], v10 offset:20480
    ds_read_b64_tr_b16 a[78:79], v10 offset:20992
    ds_read_b64_tr_b16 a[80:81], v10 offset:24576
    ds_read_b64_tr_b16 a[82:83], v10 offset:25088
    ds_read_b64_tr_b16 a[84:85], v10 offset:28672
    ds_read_b64_tr_b16 a[86:87], v10 offset:29184
    ds_read_b64_tr_b16 a[88:89], v10 offset:32768
    ds_read_b64_tr_b16 a[90:91], v10 offset:33280
    ds_read_b64_tr_b16 a[92:93], v10 offset:36864
    ds_read_b64_tr_b16 a[94:95], v10 offset:37376
    ds_read_b64_tr_b16 a[96:97], v10 offset:40960
    ds_read_b64_tr_b16 a[98:99], v10 offset:41472
    ds_read_b64_tr_b16 a[100:101], v10 offset:45056
    ds_read_b64_tr_b16 a[102:103], v10 offset:45568
    ds_read_b64_tr_b16 a[104:105], v10 offset:49152
    ds_read_b64_tr_b16 a[106:107], v10 offset:49664
    ds_read_b64_tr_b16 a[108:109], v10 offset:53248
    ds_read_b64_tr_b16 a[110:111], v10 offset:53760
    ds_read_b64_tr_b16 a[112:113], v10 offset:57344
    ds_read_b64_tr_b16 a[114:115], v10 offset:57856
    ds_read_b64_tr_b16 a[116:117], v10 offset:61440
    ds_read_b64_tr_b16 a[118:119], v10 offset:61952
    ds_read_b64_tr_b16 a[120:121], v8 offset:16384
    ds_read_b64_tr_b16 a[122:123], v8 offset:16896
    ds_read_b64_tr_b16 a[124:125], v8 offset:20480
    ds_read_b64_tr_b16 a[126:127], v8 offset:20992
    v_lshlrev_b32 v2, 3, v1
    v_add_u32 v2, s28, v2
    v_lshlrev_b32_e64 v2, 6, v2
    v_add_u32 v4, 98304, v2
    s_nop 1
    s_cmp_lg_u32 s30, 0
    s_cbranch_scc1 L_ps_77
    s_add_u32 s40, s32, 1
    s_mov_b32 exec_lo, -1
    s_mov_b32 exec_hi, 0
    s_mov_b32 s98, 0
    v_mov_b32 v2, 0
    v_mov_b32 v3, 0
    s_nop 1
L_poll_75:
    buffer_load_dwordx2 v[2:3], v4, s[24:27], 0 offen sc1
    s_add_u32 s98, s98, 1
    s_cmp_gt_u32 s98, 0x40000
    s_cbranch_scc1 L_pd_76
    s_waitcnt vmcnt(0)
    v_subrev_u32_e64 v2, s40, v2
    v_cmp_gt_u32 vcc, 64, v2
    v_cmp_eq_u32 s[42:43], s33, v3
    s_nop 1
    s_and_b64 vcc, vcc, s[42:43]
    s_cmp_eq_u64 vcc, exec
    s_cbranch_scc0 L_poll_75
L_pd_76:
    s_waitcnt vmcnt(0)
    s_mov_b64 exec, -1
L_ps_77:
    s_waitcnt lgkmcnt(0)
    s_barrier
    s_add_u32 m0, s58, 0
    s_nop 0
    buffer_load_dwordx4 v120, s[24:27], s57 offen offset:0 lds
    buffer_load_dwordx4 v121, s[24:27], s57 offen offset:1024 lds
    buffer_load_dwordx4 v122, s[24:27], s57 offen offset:2048 lds
    buffer_load_dwordx4 v123, s[24:27], s57 offen offset:3072 lds
    s_add_u32 s57, s57, s60
    s_add_u32 m0, s58, 4096
    s_nop 0
    buffer_load_dwordx4 v124, s[24:27], s57 offen offset:0 lds
    buffer_load_dwordx4 v125, s[24:27], s57 offen offset:1024 lds
    buffer_load_dwordx4 v126, s[24:27], s57 offen offset:2048 lds
    buffer_load_dwordx4 v127, s[24:27], s57 offen offset:3072 lds
    s_add_u32 s57, s57, s61
    s_lshl_b32 s41, s30, 6
    v_add_u32 v2, s41, v1
    v_lshlrev_b32 v116, 4, v2
    v_add_u32 v116, 0x20000, v116
    v_lshlrev_b32 v2, 3, v2
    s_lshl_b32 s40, s28, 15
    s_add_u32 s40, s40, 13107200
    buffer_load_dwordx2 v[32:33], v2, s[24:27], s40 offen offset:0
    buffer_load_dwordx2 v[34:35], v2, s[24:27], s40 offen offset:2048
    s_add_u32 s40, s40, 4096
    buffer_load_dwordx2 v[36:37], v2, s[24:27], s40 offen offset:0
    buffer_load_dwordx2 v[38:39], v2, s[24:27], s40 offen offset:2048
    s_add_u32 s40, s40, 4096
    buffer_load_dwordx2 v[40:41], v2, s[24:27], s40 offen offset:0
    buffer_load_dwordx2 v[42:43], v2, s[24:27], s40 offen offset:2048
    s_add_u32 s40, s40, 4096
    buffer_load_dwordx2 v[44:45], v2, s[24:27], s40 offen offset:0
    buffer_load_dwordx2 v[46:47], v2, s[24:27], s40 offen offset:2048
    s_add_u32 s40, s40, 4096
    buffer_load_dwordx2 v[104:105], v2, s[24:27], s40 offen offset:0
    buffer_load_dwordx2 v[106:107], v2, s[24:27], s40 offen offset:2048
    s_add_u32 s40, s40, 4096
    buffer_load_dwordx2 v[108:109], v2, s[24:27], s40 offen offset:0
    buffer_load_dwordx2 v[110:111], v2, s[24:27], s40 offen offset:2048
    s_add_u32 s40, s40, 4096
    buffer_load_dwordx2 v[136:137], v2, s[24:27], s40 offen offset:0
    buffer_load_dwordx2 v[138:139], v2, s[24:27], s40 offen offset:2048
    s_add_u32 s40, s40, 4096
    buffer_load_dwordx2 v[140:141], v2, s[24:27], s40 offen offset:0
    buffer_load_dwordx2 v[142:143], v2, s[24:27], s40 offen offset:2048
    s_add_u32 m0, s58, 32768
    s_nop 0
    buffer_load_dwordx4 v120, s[24:27], s57 offen offset:0 lds
    buffer_load_dwordx4 v121, s[24:27], s57 offen offset:1024 lds
    buffer_load_dwordx4 v122, s[24:27], s57 offen offset:2048 lds
    buffer_load_dwordx4 v123, s[24:27], s57 offen offset:3072 lds
    s_add_u32 s57, s57, s60
    s_add_u32 m0, s58, 36864
    s_nop 0
    buffer_load_dwordx4 v124, s[24:27], s57 offen offset:0 lds
    buffer_load_dwordx4 v125, s[24:27], s57 offen offset:1024 lds
    buffer_load_dwordx4 v126, s[24:27], s57 offen offset:2048 lds
    buffer_load_dwordx4 v127, s[24:27], s57 offen offset:3072 lds
    s_add_u32 s57, s57, s61
    s_getpc_b64 s[42:43]
L_pc_78:
    s_lshl_b32 s40, s29, 2
    s_add_u32 s40, s40, s30
    s_lshl_b32 s40, s40, 10
    v_lshlrev_b32 v2, 4, v1
    v_add_u32 v2, s40, v2
    v_min_u32 v2, 24560, v2
    v_add_u32 v2, 12288, v2
    v_min_u32 v2, L_code_end-L_pc_78-16, v2
    global_load_dwordx4 v[92:95], v2, s[42:43]
    v_lshlrev_b32_e64 v117, 4, v1
    s_lshl_b32 s63, s35, 2
    s_add_u32 s63, s63, s30
    s_mul_i32 s63, s63, 57344
    s_add_u32 s63, s63, 29360128
    s_lshl_b32 s40, s30, 3
    s_add_u32 s40, s40, s35
    s_lshl_b32 s40, s40, 6
    s_add_u32 s40, s40, 114688
    v_mov_b32 v118, s40
    v_mov_b32 v12, 0x3f803f80
    v_mov_b32 v13, 0x3f803f80
    v_mov_b32 v14, 0x3f803f80
    v_mov_b32 v15, 0x3f803f80
    s_nop 1
    v_mfma_f32_32x32x16_bf16 v[144:159], a[0:3], v[12:15], 0
    v_mfma_f32_32x32x16_bf16 v[144:159], a[4:7], v[12:15], v[144:159]
    v_mfma_f32_32x32x16_bf16 v[144:159], a[8:11], v[12:15], v[144:159]
    v_mfma_f32_32x32x16_bf16 v[144:159], a[12:15], v[12:15], v[144:159]
    v_mfma_f32_32x32x16_bf16 v[144:159], a[16:19], v[12:15], v[144:159]
    v_mfma_f32_32x32x16_bf16 v[144:159], a[20:23], v[12:15], v[144:159]
    v_mfma_f32_32x32x16_bf16 v[144:159], a[24:27], v[12:15], v[144:159]
    v_mfma_f32_32x32x16_bf16 v[144:159], a[28:31], v[12:15], v[144:159]
    v_mfma_f32_32x32x16_bf16 v[144:159], a[32:35], v[12:15], v[144:159]
    v_mfma_f32_32x32x16_bf16 v[144:159], a[36:39], v[12:15], v[144:159]
    v_mfma_f32_32x32x16_bf16 v[144:159], a[40:43], v[12:15], v[144:159]
    v_mfma_f32_32x32x16_bf16 v[144:159], a[44:47], v[12:15], v[144:159]
    v_mfma_f32_32x32x16_bf16 v[144:159], a[48:51], v[12:15], v[144:159]
    v_mfma_f32_32x32x16_bf16 v[144:159], a[52:55], v[12:15], v[144:159]
    v_mfma_f32_32x32x16_bf16 v[144:159], a[56:59], v[12:15], v[144:159]
    v_mfma_f32_32x32x16_bf16 v[144:159], a[60:63], v[12:15], v[144:159]
    v_mfma_f32_32x32x16_bf16 v[144:159], a[64:67], v[12:15], v[144:159]
    v_mfma_f32_32x32x16_bf16 v[144:159], a[68:71], v[12:15], v[144:159]
    v_mfma_f32_32x32x16_bf16 v[144:159], a[72:75], v[12:15], v[144:159]
    v_mfma_f32_32x32x16_bf16 v[144:159], a[76:79], v[12:15], v[144:159]
    v_mfma_f32_32x32x16_bf16 v[144:159], a[80:83], v[12:15], v[144:159]
    v_mfma_f32_32x32x16_bf16 v[144:159], a[84:87], v[12:15], v[144:159]
    v_mfma_f32_32x32x16_bf16 v[144:159], a[88:91], v[12:15], v[144:159]
    v_mfma_f32_32x32x16_bf16 v[144:159], a[92:95], v[12:15], v[144:159]
    v_mfma_f32_32x32x16_bf16 v[144:159], a[96:99], v[12:15], v[144:159]
    v_mfma_f32_32x32x16_bf16 v[144:159], a[100:103], v[12:15], v[144:159]
    v_mfma_f32_32x32x16_bf16 v[144:159], a[104:107], v[12:15], v[144:159]
    v_mfma_f32_32x32x16_bf16 v[144:159], a[108:111], v[12:15], v[144:159]
    v_mfma_f32_32x32x16_bf16 v[144:159], a[112:115], v[12:15], v[144:159]
    v_mfma_f32_32x32x16_bf16 v[144:159], a[116:119], v[12:15], v[144:159]
    v_mfma_f32_32x32x16_bf16 v[144:159], a[120:123], v[12:15], v[144:159]
    v_mfma_f32_32x32x16_bf16 v[144:159], a[124:127], v[12:15], v[144:159]
    s_waitcnt vmcnt(25)
    s_barrier
    ds_read_b128 v[48:51], v128 offset:0
    ds_read_b128 v[52:55], v129 offset:0
    ds_read_b128 v[56:59], v130 offset:0
    ds_read_b128 v[60:63], v131 offset:0
    ds_read_b128 v[64:67], v132 offset:0
    ds_read_b128 v[68:71], v133 offset:0
    ds_read_b128 v[72:75], v134 offset:0
    s_waitcnt lgkmcnt(3)
    v_mfma_f32_32x32x16_bf16 v[16:31], a[0:3], v[48:51], 0
    ds_read_b128 v[76:79], v135 offset:0
    v_mfma_f32_32x32x16_bf16 v[16:31], a[4:7], v[52:55], v[16:31]
    ds_read_b128 v[80:83], v128 offset:256
    s_add_u32 m0, s58, 65536
    v_mfma_f32_32x32x16_bf16 v[16:31], a[8:11], v[56:59], v[16:31]
    ds_read_b128 v[84:87], v129 offset:256
    buffer_load_dwordx4 v120, s[24:27], s57 offen offset:0 lds
    s_waitcnt vmcnt(17)
    v_add_f32 v32, v32, v104
    v_add_f32 v33, v33, v105
    s_waitcnt vmcnt(16)
    v_add_f32_e64 v34, v34, v106
    v_mfma_f32_32x32x16_bf16 v[16:31], a[12:15], v[60:63], v[16:31]
    ds_read_b128 v[48:51], v130 offset:256
    s_waitcnt lgkmcnt(3)
    buffer_load_dwordx4 v121, s[24:27], s57 offen offset:1024 lds
    v_add_f32 v35, v35, v107
    s_waitcnt vmcnt(16)
    v_add_f32 v36, v36, v108
    v_mfma_f32_32x32x16_bf16 v[16:31], a[16:19], v[64:67], v[16:31]
    ds_read_b128 v[52:55], v131 offset:256
    buffer_load_dwordx4 v122, s[24:27], s57 offen offset:2048 lds
    v_add_f32 v37, v37, v109
    s_waitcnt vmcnt(16)
    v_add_f32 v38, v38, v110
    v_add_f32 v39, v39, v111
    v_mfma_f32_32x32x16_bf16 v[16:31], a[20:23], v[68:71], v[16:31]
    ds_read_b128 v[56:59], v132 offset:256
    buffer_load_dwordx4 v123, s[24:27], s57 offen offset:3072 lds
    s_waitcnt vmcnt(16)
    v_add_f32 v40, v40, v136
    v_add_f32 v41, v41, v137
    s_waitcnt vmcnt(15)
    v_add_f32_e64 v42, v42, v138
    v_mfma_f32_32x32x16_bf16 v[16:31], a[24:27], v[72:75], v[16:31]
    ds_read_b128 v[60:63], v133 offset:256
    s_add_u32 s57, s57, s60
    v_add_f32 v43, v43, v139
    s_waitcnt vmcnt(14)
    v_add_f32 v44, v44, v140
    v_add_f32 v45, v45, v141
    s_waitcnt vmcnt(13)
    v_add_f32_e64 v46, v46, v142
    v_mfma_f32_32x32x16_bf16 v[16:31], a[28:31], v[76:79], v[16:31]
    ds_read_b128 v[64:67], v134 offset:256
    s_waitcnt lgkmcnt(3)
    v_add_f32 v47, v47, v143
    v_add_f32 v32, v32, v40
    v_add_f32 v33, v33, v41
    v_add_f32_e64 v34, v34, v42
    v_mfma_f32_32x32x16_bf16 v[16:31], a[32:35], v[80:83], v[16:31]
    ds_read_b128 v[68:71], v135 offset:256
    s_add_u32 m0, s58, 69632
    v_add_f32 v35, v35, v43
    v_add_f32 v36, v36, v44
    v_add_f32_e64 v37, v37, v45
    v_mfma_f32_32x32x16_bf16 v[16:31], a[36:39], v[84:87], v[16:31]
    ds_read_b128 v[72:75], v128 offset:512
    buffer_load_dwordx4 v124, s[24:27], s57 offen offset:0 lds
    v_add_f32 v38, v38, v46
    v_add_f32 v39, v39, v47
    v_add_f32_e64 v32, v32, v36
    v_mfma_f32_32x32x16_bf16 v[16:31], a[40:43], v[48:51], v[16:31]
    ds_read_b128 v[76:79], v129 offset:512
    buffer_load_dwordx4 v125, s[24:27], s57 offen offset:1024 lds
    v_add_f32 v33, v33, v37
    v_add_f32 v34, v34, v38
    v_add_f32_e64 v35, v35, v39
    v_mfma_f32_32x32x16_bf16 v[16:31], a[44:47], v[52:55], v[16:31]
    ds_read_b128 v[80:83], v130 offset:512
    s_waitcnt lgkmcnt(3)
    buffer_load_dwordx4 v126, s[24:27], s57 offen offset:2048 lds
    v_add_f32 v32, v32, v34
    v_add_f32_e64 v33, v33, v35
    v_mfma_f32_32x32x16_bf16 v[16:31], a[48:51], v[56:59], v[16:31]
    ds_read_b128 v[84:87], v131 offset:512
    buffer_load_dwordx4 v127, s[24:27], s57 offen offset:3072 lds
    v_mul_f32 v32, 0xbb000000, v32
    v_mul_f32 v33, 0x3b000000, v33
    v_fma_f32 v34, -v32, v32, v33
    v_mfma_f32_32x32x16_bf16 v[16:31], a[52:55], v[60:63], v[16:31]
    ds_read_b128 v[48:51], v132 offset:512
    s_add_u32 s57, s57, s61
    v_add_f32 v34, 0x3727c5ac, v34
    v_rsq_f32_e64 v33, v34
    s_nop 0
    v_mul_f32 v33, 0xbfb8aa3b, v33
    ds_write_b128 v116, v[32:35]
    v_mfma_f32_32x32x16_bf16 v[16:31], a[56:59], v[64:67], v[16:31]
    ds_read_b128 v[52:55], v133 offset:512
    v_mfma_f32_32x32x16_bf16 v[16:31], a[60:63], v[68:71], v[16:31]
    ds_read_b128 v[56:59], v134 offset:512
    s_waitcnt lgkmcnt(4)
    s_waitcnt vmcnt(9)
    s_waitcnt lgkmcnt(0)
    s_barrier
    v_mfma_f32_32x32x16_bf16 v[16:31], a[64:67], v[72:75], v[16:31]
    ds_read_b128 v[60:63], v135 offset:512
    s_add_u32 m0, s58, 98304
    v_mfma_f32_32x32x16_bf16 v[16:31], a[68:71], v[76:79], v[16:31]
    ds_read_b128 v[64:67], v128 offset:768
    buffer_load_dwordx4 v120, s[24:27], s57 offen offset:0 lds
    v_mfma_f32_32x32x16_bf16 v[16:31], a[72:75], v[80:83], v[16:31]
    ds_read_b128 v[68:71], v129 offset:768
    buffer_load_dwordx4 v121, s[24:27], s57 offen offset:1024 lds
    v_mfma_f32_32x32x16_bf16 v[16:31], a[76:79], v[84:87], v[16:31]
    ds_read_b128 v[72:75], v130 offset:768
    s_waitcnt lgkmcnt(3)
    buffer_load_dwordx4 v122, s[24:27], s57 offen offset:2048 lds
    v_mfma_f32_32x32x16_bf16 v[16:31], a[80:83], v[48:51], v[16:31]
    ds_read_b128 v[76:79], v131 offset:768
    buffer_load_dwordx4 v123, s[24:27], s57 offen offset:3072 lds
    v_mfma_f32_32x32x16_bf16 v[16:31], a[84:87], v[52:55], v[16:31]
    ds_read_b128 v[80:83], v132 offset:768
    s_add_u32 s57, s57, s60
    v_mfma_f32_32x32x16_bf16 v[16:31], a[88:91], v[56:59], v[16:31]
    ds_read_b128 v[84:87], v133 offset:768
    v_mfma_f32_32x32x16_bf16 v[16:31], a[92:95], v[60:63], v[16:31]
    ds_read_b128 v[48:51], v134 offset:768
    s_waitcnt lgkmcnt(3)
    s_add_u32 m0, s58, 102400
    v_mfma_f32_32x32x16_bf16 v[16:31], a[96:99], v[64:67], v[16:31]
    ds_read_b128 v[52:55], v135 offset:768
    ds_read_b128 v[96:99], v115 offset:0
    buffer_load_dwordx4 v124, s[24:27], s57 offen offset:0 lds
    v_mfma_f32_32x32x16_bf16 v[16:31], a[100:103], v[68:71], v[16:31]
    ds_read_b128 v[56:59], v128 offset:32768
    buffer_load_dwordx4 v125, s[24:27], s57 offen offset:1024 lds
    v_mfma_f32_32x32x16_bf16 v[16:31], a[104:107], v[72:75], v[16:31]
    ds_read_b128 v[60:63], v129 offset:32768
    buffer_load_dwordx4 v126, s[24:27], s57 offen offset:2048 lds
    v_mfma_f32_32x32x16_bf16 v[16:31], a[108:111], v[76:79], v[16:31]
    ds_read_b128 v[64:67], v130 offset:32768
    s_waitcnt lgkmcnt(4)
    buffer_load_dwordx4 v127, s[24:27], s57 offen offset:3072 lds
    v_mfma_f32_32x32x16_bf16 v[16:31], a[112:115], v[80:83], v[16:31]
    ds_read_b128 v[68:71], v131 offset:32768
    s_add_u32 s57, s57, s61
    v_mfma_f32_32x32x16_bf16 v[16:31], a[116:119], v[84:87], v[16:31]
    ds_read_b128 v[72:75], v132 offset:32768
    v_mfma_f32_32x32x16_bf16 v[16:31], a[120:123], v[48:51], v[16:31]
    ds_read_b128 v[76:79], v133 offset:32768
    v_mfma_f32_32x32x16_bf16 v[16:31], a[124:127], v[52:55], v[16:31]
    ds_read_b128 v[80:83], v134 offset:32768
    s_waitcnt lgkmcnt(3)
    v_mfma_f32_32x32x16_bf16 v[32:47], a[0:3], v[56:59], 0
    ds_read_b128 v[84:87], v135 offset:32768
    v_mfma_f32_32x32x16_bf16 v[32:47], a[4:7], v[60:63], v[32:47]
    ds_read_b128 v[48:51], v128 offset:33024
    v_mfma_f32_32x32x16_bf16 v[32:47], a[8:11], v[64:67], v[32:47]
    ds_read_b128 v[52:55], v129 offset:33024
    v_mfma_f32_32x32x16_bf16 v[32:47], a[12:15], v[68:71], v[32:47]
    ds_read_b128 v[56:59], v130 offset:33024
    s_waitcnt lgkmcnt(3)
    s_nop 0
    v_fmac_f32 v16, v96, v144
    v_fmac_f32 v17, v96, v145
    v_fmac_f32 v18, v96, v146
    v_fmac_f32 v19, v96, v147
    v_mfma_f32_32x32x16_bf16 v[32:47], a[16:19], v[72:75], v[32:47]
    ds_read_b128 v[60:63], v131 offset:33024
    v_fmac_f32 v20, v96, v148
    v_fmac_f32 v21, v96, v149
    v_fmac_f32 v22, v96, v150
    v_fmac_f32 v23, v96, v151
    v_mfma_f32_32x32x16_bf16 v[32:47], a[20:23], v[76:79], v[32:47]
    ds_read_b128 v[64:67], v132 offset:33024
    v_mul_f32 v104, v16, v97
    v_mul_f32 v105, v17, v97
    v_mul_f32 v106, v18, v97
    v_mul_f32 v107, v19, v97
    v_mfma_f32_32x32x16_bf16 v[32:47], a[24:27], v[80:83], v[32:47]
    ds_read_b128 v[68:71], v133 offset:33024
    v_mul_f32 v108, v20, v97
    v_mul_f32 v109, v21, v97
    v_mul_f32 v110, v22, v97
    v_mul_f32 v111, v23, v97
    v_mfma_f32_32x32x16_bf16 v[32:47], a[28:31], v[84:87], v[32:47]
    ds_read_b128 v[72:75], v134 offset:33024
    s_waitcnt lgkmcnt(3)
    v_fmac_f32 v24, v96, v152
    v_fmac_f32 v25, v96, v153
    v_fmac_f32 v26, v96, v154
    v_fmac_f32_e64 v27, v96, v155
    v_mfma_f32_32x32x16_bf16 v[32:47], a[32:35], v[48:51], v[32:47]
    ds_read_b128 v[76:79], v135 offset:33024
    ds_read_b128 v[140:143], v115 offset:512
    v_fmac_f32 v28, v96, v156
    v_fmac_f32 v29, v96, v157
    v_fmac_f32 v30, v96, v158
    v_fmac_f32 v31, v96, v159
    v_mfma_f32_32x32x16_bf16 v[32:47], a[36:39], v[52:55], v[32:47]
    ds_read_b128 v[80:83], v128 offset:33280
    v_exp_f32 v104, v104
    v_mul_f32 v16, v16, v24
    v_mfma_f32_32x32x16_bf16 v[32:47], a[40:43], v[56:59], v[32:47]
    ds_read_b128 v[84:87], v129 offset:33280
    v_exp_f32 v105, v105
    v_mul_f32 v17, v17, v25
    v_mfma_f32_32x32x16_bf16 v[32:47], a[44:47], v[60:63], v[32:47]
    ds_read_b128 v[48:51], v130 offset:33280
    s_waitcnt lgkmcnt(4)
    v_exp_f32 v106, v106
    v_mul_f32_e64 v18, v18, v26
    v_mfma_f32_32x32x16_bf16 v[32:47], a[48:51], v[64:67], v[32:47]
    ds_read_b128 v[52:55], v131 offset:33280
    v_exp_f32 v107, v107
    v_mul_f32 v19, v19, v27
    v_mfma_f32_32x32x16_bf16 v[32:47], a[52:55], v[68:71], v[32:47]
    ds_read_b128 v[56:59], v132 offset:33280
    v_exp_f32 v108, v108
    v_mul_f32 v20, v20, v28
    v_mfma_f32_32x32x16_bf16 v[32:47], a[56:59], v[72:75], v[32:47]
    ds_read_b128 v[60:63], v133 offset:33280
    v_exp_f32 v109, v109
    v_mul_f32 v21, v21, v29
    v_exp_f32_e64 v110, v110
    v_mfma_f32_32x32x16_bf16 v[32:47], a[60:63], v[76:79], v[32:47]
    ds_read_b128 v[64:67], v134 offset:33280
    s_waitcnt lgkmcnt(3)
    s_waitcnt vmcnt(8)
    s_barrier
    v_mul_f32 v22, v22, v30
    v_mfma_f32_32x32x16_bf16 v[32:47], a[64:67], v[80:83], v[32:47]
    ds_read_b128 v[68:71], v135 offset:33280
    s_add_u32 m0, s58, 0
    v_exp_f32 v111, v111
    v_mul_f32_e64 v23, v23, v31
    v_fma_f32 v104, v104, v98, v98
    v_mfma_f32_32x32x16_bf16 v[32:47], a[68:71], v[84:87], v[32:47]
    ds_read_b128 v[72:75], v128 offset:33536
    buffer_load_dwordx4 v120, s[24:27], s57 offen offset:0 lds
    v_fma_f32 v105, v105, v98, v98
    v_fma_f32 v106, v106, v98, v98
    v_fma_f32 v107, v107, v98, v98
    v_mfma_f32_32x32x16_bf16 v[32:47], a[72:75], v[48:51], v[32:47]
    ds_read_b128 v[76:79], v129 offset:33536
    buffer_load_dwordx4 v121, s[24:27], s57 offen offset:1024 lds
    v_fma_f32 v108, v108, v98, v98
    v_fma_f32 v109, v109, v98, v98
    v_fma_f32 v110, v110, v98, v98
    v_mfma_f32_32x32x16_bf16 v[32:47], a[76:79], v[52:55], v[32:47]
    ds_read_b128 v[80:83], v130 offset:33536
    s_waitcnt lgkmcnt(3)
    buffer_load_dwordx4 v122, s[24:27], s57 offen offset:2048 lds
    v_fma_f32 v111, v111, v98, v98
    v_mfma_f32_32x32x16_bf16 v[32:47], a[80:83], v[56:59], v[32:47]
    ds_read_b128 v[84:87], v131 offset:33536
    buffer_load_dwordx2 v[88:89], v118, s[24:27], 0 offen sc1
    buffer_load_dwordx4 v123, s[24:27], s57 offen offset:3072 lds
    v_rcp_f32 v104, v104
    v_mfma_f32_32x32x16_bf16 v[32:47], a[84:87], v[60:63], v[32:47]
    ds_read_b128 v[48:51], v132 offset:33536
    s_add_u32 s57, s57, s60
    v_rcp_f32 v105, v105
    v_mul_f32_e64 v16, v16, v104
    v_mfma_f32_32x32x16_bf16 v[32:47], a[88:91], v[64:67], v[32:47]
    ds_read_b128 v[52:55], v133 offset:33536
    v_rcp_f32 v106, v106
    v_mul_f32 v17, v17, v105
    v_mfma_f32_32x32x16_bf16 v[32:47], a[92:95], v[68:71], v[32:47]
    ds_read_b128 v[56:59], v134 offset:33536
    s_waitcnt lgkmcnt(3)
    s_add_u32 m0, s58, 4096
    v_rcp_f32 v107, v107
    v_mul_f32_e64 v18, v18, v106
    v_mfma_f32_32x32x16_bf16 v[32:47], a[96:99], v[72:75], v[32:47]
    ds_read_b128 v[60:63], v135 offset:33536
    buffer_load_dwordx4 v124, s[24:27], s57 offen offset:0 lds
    v_add_u32 v128, 65536, v128
    v_add_u32 v129, 65536, v129
    v_add_u32 v130, 65536, v130
    v_add_u32 v131, 65536, v131
    v_add_u32 v132, 65536, v132
    v_add_u32 v133, 65536, v133
    v_add_u32 v134, 65536, v134
    v_add_u32 v135, 65536, v135
    v_mfma_f32_32x32x16_bf16 v[32:47], a[100:103], v[76:79], v[32:47]
    ds_read_b128 v[64:67], v128 offset:0
    buffer_load_dwordx4 v125, s[24:27], s57 offen offset:1024 lds
    v_rcp_f32 v108, v108
    v_mul_f32 v19, v19, v107
    v_mfma_f32_32x32x16_bf16 v[32:47], a[104:107], v[80:83], v[32:47]
    ds_read_b128 v[68:71], v129 offset:0
    buffer_load_dwordx4 v126, s[24:27], s57 offen offset:2048 lds
    v_rcp_f32 v109, v109
    v_mul_f32 v20, v20, v108
    v_mfma_f32_32x32x16_bf16 v[32:47], a[108:111], v[84:87], v[32:47]
    ds_read_b128 v[72:75], v130 offset:0
    s_waitcnt lgkmcnt(3)
    buffer_load_dwordx4 v127, s[24:27], s57 offen offset:3072 lds
    v_rcp_f32 v110, v110
    v_mfma_f32_32x32x16_bf16 v[32:47], a[112:115], v[48:51], v[32:47]
    ds_read_b128 v[76:79], v131 offset:0
    s_add_u32 s57, s57, s61
    v_mul_f32 v21, v21, v109
    v_rcp_f32_e64 v111, v111
    v_mfma_f32_32x32x16_bf16 v[32:47], a[116:119], v[52:55], v[32:47]
    ds_read_b128 v[80:83], v132 offset:0
    v_mul_f32 v22, v22, v110
    v_mul_f32 v23, v23, v111
    v_cvt_pk_bf16_f32 v100, v16, v17
    v_mfma_f32_32x32x16_bf16 v[32:47], a[120:123], v[56:59], v[32:47]
    ds_read_b128 v[84:87], v133 offset:0
    v_cvt_pk_bf16_f32 v101, v18, v19
    v_mfma_f32_32x32x16_bf16 v[32:47], a[124:127], v[60:63], v[32:47]
    ds_read_b128 v[48:51], v134 offset:0
    s_waitcnt lgkmcnt(3)
    v_cvt_pk_bf16_f32 v102, v20, v21
    v_cvt_pk_bf16_f32 v103, v22, v23
    s_waitcnt vmcnt(5)
    s_add_u32 s40, s32, 1
    v_subrev_u32_e64 v2, s40, v88
    v_cmp_gt_u32 vcc, 64, v2
    v_cmp_eq_u32 s[42:43], s33, v89
    s_nop 0
    s_and_b64 vcc, vcc, s[42:43]
    s_and_b32 s42, vcc_lo, 0x1
    s_cmp_eq_u32 s42, 0x1
    s_nop 0
    s_cbranch_scc1 L_ac_79
    s_add_u32 s40, s32, 1
    s_mov_b32 exec_lo, 0x1
    s_mov_b32 exec_hi, 0
    s_mov_b32 s98, 0
    v_mov_b32 v2, 0
    v_mov_b32_e64 v3, 0
    s_nop 1
L_poll_80:
    buffer_load_dwordx2 v[2:3], v118, s[24:27], 0 offen sc1
    s_add_u32 s98, s98, 1
    s_cmp_gt_u32 s98, 0x40000
    s_cbranch_scc1 L_pd_81
    s_waitcnt vmcnt(0)
    v_subrev_u32_e64 v2, s40, v2
    v_cmp_gt_u32 vcc, 64, v2
    v_cmp_eq_u32 s[42:43], s33, v3
    s_nop 1
    s_and_b64 vcc, vcc, s[42:43]
    s_cmp_eq_u64 vcc, exec
    s_cbranch_scc1 L_pd_81
    s_sleep 2
    s_branch L_poll_80
L_pd_81:
    s_waitcnt vmcnt(0)
    s_mov_b64 exec, -1
L_ac_79:
    v_mfma_f32_32x32x16_bf16 v[16:31], a[0:3], v[64:67], 0
    ds_read_b128 v[52:55], v135 offset:0
    v_mfma_f32_32x32x16_bf16 v[16:31], a[4:7], v[68:71], v[16:31]
    ds_read_b128 v[56:59], v128 offset:256
    ds_write_b128 v112, v[100:103] offset:0
    v_mfma_f32_32x32x16_bf16 v[16:31], a[8:11], v[72:75], v[16:31]
    ds_read_b128 v[60:63], v129 offset:256
    v_mfma_f32_32x32x16_bf16 v[16:31], a[12:15], v[76:79], v[16:31]
    ds_read_b128 v[64:67], v130 offset:256
    s_waitcnt lgkmcnt(4)
    v_fmac_f32 v32, v140, v144
    v_fmac_f32 v33, v140, v145
    v_fmac_f32 v34, v140, v146
    v_fmac_f32_e64 v35, v140, v147
    v_mfma_f32_32x32x16_bf16 v[16:31], a[16:19], v[80:83], v[16:31]
    ds_read_b128 v[68:71], v131 offset:256
    v_fmac_f32 v36, v140, v148
    v_fmac_f32 v37, v140, v149
    v_fmac_f32 v38, v140, v150
    v_fmac_f32 v39, v140, v151
    v_mul_f32_e64 v104, v32, v141
    v_mfma_f32_32x32x16_bf16 v[16:31], a[20:23], v[84:87], v[16:31]
    ds_read_b128 v[72:75], v132 offset:256
    v_mul_f32 v105, v33, v141
    v_mul_f32 v106, v34, v141
    v_mul_f32 v107, v35, v141
    v_mul_f32 v108, v36, v141
    v_mul_f32_e64 v109, v37, v141
    v_mfma_f32_32x32x16_bf16 v[16:31], a[24:27], v[48:51], v[16:31]
    ds_read_b128 v[76:79], v133 offset:256
    v_mul_f32 v110, v38, v141
    v_mul_f32 v111, v39, v141
    v_fmac_f32 v40, v140, v152
    v_fmac_f32 v41, v140, v153
    v_fmac_f32_e64 v42, v140, v154
    v_mfma_f32_32x32x16_bf16 v[16:31], a[28:31], v[52:55], v[16:31]
    ds_read_b128 v[80:83], v134 offset:256
    s_waitcnt lgkmcnt(3)
    v_fmac_f32 v43, v140, v155
    v_fmac_f32 v44, v140, v156
    v_fmac_f32 v45, v140, v157
    v_fmac_f32_e64 v46, v140, v158
    v_mfma_f32_32x32x16_bf16 v[16:31], a[32:35], v[56:59], v[16:31]
    ds_read_b128 v[84:87], v135 offset:256
    ds_read_b128 v[96:99], v115 offset:1024
    v_fmac_f32 v47, v140, v159
    v_exp_f32 v104, v104
    v_mul_f32_e64 v32, v32, v40
    v_mfma_f32_32x32x16_bf16 v[16:31], a[36:39], v[60:63], v[16:31]
    ds_read_b128 v[48:51], v128 offset:512
    v_exp_f32 v105, v105
    v_mul_f32 v33, v33, v41
    v_exp_f32_e64 v106, v106
    v_mfma_f32_32x32x16_bf16 v[16:31], a[40:43], v[64:67], v[16:31]
    ds_read_b128 v[52:55], v129 offset:512
    v_mul_f32 v34, v34, v42
    v_exp_f32 v107, v107
    v_mul_f32_e64 v35, v35, v43
    v_mfma_f32_32x32x16_bf16 v[16:31], a[44:47], v[68:71], v[16:31]
    ds_read_b128 v[56:59], v130 offset:512
    s_waitcnt lgkmcnt(4)
    v_exp_f32 v108, v108
    v_mul_f32_e64 v36, v36, v44
    v_mfma_f32_32x32x16_bf16 v[16:31], a[48:51], v[72:75], v[16:31]
    ds_read_b128 v[60:63], v131 offset:512
    v_exp_f32 v109, v109
    v_mul_f32 v37, v37, v45
    v_exp_f32_e64 v110, v110
    v_mfma_f32_32x32x16_bf16 v[16:31], a[52:55], v[76:79], v[16:31]
    ds_read_b128 v[64:67], v132 offset:512
    v_mul_f32 v38, v38, v46
    v_exp_f32 v111, v111
    v_mul_f32_e64 v39, v39, v47
    v_fma_f32 v104, v104, v142, v142
    v_mfma_f32_32x32x16_bf16 v[16:31], a[56:59], v[80:83], v[16:31]
    ds_read_b128 v[68:71], v133 offset:512
    v_fma_f32 v105, v105, v142, v142
    v_fma_f32 v106, v106, v142, v142
    v_fma_f32 v107, v107, v142, v142
    v_fma_f32 v108, v108, v142, v142
    v_fma_f32 v109, v109, v142, v142
    v_mfma_f32_32x32x16_bf16 v[16:31], a[60:63], v[84:87], v[16:31]
    ds_read_b128 v[72:75], v134 offset:512
    s_waitcnt lgkmcnt(3)
    s_barrier
    ds_read_b128 v[92:95], v113 offset:0
    v_fma_f32 v110, v110, v142, v142
    v_mfma_f32_32x32x16_bf16 v[16:31], a[64:67], v[48:51], v[16:31]
    ds_read_b128 v[76:79], v135 offset:512
    s_add_u32 m0, s58, 32768
    s_nop 0
    buffer_load_dwordx4 v120, s[24:27], s57 offen offset:0 lds
    v_fma_f32 v111, v111, v142, v142
    v_mfma_f32_32x32x16_bf16 v[16:31], a[68:71], v[52:55], v[16:31]
    ds_read_b128 v[80:83], v128 offset:768
    buffer_load_dwordx4 v121, s[24:27], s57 offen offset:1024 lds
    buffer_load_dwordx4 v122, s[24:27], s57 offen offset:2048 lds
    v_mfma_f32_32x32x16_bf16 v[16:31], a[72:75], v[56:59], v[16:31]
    ds_read_b128 v[84:87], v129 offset:768
    buffer_load_dwordx4 v123, s[24:27], s57 offen offset:3072 lds
    s_add_u32 s57, s57, s60
    v_rcp_f32_e64 v104, v104
    v_mfma_f32_32x32x16_bf16 v[16:31], a[76:79], v[60:63], v[16:31]
    ds_read_b128 v[48:51], v130 offset:768
    s_waitcnt lgkmcnt(3)
    s_add_u32 m0, s58, 36864
    v_rcp_f32 v105, v105
    v_mul_f32_e64 v32, v32, v104
    v_mfma_f32_32x32x16_bf16 v[16:31], a[80:83], v[64:67], v[16:31]
    ds_read_b128 v[52:55], v131 offset:768
    buffer_load_dwordx4 v124, s[24:27], s57 offen offset:0 lds
    buffer_load_dwordx4 v125, s[24:27], s57 offen offset:1024 lds
    v_mfma_f32_32x32x16_bf16 v[16:31], a[84:87], v[68:71], v[16:31]
    ds_read_b128 v[56:59], v132 offset:768
    buffer_load_dwordx4 v126, s[24:27], s57 offen offset:2048 lds
    buffer_load_dwordx4 v127, s[24:27], s57 offen offset:3072 lds
    v_mfma_f32_32x32x16_bf16 v[16:31], a[88:91], v[72:75], v[16:31]
    ds_read_b128 v[60:63], v133 offset:768
    s_add_u32 s57, s57, s61
    v_rcp_f32 v106, v106
    v_mul_f32_e64 v33, v33, v105
    v_mfma_f32_32x32x16_bf16 v[16:31], a[92:95], v[76:79], v[16:31]
    ds_read_b128 v[64:67], v134 offset:768
    s_waitcnt lgkmcnt(3)
    buffer_load_dwordx4 a[128:131], v117, s[24:27], s63 offen offset:0
    buffer_load_dwordx4 a[132:135], v117, s[24:27], s63 offen offset:1024
    v_mfma_f32_32x32x16_bf16 v[16:31], a[96:99], v[80:83], v[16:31]
    ds_read_b128 v[68:71], v135 offset:768
    buffer_load_dwordx4 a[136:139], v117, s[24:27], s63 offen offset:2048
    buffer_load_dwordx4 a[140:143], v117, s[24:27], s63 offen offset:3072
    v_mfma_f32_32x32x16_bf16 v[16:31], a[100:103], v[84:87], v[16:31]
    ds_read_b128 v[72:75], v128 offset:32768
    s_add_u32 s63, s63, 4096
    buffer_load_dwordx4 a[144:147], v117, s[24:27], s63 offen offset:0
    v_rcp_f32 v107, v107
    v_mfma_f32_32x32x16_bf16 v[16:31], a[104:107], v[48:51], v[16:31]
    ds_read_b128 v[76:79], v129 offset:32768
    buffer_load_dwordx4 a[148:151], v117, s[24:27], s63 offen offset:1024
    v_mul_f32 v34, v34, v106
    v_rcp_f32 v108, v108
    v_mfma_f32_32x32x16_bf16 v[16:31], a[108:111], v[52:55], v[16:31]
    ds_read_b128 v[80:83], v130 offset:32768
    s_waitcnt lgkmcnt(3)
    buffer_load_dwordx4 a[152:155], v117, s[24:27], s63 offen offset:2048
    buffer_load_dwordx4 a[156:159], v117, s[24:27], s63 offen offset:3072
    v_mfma_f32_32x32x16_bf16 v[16:31], a[112:115], v[56:59], v[16:31]
    ds_read_b128 v[84:87], v131 offset:32768
    s_add_u32 s63, s63, 4096
    buffer_load_dwordx4 a[160:163], v117, s[24:27], s63 offen offset:0
    v_mul_f32 v35, v35, v107
    v_mfma_f32_32x32x16_bf16 v[16:31], a[116:119], v[60:63], v[16:31]
    ds_read_b128 v[48:51], v132 offset:32768
    buffer_load_dwordx4 a[164:167], v117, s[24:27], s63 offen offset:1024
    v_rcp_f32 v109, v109
    v_mul_f32 v36, v36, v108
    v_mfma_f32_32x32x16_bf16 v[16:31], a[120:123], v[64:67], v[16:31]
    ds_read_b128 v[52:55], v133 offset:32768
    buffer_store_dwordx4 v[92:95], v114, s[24:27], s59 offen sc1
    s_add_u32 s59, s59, s62
    v_mfma_f32_32x32x16_bf16 v[16:31], a[124:127], v[68:71], v[16:31]
    ds_read_b128 v[56:59], v134 offset:32768
    s_waitcnt lgkmcnt(3)
    v_rcp_f32 v110, v110
    v_mul_f32 v37, v37, v109
    v_rcp_f32 v111, v111
    v_mul_f32 v38, v38, v110
    v_mul_f32_e64 v39, v39, v111
    v_cvt_pk_bf16_f32 v100, v32, v33
    v_cvt_pk_bf16_f32 v101, v34, v35
    v_cvt_pk_bf16_f32 v102, v36, v37
    v_cvt_pk_bf16_f32 v103, v38, v39
    v_mfma_f32_32x32x16_bf16 v[32:47], a[0:3], v[72:75], 0
    ds_read_b128 v[60:63], v135 offset:32768
    v_mfma_f32_32x32x16_bf16 v[32:47], a[4:7], v[76:79], v[32:47]
    ds_read_b128 v[64:67], v128 offset:33024
    ds_write_b128 v112, v[100:103] offset:4096
    v_mfma_f32_32x32x16_bf16 v[32:47], a[8:11], v[80:83], v[32:47]
    ds_read_b128 v[68:71], v129 offset:33024
    v_mfma_f32_32x32x16_bf16 v[32:47], a[12:15], v[84:87], v[32:47]
    ds_read_b128 v[72:75], v130 offset:33024
    s_waitcnt lgkmcnt(4)
    v_fmac_f32 v16, v96, v144
    v_fmac_f32 v17, v96, v145
    v_fmac_f32 v18, v96, v146
    v_fmac_f32_e64 v19, v96, v147
    v_mfma_f32_32x32x16_bf16 v[32:47], a[16:19], v[48:51], v[32:47]
    ds_read_b128 v[76:79], v131 offset:33024
    v_fmac_f32 v20, v96, v148
    v_fmac_f32 v21, v96, v149
    v_fmac_f32 v22, v96, v150
    v_fmac_f32 v23, v96, v151
    v_mul_f32_e64 v104, v16, v97
    v_mfma_f32_32x32x16_bf16 v[32:47], a[20:23], v[52:55], v[32:47]
    ds_read_b128 v[80:83], v132 offset:33024
    v_mul_f32 v105, v17, v97
    v_mul_f32 v106, v18, v97
    v_mul_f32 v107, v19, v97
    v_mul_f32 v108, v20, v97
    v_mul_f32_e64 v109, v21, v97
    v_mfma_f32_32x32x16_bf16 v[32:47], a[24:27], v[56:59], v[32:47]
    ds_read_b128 v[84:87], v133 offset:33024
    v_mul_f32 v110, v22, v97
    v_mul_f32 v111, v23, v97
    v_fmac_f32 v24, v96, v152
    v_fmac_f32 v25, v96, v153
    v_fmac_f32_e64 v26, v96, v154
    v_mfma_f32_32x32x16_bf16 v[32:47], a[28:31], v[60:63], v[32:47]
    ds_read_b128 v[48:51], v134 offset:33024
    s_waitcnt lgkmcnt(3)
    v_fmac_f32 v27, v96, v155
    v_fmac_f32 v28, v96, v156
    v_fmac_f32 v29, v96, v157
    v_fmac_f32_e64 v30, v96, v158
    v_mfma_f32_32x32x16_bf16 v[32:47], a[32:35], v[64:67], v[32:47]
    ds_read_b128 v[52:55], v135 offset:33024
    ds_read_b128 v[140:143], v115 offset:1536
    v_fmac_f32 v31, v96, v159
    v_exp_f32 v104, v104
    v_mul_f32_e64 v16, v16, v24
    v_mfma_f32_32x32x16_bf16 v[32:47], a[36:39], v[68:71], v[32:47]
    ds_read_b128 v[56:59], v128 offset:33280
    v_exp_f32 v105, v105
    v_mul_f32 v17, v17, v25
    v_exp_f32_e64 v106, v106
    v_mfma_f32_32x32x16_bf16 v[32:47], a[40:43], v[72:75], v[32:47]
    ds_read_b128 v[60:63], v129 offset:33280
    v_mul_f32 v18, v18, v26
    v_exp_f32 v107, v107
    v_mul_f32_e64 v19, v19, v27
    v_mfma_f32_32x32x16_bf16 v[32:47], a[44:47], v[76:79], v[32:47]
    ds_read_b128 v[64:67], v130 offset:33280
    s_waitcnt lgkmcnt(4)
    v_exp_f32 v108, v108
    v_mul_f32_e64 v20, v20, v28
    v_mfma_f32_32x32x16_bf16 v[32:47], a[48:51], v[80:83], v[32:47]
    ds_read_b128 v[68:71], v131 offset:33280
    v_exp_f32 v109, v109
    v_mul_f32 v21, v21, v29
    v_exp_f32_e64 v110, v110
    v_mfma_f32_32x32x16_bf16 v[32:47], a[52:55], v[84:87], v[32:47]
    ds_read_b128 v[72:75], v132 offset:33280
    v_mul_f32 v22, v22, v30
    v_exp_f32 v111, v111
    v_mul_f32_e64 v23, v23, v31
    v_fma_f32 v104, v104, v98, v98
    v_mfma_f32_32x32x16_bf16 v[32:47], a[56:59], v[48:51], v[32:47]
    ds_read_b128 v[76:79], v133 offset:33280
    v_fma_f32 v105, v105, v98, v98
    v_fma_f32 v106, v106, v98, v98
    v_fma_f32 v107, v107, v98, v98
    v_fma_f32 v108, v108, v98, v98
    v_fma_f32 v109, v109, v98, v98
    v_mfma_f32_32x32x16_bf16 v[32:47], a[60:63], v[52:55], v[32:47]
    ds_read_b128 v[80:83], v134 offset:33280
    s_waitcnt lgkmcnt(3)
    s_waitcnt vmcnt(19)
    s_barrier
    ds_read_b128 v[92:95], v113 offset:4096
    v_fma_f32 v110, v110, v98, v98
    v_mfma_f32_32x32x16_bf16 v[32:47], a[64:67], v[56:59], v[32:47]
    ds_read_b128 v[84:87], v135 offset:33280
    s_add_u32 m0, s58, 65536
    s_nop 0
    buffer_load_dwordx4 v120, s[24:27], s57 offen offset:0 lds
    v_fma_f32 v111, v111, v98, v98
    v_mfma_f32_32x32x16_bf16 v[32:47], a[68:71], v[60:63], v[32:47]
    ds_read_b128 v[48:51], v128 offset:33536
    buffer_load_dwordx4 v121, s[24:27], s57 offen offset:1024 lds
    buffer_load_dwordx4 v122, s[24:27], s57 offen offset:2048 lds
    v_mfma_f32_32x32x16_bf16 v[32:47], a[72:75], v[64:67], v[32:47]
    ds_read_b128 v[52:55], v129 offset:33536
    buffer_load_dwordx4 v123, s[24:27], s57 offen offset:3072 lds
    s_add_u32 s57, s57, s60
    v_rcp_f32 v104, v104
    v_mfma_f32_32x32x16_bf16 v[32:47], a[76:79], v[68:71], v[32:47]
    ds_read_b128 v[56:59], v130 offset:33536
    s_waitcnt lgkmcnt(3)
    s_add_u32 m0, s58, 69632
    v_rcp_f32 v105, v105
    v_mul_f32_e64 v16, v16, v104
    v_mfma_f32_32x32x16_bf16 v[32:47], a[80:83], v[72:75], v[32:47]
    ds_read_b128 v[60:63], v131 offset:33536
    buffer_load_dwordx4 v124, s[24:27], s57 offen offset:0 lds
    buffer_load_dwordx4 v125, s[24:27], s57 offen offset:1024 lds
    v_mfma_f32_32x32x16_bf16 v[32:47], a[84:87], v[76:79], v[32:47]
    ds_read_b128 v[64:67], v132 offset:33536
    buffer_load_dwordx4 v126, s[24:27], s57 offen offset:2048 lds
    buffer_load_dwordx4 v127, s[24:27], s57 offen offset:3072 lds
    v_mfma_f32_32x32x16_bf16 v[32:47], a[88:91], v[80:83], v[32:47]
    ds_read_b128 v[68:71], v133 offset:33536
    s_add_u32 s57, s57, s61
    v_rcp_f32 v106, v106
    v_mul_f32_e64 v17, v17, v105
    v_mfma_f32_32x32x16_bf16 v[32:47], a[92:95], v[84:87], v[32:47]
    ds_read_b128 v[72:75], v134 offset:33536
    s_waitcnt lgkmcnt(3)
    buffer_load_dwordx4 a[168:171], v117, s[24:27], s63 offen offset:2048
    buffer_load_dwordx4 a[172:175], v117, s[24:27], s63 offen offset:3072
    v_mfma_f32_32x32x16_bf16 v[32:47], a[96:99], v[48:51], v[32:47]
    ds_read_b128 v[76:79], v135 offset:33536
    s_add_u32 s63, s63, 4096
    buffer_load_dwordx4 a[176:179], v117, s[24:27], s63 offen offset:0
    v_add_u32 v128, 4294901760, v128
    v_add_u32 v129, 4294901760, v129
    v_add_u32 v130, 4294901760, v130
    v_add_u32 v131, 4294901760, v131
    v_add_u32 v132, 4294901760, v132
    v_add_u32 v133, 4294901760, v133
    v_add_u32 v134, 4294901760, v134
    v_add_u32 v135, 4294901760, v135
    v_mfma_f32_32x32x16_bf16 v[32:47], a[100:103], v[52:55], v[32:47]
    ds_read_b128 v[80:83], v128 offset:0
    buffer_load_dwordx4 a[180:183], v117, s[24:27], s63 offen offset:1024
    buffer_load_dwordx4 a[184:187], v117, s[24:27], s63 offen offset:2048
    v_mfma_f32_32x32x16_bf16 v[32:47], a[104:107], v[56:59], v[32:47]
    ds_read_b128 v[84:87], v129 offset:0
    buffer_load_dwordx4 a[188:191], v117, s[24:27], s63 offen offset:3072
    v_rcp_f32 v107, v107
    v_mul_f32_e64 v18, v18, v106
    v_mfma_f32_32x32x16_bf16 v[32:47], a[108:111], v[60:63], v[32:47]
    ds_read_b128 v[48:51], v130 offset:0
    s_waitcnt lgkmcnt(3)
    s_add_u32 s63, s63, 4096
    buffer_load_dwordx4 a[192:195], v117, s[24:27], s63 offen offset:0
    v_mfma_f32_32x32x16_bf16 v[32:47], a[112:115], v[64:67], v[32:47]
    ds_read_b128 v[52:55], v131 offset:0
    buffer_load_dwordx4 a[196:199], v117, s[24:27], s63 offen offset:1024
    buffer_load_dwordx4 a[200:203], v117, s[24:27], s63 offen offset:2048
    v_mfma_f32_32x32x16_bf16 v[32:47], a[116:119], v[68:71], v[32:47]
    ds_read_b128 v[56:59], v132 offset:0
    buffer_load_dwordx4 a[204:207], v117, s[24:27], s63 offen offset:3072
    v_rcp_f32 v108, v108
    v_mul_f32_e64 v19, v19, v107
    v_mfma_f32_32x32x16_bf16 v[32:47], a[120:123], v[72:75], v[32:47]
    ds_read_b128 v[60:63], v133 offset:0
    buffer_store_dwordx4 v[92:95], v114, s[24:27], s59 offen sc1
    s_add_u32 s59, s59, s62
    v_mfma_f32_32x32x16_bf16 v[32:47], a[124:127], v[76:79], v[32:47]
    ds_read_b128 v[64:67], v134 offset:0
    s_waitcnt lgkmcnt(3)
    v_rcp_f32 v109, v109
    v_mul_f32 v20, v20, v108
    v_rcp_f32 v110, v110
    v_mul_f32 v21, v21, v109
    v_rcp_f32 v111, v111
    v_mul_f32 v22, v22, v110
    v_mul_f32_e64 v23, v23, v111
    v_cvt_pk_bf16_f32 v100, v16, v17
    v_cvt_pk_bf16_f32 v101, v18, v19
    v_cvt_pk_bf16_f32 v102, v20, v21
    v_cvt_pk_bf16_f32 v103, v22, v23
    v_mfma_f32_32x32x16_bf16 v[16:31], a[0:3], v[80:83], 0
    ds_read_b128 v[68:71], v135 offset:0
    v_mfma_f32_32x32x16_bf16 v[16:31], a[4:7], v[84:87], v[16:31]
    ds_read_b128 v[72:75], v128 offset:256
    ds_write_b128 v112, v[100:103] offset:0
    v_mfma_f32_32x32x16_bf16 v[16:31], a[8:11], v[48:51], v[16:31]
    ds_read_b128 v[76:79], v129 offset:256
    v_mfma_f32_32x32x16_bf16 v[16:31], a[12:15], v[52:55], v[16:31]
    ds_read_b128 v[80:83], v130 offset:256
    s_waitcnt lgkmcnt(4)
    v_fmac_f32 v32, v140, v144
    v_fmac_f32 v33, v140, v145
    v_fmac_f32 v34, v140, v146
    v_fmac_f32_e64 v35, v140, v147
    v_mfma_f32_32x32x16_bf16 v[16:31], a[16:19], v[56:59], v[16:31]
    ds_read_b128 v[84:87], v131 offset:256
    v_fmac_f32 v36, v140, v148
    v_fmac_f32 v37, v140, v149
    v_fmac_f32 v38, v140, v150
    v_fmac_f32 v39, v140, v151
    v_mul_f32_e64 v104, v32, v141
    v_mfma_f32_32x32x16_bf16 v[16:31], a[20:23], v[60:63], v[16:31]
    ds_read_b128 v[48:51], v132 offset:256
    v_mul_f32 v105, v33, v141
    v_mul_f32 v106, v34, v141
    v_mul_f32 v107, v35, v141
    v_mul_f32 v108, v36, v141
    v_mul_f32_e64 v109, v37, v141
    v_mfma_f32_32x32x16_bf16 v[16:31], a[24:27], v[64:67], v[16:31]
    ds_read_b128 v[52:55], v133 offset:256
    v_mul_f32 v110, v38, v141
    v_mul_f32 v111, v39, v141
    v_fmac_f32 v40, v140, v152
    v_fmac_f32 v41, v140, v153
    v_fmac_f32_e64 v42, v140, v154
    v_mfma_f32_32x32x16_bf16 v[16:31], a[28:31], v[68:71], v[16:31]
    ds_read_b128 v[56:59], v134 offset:256
    s_waitcnt lgkmcnt(3)
    v_fmac_f32 v43, v140, v155
    v_fmac_f32 v44, v140, v156
    v_fmac_f32 v45, v140, v157
    v_fmac_f32_e64 v46, v140, v158
    v_mfma_f32_32x32x16_bf16 v[16:31], a[32:35], v[72:75], v[16:31]
    ds_read_b128 v[60:63], v135 offset:256
    ds_read_b128 v[96:99], v115 offset:2048
    v_fmac_f32 v47, v140, v159
    v_exp_f32 v104, v104
    v_mul_f32_e64 v32, v32, v40
    v_mfma_f32_32x32x16_bf16 v[16:31], a[36:39], v[76:79], v[16:31]
    ds_read_b128 v[64:67], v128 offset:512
    v_exp_f32 v105, v105
    v_mul_f32 v33, v33, v41
    v_exp_f32_e64 v106, v106
    v_mfma_f32_32x32x16_bf16 v[16:31], a[40:43], v[80:83], v[16:31]
    ds_read_b128 v[68:71], v129 offset:512
    v_mul_f32 v34, v34, v42
    v_exp_f32 v107, v107
    v_mul_f32_e64 v35, v35, v43
    v_mfma_f32_32x32x16_bf16 v[16:31], a[44:47], v[84:87], v[16:31]
    ds_read_b128 v[72:75], v130 offset:512
    s_waitcnt lgkmcnt(4)
    v_exp_f32 v108, v108
    v_mul_f32_e64 v36, v36, v44
    v_mfma_f32_32x32x16_bf16 v[16:31], a[48:51], v[48:51], v[16:31]
    ds_read_b128 v[76:79], v131 offset:512
    v_exp_f32 v109, v109
    v_mul_f32 v37, v37, v45
    v_exp_f32_e64 v110, v110
    v_mfma_f32_32x32x16_bf16 v[16:31], a[52:55], v[52:55], v[16:31]
    ds_read_b128 v[80:83], v132 offset:512
    v_mul_f32 v38, v38, v46
    v_exp_f32 v111, v111
    v_mul_f32_e64 v39, v39, v47
    v_fma_f32 v104, v104, v142, v142
    v_mfma_f32_32x32x16_bf16 v[16:31], a[56:59], v[56:59], v[16:31]
    ds_read_b128 v[84:87], v133 offset:512
    v_fma_f32 v105, v105, v142, v142
    v_fma_f32 v106, v106, v142, v142
    v_fma_f32 v107, v107, v142, v142
    v_fma_f32 v108, v108, v142, v142
    v_fma_f32 v109, v109, v142, v142
    v_mfma_f32_32x32x16_bf16 v[16:31], a[60:63], v[60:63], v[16:31]
    ds_read_b128 v[48:51], v134 offset:512
    s_waitcnt lgkmcnt(3)
    s_waitcnt vmcnt(30)
    s_barrier
    ds_read_b128 v[92:95], v113 offset:0
    v_fma_f32 v110, v110, v142, v142
    v_mfma_f32_32x32x16_bf16 v[16:31], a[64:67], v[64:67], v[16:31]
    ds_read_b128 v[52:55], v135 offset:512
    s_add_u32 m0, s58, 98304
    s_nop 0
    buffer_load_dwordx4 v120, s[24:27], s57 offen offset:0 lds
    v_fma_f32 v111, v111, v142, v142
    v_mfma_f32_32x32x16_bf16 v[16:31], a[68:71], v[68:71], v[16:31]
    ds_read_b128 v[56:59], v128 offset:768
    buffer_load_dwordx4 v121, s[24:27], s57 offen offset:1024 lds
    buffer_load_dwordx4 v122, s[24:27], s57 offen offset:2048 lds
    v_mfma_f32_32x32x16_bf16 v[16:31], a[72:75], v[72:75], v[16:31]
    ds_read_b128 v[60:63], v129 offset:768
    buffer_load_dwordx4 v123, s[24:27], s57 offen offset:3072 lds
    s_add_u32 s57, s57, s60
    v_rcp_f32 v104, v104
    v_mfma_f32_32x32x16_bf16 v[16:31], a[76:79], v[76:79], v[16:31]
    ds_read_b128 v[64:67], v130 offset:768
    s_waitcnt lgkmcnt(3)
    s_add_u32 m0, s58, 102400
    v_rcp_f32 v105, v105
    v_mul_f32_e64 v32, v32, v104
    v_mfma_f32_32x32x16_bf16 v[16:31], a[80:83], v[80:83], v[16:31]
    ds_read_b128 v[68:71], v131 offset:768
    buffer_load_dwordx4 v124, s[24:27], s57 offen offset:0 lds
    buffer_load_dwordx4 v125, s[24:27], s57 offen offset:1024 lds
    v_mfma_f32_32x32x16_bf16 v[16:31], a[84:87], v[84:87], v[16:31]
    ds_read_b128 v[72:75], v132 offset:768
    buffer_load_dwordx4 v126, s[24:27], s57 offen offset:2048 lds
    buffer_load_dwordx4 v127, s[24:27], s57 offen offset:3072 lds
    v_mfma_f32_32x32x16_bf16 v[16:31], a[88:91], v[48:51], v[16:31]
    ds_read_b128 v[76:79], v133 offset:768
    s_add_u32 s57, s57, s61
    v_rcp_f32 v106, v106
    v_mul_f32_e64 v33, v33, v105
    v_mfma_f32_32x32x16_bf16 v[16:31], a[92:95], v[52:55], v[16:31]
    ds_read_b128 v[80:83], v134 offset:768
    s_waitcnt lgkmcnt(3)
    s_add_u32 s63, s63, 4096
    buffer_load_dwordx4 a[208:211], v117, s[24:27], s63 offen offset:0
    v_mfma_f32_32x32x16_bf16 v[16:31], a[96:99], v[56:59], v[16:31]
    ds_read_b128 v[84:87], v135 offset:768
    buffer_load_dwordx4 a[212:215], v117, s[24:27], s63 offen offset:1024
    buffer_load_dwordx4 a[216:219], v117, s[24:27], s63 offen offset:2048
    v_mfma_f32_32x32x16_bf16 v[16:31], a[100:103], v[60:63], v[16:31]
    ds_read_b128 v[48:51], v128 offset:32768
    buffer_load_dwordx4 a[220:223], v117, s[24:27], s63 offen offset:3072
    s_add_u32 s63, s63, 4096
    v_rcp_f32 v107, v107
    v_mfma_f32_32x32x16_bf16 v[16:31], a[104:107], v[64:67], v[16:31]
    ds_read_b128 v[52:55], v129 offset:32768
    buffer_load_dwordx4 a[224:227], v117, s[24:27], s63 offen offset:0
    v_mul_f32 v34, v34, v106
    v_rcp_f32 v108, v108
    v_mfma_f32_32x32x16_bf16 v[16:31], a[108:111], v[68:71], v[16:31]
    ds_read_b128 v[56:59], v130 offset:32768
    s_waitcnt lgkmcnt(3)
    buffer_load_dwordx4 a[228:231], v117, s[24:27], s63 offen offset:1024
    buffer_load_dwordx4 a[232:235], v117, s[24:27], s63 offen offset:2048
    v_mfma_f32_32x32x16_bf16 v[16:31], a[112:115], v[72:75], v[16:31]
    ds_read_b128 v[60:63], v131 offset:32768
    buffer_load_dwordx4 a[236:239], v117, s[24:27], s63 offen offset:3072
    s_add_u32 s63, s63, 4096
    v_mul_f32 v35, v35, v107
    v_mfma_f32_32x32x16_bf16 v[16:31], a[116:119], v[76:79], v[16:31]
    ds_read_b128 v[64:67], v132 offset:32768
    buffer_load_dwordx4 a[240:243], v117, s[24:27], s63 offen offset:0
    v_rcp_f32 v109, v109
    v_mul_f32 v36, v36, v108
    v_mfma_f32_32x32x16_bf16 v[16:31], a[120:123], v[80:83], v[16:31]
    ds_read_b128 v[68:71], v133 offset:32768
    buffer_store_dwordx4 v[92:95], v114, s[24:27], s59 offen sc1
    s_add_u32 s59, s59, s62
    v_mfma_f32_32x32x16_bf16 v[16:31], a[124:127], v[84:87], v[16:31]
    ds_read_b128 v[72:75], v134 offset:32768
    s_waitcnt lgkmcnt(3)
    v_rcp_f32 v110, v110
    v_mul_f32 v37, v37, v109
    v_rcp_f32 v111, v111
    v_mul_f32 v38, v38, v110
    v_mul_f32_e64 v39, v39, v111
    v_cvt_pk_bf16_f32 v100, v32, v33
    v_cvt_pk_bf16_f32 v101, v34, v35
    v_cvt_pk_bf16_f32 v102, v36, v37
    v_cvt_pk_bf16_f32 v103, v38, v39
    v_mfma_f32_32x32x16_bf16 v[32:47], a[0:3], v[48:51], 0
    ds_read_b128 v[76:79], v135 offset:32768
    v_mfma_f32_32x32x16_bf16 v[32:47], a[4:7], v[52:55], v[32:47]
    ds_read_b128 v[80:83], v128 offset:33024
    ds_write_b128 v112, v[100:103] offset:4096
    v_mfma_f32_32x32x16_bf16 v[32:47], a[8:11], v[56:59], v[32:47]
    ds_read_b128 v[84:87], v129 offset:33024
    buffer_load_dwordx4 a[244:247], v117, s[24:27], s63 offen offset:1024
    v_mfma_f32_32x32x16_bf16 v[32:47], a[12:15], v[60:63], v[32:47]
    ds_read_b128 v[48:51], v130 offset:33024
    s_waitcnt lgkmcnt(4)
    v_fmac_f32 v16, v96, v144
    v_fmac_f32 v17, v96, v145
    v_fmac_f32 v18, v96, v146
    v_fmac_f32_e64 v19, v96, v147
    v_mfma_f32_32x32x16_bf16 v[32:47], a[16:19], v[64:67], v[32:47]
    ds_read_b128 v[52:55], v131 offset:33024
    buffer_load_dwordx4 a[248:251], v117, s[24:27], s63 offen offset:2048
    v_fmac_f32 v20, v96, v148
    v_fmac_f32 v21, v96, v149
    v_fmac_f32_e64 v22, v96, v150
    v_mfma_f32_32x32x16_bf16 v[32:47], a[20:23], v[68:71], v[32:47]
    ds_read_b128 v[56:59], v132 offset:33024
    v_fmac_f32 v23, v96, v151
    v_mul_f32 v104, v16, v97
    v_mul_f32 v105, v17, v97
    v_mul_f32 v106, v18, v97
    v_mfma_f32_32x32x16_bf16 v[32:47], a[24:27], v[72:75], v[32:47]
    ds_read_b128 v[60:63], v133 offset:33024
    buffer_load_dwordx4 a[252:255], v117, s[24:27], s63 offen offset:3072
    v_mul_f32 v107, v19, v97
    v_mul_f32 v108, v20, v97
    v_mul_f32_e64 v109, v21, v97
    v_mfma_f32_32x32x16_bf16 v[32:47], a[28:31], v[76:79], v[32:47]
    ds_read_b128 v[64:67], v134 offset:33024
    s_waitcnt lgkmcnt(3)
    v_mul_f32 v110, v22, v97
    v_mul_f32 v111, v23, v97
    v_fmac_f32 v24, v96, v152
    v_fmac_f32_e64 v25, v96, v153
    v_mfma_f32_32x32x16_bf16 v[32:47], a[32:35], v[80:83], v[32:47]
    ds_read_b128 v[68:71], v135 offset:33024
    ds_read_b128 v[140:143], v115 offset:2560
    v_fmac_f32 v26, v96, v154
    v_fmac_f32 v27, v96, v155
    v_fmac_f32 v28, v96, v156
    v_fmac_f32 v29, v96, v157
    v_mfma_f32_32x32x16_bf16 v[32:47], a[36:39], v[84:87], v[32:47]
    ds_read_b128 v[72:75], v128 offset:33280
    s_add_u32 s63, s63, 4096
    v_fmac_f32 v30, v96, v158
    v_fmac_f32 v31, v96, v159
    v_exp_f32_e64 v104, v104
    v_mfma_f32_32x32x16_bf16 v[32:47], a[40:43], v[48:51], v[32:47]
    ds_read_b128 v[76:79], v129 offset:33280
    v_mul_f32 v16, v16, v24
    v_exp_f32 v105, v105
    v_mul_f32_e64 v17, v17, v25
    v_mfma_f32_32x32x16_bf16 v[32:47], a[44:47], v[52:55], v[32:47]
    ds_read_b128 v[80:83], v130 offset:33280
    s_waitcnt lgkmcnt(4)
    buffer_load_dwordx4 v[160:163], v117, s[24:27], s63 offen offset:0
    v_exp_f32 v106, v106
    v_mfma_f32_32x32x16_bf16 v[32:47], a[48:51], v[56:59], v[32:47]
    ds_read_b128 v[84:87], v131 offset:33280
    v_mul_f32 v18, v18, v26
    v_exp_f32 v107, v107
    v_mul_f32_e64 v19, v19, v27
    v_mfma_f32_32x32x16_bf16 v[32:47], a[52:55], v[60:63], v[32:47]
    ds_read_b128 v[48:51], v132 offset:33280
    buffer_load_dwordx4 v[164:167], v117, s[24:27], s63 offen offset:1024
    v_exp_f32 v108, v108
    v_mul_f32 v20, v20, v28
    v_mfma_f32_32x32x16_bf16 v[32:47], a[56:59], v[64:67], v[32:47]
    ds_read_b128 v[52:55], v133 offset:33280
    v_exp_f32 v109, v109
    v_mul_f32 v21, v21, v29
    v_mfma_f32_32x32x16_bf16 v[32:47], a[60:63], v[68:71], v[32:47]
    ds_read_b128 v[56:59], v134 offset:33280
    s_waitcnt lgkmcnt(3)
    s_waitcnt vmcnt(34)
    s_barrier
    ds_read_b128 v[92:95], v113 offset:4096
    v_mfma_f32_32x32x16_bf16 v[32:47], a[64:67], v[72:75], v[32:47]
    ds_read_b128 v[60:63], v135 offset:33280
    buffer_load_dwordx4 v[168:171], v117, s[24:27], s63 offen offset:2048
    v_exp_f32 v110, v110
    v_mul_f32_e64 v22, v22, v30
    v_mfma_f32_32x32x16_bf16 v[32:47], a[68:71], v[76:79], v[32:47]
    ds_read_b128 v[64:67], v128 offset:33536
    v_exp_f32 v111, v111
    v_mul_f32 v23, v23, v31
    v_fma_f32 v104, v104, v98, v98
    v_mfma_f32_32x32x16_bf16 v[32:47], a[72:75], v[80:83], v[32:47]
    ds_read_b128 v[68:71], v129 offset:33536
    buffer_load_dwordx4 v[172:175], v117, s[24:27], s63 offen offset:3072
    v_fma_f32 v105, v105, v98, v98
    v_fma_f32 v106, v106, v98, v98
    v_fma_f32 v107, v107, v98, v98
    v_mfma_f32_32x32x16_bf16 v[32:47], a[76:79], v[84:87], v[32:47]
    ds_read_b128 v[72:75], v130 offset:33536
    s_waitcnt lgkmcnt(3)
    v_fma_f32 v108, v108, v98, v98
    v_fma_f32 v109, v109, v98, v98
    v_fma_f32 v110, v110, v98, v98
    v_mfma_f32_32x32x16_bf16 v[32:47], a[80:83], v[48:51], v[32:47]
    ds_read_b128 v[76:79], v131 offset:33536
    s_add_u32 s63, s63, 4096
    v_fma_f32 v111, v111, v98, v98
    v_rcp_f32 v104, v104
    v_mfma_f32_32x32x16_bf16 v[32:47], a[84:87], v[52:55], v[32:47]
    ds_read_b128 v[80:83], v132 offset:33536
    v_rcp_f32 v105, v105
    v_mul_f32 v16, v16, v104
    v_mfma_f32_32x32x16_bf16 v[32:47], a[88:91], v[56:59], v[32:47]
    ds_read_b128 v[84:87], v133 offset:33536
    v_rcp_f32 v106, v106
    v_mul_f32 v17, v17, v105
    v_mfma_f32_32x32x16_bf16 v[32:47], a[92:95], v[60:63], v[32:47]
    ds_read_b128 v[48:51], v134 offset:33536
    s_waitcnt lgkmcnt(3)
    buffer_load_dwordx4 v[176:179], v117, s[24:27], s63 offen offset:0
    v_rcp_f32 v107, v107
    v_mfma_f32_32x32x16_bf16 v[32:47], a[96:99], v[64:67], v[32:47]
    ds_read_b128 v[52:55], v135 offset:33536
    v_add_u32 v128, 65536, v128
    v_add_u32 v129, 65536, v129
    v_add_u32 v130, 65536, v130
    v_add_u32 v131, 65536, v131
    v_add_u32 v132, 65536, v132
    v_add_u32 v133, 65536, v133
    v_add_u32 v134, 65536, v134
    v_add_u32 v135, 65536, v135
    v_mfma_f32_32x32x16_bf16 v[32:47], a[100:103], v[68:71], v[32:47]
    ds_read_b128 v[56:59], v128 offset:0
    buffer_load_dwordx4 v[180:183], v117, s[24:27], s63 offen offset:1024
    v_mul_f32 v18, v18, v106
    v_rcp_f32 v108, v108
    v_mfma_f32_32x32x16_bf16 v[32:47], a[104:107], v[72:75], v[32:47]
    ds_read_b128 v[60:63], v129 offset:0
    v_mul_f32 v19, v19, v107
    v_rcp_f32 v109, v109
    v_mul_f32_e64 v20, v20, v108
    v_mfma_f32_32x32x16_bf16 v[32:47], a[108:111], v[76:79], v[32:47]
    ds_read_b128 v[64:67], v130 offset:0
    s_waitcnt lgkmcnt(3)
    buffer_load_dwordx4 v[184:187], v117, s[24:27], s63 offen offset:2048
    v_rcp_f32 v110, v110
    v_mfma_f32_32x32x16_bf16 v[32:47], a[112:115], v[80:83], v[32:47]
    ds_read_b128 v[68:71], v131 offset:0
    v_mul_f32 v21, v21, v109
    v_rcp_f32 v111, v111
    v_mfma_f32_32x32x16_bf16 v[32:47], a[116:119], v[84:87], v[32:47]
    ds_read_b128 v[72:75], v132 offset:0
    v_mul_f32 v22, v22, v110
    v_mul_f32 v23, v23, v111
    v_cvt_pk_bf16_f32 v100, v16, v17
    v_mfma_f32_32x32x16_bf16 v[32:47], a[120:123], v[48:51], v[32:47]
    ds_read_b128 v[76:79], v133 offset:0
    buffer_store_dwordx4 v[92:95], v114, s[24:27], s59 offen sc1
    s_add_u32 s59, s59, s62
    v_cvt_pk_bf16_f32 v101, v18, v19
    v_mfma_f32_32x32x16_bf16 v[32:47], a[124:127], v[52:55], v[32:47]
    ds_read_b128 v[80:83], v134 offset:0
    s_waitcnt lgkmcnt(3)
    v_cvt_pk_bf16_f32 v102, v20, v21
    v_cvt_pk_bf16_f32 v103, v22, v23
    v_mfma_f32_32x32x16_bf16 v[16:31], a[0:3], v[56:59], 0
    ds_read_b128 v[84:87], v135 offset:0
    v_mfma_f32_32x32x16_bf16 v[16:31], a[4:7], v[60:63], v[16:31]
    ds_read_b128 v[48:51], v128 offset:256
    ds_write_b128 v112, v[100:103] offset:0
    v_mfma_f32_32x32x16_bf16 v[16:31], a[8:11], v[64:67], v[16:31]
    ds_read_b128 v[52:55], v129 offset:256
    buffer_load_dwordx4 v[188:191], v117, s[24:27], s63 offen offset:3072
    v_mfma_f32_32x32x16_bf16 v[16:31], a[12:15], v[68:71], v[16:31]
    ds_read_b128 v[56:59], v130 offset:256
    s_waitcnt lgkmcnt(4)
    v_fmac_f32 v32, v140, v144
    v_fmac_f32 v33, v140, v145
    v_fmac_f32 v34, v140, v146
    v_fmac_f32_e64 v35, v140, v147
    v_mfma_f32_32x32x16_bf16 v[16:31], a[16:19], v[72:75], v[16:31]
    ds_read_b128 v[60:63], v131 offset:256
    s_add_u32 s63, s63, 4096
    v_fmac_f32 v36, v140, v148
    v_fmac_f32 v37, v140, v149
    v_fmac_f32 v38, v140, v150
    v_fmac_f32 v39, v140, v151
    v_mfma_f32_32x32x16_bf16 v[16:31], a[20:23], v[76:79], v[16:31]
    ds_read_b128 v[64:67], v132 offset:256
    v_mul_f32 v104, v32, v141
    v_mul_f32 v105, v33, v141
    v_mul_f32 v106, v34, v141
    v_mul_f32 v107, v35, v141
    v_mfma_f32_32x32x16_bf16 v[16:31], a[24:27], v[80:83], v[16:31]
    ds_read_b128 v[68:71], v133 offset:256
    buffer_load_dwordx4 v[192:195], v117, s[24:27], s63 offen offset:0
    v_mul_f32 v108, v36, v141
    v_mul_f32 v109, v37, v141
    v_mul_f32_e64 v110, v38, v141
    v_mfma_f32_32x32x16_bf16 v[16:31], a[28:31], v[84:87], v[16:31]
    ds_read_b128 v[72:75], v134 offset:256
    s_waitcnt lgkmcnt(3)
    v_mul_f32 v111, v39, v141
    v_fmac_f32 v40, v140, v152
    v_fmac_f32 v41, v140, v153
    v_mfma_f32_32x32x16_bf16 v[16:31], a[32:35], v[48:51], v[16:31]
    ds_read_b128 v[76:79], v135 offset:256
    ds_read_b128 v[96:99], v115 offset:3072
    v_fmac_f32 v42, v140, v154
    v_fmac_f32 v43, v140, v155
    v_fmac_f32_e64 v44, v140, v156
    v_mfma_f32_32x32x16_bf16 v[16:31], a[36:39], v[52:55], v[16:31]
    ds_read_b128 v[80:83], v128 offset:512
    buffer_load_dwordx4 v[196:199], v117, s[24:27], s63 offen offset:1024
    v_fmac_f32 v45, v140, v157
    v_fmac_f32 v46, v140, v158
    v_fmac_f32_e64 v47, v140, v159
    v_mfma_f32_32x32x16_bf16 v[16:31], a[40:43], v[56:59], v[16:31]
    ds_read_b128 v[84:87], v129 offset:512
    v_exp_f32 v104, v104
    v_mul_f32 v32, v32, v40
    v_mfma_f32_32x32x16_bf16 v[16:31], a[44:47], v[60:63], v[16:31]
    ds_read_b128 v[48:51], v130 offset:512
    s_waitcnt lgkmcnt(4)
    buffer_load_dwordx4 v[200:203], v117, s[24:27], s63 offen offset:2048
    v_exp_f32 v105, v105
    v_mfma_f32_32x32x16_bf16 v[16:31], a[48:51], v[64:67], v[16:31]
    ds_read_b128 v[52:55], v131 offset:512
    v_mul_f32 v33, v33, v41
    v_exp_f32 v106, v106
    v_mul_f32_e64 v34, v34, v42
    v_mfma_f32_32x32x16_bf16 v[16:31], a[52:55], v[68:71], v[16:31]
    ds_read_b128 v[56:59], v132 offset:512
    buffer_load_dwordx4 v[204:207], v117, s[24:27], s63 offen offset:3072
    v_exp_f32 v107, v107
    v_mul_f32 v35, v35, v43
    v_mfma_f32_32x32x16_bf16 v[16:31], a[56:59], v[72:75], v[16:31]
    ds_read_b128 v[60:63], v133 offset:512
    v_exp_f32 v108, v108
    v_mul_f32 v36, v36, v44
    v_mfma_f32_32x32x16_bf16 v[16:31], a[60:63], v[76:79], v[16:31]
    ds_read_b128 v[64:67], v134 offset:512
    s_waitcnt lgkmcnt(3)
    s_waitcnt vmcnt(26)
    s_waitcnt vmcnt(5)
    s_barrier
    s_nop 6
    s_cmp_lg_u32 s30, 0
    s_cbranch_scc1 L_fs_83
    s_add_u32 s40, s32, 2
    v_mov_b32 v2, s40
    v_mov_b32_e64 v3, s33
    s_lshl_b32 s41, s2, 6
    s_add_u32 s41, s41, 98304
    v_mov_b32 v4, s41
    s_mov_b64 exec, 1
    buffer_store_dwordx2 v[2:3], v4, s[24:27], 0 offen sc1
    s_mov_b64 exec, -1
L_fs_83:
    ds_read_b128 v[92:95], v113 offset:0
    v_mfma_f32_32x32x16_bf16 v[16:31], a[64:67], v[80:83], v[16:31]
    ds_read_b128 v[68:71], v135 offset:512
    s_add_u32 s63, s63, 4096
    v_exp_f32 v109, v109
    v_mul_f32_e64 v37, v37, v45
    v_mfma_f32_32x32x16_bf16 v[16:31], a[68:71], v[84:87], v[16:31]
    ds_read_b128 v[72:75], v128 offset:768
    v_exp_f32 v110, v110
    v_mul_f32 v38, v38, v46
    v_mfma_f32_32x32x16_bf16 v[16:31], a[72:75], v[48:51], v[16:31]
    ds_read_b128 v[76:79], v129 offset:768
    buffer_load_dwordx4 v[208:211], v117, s[24:27], s63 offen offset:0
    v_exp_f32 v111, v111
    v_mul_f32 v39, v39, v47
    v_mfma_f32_32x32x16_bf16 v[16:31], a[76:79], v[52:55], v[16:31]
    ds_read_b128 v[80:83], v130 offset:768
    s_waitcnt lgkmcnt(3)
    v_fma_f32 v104, v104, v142, v142
    v_fma_f32 v105, v105, v142, v142
    v_fma_f32 v106, v106, v142, v142
    v_mfma_f32_32x32x16_bf16 v[16:31], a[80:83], v[56:59], v[16:31]
    ds_read_b128 v[84:87], v131 offset:768
    buffer_load_dwordx4 v[212:215], v117, s[24:27], s63 offen offset:1024
    v_fma_f32 v107, v107, v142, v142
    v_fma_f32 v108, v108, v142, v142
    v_fma_f32 v109, v109, v142, v142
    v_mfma_f32_32x32x16_bf16 v[16:31], a[84:87], v[60:63], v[16:31]
    ds_read_b128 v[48:51], v132 offset:768
    v_fma_f32 v110, v110, v142, v142
    v_fma_f32 v111, v111, v142, v142
    v_rcp_f32 v104, v104
    v_mfma_f32_32x32x16_bf16 v[16:31], a[88:91], v[64:67], v[16:31]
    ds_read_b128 v[52:55], v133 offset:768
    v_rcp_f32 v105, v105
    v_mul_f32 v32, v32, v104
    v_mfma_f32_32x32x16_bf16 v[16:31], a[92:95], v[68:71], v[16:31]
    ds_read_b128 v[56:59], v134 offset:768
    s_waitcnt lgkmcnt(3)
    buffer_load_dwordx4 v[216:219], v117, s[24:27], s63 offen offset:2048
    v_rcp_f32 v106, v106
    v_mfma_f32_32x32x16_bf16 v[16:31], a[96:99], v[72:75], v[16:31]
    ds_read_b128 v[60:63], v135 offset:768
    v_mul_f32 v33, v33, v105
    v_rcp_f32 v107, v107
    v_mul_f32_e64 v34, v34, v106
    v_mfma_f32_32x32x16_bf16 v[16:31], a[100:103], v[76:79], v[16:31]
    ds_read_b128 v[64:67], v128 offset:32768
    buffer_load_dwordx4 v[220:223], v117, s[24:27], s63 offen offset:3072
    v_rcp_f32_e64 v108, v108
    v_mfma_f32_32x32x16_bf16 v[16:31], a[104:107], v[80:83], v[16:31]
    ds_read_b128 v[68:71], v129 offset:32768
    v_mul_f32 v35, v35, v107
    v_rcp_f32 v109, v109
    v_mul_f32_e64 v36, v36, v108
    v_mfma_f32_32x32x16_bf16 v[16:31], a[108:111], v[84:87], v[16:31]
    ds_read_b128 v[72:75], v130 offset:32768
    s_waitcnt lgkmcnt(3)
    s_add_u32 s63, s63, 4096
    v_rcp_f32 v110, v110
    v_mfma_f32_32x32x16_bf16 v[16:31], a[112:115], v[48:51], v[16:31]
    ds_read_b128 v[76:79], v131 offset:32768
    v_mul_f32 v37, v37, v109
    v_rcp_f32 v111, v111
    v_mfma_f32_32x32x16_bf16 v[16:31], a[116:119], v[52:55], v[16:31]
    ds_read_b128 v[80:83], v132 offset:32768
    v_mul_f32 v38, v38, v110
    v_mul_f32 v39, v39, v111
    v_cvt_pk_bf16_f32 v100, v32, v33
    v_mfma_f32_32x32x16_bf16 v[16:31], a[120:123], v[56:59], v[16:31]
    ds_read_b128 v[84:87], v133 offset:32768
    buffer_store_dwordx4 v[92:95], v114, s[24:27], s59 offen sc1
    s_add_u32 s59, s59, s62
    v_cvt_pk_bf16_f32 v101, v34, v35
    v_mfma_f32_32x32x16_bf16 v[16:31], a[124:127], v[60:63], v[16:31]
    ds_read_b128 v[48:51], v134 offset:32768
    s_waitcnt lgkmcnt(3)
    v_cvt_pk_bf16_f32 v102, v36, v37
    v_cvt_pk_bf16_f32 v103, v38, v39
    v_mfma_f32_32x32x16_bf16 v[32:47], a[0:3], v[64:67], 0
    ds_read_b128 v[52:55], v135 offset:32768
    v_mfma_f32_32x32x16_bf16 v[32:47], a[4:7], v[68:71], v[32:47]
    ds_read_b128 v[56:59], v128 offset:33024
    ds_write_b128 v112, v[100:103] offset:4096
    v_mfma_f32_32x32x16_bf16 v[32:47], a[8:11], v[72:75], v[32:47]
    ds_read_b128 v[60:63], v129 offset:33024
    buffer_load_dwordx4 v[224:227], v117, s[24:27], s63 offen offset:0
    v_mfma_f32_32x32x16_bf16 v[32:47], a[12:15], v[76:79], v[32:47]
    ds_read_b128 v[64:67], v130 offset:33024
    s_waitcnt lgkmcnt(4)
    v_fmac_f32 v16, v96, v144
    v_fmac_f32 v17, v96, v145
    v_fmac_f32 v18, v96, v146
    v_fmac_f32_e64 v19, v96, v147
    v_mfma_f32_32x32x16_bf16 v[32:47], a[16:19], v[80:83], v[32:47]
    ds_read_b128 v[68:71], v131 offset:33024
    v_fmac_f32 v20, v96, v148
    v_fmac_f32 v21, v96, v149
    v_fmac_f32 v22, v96, v150
    v_fmac_f32 v23, v96, v151
    v_mfma_f32_32x32x16_bf16 v[32:47], a[20:23], v[84:87], v[32:47]
    ds_read_b128 v[72:75], v132 offset:33024
    buffer_load_dwordx4 v[228:231], v117, s[24:27], s63 offen offset:1024
    v_mul_f32 v104, v16, v97
    v_mul_f32 v105, v17, v97
    v_mul_f32_e64 v106, v18, v97
    v_mfma_f32_32x32x16_bf16 v[32:47], a[24:27], v[48:51], v[32:47]
    ds_read_b128 v[76:79], v133 offset:33024
    v_mul_f32 v107, v19, v97
    v_mul_f32 v108, v20, v97
    v_mul_f32 v109, v21, v97
    v_mul_f32 v110, v22, v97
    v_mfma_f32_32x32x16_bf16 v[32:47], a[28:31], v[52:55], v[32:47]
    ds_read_b128 v[80:83], v134 offset:33024
    s_waitcnt lgkmcnt(3)
    v_mul_f32 v111, v23, v97
    v_fmac_f32 v24, v96, v152
    v_fmac_f32 v25, v96, v153
    v_mfma_f32_32x32x16_bf16 v[32:47], a[32:35], v[56:59], v[32:47]
    ds_read_b128 v[84:87], v135 offset:33024
    ds_read_b128 v[140:143], v115 offset:3584
    buffer_load_dwordx4 v[232:235], v117, s[24:27], s63 offen offset:2048
    v_fmac_f32 v26, v96, v154
    v_fmac_f32 v27, v96, v155
    v_mfma_f32_32x32x16_bf16 v[32:47], a[36:39], v[60:63], v[32:47]
    ds_read_b128 v[48:51], v128 offset:33280
    v_fmac_f32 v28, v96, v156
    v_fmac_f32 v29, v96, v157
    v_fmac_f32 v30, v96, v158
    v_fmac_f32 v31, v96, v159
    v_mfma_f32_32x32x16_bf16 v[32:47], a[40:43], v[64:67], v[32:47]
    ds_read_b128 v[52:55], v129 offset:33280
    v_exp_f32 v104, v104
    v_mul_f32 v16, v16, v24
    v_mfma_f32_32x32x16_bf16 v[32:47], a[44:47], v[68:71], v[32:47]
    ds_read_b128 v[56:59], v130 offset:33280
    s_waitcnt lgkmcnt(4)
    buffer_load_dwordx4 v[236:239], v117, s[24:27], s63 offen offset:3072
    v_exp_f32 v105, v105
    v_mfma_f32_32x32x16_bf16 v[32:47], a[48:51], v[72:75], v[32:47]
    ds_read_b128 v[60:63], v131 offset:33280
    v_mul_f32 v17, v17, v25
    v_exp_f32 v106, v106
    v_mul_f32_e64 v18, v18, v26
    v_mfma_f32_32x32x16_bf16 v[32:47], a[52:55], v[76:79], v[32:47]
    ds_read_b128 v[64:67], v132 offset:33280
    v_exp_f32 v107, v107
    v_mul_f32 v19, v19, v27
    v_mfma_f32_32x32x16_bf16 v[32:47], a[56:59], v[80:83], v[32:47]
    ds_read_b128 v[68:71], v133 offset:33280
    s_add_u32 s63, s63, 4096
    v_exp_f32 v108, v108
    v_mul_f32 v20, v20, v28
    v_mfma_f32_32x32x16_bf16 v[32:47], a[60:63], v[84:87], v[32:47]
    ds_read_b128 v[72:75], v134 offset:33280
    s_waitcnt lgkmcnt(3)
    s_barrier
    ds_read_b128 v[92:95], v113 offset:4096
    v_mfma_f32_32x32x16_bf16 v[32:47], a[64:67], v[48:51], v[32:47]
    ds_read_b128 v[76:79], v135 offset:33280
    v_exp_f32 v109, v109
    v_mul_f32 v21, v21, v29
    v_mfma_f32_32x32x16_bf16 v[32:47], a[68:71], v[52:55], v[32:47]
    ds_read_b128 v[80:83], v128 offset:33536
    buffer_load_dwordx4 v[240:243], v117, s[24:27], s63 offen offset:0
    v_exp_f32 v110, v110
    v_mul_f32 v22, v22, v30
    v_mfma_f32_32x32x16_bf16 v[32:47], a[72:75], v[56:59], v[32:47]
    ds_read_b128 v[84:87], v129 offset:33536
    v_exp_f32 v111, v111
    v_mul_f32 v23, v23, v31
    v_fma_f32 v104, v104, v98, v98
    v_mfma_f32_32x32x16_bf16 v[32:47], a[76:79], v[60:63], v[32:47]
    ds_read_b128 v[48:51], v130 offset:33536
    s_waitcnt lgkmcnt(3)
    v_fma_f32 v105, v105, v98, v98
    v_fma_f32 v106, v106, v98, v98
    v_fma_f32 v107, v107, v98, v98
    v_fma_f32 v108, v108, v98, v98
    v_mfma_f32_32x32x16_bf16 v[32:47], a[80:83], v[64:67], v[32:47]
    ds_read_b128 v[52:55], v131 offset:33536
    buffer_load_dwordx4 v[244:247], v117, s[24:27], s63 offen offset:1024
    v_fma_f32 v109, v109, v98, v98
    v_fma_f32 v110, v110, v98, v98
    v_fma_f32 v111, v111, v98, v98
    v_mfma_f32_32x32x16_bf16 v[32:47], a[84:87], v[68:71], v[32:47]
    ds_read_b128 v[56:59], v132 offset:33536
    v_rcp_f32 v104, v104
    v_rcp_f32_e64 v105, v105
    v_mfma_f32_32x32x16_bf16 v[32:47], a[88:91], v[72:75], v[32:47]
    ds_read_b128 v[60:63], v133 offset:33536
    v_mul_f32 v16, v16, v104
    v_rcp_f32 v106, v106
    v_mul_f32_e64 v17, v17, v105
    v_mfma_f32_32x32x16_bf16 v[32:47], a[92:95], v[76:79], v[32:47]
    ds_read_b128 v[64:67], v134 offset:33536
    s_waitcnt lgkmcnt(3)
    buffer_load_dwordx4 v[248:251], v117, s[24:27], s63 offen offset:2048
    v_rcp_f32 v107, v107
    v_mfma_f32_32x32x16_bf16 v[32:47], a[96:99], v[80:83], v[32:47]
    ds_read_b128 v[68:71], v135 offset:33536
    v_mfma_f32_32x32x16_bf16 v[32:47], a[100:103], v[84:87], v[32:47]
    v_mul_f32 v18, v18, v106
    v_rcp_f32 v108, v108
    v_mul_f32_e64 v19, v19, v107
    v_mfma_f32_32x32x16_bf16 v[32:47], a[104:107], v[48:51], v[32:47]
    buffer_load_dwordx4 v[252:255], v117, s[24:27], s63 offen offset:3072
    v_rcp_f32_e64 v109, v109
    v_mfma_f32_32x32x16_bf16 v[32:47], a[108:111], v[52:55], v[32:47]
    s_waitcnt lgkmcnt(0)
    v_mul_f32 v20, v20, v108
    v_rcp_f32_e64 v110, v110
    v_mfma_f32_32x32x16_bf16 v[32:47], a[112:115], v[56:59], v[32:47]
    v_mul_f32 v21, v21, v109
    v_rcp_f32 v111, v111
    v_mfma_f32_32x32x16_bf16 v[32:47], a[116:119], v[60:63], v[32:47]
    v_mul_f32 v22, v22, v110
    v_mul_f32 v23, v23, v111
    v_cvt_pk_bf16_f32 v100, v16, v17
    v_mfma_f32_32x32x16_bf16 v[32:47], a[120:123], v[64:67], v[32:47]
    buffer_store_dwordx4 v[92:95], v114, s[24:27], s59 offen sc1
    s_add_u32 s59, s59, s62
    v_cvt_pk_bf16_f32 v101, v18, v19
    v_mfma_f32_32x32x16_bf16 v[32:47], a[124:127], v[68:71], v[32:47]
    v_cvt_pk_bf16_f32 v102, v20, v21
    v_cvt_pk_bf16_f32 v103, v22, v23
    ds_write_b128 v112, v[100:103]
    s_nop 8
    v_fmac_f32 v32, v140, v144
    v_fmac_f32 v33, v140, v145
    v_fmac_f32 v34, v140, v146
    v_fmac_f32 v35, v140, v147
    v_fmac_f32 v36, v140, v148
    v_fmac_f32 v37, v140, v149
    v_fmac_f32 v38, v140, v150
    v_fmac_f32 v39, v140, v151
    v_mul_f32 v104, v32, v141
    v_mul_f32 v105, v33, v141
    v_mul_f32 v106, v34, v141
    v_mul_f32 v107, v35, v141
    v_mul_f32 v108, v36, v141
    v_mul_f32 v109, v37, v141
    v_mul_f32 v110, v38, v141
    v_mul_f32 v111, v39, v141
    v_fmac_f32 v40, v140, v152
    v_fmac_f32 v41, v140, v153
    v_fmac_f32 v42, v140, v154
    v_fmac_f32 v43, v140, v155
    v_fmac_f32 v44, v140, v156
    v_fmac_f32 v45, v140, v157
    v_fmac_f32 v46, v140, v158
    v_fmac_f32 v47, v140, v159
    v_exp_f32 v104, v104
    v_mul_f32 v32, v32, v40
    v_exp_f32 v105, v105
    v_mul_f32 v33, v33, v41
    v_exp_f32 v106, v106
    v_mul_f32 v34, v34, v42
    v_exp_f32 v107, v107
    v_mul_f32 v35, v35, v43
    v_exp_f32 v108, v108
    v_mul_f32 v36, v36, v44
    v_exp_f32 v109, v109
    v_mul_f32 v37, v37, v45
    v_exp_f32 v110, v110
    v_mul_f32 v38, v38, v46
    v_exp_f32 v111, v111
    v_mul_f32 v39, v39, v47
    v_fma_f32 v104, v104, v142, v142
    v_fma_f32 v105, v105, v142, v142
    v_fma_f32 v106, v106, v142, v142
    v_fma_f32 v107, v107, v142, v142
    v_fma_f32 v108, v108, v142, v142
    v_fma_f32 v109, v109, v142, v142
    v_fma_f32 v110, v110, v142, v142
    v_fma_f32 v111, v111, v142, v142
    v_rcp_f32 v104, v104
    v_rcp_f32 v105, v105
    v_mul_f32 v32, v32, v104
    v_rcp_f32 v106, v106
    v_mul_f32 v33, v33, v105
    v_rcp_f32 v107, v107
    v_mul_f32 v34, v34, v106
    v_rcp_f32 v108, v108
    v_mul_f32 v35, v35, v107
    v_rcp_f32 v109, v109
    v_mul_f32 v36, v36, v108
    v_rcp_f32 v110, v110
    v_mul_f32 v37, v37, v109
    v_rcp_f32 v111, v111
    v_mul_f32 v38, v38, v110
    v_mul_f32 v39, v39, v111
    v_cvt_pk_bf16_f32 v100, v32, v33
    v_cvt_pk_bf16_f32 v101, v34, v35
    v_cvt_pk_bf16_f32 v102, v36, v37
    v_cvt_pk_bf16_f32 v103, v38, v39
    ds_write_b128 v112, v[100:103] offset:4096
    s_waitcnt lgkmcnt(0)
    s_barrier
    ds_read_b128 v[92:95], v113
    ds_read_b128 v[88:91], v113 offset:4096
    s_waitcnt lgkmcnt(1)
    buffer_store_dwordx4 v[92:95], v114, s[24:27], s59 offen sc1
    s_add_u32 s59, s59, s62
    s_waitcnt lgkmcnt(0)
    buffer_store_dwordx4 v[88:91], v114, s[24:27], s59 offen sc1
    s_waitcnt vmcnt(0)
    s_barrier
    s_cmp_lg_u32 s30, 0
    s_cbranch_scc1 L_fs_84
    s_add_u32 s40, s32, 3
    v_mov_b32 v2, s40
    v_mov_b32_e64 v3, s33
    s_lshl_b32 s41, s2, 6
    s_add_u32 s41, s41, 98304
    v_mov_b32 v4, s41
    s_mov_b64 exec, 1
    buffer_store_dwordx2 v[2:3], v4, s[24:27], 0 offen sc1
    s_mov_b64 exec, -1
L_fs_84:
    s_waitcnt vmcnt(0)
    s_branch L_gudone_72
L_idle_71:
    s_cmp_lg_u32 s30, 0
    s_cbranch_scc1 L_fs_85
    s_add_u32 s40, s32, 3
    v_mov_b32 v2, s40
    v_mov_b32_e64 v3, s33
    s_lshl_b32 s41, s2, 6
    s_add_u32 s41, s41, 98304
    v_mov_b32 v4, s41
    s_mov_b64 exec, 1
    buffer_store_dwordx2 v[2:3], v4, s[24:27], 0 offen sc1
    s_mov_b64 exec, -1
L_fs_85:
    s_lshl_b32 s44, s28, 2
    s_add_u32 s44, s44, s29
    s_sub_u32 s44, s44, 28
    s_and_b32 s45, s44, 7
    s_lshr_b32 s46, s44, 3
    v_lshrrev_b32 v2, 3, v1
    v_and_b32 v3, 7, v1
    v_lshlrev_b32_e64 v4, 10, v2
    v_lshl_add_u32 v4, v3, 4, v4
    s_mul_i32 s47, s46, 448
    s_mul_i32 s40, s30, 112
    s_add_u32 s47, s47, s40
    s_lshl_b32 s47, s47, 10
    s_lshl_b32 s40, s45, 7
    s_add_u32 s47, s47, s40
    buffer_load_dwordx4 v[16:19], v4, s[16:19], s47 offen
    s_add_u32 s47, s47, 8192
    buffer_load_dwordx4 v[20:23], v4, s[16:19], s47 offen
    s_add_u32 s47, s47, 8192
    buffer_load_dwordx4 v[24:27], v4, s[16:19], s47 offen
    s_add_u32 s47, s47, 8192
    buffer_load_dwordx4 v[28:31], v4, s[16:19], s47 offen
    s_add_u32 s47, s47, 8192
    buffer_load_dwordx4 v[32:35], v4, s[16:19], s47 offen
    s_add_u32 s47, s47, 8192
    buffer_load_dwordx4 v[36:39], v4, s[16:19], s47 offen
    s_add_u32 s47, s47, 8192
    buffer_load_dwordx4 v[40:43], v4, s[16:19], s47 offen
    s_add_u32 s47, s47, 8192
    buffer_load_dwordx4 v[44:47], v4, s[16:19], s47 offen
    s_add_u32 s47, s47, 8192
    buffer_load_dwordx4 v[48:51], v4, s[16:19], s47 offen
    s_add_u32 s47, s47, 8192
    buffer_load_dwordx4 v[52:55], v4, s[16:19], s47 offen
    s_add_u32 s47, s47, 8192
    buffer_load_dwordx4 v[56:59], v4, s[16:19], s47 offen
    s_add_u32 s47, s47, 8192
    buffer_load_dwordx4 v[60:63], v4, s[16:19], s47 offen
    s_add_u32 s47, s47, 8192
    buffer_load_dwordx4 v[64:67], v4, s[16:19], s47 offen
    s_add_u32 s47, s47, 8192
    buffer_load_dwordx4 v[68:71], v4, s[16:19], s47 offen
    v_bfe_u32 v8, v2, 1, 1
    v_lshlrev_b32 v8, 2, v8
    v_xor_b32 v3, v3, v8
    v_lshlrev_b32_e64 v3, 4, v3
    v_lshl_add_u32 v5, v2, 7, v3
    v_and_b32 v6, 15, v1
    v_lshrrev_b32 v7, 4, v1
    v_lshrrev_b32 v8, 2, v6
    v_and_b32 v9, 3, v6
    v_and_b32 v10, 1, v7
    v_lshrrev_b32 v7, 1, v7
    v_and_b32_e64 v11, 1, v9
    v_lshl_add_u32 v11, v10, 1, v11
    v_bfe_u32 v6, v8, 1, 1
    v_lshlrev_b32 v6, 2, v6
    v_xor_b32 v11, v11, v6
    v_lshlrev_b32 v11, 4, v11
    v_lshrrev_b32 v9, 1, v9
    v_lshl_add_u32 v11, v9, 3, v11
    v_lshl_add_u32 v8, v7, 3, v8
    v_lshl_add_u32 v6, v8, 7, v11
    v_xor_b32_e64 v7, 64, v6
    s_mul_i32 s41, s30, 14336
    s_add_u32 s41, s41, 106496
    v_add_u32 v5, s41, v5
    v_add_u32 v6, s41, v6
    v_add_u32 v7, s41, v7
    s_waitcnt vmcnt(13)
    ds_write_b128 v5, v[16:19] offset:0
    s_waitcnt vmcnt(12)
    ds_write_b128 v5, v[20:23] offset:1024
    s_waitcnt vmcnt(11)
    ds_write_b128 v5, v[24:27] offset:2048
    s_waitcnt vmcnt(10)
    ds_write_b128 v5, v[28:31] offset:3072
    s_waitcnt vmcnt(9)
    ds_write_b128 v5, v[32:35] offset:4096
    s_waitcnt vmcnt(8)
    ds_write_b128 v5, v[36:39] offset:5120
    s_waitcnt vmcnt(7)
    ds_write_b128 v5, v[40:43] offset:6144
    s_waitcnt vmcnt(6)
    ds_write_b128 v5, v[44:47] offset:7168
    s_waitcnt vmcnt(5)
    ds_write_b128 v5, v[48:51] offset:8192
    s_waitcnt vmcnt(4)
    ds_write_b128 v5, v[52:55] offset:9216
    s_waitcnt vmcnt(3)
    ds_write_b128 v5, v[56:59] offset:10240
    s_waitcnt vmcnt(2)
    ds_write_b128 v5, v[60:63] offset:11264
    s_waitcnt vmcnt(1)
    ds_write_b128 v5, v[64:67] offset:12288
    s_waitcnt vmcnt(0)
    ds_write_b128 v5, v[68:71] offset:13312
    ds_read_b64_tr_b16 v[72:73], v6 offset:0
    ds_read_b64_tr_b16 v[74:75], v6 offset:512
    ds_read_b64_tr_b16 v[76:77], v7 offset:0
    ds_read_b64_tr_b16 v[78:79], v7 offset:512
    ds_read_b64_tr_b16 v[80:81], v6 offset:2048
    ds_read_b64_tr_b16 v[82:83], v6 offset:2560
    ds_read_b64_tr_b16 v[84:85], v7 offset:2048
    ds_read_b64_tr_b16 v[86:87], v7 offset:2560
    ds_read_b64_tr_b16 v[88:89], v6 offset:4096
    ds_read_b64_tr_b16 v[90:91], v6 offset:4608
    ds_read_b64_tr_b16 v[92:93], v7 offset:4096
    ds_read_b64_tr_b16 v[94:95], v7 offset:4608
    ds_read_b64_tr_b16 v[96:97], v6 offset:6144
    ds_read_b64_tr_b16 v[98:99], v6 offset:6656
    ds_read_b64_tr_b16 v[100:101], v7 offset:6144
    ds_read_b64_tr_b16 v[102:103], v7 offset:6656
    ds_read_b64_tr_b16 v[104:105], v6 offset:8192
    ds_read_b64_tr_b16 v[106:107], v6 offset:8704
    ds_read_b64_tr_b16 v[108:109], v7 offset:8192
    ds_read_b64_tr_b16 v[110:111], v7 offset:8704
    ds_read_b64_tr_b16 v[112:113], v6 offset:10240
    ds_read_b64_tr_b16 v[114:115], v6 offset:10752
    ds_read_b64_tr_b16 v[116:117], v7 offset:10240
    ds_read_b64_tr_b16 v[118:119], v7 offset:10752
    ds_read_b64_tr_b16 v[120:121], v6 offset:12288
    ds_read_b64_tr_b16 v[122:123], v6 offset:12800
    ds_read_b64_tr_b16 v[124:125], v7 offset:12288
    ds_read_b64_tr_b16 v[126:127], v7 offset:12800
    v_lshlrev_b32 v4, 4, v1
    s_lshl_b32 s47, s45, 2
    s_add_u32 s47, s47, s46
    s_mul_i32 s47, s47, 56
    s_mul_i32 s40, s30, 14
    s_add_u32 s47, s47, s40
    s_lshl_b32 s47, s47, 10
    s_add_u32 s47, s47, 29360128
    s_waitcnt lgkmcnt(15)
    buffer_store_dwordx4 v[72:75], v4, s[24:27], s47 offen offset:0 sc1
    s_waitcnt lgkmcnt(15)
    buffer_store_dwordx4 v[76:79], v4, s[24:27], s47 offen offset:1024 sc1
    s_waitcnt lgkmcnt(15)
    buffer_store_dwordx4 v[80:83], v4, s[24:27], s47 offen offset:2048 sc1
    s_waitcnt lgkmcnt(15)
    buffer_store_dwordx4 v[84:87], v4, s[24:27], s47 offen offset:3072 sc1
    s_add_u32 s47, s47, 4096
    s_waitcnt lgkmcnt(15)
    buffer_store_dwordx4 v[88:91], v4, s[24:27], s47 offen offset:0 sc1
    s_waitcnt lgkmcnt(15)
    buffer_store_dwordx4 v[92:95], v4, s[24:27], s47 offen offset:1024 sc1
    s_waitcnt lgkmcnt(14)
    buffer_store_dwordx4 v[96:99], v4, s[24:27], s47 offen offset:2048 sc1
    s_waitcnt lgkmcnt(12)
    buffer_store_dwordx4 v[100:103], v4, s[24:27], s47 offen offset:3072 sc1
    s_add_u32 s47, s47, 4096
    s_waitcnt lgkmcnt(10)
    buffer_store_dwordx4 v[104:107], v4, s[24:27], s47 offen offset:0 sc1
    s_waitcnt lgkmcnt(8)
    buffer_store_dwordx4 v[108:111], v4, s[24:27], s47 offen offset:1024 sc1
    s_waitcnt lgkmcnt(6)
    buffer_store_dwordx4 v[112:115], v4, s[24:27], s47 offen offset:2048 sc1
    s_waitcnt lgkmcnt(4)
    buffer_store_dwordx4 v[116:119], v4, s[24:27], s47 offen offset:3072 sc1
    s_add_u32 s47, s47, 4096
    s_waitcnt lgkmcnt(2)
    buffer_store_dwordx4 v[120:123], v4, s[24:27], s47 offen offset:0 sc1
    s_waitcnt lgkmcnt(0)
    buffer_store_dwordx4 v[124:127], v4, s[24:27], s47 offen offset:1024 sc1
    s_waitcnt vmcnt(0)
    s_barrier
    s_cmp_lg_u32 s30, 0
    s_cbranch_scc1 L_wf_86
    s_add_u32 s40, s32, 1
    v_mov_b32 v2, s40
    v_mov_b32 v3, s33
    s_lshl_b32 s41, s44, 6
    s_add_u32 s41, s41, 114688
    v_mov_b32 v4, s41
    s_mov_b64 exec, 1
    buffer_store_dwordx2 v[2:3], v4, s[24:27], 0 offen sc1
    s_mov_b64 exec, -1
L_wf_86:
    s_lshl_b32 s40, s30, 3
    s_add_u32 s40, s40, s35
    s_lshl_b32 s40, s40, 6
    s_add_u32 s40, s40, 114688
    v_mov_b32 v118, s40
    s_add_u32 s40, s32, 1
    s_mov_b32 exec_lo, 0x1
    s_mov_b32 exec_hi, 0
    s_mov_b32 s98, 0
    v_mov_b32 v2, 0
    v_mov_b32 v3, 0
    s_nop 1
L_poll_87:
    buffer_load_dwordx2 v[2:3], v118, s[24:27], 0 offen sc1
    s_add_u32 s98, s98, 1
    s_cmp_gt_u32 s98, 0x40000
    s_cbranch_scc1 L_pd_88
    s_waitcnt vmcnt(0)
    v_subrev_u32_e64 v2, s40, v2
    v_cmp_gt_u32 vcc, 64, v2
    v_cmp_eq_u32 s[42:43], s33, v3
    s_nop 1
    s_and_b64 vcc, vcc, s[42:43]
    s_cmp_eq_u64 vcc, exec
    s_cbranch_scc1 L_pd_88
    s_sleep 4
    s_branch L_poll_87
L_pd_88:
    s_waitcnt vmcnt(0)
    s_mov_b64 exec, -1
    v_lshlrev_b32_e64 v117, 4, v1
    s_lshl_b32 s63, s35, 2
    s_add_u32 s63, s63, s30
    s_mul_i32 s63, s63, 57344
    s_add_u32 s63, s63, 29360128
    buffer_load_dwordx4 a[128:131], v117, s[24:27], s63 offen offset:0
    buffer_load_dwordx4 a[132:135], v117, s[24:27], s63 offen offset:1024
    buffer_load_dwordx4 a[136:139], v117, s[24:27], s63 offen offset:2048
    buffer_load_dwordx4 a[140:143], v117, s[24:27], s63 offen offset:3072
    s_add_u32 s63, s63, 4096
    buffer_load_dwordx4 a[144:147], v117, s[24:27], s63 offen offset:0
    buffer_load_dwordx4 a[148:151], v117, s[24:27], s63 offen offset:1024
    buffer_load_dwordx4 a[152:155], v117, s[24:27], s63 offen offset:2048
    buffer_load_dwordx4 a[156:159], v117, s[24:27], s63 offen offset:3072
    s_add_u32 s63, s63, 4096
    buffer_load_dwordx4 a[160:163], v117, s[24:27], s63 offen offset:0
    buffer_load_dwordx4 a[164:167], v117, s[24:27], s63 offen offset:1024
    buffer_load_dwordx4 a[168:171], v117, s[24:27], s63 offen offset:2048
    buffer_load_dwordx4 a[172:175], v117, s[24:27], s63 offen offset:3072
    s_add_u32 s63, s63, 4096
    buffer_load_dwordx4 a[176:179], v117, s[24:27], s63 offen offset:0
    buffer_load_dwordx4 a[180:183], v117, s[24:27], s63 offen offset:1024
    buffer_load_dwordx4 a[184:187], v117, s[24:27], s63 offen offset:2048
    buffer_load_dwordx4 a[188:191], v117, s[24:27], s63 offen offset:3072
    s_add_u32 s63, s63, 4096
    buffer_load_dwordx4 a[192:195], v117, s[24:27], s63 offen offset:0
    buffer_load_dwordx4 a[196:199], v117, s[24:27], s63 offen offset:1024
    buffer_load_dwordx4 a[200:203], v117, s[24:27], s63 offen offset:2048
    buffer_load_dwordx4 a[204:207], v117, s[24:27], s63 offen offset:3072
    s_add_u32 s63, s63, 4096
    buffer_load_dwordx4 a[208:211], v117, s[24:27], s63 offen offset:0
    buffer_load_dwordx4 a[212:215], v117, s[24:27], s63 offen offset:1024
    buffer_load_dwordx4 a[216:219], v117, s[24:27], s63 offen offset:2048
    buffer_load_dwordx4 a[220:223], v117, s[24:27], s63 offen offset:3072
    s_add_u32 s63, s63, 4096
    buffer_load_dwordx4 a[224:227], v117, s[24:27], s63 offen offset:0
    buffer_load_dwordx4 a[228:231], v117, s[24:27], s63 offen offset:1024
    buffer_load_dwordx4 a[232:235], v117, s[24:27], s63 offen offset:2048
    buffer_load_dwordx4 a[236:239], v117, s[24:27], s63 offen offset:3072
    s_add_u32 s63, s63, 4096
    buffer_load_dwordx4 a[240:243], v117, s[24:27], s63 offen offset:0
    buffer_load_dwordx4 a[244:247], v117, s[24:27], s63 offen offset:1024
    buffer_load_dwordx4 a[248:251], v117, s[24:27], s63 offen offset:2048
    buffer_load_dwordx4 a[252:255], v117, s[24:27], s63 offen offset:3072
    s_add_u32 s63, s63, 4096
    buffer_load_dwordx4 v[160:163], v117, s[24:27], s63 offen offset:0
    buffer_load_dwordx4 v[164:167], v117, s[24:27], s63 offen offset:1024
    buffer_load_dwordx4 v[168:171], v117, s[24:27], s63 offen offset:2048
    buffer_load_dwordx4 v[172:175], v117, s[24:27], s63 offen offset:3072
    s_add_u32 s63, s63, 4096
    buffer_load_dwordx4 v[176:179], v117, s[24:27], s63 offen offset:0
    buffer_load_dwordx4 v[180:183], v117, s[24:27], s63 offen offset:1024
    buffer_load_dwordx4 v[184:187], v117, s[24:27], s63 offen offset:2048
    buffer_load_dwordx4 v[188:191], v117, s[24:27], s63 offen offset:3072
    s_add_u32 s63, s63, 4096
    buffer_load_dwordx4 v[192:195], v117, s[24:27], s63 offen offset:0
    buffer_load_dwordx4 v[196:199], v117, s[24:27], s63 offen offset:1024
    buffer_load_dwordx4 v[200:203], v117, s[24:27], s63 offen offset:2048
    buffer_load_dwordx4 v[204:207], v117, s[24:27], s63 offen offset:3072
    s_add_u32 s63, s63, 4096
    buffer_load_dwordx4 v[208:211], v117, s[24:27], s63 offen offset:0
    buffer_load_dwordx4 v[212:215], v117, s[24:27], s63 offen offset:1024
    buffer_load_dwordx4 v[216:219], v117, s[24:27], s63 offen offset:2048
    buffer_load_dwordx4 v[220:223], v117, s[24:27], s63 offen offset:3072
    s_add_u32 s63, s63, 4096
    buffer_load_dwordx4 v[224:227], v117, s[24:27], s63 offen offset:0
    buffer_load_dwordx4 v[228:231], v117, s[24:27], s63 offen offset:1024
    buffer_load_dwordx4 v[232:235], v117, s[24:27], s63 offen offset:2048
    buffer_load_dwordx4 v[236:239], v117, s[24:27], s63 offen offset:3072
    s_add_u32 s63, s63, 4096
    buffer_load_dwordx4 v[240:243], v117, s[24:27], s63 offen offset:0
    buffer_load_dwordx4 v[244:247], v117, s[24:27], s63 offen offset:1024
    buffer_load_dwordx4 v[248:251], v117, s[24:27], s63 offen offset:2048
    buffer_load_dwordx4 v[252:255], v117, s[24:27], s63 offen offset:3072
    s_waitcnt vmcnt(0)
L_gudone_72:
    s_lshr_b32 s44, s29, 3
    v_and_b32 v3, 31, v1
    v_lshrrev_b32 v4, 5, v1
    v_bfe_u32 v5, v3, 1, 3
    s_lshl_b32 s40, s30, 14
    v_add_u32 v6, 0, v4
    v_xor_b32 v6, v6, v5
    v_lshlrev_b32 v6, 4, v6
    v_lshl_add_u32 v6, v3, 7, v6
    v_add_u32 v104, s40, v6
    v_add_u32 v6, 2, v4
    v_xor_b32 v6, v6, v5
    v_lshlrev_b32 v6, 4, v6
    v_lshl_add_u32 v6, v3, 7, v6
    v_add_u32 v105, s40, v6
    v_add_u32 v6, 4, v4
    v_xor_b32 v6, v6, v5
    v_lshlrev_b32 v6, 4, v6
    v_lshl_add_u32 v6, v3, 7, v6
    v_add_u32 v106, s40, v6
    v_add_u32 v6, 6, v4
    v_xor_b32 v6, v6, v5
    v_lshlrev_b32 v6, 4, v6
    v_lshl_add_u32 v6, v3, 7, v6
    v_add_u32 v107, s40, v6
    v_lshrrev_b32 v6, 3, v1
    v_and_b32 v7, 7, v1
    s_movk_i32 s41, 3712
    v_add_u32_e64 v8, 0, v6
    v_bfe_u32 v9, v8, 1, 3
    v_xor_b32_e64 v9, v9, v7
    v_mul_lo_u32 v8, v8, s41
    v_lshl_add_u32 v108, v9, 4, v8
    v_add_u32_e64 v8, 8, v6
    v_bfe_u32 v9, v8, 1, 3
    v_xor_b32_e64 v9, v9, v7
    v_mul_lo_u32 v8, v8, s41
    v_lshl_add_u32 v109, v9, 4, v8
    v_add_u32_e64 v8, 16, v6
    v_bfe_u32 v9, v8, 1, 3
    v_xor_b32_e64 v9, v9, v7
    v_mul_lo_u32 v8, v8, s41
    v_lshl_add_u32 v110, v9, 4, v8
    v_add_u32_e64 v8, 24, v6
    v_bfe_u32 v9, v8, 1, 3
    v_xor_b32_e64 v9, v9, v7
    v_mul_lo_u32 v8, v8, s41
    v_lshl_add_u32 v111, v9, 4, v8
    s_lshl_b32 s57, s28, 8
    s_lshl_b32 s41, s44, 5
    s_add_u32 s57, s57, s41
    s_mul_i32 s57, s57, 3712
    s_mul_i32 s41, s30, 896
    s_add_u32 s57, s57, s41
    s_add_u32 s57, s57, 13631488
    s_lshl_b32 s58, s30, 14
    s_lshl_b32 s41, s35, 7
    s_lshr_b32 s42, s30, 1
    s_lshl_b32 s42, s42, 6
    s_add_u32 s41, s41, s42
    s_and_b32 s42, s30, 1
    s_lshl_b32 s42, s42, 5
    s_add_u32 s41, s41, s42
    v_lshlrev_b32 v12, 4, v4
    v_add_u32 v12, s41, v12
    s_lshl_b32 s42, s28, 8
    s_lshl_b32 s43, s44, 5
    s_add_u32 s42, s42, s43
    v_add_u32_e64 v13, s42, v3
    s_movk_i32 s43, 1152
    v_mul_lo_u32 v13, v13, s43
    v_add_u32 v13, v13, v12
    v_mov_b32 v14, v13
    v_add_u32 v15, 147456, v13
    v_lshlrev_b32 v2, 3, v1
    v_add_u32 v2, s28, v2
    v_lshlrev_b32_e64 v2, 6, v2
    v_add_u32 v115, 98304, v2
    s_add_u32 s40, s32, 2
    s_mov_b32 exec_lo, -1
    s_mov_b32 exec_hi, 0
    s_mov_b32 s98, 0
    v_mov_b32 v2, 0
    v_mov_b32_e64 v3, 0
    s_nop 1
L_poll_90:
    buffer_load_dwordx2 v[2:3], v115, s[24:27], 0 offen sc1
    s_add_u32 s98, s98, 1
    s_cmp_gt_u32 s98, 0x40000
    s_cbranch_scc1 L_pd_91
    s_waitcnt vmcnt(0)
    v_subrev_u32_e64 v2, s40, v2
    v_cmp_gt_u32 vcc, 64, v2
    v_cmp_eq_u32 s[42:43], s33, v3
    s_nop 1
    s_and_b64 vcc, vcc, s[42:43]
    s_cmp_eq_u64 vcc, exec
    s_cbranch_scc1 L_pd_91
    s_sleep 8
    s_branch L_poll_90
L_pd_91:
    s_waitcnt vmcnt(0)
    s_mov_b64 exec, -1
    s_add_u32 m0, s58, 0
    s_nop 0
    buffer_load_dwordx4 v108, s[24:27], s57 offen lds
    s_add_u32 m0, s58, 1024
    s_nop 0
    buffer_load_dwordx4 v109, s[24:27], s57 offen lds
    s_add_u32 m0, s58, 2048
    s_nop 0
    buffer_load_dwordx4 v110, s[24:27], s57 offen lds
    s_add_u32 m0, s58, 3072
    s_nop 0
    buffer_load_dwordx4 v111, s[24:27], s57 offen lds
    s_add_u32 s57, s57, 128
    s_add_u32 m0, s58, 4096
    s_nop 0
    buffer_load_dwordx4 v108, s[24:27], s57 offen lds
    s_add_u32 m0, s58, 5120
    s_nop 0
    buffer_load_dwordx4 v109, s[24:27], s57 offen lds
    s_add_u32 m0, s58, 6144
    s_nop 0
    buffer_load_dwordx4 v110, s[24:27], s57 offen lds
    s_add_u32 m0, s58, 7168
    s_nop 0
    buffer_load_dwordx4 v111, s[24:27], s57 offen lds
    s_add_u32 s57, s57, 128
    s_add_u32 m0, s58, 8192
    s_nop 0
    buffer_load_dwordx4 v108, s[24:27], s57 offen lds
    s_add_u32 m0, s58, 9216
    s_nop 0
    buffer_load_dwordx4 v109, s[24:27], s57 offen lds
    s_add_u32 m0, s58, 10240
    s_nop 0
    buffer_load_dwordx4 v110, s[24:27], s57 offen lds
    s_add_u32 m0, s58, 11264
    s_nop 0
    buffer_load_dwordx4 v111, s[24:27], s57 offen lds
    s_add_u32 s57, s57, 128
    s_mov_b32 s47, 5242880
    buffer_load_dwordx4 v[96:99], v13, s[24:27], s47 offen
    v_add_u32 v13, 147456, v13
    buffer_load_dwordx4 v[100:103], v13, s[24:27], s47 offen
    s_mov_b32 s46, 7864320
    buffer_load_dword v116, v14, s[24:27], s46 offen
    buffer_load_dword v117, v15, s[24:27], s46 offen
    s_getpc_b64 s[42:43]
L_pc_93:
    s_lshl_b32 s40, s29, 2
    s_add_u32 s40, s40, s30
    s_lshl_b32 s40, s40, 10
    v_lshlrev_b32 v2, 4, v1
    v_add_u32_e64 v2, s40, v2
    v_min_u32 v2, 24560, v2
    v_add_u32 v2, 4096, v2
    v_min_u32 v2, L_code_end-L_pc_93-16, v2
    global_load_dwordx4 v[120:123], v2, s[42:43]
    s_waitcnt vmcnt(13)
    ds_read_b128 v[80:83], v104 offset:0
    ds_read_b128 v[84:87], v105 offset:0
    s_waitcnt lgkmcnt(1)
    v_mfma_f32_32x32x16_bf16 v[16:31], a[128:131], v[80:83], 0
    ds_read_b128 v[88:91], v106 offset:0
    v_mfma_f32_32x32x16_bf16 v[32:47], a[132:135], v[80:83], 0
    s_add_u32 m0, s58, 12288
    s_nop 0
    buffer_load_dwordx4 v108, s[24:27], s57 offen lds
    s_waitcnt lgkmcnt(1)
    v_mfma_f32_32x32x16_bf16 v[16:31], a[136:139], v[84:87], v[16:31]
    ds_read_b128 v[92:95], v107 offset:0
    v_mfma_f32_32x32x16_bf16 v[32:47], a[140:143], v[84:87], v[32:47]
    s_add_u32 m0, s58, 13312
    s_nop 0
    buffer_load_dwordx4 v109, s[24:27], s57 offen lds
    s_waitcnt vmcnt(11)
    s_waitcnt lgkmcnt(1)
    v_mfma_f32_32x32x16_bf16 v[16:31], a[144:147], v[88:91], v[16:31]
    ds_read_b128 v[80:83], v104 offset:4096
    v_mfma_f32_32x32x16_bf16 v[32:47], a[148:151], v[88:91], v[32:47]
    s_add_u32 m0, s58, 14336
    s_nop 0
    buffer_load_dwordx4 v110, s[24:27], s57 offen lds
    s_waitcnt lgkmcnt(1)
    v_mfma_f32_32x32x16_bf16 v[16:31], a[152:155], v[92:95], v[16:31]
    ds_read_b128 v[84:87], v105 offset:4096
    v_mfma_f32_32x32x16_bf16 v[32:47], a[156:159], v[92:95], v[32:47]
    s_add_u32 m0, s58, 15360
    s_nop 0
    buffer_load_dwordx4 v111, s[24:27], s57 offen lds
    s_add_u32 s57, s57, 128
    s_waitcnt lgkmcnt(1)
    v_mfma_f32_32x32x16_bf16 v[16:31], a[160:163], v[80:83], v[16:31]
    ds_read_b128 v[88:91], v106 offset:4096
    v_mfma_f32_32x32x16_bf16 v[32:47], a[164:167], v[80:83], v[32:47]
    s_add_u32 m0, s58, 0
    s_nop 0
    buffer_load_dwordx4 v108, s[24:27], s57 offen lds
    s_waitcnt lgkmcnt(1)
    v_mfma_f32_32x32x16_bf16 v[16:31], a[168:171], v[84:87], v[16:31]
    ds_read_b128 v[92:95], v107 offset:4096
    v_mfma_f32_32x32x16_bf16 v[32:47], a[172:175], v[84:87], v[32:47]
    s_add_u32 m0, s58, 1024
    s_nop 0
    buffer_load_dwordx4 v109, s[24:27], s57 offen lds
    s_waitcnt vmcnt(11)
    s_waitcnt lgkmcnt(1)
    v_mfma_f32_32x32x16_bf16 v[16:31], a[176:179], v[88:91], v[16:31]
    ds_read_b128 v[80:83], v104 offset:8192
    v_mfma_f32_32x32x16_bf16 v[32:47], a[180:183], v[88:91], v[32:47]
    s_add_u32 m0, s58, 2048
    s_nop 0
    buffer_load_dwordx4 v110, s[24:27], s57 offen lds
    s_waitcnt lgkmcnt(1)
    v_mfma_f32_32x32x16_bf16 v[16:31], a[184:187], v[92:95], v[16:31]
    ds_read_b128 v[84:87], v105 offset:8192
    v_mfma_f32_32x32x16_bf16 v[32:47], a[188:191], v[92:95], v[32:47]
    s_add_u32 m0, s58, 3072
    s_nop 0
    buffer_load_dwordx4 v111, s[24:27], s57 offen lds
    s_add_u32 s57, s57, 128
    s_waitcnt lgkmcnt(1)
    v_mfma_f32_32x32x16_bf16 v[16:31], a[192:195], v[80:83], v[16:31]
    ds_read_b128 v[88:91], v106 offset:8192
    v_mfma_f32_32x32x16_bf16 v[32:47], a[196:199], v[80:83], v[32:47]
    s_add_u32 m0, s58, 4096
    s_nop 0
    buffer_load_dwordx4 v108, s[24:27], s57 offen lds
    s_waitcnt lgkmcnt(1)
    v_mfma_f32_32x32x16_bf16 v[16:31], a[200:203], v[84:87], v[16:31]
    ds_read_b128 v[92:95], v107 offset:8192
    v_mfma_f32_32x32x16_bf16 v[32:47], a[204:207], v[84:87], v[32:47]
    s_add_u32 m0, s58, 5120
    s_nop 0
    buffer_load_dwordx4 v109, s[24:27], s57 offen lds
    s_waitcnt vmcnt(6)
    s_waitcnt lgkmcnt(1)
    v_mfma_f32_32x32x16_bf16 v[16:31], a[208:211], v[88:91], v[16:31]
    ds_read_b128 v[80:83], v104 offset:12288
    v_mfma_f32_32x32x16_bf16 v[32:47], a[212:215], v[88:91], v[32:47]
    s_add_u32 m0, s58, 6144
    s_nop 0
    buffer_load_dwordx4 v110, s[24:27], s57 offen lds
    s_waitcnt lgkmcnt(1)
    v_mfma_f32_32x32x16_bf16 v[16:31], a[216:219], v[92:95], v[16:31]
    ds_read_b128 v[84:87], v105 offset:12288
    v_mfma_f32_32x32x16_bf16 v[32:47], a[220:223], v[92:95], v[32:47]
    s_add_u32 m0, s58, 7168
    s_nop 0
    buffer_load_dwordx4 v111, s[24:27], s57 offen lds
    s_add_u32 s57, s57, 128
    s_waitcnt lgkmcnt(1)
    v_mfma_f32_32x32x16_bf16 v[16:31], a[224:227], v[80:83], v[16:31]
    ds_read_b128 v[88:91], v106 offset:12288
    v_mfma_f32_32x32x16_bf16 v[32:47], a[228:231], v[80:83], v[32:47]
    s_add_u32 m0, s58, 8192
    s_nop 0
    buffer_load_dwordx4 v108, s[24:27], s57 offen lds
    s_waitcnt lgkmcnt(1)
    v_mfma_f32_32x32x16_bf16 v[16:31], a[232:235], v[84:87], v[16:31]
    ds_read_b128 v[92:95], v107 offset:12288
    v_mfma_f32_32x32x16_bf16 v[32:47], a[236:239], v[84:87], v[32:47]
    s_add_u32 m0, s58, 9216
    s_nop 0
    buffer_load_dwordx4 v109, s[24:27], s57 offen lds
    s_waitcnt vmcnt(6)
    s_waitcnt lgkmcnt(1)
    v_mfma_f32_32x32x16_bf16 v[16:31], a[240:243], v[88:91], v[16:31]
    ds_read_b128 v[80:83], v104 offset:0
    v_mfma_f32_32x32x16_bf16 v[32:47], a[244:247], v[88:91], v[32:47]
    s_add_u32 m0, s58, 10240
    s_nop 0
    buffer_load_dwordx4 v110, s[24:27], s57 offen lds
    s_waitcnt lgkmcnt(1)
    v_mfma_f32_32x32x16_bf16 v[16:31], a[248:251], v[92:95], v[16:31]
    ds_read_b128 v[84:87], v105 offset:0
    v_mfma_f32_32x32x16_bf16 v[32:47], a[252:255], v[92:95], v[32:47]
    s_add_u32 m0, s58, 11264
    s_nop 0
    buffer_load_dwordx4 v111, s[24:27], s57 offen lds
    s_add_u32 s57, s57, 474368
    s_waitcnt lgkmcnt(1)
    v_mfma_f32_32x32x16_bf16 v[16:31], v[160:163], v[80:83], v[16:31]
    ds_read_b128 v[88:91], v106 offset:0
    v_mfma_f32_32x32x16_bf16 v[32:47], v[164:167], v[80:83], v[32:47]
    s_add_u32 s40, s32, 3
    s_mov_b32 exec_lo, -1
    s_mov_b32 exec_hi, 0
    s_mov_b32 s98, 0
    v_mov_b32 v2, 0
    v_mov_b32 v3, 0
    s_nop 5
L_poll_94:
    buffer_load_dwordx2 v[2:3], v115, s[24:27], 0 offen sc1
    s_add_u32 s98, s98, 1
    s_cmp_gt_u32 s98, 0x40000
    s_cbranch_scc1 L_pd_95
    s_waitcnt vmcnt(0)
    v_subrev_u32_e64 v2, s40, v2
    v_cmp_gt_u32 vcc, 64, v2
    v_cmp_eq_u32 s[42:43], s33, v3
    s_nop 1
    s_and_b64 vcc, vcc, s[42:43]
    s_cmp_eq_u64 vcc, exec
    s_cbranch_scc0 L_poll_94
L_pd_95:
    s_waitcnt vmcnt(0)
    s_mov_b64 exec, -1
    s_add_u32 m0, s58, 12288
    s_nop 0
    buffer_load_dwordx4 v108, s[24:27], s57 offen lds
    s_waitcnt lgkmcnt(1)
    v_mfma_f32_32x32x16_bf16 v[16:31], v[168:171], v[84:87], v[16:31]
    ds_read_b128 v[92:95], v107 offset:0
    v_mfma_f32_32x32x16_bf16 v[32:47], v[172:175], v[84:87], v[32:47]
    s_add_u32 m0, s58, 13312
    s_nop 0
    buffer_load_dwordx4 v109, s[24:27], s57 offen lds
    s_waitcnt lgkmcnt(1)
    v_mfma_f32_32x32x16_bf16 v[16:31], v[176:179], v[88:91], v[16:31]
    ds_read_b128 v[80:83], v104 offset:4096
    v_mfma_f32_32x32x16_bf16 v[32:47], v[180:183], v[88:91], v[32:47]
    s_add_u32 m0, s58, 14336
    s_nop 0
    buffer_load_dwordx4 v110, s[24:27], s57 offen lds
    s_waitcnt lgkmcnt(1)
    v_mfma_f32_32x32x16_bf16 v[16:31], v[184:187], v[92:95], v[16:31]
    ds_read_b128 v[84:87], v105 offset:4096
    v_mfma_f32_32x32x16_bf16 v[32:47], v[188:191], v[92:95], v[32:47]
    s_add_u32 m0, s58, 15360
    s_nop 0
    buffer_load_dwordx4 v111, s[24:27], s57 offen lds
    s_add_u32 s57, s57, 128
    s_waitcnt lgkmcnt(1)
    v_mfma_f32_32x32x16_bf16 v[16:31], v[192:195], v[80:83], v[16:31]
    ds_read_b128 v[88:91], v106 offset:4096
    v_mfma_f32_32x32x16_bf16 v[32:47], v[196:199], v[80:83], v[32:47]
    s_add_u32 m0, s58, 0
    s_nop 0
    buffer_load_dwordx4 v108, s[24:27], s57 offen lds
    s_waitcnt lgkmcnt(1)
    v_mfma_f32_32x32x16_bf16 v[16:31], v[200:203], v[84:87], v[16:31]
    ds_read_b128 v[92:95], v107 offset:4096
    v_mfma_f32_32x32x16_bf16 v[32:47], v[204:207], v[84:87], v[32:47]
    s_add_u32 m0, s58, 1024
    s_nop 0
    buffer_load_dwordx4 v109, s[24:27], s57 offen lds
    s_waitcnt lgkmcnt(1)
    v_mfma_f32_32x32x16_bf16 v[16:31], v[208:211], v[88:91], v[16:31]
    ds_read_b128 v[80:83], v104 offset:8192
    v_mfma_f32_32x32x16_bf16 v[32:47], v[212:215], v[88:91], v[32:47]
    s_add_u32 m0, s58, 2048
    s_nop 0
    buffer_load_dwordx4 v110, s[24:27], s57 offen lds
    s_waitcnt lgkmcnt(1)
    v_mfma_f32_32x32x16_bf16 v[16:31], v[216:219], v[92:95], v[16:31]
    ds_read_b128 v[84:87], v105 offset:8192
    v_mfma_f32_32x32x16_bf16 v[32:47], v[220:223], v[92:95], v[32:47]
    s_add_u32 m0, s58, 3072
    s_nop 0
    buffer_load_dwordx4 v111, s[24:27], s57 offen lds
    s_add_u32 s57, s57, 128
    s_waitcnt lgkmcnt(1)
    v_mfma_f32_32x32x16_bf16 v[16:31], v[224:227], v[80:83], v[16:31]
    ds_read_b128 v[88:91], v106 offset:8192
    v_mfma_f32_32x32x16_bf16 v[32:47], v[228:231], v[80:83], v[32:47]
    s_add_u32 m0, s58, 4096
    s_nop 0
    buffer_load_dwordx4 v108, s[24:27], s57 offen lds
    s_waitcnt lgkmcnt(1)
    v_mfma_f32_32x32x16_bf16 v[16:31], v[232:235], v[84:87], v[16:31]
    ds_read_b128 v[92:95], v107 offset:8192
    v_mfma_f32_32x32x16_bf16 v[32:47], v[236:239], v[84:87], v[32:47]
    s_add_u32 m0, s58, 5120
    s_nop 0
    buffer_load_dwordx4 v109, s[24:27], s57 offen lds
    s_waitcnt vmcnt(6)
    s_waitcnt lgkmcnt(1)
    v_mfma_f32_32x32x16_bf16 v[16:31], v[240:243], v[88:91], v[16:31]
    ds_read_b128 v[80:83], v104 offset:12288
    v_mfma_f32_32x32x16_bf16 v[32:47], v[244:247], v[88:91], v[32:47]
    s_add_u32 m0, s58, 6144
    s_nop 0
    buffer_load_dwordx4 v110, s[24:27], s57 offen lds
    s_waitcnt lgkmcnt(1)
    v_mfma_f32_32x32x16_bf16 v[16:31], v[248:251], v[92:95], v[16:31]
    ds_read_b128 v[84:87], v105 offset:12288
    v_mfma_f32_32x32x16_bf16 v[32:47], v[252:255], v[92:95], v[32:47]
    s_add_u32 m0, s58, 7168
    s_nop 0
    buffer_load_dwordx4 v111, s[24:27], s57 offen lds
    s_add_u32 s57, s57, 128
    s_waitcnt lgkmcnt(1)
    v_mfma_f32_32x32x16_bf16 v[48:63], a[128:131], v[80:83], 0
    ds_read_b128 v[88:91], v106 offset:12288
    v_mfma_f32_32x32x16_bf16 v[64:79], a[132:135], v[80:83], 0
    s_add_u32 m0, s58, 8192
    s_nop 0
    buffer_load_dwordx4 v108, s[24:27], s57 offen lds
    s_waitcnt lgkmcnt(1)
    v_mfma_f32_32x32x16_bf16 v[48:63], a[136:139], v[84:87], v[48:63]
    ds_read_b128 v[92:95], v107 offset:12288
    v_mfma_f32_32x32x16_bf16 v[64:79], a[140:143], v[84:87], v[64:79]
    s_add_u32 m0, s58, 9216
    s_nop 0
    buffer_load_dwordx4 v109, s[24:27], s57 offen lds
    s_waitcnt vmcnt(6)
    s_waitcnt lgkmcnt(1)
    v_mfma_f32_32x32x16_bf16 v[48:63], a[144:147], v[88:91], v[48:63]
    ds_read_b128 v[80:83], v104 offset:0
    v_mfma_f32_32x32x16_bf16 v[64:79], a[148:151], v[88:91], v[64:79]
    s_add_u32 m0, s58, 10240
    s_nop 0
    buffer_load_dwordx4 v110, s[24:27], s57 offen lds
    s_waitcnt lgkmcnt(1)
    v_mfma_f32_32x32x16_bf16 v[48:63], a[152:155], v[92:95], v[48:63]
    ds_read_b128 v[84:87], v105 offset:0
    v_mfma_f32_32x32x16_bf16 v[64:79], a[156:159], v[92:95], v[64:79]
    s_add_u32 m0, s58, 11264
    s_nop 0
    buffer_load_dwordx4 v111, s[24:27], s57 offen lds
    s_add_u32 s57, s57, 128
    s_waitcnt lgkmcnt(1)
    v_mfma_f32_32x32x16_bf16 v[48:63], a[160:163], v[80:83], v[48:63]
    ds_read_b128 v[88:91], v106 offset:0
    v_mfma_f32_32x32x16_bf16 v[64:79], a[164:167], v[80:83], v[64:79]
    s_add_u32 m0, s58, 12288
    s_nop 0
    buffer_load_dwordx4 v108, s[24:27], s57 offen lds
    s_waitcnt lgkmcnt(1)
    v_mfma_f32_32x32x16_bf16 v[48:63], a[168:171], v[84:87], v[48:63]
    ds_read_b128 v[92:95], v107 offset:0
    v_mfma_f32_32x32x16_bf16 v[64:79], a[172:175], v[84:87], v[64:79]
    s_add_u32 m0, s58, 13312
    s_nop 0
    buffer_load_dwordx4 v109, s[24:27], s57 offen lds
    s_waitcnt vmcnt(6)
    s_waitcnt lgkmcnt(1)
    v_mfma_f32_32x32x16_bf16 v[48:63], a[176:179], v[88:91], v[48:63]
    ds_read_b128 v[80:83], v104 offset:4096
    v_mfma_f32_32x32x16_bf16 v[64:79], a[180:183], v[88:91], v[64:79]
    s_add_u32 m0, s58, 14336
    s_nop 0
    buffer_load_dwordx4 v110, s[24:27], s57 offen lds
    s_waitcnt lgkmcnt(1)
    v_mfma_f32_32x32x16_bf16 v[48:63], a[184:187], v[92:95], v[48:63]
    ds_read_b128 v[84:87], v105 offset:4096
    v_mfma_f32_32x32x16_bf16 v[64:79], a[188:191], v[92:95], v[64:79]
    s_add_u32 m0, s58, 15360
    s_nop 0
    buffer_load_dwordx4 v111, s[24:27], s57 offen lds
    s_add_u32 s57, s57, 128
    s_waitcnt lgkmcnt(1)
    v_mfma_f32_32x32x16_bf16 v[48:63], a[192:195], v[80:83], v[48:63]
    ds_read_b128 v[88:91], v106 offset:4096
    v_mfma_f32_32x32x16_bf16 v[64:79], a[196:199], v[80:83], v[64:79]
    s_add_u32 m0, s58, 0
    s_nop 0
    buffer_load_dwordx4 v108, s[24:27], s57 offen lds
    s_waitcnt lgkmcnt(1)
    v_mfma_f32_32x32x16_bf16 v[48:63], a[200:203], v[84:87], v[48:63]
    ds_read_b128 v[92:95], v107 offset:4096
    v_mfma_f32_32x32x16_bf16 v[64:79], a[204:207], v[84:87], v[64:79]
    s_add_u32 m0, s58, 1024
    s_nop 0
    buffer_load_dwordx4 v109, s[24:27], s57 offen lds
    s_waitcnt vmcnt(6)
    s_waitcnt lgkmcnt(1)
    v_mfma_f32_32x32x16_bf16 v[48:63], a[208:211], v[88:91], v[48:63]
    ds_read_b128 v[80:83], v104 offset:8192
    v_mfma_f32_32x32x16_bf16 v[64:79], a[212:215], v[88:91], v[64:79]
    s_add_u32 m0, s58, 2048
    s_nop 0
    buffer_load_dwordx4 v110, s[24:27], s57 offen lds
    s_waitcnt lgkmcnt(1)
    v_mfma_f32_32x32x16_bf16 v[48:63], a[216:219], v[92:95], v[48:63]
    ds_read_b128 v[84:87], v105 offset:8192
    v_mfma_f32_32x32x16_bf16 v[64:79], a[220:223], v[92:95], v[64:79]
    s_add_u32 m0, s58, 3072
    s_nop 0
    buffer_load_dwordx4 v111, s[24:27], s57 offen lds
    s_add_u32 s57, s57, 128
    s_waitcnt lgkmcnt(1)
    v_mfma_f32_32x32x16_bf16 v[48:63], a[224:227], v[80:83], v[48:63]
    ds_read_b128 v[88:91], v106 offset:8192
    v_mfma_f32_32x32x16_bf16 v[64:79], a[228:231], v[80:83], v[64:79]
    s_add_u32 m0, s58, 4096
    s_nop 0
    buffer_load_dwordx4 v108, s[24:27], s57 offen lds
    s_waitcnt lgkmcnt(1)
    v_mfma_f32_32x32x16_bf16 v[48:63], a[232:235], v[84:87], v[48:63]
    ds_read_b128 v[92:95], v107 offset:8192
    v_mfma_f32_32x32x16_bf16 v[64:79], a[236:239], v[84:87], v[64:79]
    s_add_u32 m0, s58, 5120
    s_nop 0
    buffer_load_dwordx4 v109, s[24:27], s57 offen lds
    s_waitcnt vmcnt(6)
    s_waitcnt lgkmcnt(1)
    v_mfma_f32_32x32x16_bf16 v[48:63], a[240:243], v[88:91], v[48:63]
    ds_read_b128 v[80:83], v104 offset:12288
    v_mfma_f32_32x32x16_bf16 v[64:79], a[244:247], v[88:91], v[64:79]
    s_add_u32 m0, s58, 6144
    s_nop 0
    buffer_load_dwordx4 v110, s[24:27], s57 offen lds
    s_waitcnt lgkmcnt(1)
    v_mfma_f32_32x32x16_bf16 v[48:63], a[248:251], v[92:95], v[48:63]
    ds_read_b128 v[84:87], v105 offset:12288
    v_mfma_f32_32x32x16_bf16 v[64:79], a[252:255], v[92:95], v[64:79]
    s_add_u32 m0, s58, 7168
    s_nop 0
    buffer_load_dwordx4 v111, s[24:27], s57 offen lds
    s_add_u32 s57, s57, 128
    s_waitcnt lgkmcnt(1)
    v_mfma_f32_32x32x16_bf16 v[48:63], v[160:163], v[80:83], v[48:63]
    ds_read_b128 v[88:91], v106 offset:12288
    v_mfma_f32_32x32x16_bf16 v[64:79], v[164:167], v[80:83], v[64:79]
    s_waitcnt lgkmcnt(1)
    v_mfma_f32_32x32x16_bf16 v[48:63], v[168:171], v[84:87], v[48:63]
    ds_read_b128 v[92:95], v107 offset:12288
    v_mfma_f32_32x32x16_bf16 v[64:79], v[172:175], v[84:87], v[64:79]
    s_waitcnt vmcnt(4)
    s_waitcnt lgkmcnt(1)
    v_mfma_f32_32x32x16_bf16 v[48:63], v[176:179], v[88:91], v[48:63]
    ds_read_b128 v[80:83], v104 offset:0
    v_mfma_f32_32x32x16_bf16 v[64:79], v[180:183], v[88:91], v[64:79]
    s_waitcnt lgkmcnt(1)
    v_mfma_f32_32x32x16_bf16 v[48:63], v[184:187], v[92:95], v[48:63]
    ds_read_b128 v[84:87], v105 offset:0
    v_mfma_f32_32x32x16_bf16 v[64:79], v[188:191], v[92:95], v[64:79]
    s_waitcnt lgkmcnt(1)
    v_mfma_f32_32x32x16_bf16 v[48:63], v[192:195], v[80:83], v[48:63]
    ds_read_b128 v[88:91], v106 offset:0
    v_mfma_f32_32x32x16_bf16 v[64:79], v[196:199], v[80:83], v[64:79]
    s_waitcnt lgkmcnt(1)
    v_mfma_f32_32x32x16_bf16 v[48:63], v[200:203], v[84:87], v[48:63]
    ds_read_b128 v[92:95], v107 offset:0
    v_mfma_f32_32x32x16_bf16 v[64:79], v[204:207], v[84:87], v[64:79]
    s_waitcnt vmcnt(0)
    s_waitcnt lgkmcnt(1)
    v_mfma_f32_32x32x16_bf16 v[48:63], v[208:211], v[88:91], v[48:63]
    ds_read_b128 v[80:83], v104 offset:4096
    v_mfma_f32_32x32x16_bf16 v[64:79], v[212:215], v[88:91], v[64:79]
    s_waitcnt lgkmcnt(1)
    v_mfma_f32_32x32x16_bf16 v[48:63], v[216:219], v[92:95], v[48:63]
    ds_read_b128 v[84:87], v105 offset:4096
    v_mfma_f32_32x32x16_bf16 v[64:79], v[220:223], v[92:95], v[64:79]
    s_waitcnt lgkmcnt(1)
    v_mfma_f32_32x32x16_bf16 v[48:63], v[224:227], v[80:83], v[48:63]
    ds_read_b128 v[88:91], v106 offset:4096
    v_mfma_f32_32x32x16_bf16 v[64:79], v[228:231], v[80:83], v[64:79]
    s_waitcnt lgkmcnt(1)
    v_mfma_f32_32x32x16_bf16 v[48:63], v[232:235], v[84:87], v[48:63]
    ds_read_b128 v[92:95], v107 offset:4096
    v_mfma_f32_32x32x16_bf16 v[64:79], v[236:239], v[84:87], v[64:79]
    s_waitcnt lgkmcnt(1)
    v_mfma_f32_32x32x16_bf16 v[48:63], v[240:243], v[88:91], v[48:63]
    v_mfma_f32_32x32x16_bf16 v[64:79], v[244:247], v[88:91], v[64:79]
    s_waitcnt lgkmcnt(0)
    v_mfma_f32_32x32x16_bf16 v[48:63], v[248:251], v[92:95], v[48:63]
    v_mfma_f32_32x32x16_bf16 v[64:79], v[252:255], v[92:95], v[64:79]
    v_lshlrev_b32 v2, 4, v1
    s_lshl_b32 s40, s35, 15
    s_lshl_b32 s41, s30, 13
    s_add_u32 s40, s40, s41
    s_add_u32 s40, s40, 524288
    s_add_u32 s41, s41, 131072
    s_add_u32 m0, s41, 0
    s_nop 0
    buffer_load_dwordx4 v2, s[24:27], s40 offen offset:0 lds
    buffer_load_dwordx4 v2, s[24:27], s40 offen offset:1024 lds
    buffer_load_dwordx4 v2, s[24:27], s40 offen offset:2048 lds
    buffer_load_dwordx4 v2, s[24:27], s40 offen offset:3072 lds
    s_add_u32 m0, s41, 4096
    s_add_u32 s40, s40, 4096
    buffer_load_dwordx4 v2, s[24:27], s40 offen offset:0 lds
    buffer_load_dwordx4 v2, s[24:27], s40 offen offset:1024 lds
    buffer_load_dwordx4 v2, s[24:27], s40 offen offset:2048 lds
    buffer_load_dwordx4 v2, s[24:27], s40 offen offset:3072 lds
    v_lshlrev_b32 v2, 4, v1
    s_lshl_b32 s40, s30, 14
    v_add_u32_e64 v3, s40, v2
    ds_write_b128 v3, v[16:19] offset:0
    ds_write_b128 v3, v[20:23] offset:1024
    ds_write_b128 v3, v[24:27] offset:2048
    ds_write_b128 v3, v[28:31] offset:3072
    ds_write_b128 v3, v[32:35] offset:4096
    ds_write_b128 v3, v[36:39] offset:5120
    ds_write_b128 v3, v[40:43] offset:6144
    ds_write_b128 v3, v[44:47] offset:7168
    ds_write_b128 v3, v[48:51] offset:8192
    ds_write_b128 v3, v[52:55] offset:9216
    ds_write_b128 v3, v[56:59] offset:10240
    ds_write_b128 v3, v[60:63] offset:11264
    ds_write_b128 v3, v[64:67] offset:12288
    ds_write_b128 v3, v[68:71] offset:13312
    ds_write_b128 v3, v[72:75] offset:14336
    ds_write_b128 v3, v[76:79] offset:15360
    s_waitcnt lgkmcnt(0)
    s_barrier
    s_lshl_b32 s40, s30, 11
    v_add_u32 v3, s40, v2
    ds_read_b128 v[16:19], v3 offset:0
    ds_read_b128 v[20:23], v3 offset:1024
    ds_read_b128 v[24:27], v3 offset:16384
    ds_read_b128 v[28:31], v3 offset:17408
    ds_read_b128 v[32:35], v3 offset:32768
    ds_read_b128 v[36:39], v3 offset:33792
    ds_read_b128 v[40:43], v3 offset:49152
    ds_read_b128 v[44:47], v3 offset:50176
    ds_read_b128 v[48:51], v3 offset:8192
    ds_read_b128 v[52:55], v3 offset:9216
    ds_read_b128 v[56:59], v3 offset:24576
    ds_read_b128 v[60:63], v3 offset:25600
    ds_read_b128 v[64:67], v3 offset:40960
    ds_read_b128 v[68:71], v3 offset:41984
    ds_read_b128 v[72:75], v3 offset:57344
    ds_read_b128 v[76:79], v3 offset:58368
    s_mov_b32 s54, 0xffff0000
    s_waitcnt lgkmcnt(13)
    v_add_f32 v16, v16, v24
    v_add_f32 v17, v17, v25
    v_add_f32 v18, v18, v26
    v_add_f32 v19, v19, v27
    s_waitcnt lgkmcnt(12)
    v_add_f32 v20, v20, v28
    v_add_f32 v21, v21, v29
    v_add_f32 v22, v22, v30
    v_add_f32 v23, v23, v31
    s_waitcnt lgkmcnt(9)
    v_add_f32 v32, v32, v40
    v_add_f32 v33, v33, v41
    v_add_f32 v34, v34, v42
    v_add_f32 v35, v35, v43
    s_waitcnt lgkmcnt(8)
    v_add_f32 v36, v36, v44
    v_add_f32 v37, v37, v45
    v_add_f32 v38, v38, v46
    v_add_f32 v39, v39, v47
    v_add_f32 v16, v16, v32
    v_add_f32 v17, v17, v33
    v_add_f32 v18, v18, v34
    v_add_f32 v19, v19, v35
    v_add_f32 v20, v20, v36
    v_add_f32 v21, v21, v37
    v_add_f32 v22, v22, v38
    v_add_f32 v23, v23, v39
    v_lshlrev_b32 v24, 16, v96
    v_and_b32 v25, s54, v96
    v_lshlrev_b32 v26, 16, v97
    v_and_b32 v27, s54, v97
    v_lshlrev_b32 v28, 16, v98
    v_and_b32 v29, s54, v98
    v_lshlrev_b32 v30, 16, v99
    v_and_b32 v31, s54, v99
    v_add_f32 v16, v16, v24
    v_add_f32 v17, v17, v25
    v_add_f32 v18, v18, v26
    v_add_f32 v19, v19, v27
    v_add_f32 v20, v20, v28
    v_add_f32 v21, v21, v29
    v_add_f32 v22, v22, v30
    v_add_f32 v23, v23, v31
    v_cvt_pk_bf16_f32 v32, v16, v17
    v_cvt_pk_bf16_f32 v33, v18, v19
    v_cvt_pk_bf16_f32 v34, v20, v21
    v_cvt_pk_bf16_f32 v35, v22, v23
    s_mov_b32 s46, 7864320
    buffer_store_dwordx4 v[32:35], v14, s[24:27], s46 offen sc1
    s_waitcnt lgkmcnt(5)
    v_add_f32 v48, v48, v56
    v_add_f32 v49, v49, v57
    v_add_f32 v50, v50, v58
    v_add_f32 v51, v51, v59
    s_waitcnt lgkmcnt(4)
    v_add_f32 v52, v52, v60
    v_add_f32 v53, v53, v61
    v_add_f32 v54, v54, v62
    v_add_f32 v55, v55, v63
    s_waitcnt lgkmcnt(1)
    v_add_f32 v64, v64, v72
    v_add_f32 v65, v65, v73
    v_add_f32 v66, v66, v74
    v_add_f32 v67, v67, v75
    s_waitcnt lgkmcnt(0)
    v_add_f32 v68, v68, v76
    v_add_f32 v69, v69, v77
    v_add_f32 v70, v70, v78
    v_add_f32 v71, v71, v79
    v_add_f32 v48, v48, v64
    v_add_f32 v49, v49, v65
    v_add_f32 v50, v50, v66
    v_add_f32 v51, v51, v67
    v_add_f32 v52, v52, v68
    v_add_f32 v53, v53, v69
    v_add_f32 v54, v54, v70
    v_add_f32 v55, v55, v71
    v_lshlrev_b32 v56, 16, v100
    v_and_b32 v57, s54, v100
    v_lshlrev_b32 v58, 16, v101
    v_and_b32 v59, s54, v101
    v_lshlrev_b32 v60, 16, v102
    v_and_b32 v61, s54, v102
    v_lshlrev_b32 v62, 16, v103
    v_and_b32 v63, s54, v103
    v_add_f32 v48, v48, v56
    v_add_f32 v49, v49, v57
    v_add_f32 v50, v50, v58
    v_add_f32 v51, v51, v59
    v_add_f32 v52, v52, v60
    v_add_f32 v53, v53, v61
    v_add_f32 v54, v54, v62
    v_add_f32 v55, v55, v63
    v_cvt_pk_bf16_f32 v64, v48, v49
    v_cvt_pk_bf16_f32 v65, v50, v51
    v_cvt_pk_bf16_f32 v66, v52, v53
    v_cvt_pk_bf16_f32 v67, v54, v55
    s_mov_b32 s46, 7864320
    buffer_store_dwordx4 v[64:67], v15, s[24:27], s46 offen sc1
    s_waitcnt vmcnt(0)
    s_barrier
    s_cmp_lg_u32 s30, 0
    s_cbranch_scc1 L_fs_97
    s_add_u32 s40, s32, 4
    v_mov_b32 v2, s40
    v_mov_b32 v3, s33
    s_lshl_b32 s41, s2, 6
    s_add_u32 s41, s41, 98304
    v_mov_b32 v4, s41
    s_mov_b64 exec, 1
    buffer_store_dwordx2 v[2:3], v4, s[24:27], 0 offen sc1
    s_mov_b64 exec, -1
L_fs_97:
    v_and_b32 v2, 15, v1
    v_lshrrev_b32 v3, 4, v1
    v_cvt_f32_u32 v2, v2
    s_lshl_b32 s40, s36, 2
    s_add_u32 s40, s40, s30
    s_lshl_b32 s40, s40, 4
    s_add_u32 s40, s40, s37
    v_lshlrev_b32 v3, 9, v3
    v_add_u32 v3, s40, v3
    v_cvt_f32_u32_e64 v3, v3
    v_mul_f32 v3, 0x3a000000, v3
    v_mul_f32_e64 v4, v2, v3
    v_mul_f32 v5, 0x3d800000, v2
    v_fract_f32 v8, v4
    v_add_f32 v4, v4, v5
    v_fract_f32 v9, v4
    v_add_f32 v4, v4, v5
    v_fract_f32 v10, v4
    v_add_f32 v4, v4, v5
    v_fract_f32 v11, v4
    v_cos_f32 v12, v8
    v_cos_f32 v13, v9
    v_cos_f32 v14, v10
    v_cos_f32 v15, v11
    v_sin_f32 v8, v8
    v_sin_f32 v9, v9
    v_sin_f32 v10, v10
    v_sin_f32_e64 v11, v11
    v_cvt_pk_bf16_f32 v136, v12, v13
    v_cvt_pk_bf16_f32 v137, v14, v15
    v_cvt_pk_bf16_f32 v138, v8, v9
    v_cvt_pk_bf16_f32 v139, v10, v11
    v_xor_b32 v140, 0x80008000, v138
    v_xor_b32 v141, 0x80008000, v139
    v_mov_b32 v142, v136
    v_mov_b32 v143, v137
    v_lshlrev_b32 v2, 3, v1
    v_add_u32 v2, s28, v2
    v_lshlrev_b32_e64 v2, 6, v2
    v_add_u32 v4, 98304, v2
    s_nop 1
    s_cmp_lg_u32 s30, 0
    s_cbranch_scc1 L_ps_100
    s_add_u32 s40, s32, 4
    s_mov_b32 exec_lo, -1
    s_mov_b32 exec_hi, 0
    s_mov_b32 s98, 0
    v_mov_b32 v2, 0
    v_mov_b32 v3, 0
    s_nop 1
L_poll_98:
    buffer_load_dwordx2 v[2:3], v4, s[24:27], 0 offen sc1
    s_add_u32 s98, s98, 1
    s_cmp_gt_u32 s98, 0x40000
    s_cbranch_scc1 L_pd_99
    s_waitcnt vmcnt(0)
    v_subrev_u32_e64 v2, s40, v2
    v_cmp_gt_u32 vcc, 64, v2
    v_cmp_eq_u32 s[42:43], s33, v3
    s_nop 1
    s_and_b64 vcc, vcc, s[42:43]
    s_cmp_eq_u64 vcc, exec
    s_cbranch_scc0 L_poll_98
L_pd_99:
    s_waitcnt vmcnt(0)
    s_mov_b64 exec, -1
L_ps_100:
    s_waitcnt vmcnt(0)
    s_barrier
    v_lshlrev_b32 v14, 4, v1
    s_lshl_b32 s50, s34, 7
    s_lshl_b32 s41, s36, 6
    s_add_u32 s50, s50, s41
    s_lshl_b32 s41, s30, 4
    s_add_u32 s50, s50, s41
    s_lshl_b32 s41, s28, 8
    s_add_u32 s50, s50, s41
    s_mul_i32 s50, s50, 1152
    s_add_u32 s50, s50, 7864320
    s_lshl_b32 s51, s30, 14
    s_add_u32 s51, s51, 0
    v_xor_b32_e64 v15, 0, v14
    s_mov_b32 m0, s51
    s_nop 0
    buffer_load_dwordx4 v15, s[24:27], s50 offen lds
    s_add_u32 s50, s50, 1152
    s_add_u32 s51, s51, 1024
    v_xor_b32_e64 v15, 16, v14
    s_mov_b32 m0, s51
    s_nop 0
    buffer_load_dwordx4 v15, s[24:27], s50 offen lds
    s_add_u32 s50, s50, 1152
    s_add_u32 s51, s51, 1024
    v_xor_b32_e64 v15, 32, v14
    s_mov_b32 m0, s51
    s_nop 0
    buffer_load_dwordx4 v15, s[24:27], s50 offen lds
    s_add_u32 s50, s50, 1152
    s_add_u32 s51, s51, 1024
    v_xor_b32_e64 v15, 48, v14
    s_mov_b32 m0, s51
    s_nop 0
    buffer_load_dwordx4 v15, s[24:27], s50 offen lds
    s_add_u32 s50, s50, 1152
    s_add_u32 s51, s51, 1024
    v_xor_b32_e64 v15, 64, v14
    s_mov_b32 m0, s51
    s_nop 0
    buffer_load_dwordx4 v15, s[24:27], s50 offen lds
    s_add_u32 s50, s50, 1152
    s_add_u32 s51, s51, 1024
    v_xor_b32 v15, 80, v14
    s_mov_b32 m0, s51
    s_nop 0
    buffer_load_dwordx4 v15, s[24:27], s50 offen lds
    s_add_u32 s50, s50, 1152
    s_add_u32 s51, s51, 1024
    v_xor_b32 v15, 96, v14
    s_mov_b32 m0, s51
    s_nop 0
    buffer_load_dwordx4 v15, s[24:27], s50 offen lds
    s_add_u32 s50, s50, 1152
    s_add_u32 s51, s51, 1024
    v_xor_b32 v15, 112, v14
    s_mov_b32 m0, s51
    s_nop 0
    buffer_load_dwordx4 v15, s[24:27], s50 offen lds
    s_add_u32 s50, s50, 1152
    s_add_u32 s51, s51, 1024
    v_xor_b32 v15, 128, v14
    s_mov_b32 m0, s51
    s_nop 0
    buffer_load_dwordx4 v15, s[24:27], s50 offen lds
    s_add_u32 s50, s50, 1152
    s_add_u32 s51, s51, 1024
    v_xor_b32 v15, 144, v14
    s_mov_b32 m0, s51
    s_nop 0
    buffer_load_dwordx4 v15, s[24:27], s50 offen lds
    s_add_u32 s50, s50, 1152
    s_add_u32 s51, s51, 1024
    v_xor_b32 v15, 160, v14
    s_mov_b32 m0, s51
    s_nop 0
    buffer_load_dwordx4 v15, s[24:27], s50 offen lds
    s_add_u32 s50, s50, 1152
    s_add_u32 s51, s51, 1024
    v_xor_b32 v15, 176, v14
    s_mov_b32 m0, s51
    s_nop 0
    buffer_load_dwordx4 v15, s[24:27], s50 offen lds
    s_add_u32 s50, s50, 1152
    s_add_u32 s51, s51, 1024
    v_xor_b32 v15, 192, v14
    s_mov_b32 m0, s51
    s_nop 0
    buffer_load_dwordx4 v15, s[24:27], s50 offen lds
    s_add_u32 s50, s50, 1152
    s_add_u32 s51, s51, 1024
    v_xor_b32 v15, 208, v14
    s_mov_b32 m0, s51
    s_nop 0
    buffer_load_dwordx4 v15, s[24:27], s50 offen lds
    s_add_u32 s50, s50, 1152
    s_add_u32 s51, s51, 1024
    v_xor_b32 v15, 224, v14
    s_mov_b32 m0, s51
    s_nop 0
    buffer_load_dwordx4 v15, s[24:27], s50 offen lds
    s_add_u32 s50, s50, 1152
    s_add_u32 s51, s51, 1024
    v_xor_b32 v15, 240, v14
    s_mov_b32 m0, s51
    s_nop 0
    buffer_load_dwordx4 v15, s[24:27], s50 offen lds
    v_and_b32 v2, 15, v1
    v_lshrrev_b32 v3, 4, v1
    v_and_b32 v8, 3, v2
    v_xor_b32 v8, v8, v3
    v_lshlrev_b32 v8, 4, v8
    v_lshrrev_b32 v9, 2, v2
    v_lshl_add_u32 v11, v2, 10, v8
    s_lshl_b32 s40, s30, 14
    s_add_u32 s40, s40, 0
    v_add_u32_e64 v11, s40, v11
    v_lshl_add_u32 v8, v2, 9, v8
    v_add_u32 v8, 0x20000, v8
    v_xor_b32_e64 v10, 0, v9
    v_lshl_add_u32 v4, v10, 6, v8
    v_lshl_add_u32 v16, v10, 6, v11
    v_xor_b32_e64 v10, 1, v9
    v_lshl_add_u32 v5, v10, 6, v8
    v_lshl_add_u32 v17, v10, 6, v11
    v_xor_b32_e64 v10, 2, v9
    v_lshl_add_u32 v6, v10, 6, v8
    v_lshl_add_u32 v18, v10, 6, v11
    v_xor_b32_e64 v10, 3, v9
    v_lshl_add_u32 v7, v10, 6, v8
    v_lshl_add_u32 v19, v10, 6, v11
    v_mov_b32 v12, 0x3f803f80
    v_mov_b32 v13, 0x3f803f80
    v_mov_b32 v14, 0x3f803f80
    v_mov_b32 v15, 0x3f803f80
    ds_read_b128 v[104:107], v4 offset:0
    ds_read_b128 v[108:111], v4 offset:8192
    ds_read_b128 v[112:115], v4 offset:16384
    ds_read_b128 v[116:119], v4 offset:24576
    s_waitcnt vmcnt(0)
    ds_read_b128 v[24:27], v16 offset:0
    ds_read_b128 v[28:31], v17 offset:0
    ds_read_b128 v[32:35], v18 offset:0
    ds_read_b128 v[36:39], v19 offset:0
    ds_read_b128 v[40:43], v16 offset:256
    ds_read_b128 v[44:47], v17 offset:256
    ds_read_b128 v[48:51], v18 offset:256
    s_waitcnt lgkmcnt(6)
    v_mfma_f32_16x16x32_bf16 v[96:99], v[24:27], v[12:15], 0
    v_mfma_f32_16x16x32_bf16 v[100:103], v[24:27], v[24:27], 0
    ds_read_b128 v[52:55], v19 offset:256
    s_waitcnt lgkmcnt(6)
    v_mfma_f32_16x16x32_bf16 v[96:99], v[28:31], v[12:15], v[96:99]
    v_mfma_f32_16x16x32_bf16 v[100:103], v[28:31], v[28:31], v[100:103]
    ds_read_b128 v[24:27], v16 offset:512
    s_waitcnt lgkmcnt(6)
    v_mfma_f32_16x16x32_bf16 v[96:99], v[32:35], v[12:15], v[96:99]
    v_mfma_f32_16x16x32_bf16 v[100:103], v[32:35], v[32:35], v[100:103]
    ds_read_b128 v[28:31], v17 offset:512
    s_waitcnt lgkmcnt(6)
    v_mfma_f32_16x16x32_bf16 v[96:99], v[36:39], v[12:15], v[96:99]
    v_mfma_f32_16x16x32_bf16 v[100:103], v[36:39], v[36:39], v[100:103]
    ds_read_b128 v[32:35], v18 offset:512
    s_waitcnt lgkmcnt(6)
    v_mfma_f32_16x16x32_bf16 v[96:99], v[40:43], v[12:15], v[96:99]
    v_mfma_f32_16x16x32_bf16 v[100:103], v[40:43], v[40:43], v[100:103]
    ds_read_b128 v[36:39], v19 offset:512
    s_waitcnt lgkmcnt(6)
    v_mfma_f32_16x16x32_bf16 v[96:99], v[44:47], v[12:15], v[96:99]
    v_mfma_f32_16x16x32_bf16 v[100:103], v[44:47], v[44:47], v[100:103]
    ds_read_b128 v[40:43], v16 offset:768
    s_waitcnt lgkmcnt(6)
    v_mfma_f32_16x16x32_bf16 v[96:99], v[48:51], v[12:15], v[96:99]
    v_mfma_f32_16x16x32_bf16 v[100:103], v[48:51], v[48:51], v[100:103]
    ds_read_b128 v[44:47], v17 offset:768
    s_waitcnt lgkmcnt(6)
    v_mfma_f32_16x16x32_bf16 v[96:99], v[52:55], v[12:15], v[96:99]
    v_mfma_f32_16x16x32_bf16 v[100:103], v[52:55], v[52:55], v[100:103]
    ds_read_b128 v[48:51], v18 offset:768
    s_waitcnt lgkmcnt(6)
    v_mfma_f32_16x16x32_bf16 v[96:99], v[24:27], v[12:15], v[96:99]
    v_mfma_f32_16x16x32_bf16 v[100:103], v[24:27], v[24:27], v[100:103]
    ds_read_b128 v[52:55], v19 offset:768
    s_waitcnt lgkmcnt(6)
    v_mfma_f32_16x16x32_bf16 v[96:99], v[28:31], v[12:15], v[96:99]
    v_mfma_f32_16x16x32_bf16 v[100:103], v[28:31], v[28:31], v[100:103]
    s_waitcnt lgkmcnt(5)
    v_mfma_f32_16x16x32_bf16 v[96:99], v[32:35], v[12:15], v[96:99]
    v_mfma_f32_16x16x32_bf16 v[100:103], v[32:35], v[32:35], v[100:103]
    s_waitcnt lgkmcnt(4)
    v_mfma_f32_16x16x32_bf16 v[96:99], v[36:39], v[12:15], v[96:99]
    v_mfma_f32_16x16x32_bf16 v[100:103], v[36:39], v[36:39], v[100:103]
    s_waitcnt lgkmcnt(3)
    v_mfma_f32_16x16x32_bf16 v[96:99], v[40:43], v[12:15], v[96:99]
    v_mfma_f32_16x16x32_bf16 v[100:103], v[40:43], v[40:43], v[100:103]
    s_waitcnt lgkmcnt(2)
    v_mfma_f32_16x16x32_bf16 v[96:99], v[44:47], v[12:15], v[96:99]
    v_mfma_f32_16x16x32_bf16 v[100:103], v[44:47], v[44:47], v[100:103]
    s_waitcnt lgkmcnt(1)
    v_mfma_f32_16x16x32_bf16 v[96:99], v[48:51], v[12:15], v[96:99]
    v_mfma_f32_16x16x32_bf16 v[100:103], v[48:51], v[48:51], v[100:103]
    s_waitcnt lgkmcnt(0)
    v_mfma_f32_16x16x32_bf16 v[96:99], v[52:55], v[12:15], v[96:99]
    v_mfma_f32_16x16x32_bf16 v[100:103], v[52:55], v[52:55], v[100:103]
    ds_read_b128 v[24:27], v16 offset:0
    ds_read_b128 v[28:31], v16 offset:512
    ds_read_b128 v[32:35], v17 offset:0
    ds_read_b128 v[36:39], v17 offset:512
    s_waitcnt lgkmcnt(3)
    v_mfma_f32_16x16x32_bf16 v[80:83], v[24:27], v[104:107], 0
    s_waitcnt lgkmcnt(2)
    v_mfma_f32_16x16x32_bf16 v[120:123], v[28:31], v[104:107], 0
    ds_read_b128 v[104:107], v5 offset:0
    v_mfma_f32_16x16x32_bf16 v[84:87], v[24:27], v[108:111], 0
    v_mfma_f32_16x16x32_bf16 v[124:127], v[28:31], v[108:111], 0
    ds_read_b128 v[108:111], v5 offset:8192
    v_mfma_f32_16x16x32_bf16 v[88:91], v[24:27], v[112:115], 0
    v_mfma_f32_16x16x32_bf16 v[128:131], v[28:31], v[112:115], 0
    ds_read_b128 v[112:115], v5 offset:16384
    v_mfma_f32_16x16x32_bf16 v[92:95], v[24:27], v[116:119], 0
    v_mfma_f32_16x16x32_bf16 v[132:135], v[28:31], v[116:119], 0
    ds_read_b128 v[116:119], v5 offset:24576
    ds_read_b128 v[40:43], v18 offset:0
    ds_read_b128 v[44:47], v18 offset:512
    s_waitcnt lgkmcnt(5)
    v_mfma_f32_16x16x32_bf16 v[80:83], v[32:35], v[104:107], v[80:83]
    v_mfma_f32_16x16x32_bf16 v[120:123], v[36:39], v[104:107], v[120:123]
    ds_read_b128 v[104:107], v6 offset:0
    v_lshrrev_b32_e64 v3, 4, v1
    v_mul_u32_u24 v3, 80, v3
    s_waitcnt lgkmcnt(5)
    v_mfma_f32_16x16x32_bf16 v[84:87], v[32:35], v[108:111], v[84:87]
    v_mfma_f32_16x16x32_bf16 v[124:127], v[36:39], v[108:111], v[124:127]
    ds_read_b128 v[108:111], v6 offset:8192
    v_add_u32 v2, 0, v3
    ds_bpermute_b32 v8, v2, v100
    s_waitcnt lgkmcnt(6)
    v_mfma_f32_16x16x32_bf16 v[88:91], v[32:35], v[112:115], v[88:91]
    v_mfma_f32_16x16x32_bf16 v[128:131], v[36:39], v[112:115], v[128:131]
    ds_read_b128 v[112:115], v6 offset:16384
    v_add_u32 v2, 4, v3
    ds_bpermute_b32 v9, v2, v101
    s_waitcnt lgkmcnt(7)
    v_mfma_f32_16x16x32_bf16 v[92:95], v[32:35], v[116:119], v[92:95]
    v_mfma_f32_16x16x32_bf16 v[132:135], v[36:39], v[116:119], v[132:135]
    ds_read_b128 v[116:119], v6 offset:24576
    v_add_u32 v2, 8, v3
    ds_bpermute_b32 v10, v2, v102
    ds_read_b128 v[48:51], v19 offset:0
    ds_read_b128 v[52:55], v19 offset:512
    s_waitcnt lgkmcnt(8)
    v_mfma_f32_16x16x32_bf16 v[80:83], v[40:43], v[104:107], v[80:83]
    v_mfma_f32_16x16x32_bf16 v[120:123], v[44:47], v[104:107], v[120:123]
    ds_read_b128 v[104:107], v7 offset:0
    v_add_u32 v2, 12, v3
    ds_bpermute_b32 v11, v2, v103
    s_waitcnt lgkmcnt(9)
    v_mfma_f32_16x16x32_bf16 v[84:87], v[40:43], v[108:111], v[84:87]
    v_mfma_f32_16x16x32_bf16 v[124:127], v[44:47], v[108:111], v[124:127]
    ds_read_b128 v[108:111], v7 offset:8192
    v_mul_f32 v96, 0x3b000000, v96
    v_mul_f32 v97, 0x3b000000, v97
    s_waitcnt lgkmcnt(8)
    v_mfma_f32_16x16x32_bf16 v[88:91], v[40:43], v[112:115], v[88:91]
    v_mfma_f32_16x16x32_bf16 v[128:131], v[44:47], v[112:115], v[128:131]
    ds_read_b128 v[112:115], v7 offset:16384
    v_mul_f32 v98, 0x3b000000, v98
    v_mul_f32 v99, 0x3b000000, v99
    s_waitcnt lgkmcnt(7)
    v_mfma_f32_16x16x32_bf16 v[92:95], v[40:43], v[116:119], v[92:95]
    v_mfma_f32_16x16x32_bf16 v[132:135], v[44:47], v[116:119], v[132:135]
    ds_read_b128 v[116:119], v7 offset:24576
    v_mul_f32 v8, 0x3b000000, v8
    v_mul_f32 v9, 0x3b000000, v9
    ds_read_b128 v[24:27], v16 offset:256
    ds_read_b128 v[28:31], v16 offset:768
    s_waitcnt lgkmcnt(6)
    v_mfma_f32_16x16x32_bf16 v[80:83], v[48:51], v[104:107], v[80:83]
    v_mfma_f32_16x16x32_bf16 v[120:123], v[52:55], v[104:107], v[120:123]
    ds_read_b128 v[104:107], v4 offset:256
    v_mul_f32 v10, 0x3b000000, v10
    s_waitcnt lgkmcnt(6)
    v_mul_f32 v11, 0x3b000000, v11
    s_waitcnt lgkmcnt(5)
    v_mfma_f32_16x16x32_bf16 v[84:87], v[48:51], v[108:111], v[84:87]
    v_mfma_f32_16x16x32_bf16 v[124:127], v[52:55], v[108:111], v[124:127]
    ds_read_b128 v[108:111], v4 offset:8448
    v_fma_f32 v8, -v96, v96, v8
    v_fma_f32 v9, -v97, v97, v9
    s_waitcnt lgkmcnt(5)
    v_mfma_f32_16x16x32_bf16 v[88:91], v[48:51], v[112:115], v[88:91]
    v_mfma_f32_16x16x32_bf16 v[128:131], v[52:55], v[112:115], v[128:131]
    ds_read_b128 v[112:115], v4 offset:16640
    v_fma_f32 v10, -v98, v98, v10
    v_fma_f32 v11, -v99, v99, v11
    s_waitcnt lgkmcnt(5)
    v_mfma_f32_16x16x32_bf16 v[92:95], v[48:51], v[116:119], v[92:95]
    v_mfma_f32_16x16x32_bf16 v[132:135], v[52:55], v[116:119], v[132:135]
    ds_read_b128 v[116:119], v4 offset:24832
    v_add_f32 v8, 0x3727c5ac, v8
    v_add_f32 v9, 0x3727c5ac, v9
    ds_read_b128 v[32:35], v17 offset:256
    ds_read_b128 v[36:39], v17 offset:768
    s_waitcnt lgkmcnt(5)
    v_mfma_f32_16x16x32_bf16 v[80:83], v[24:27], v[104:107], v[80:83]
    v_mfma_f32_16x16x32_bf16 v[120:123], v[28:31], v[104:107], v[120:123]
    ds_read_b128 v[104:107], v5 offset:256
    v_add_f32 v10, 0x3727c5ac, v10
    v_add_f32 v11, 0x3727c5ac, v11
    s_waitcnt lgkmcnt(5)
    v_mfma_f32_16x16x32_bf16 v[84:87], v[24:27], v[108:111], v[84:87]
    v_mfma_f32_16x16x32_bf16 v[124:127], v[28:31], v[108:111], v[124:127]
    ds_read_b128 v[108:111], v5 offset:8448
    v_rsq_f32 v8, v8
    v_rsq_f32_e64 v9, v9
    s_waitcnt lgkmcnt(5)
    v_mfma_f32_16x16x32_bf16 v[88:91], v[24:27], v[112:115], v[88:91]
    v_mfma_f32_16x16x32_bf16 v[128:131], v[28:31], v[112:115], v[128:131]
    ds_read_b128 v[112:115], v5 offset:16640
    v_rsq_f32 v10, v10
    v_rsq_f32_e64 v11, v11
    s_waitcnt lgkmcnt(5)
    v_mfma_f32_16x16x32_bf16 v[92:95], v[24:27], v[116:119], v[92:95]
    v_mfma_f32_16x16x32_bf16 v[132:135], v[28:31], v[116:119], v[132:135]
    ds_read_b128 v[116:119], v5 offset:24832
    v_and_b32 v2, 1, v1
    v_lshlrev_b32 v2, 31, v2
    ds_read_b128 v[40:43], v18 offset:256
    ds_read_b128 v[44:47], v18 offset:768
    s_waitcnt lgkmcnt(5)
    v_mfma_f32_16x16x32_bf16 v[80:83], v[32:35], v[104:107], v[80:83]
    v_mfma_f32_16x16x32_bf16 v[120:123], v[36:39], v[104:107], v[120:123]
    ds_read_b128 v[104:107], v6 offset:256
    v_or_b32_e64 v2, 1.0, v2
    s_waitcnt lgkmcnt(5)
    v_mfma_f32_16x16x32_bf16 v[84:87], v[32:35], v[108:111], v[84:87]
    v_mfma_f32_16x16x32_bf16 v[124:127], v[36:39], v[108:111], v[124:127]
    ds_read_b128 v[108:111], v6 offset:8448
    s_waitcnt lgkmcnt(5)
    v_mfma_f32_16x16x32_bf16 v[88:91], v[32:35], v[112:115], v[88:91]
    v_mfma_f32_16x16x32_bf16 v[128:131], v[36:39], v[112:115], v[128:131]
    ds_read_b128 v[112:115], v6 offset:16640
    s_waitcnt lgkmcnt(5)
    v_mfma_f32_16x16x32_bf16 v[92:95], v[32:35], v[116:119], v[92:95]
    v_mfma_f32_16x16x32_bf16 v[132:135], v[36:39], v[116:119], v[132:135]
    ds_read_b128 v[116:119], v6 offset:24832
    ds_read_b128 v[48:51], v19 offset:256
    ds_read_b128 v[52:55], v19 offset:768
    s_waitcnt lgkmcnt(5)
    v_mfma_f32_16x16x32_bf16 v[80:83], v[40:43], v[104:107], v[80:83]
    v_mfma_f32_16x16x32_bf16 v[120:123], v[44:47], v[104:107], v[120:123]
    ds_read_b128 v[104:107], v7 offset:256
    s_waitcnt lgkmcnt(5)
    v_mfma_f32_16x16x32_bf16 v[84:87], v[40:43], v[108:111], v[84:87]
    v_mfma_f32_16x16x32_bf16 v[124:127], v[44:47], v[108:111], v[124:127]
    ds_read_b128 v[108:111], v7 offset:8448
    s_waitcnt lgkmcnt(5)
    v_mfma_f32_16x16x32_bf16 v[88:91], v[40:43], v[112:115], v[88:91]
    v_mfma_f32_16x16x32_bf16 v[128:131], v[44:47], v[112:115], v[128:131]
    ds_read_b128 v[112:115], v7 offset:16640
    s_waitcnt lgkmcnt(5)
    v_mfma_f32_16x16x32_bf16 v[92:95], v[40:43], v[116:119], v[92:95]
    v_mfma_f32_16x16x32_bf16 v[132:135], v[44:47], v[116:119], v[132:135]
    ds_read_b128 v[116:119], v7 offset:24832
    s_waitcnt lgkmcnt(3)
    v_mfma_f32_16x16x32_bf16 v[80:83], v[48:51], v[104:107], v[80:83]
    v_mfma_f32_16x16x32_bf16 v[120:123], v[52:55], v[104:107], v[120:123]
    s_waitcnt lgkmcnt(2)
    v_mfma_f32_16x16x32_bf16 v[84:87], v[48:51], v[108:111], v[84:87]
    v_mfma_f32_16x16x32_bf16 v[124:127], v[52:55], v[108:111], v[124:127]
    s_waitcnt lgkmcnt(1)
    v_mfma_f32_16x16x32_bf16 v[88:91], v[48:51], v[112:115], v[88:91]
    v_mfma_f32_16x16x32_bf16 v[128:131], v[52:55], v[112:115], v[128:131]
    s_waitcnt lgkmcnt(0)
    v_mfma_f32_16x16x32_bf16 v[92:95], v[48:51], v[116:119], v[92:95]
    v_mfma_f32_16x16x32_bf16 v[132:135], v[52:55], v[116:119], v[132:135]
    v_fmac_f32 v80, v2, v120
    v_fmac_f32 v81, v2, v121
    v_fmac_f32 v82, v2, v122
    v_fmac_f32 v83, v2, v123
    v_fmac_f32 v84, v2, v124
    v_fmac_f32 v85, v2, v125
    v_fmac_f32 v86, v2, v126
    v_fmac_f32 v87, v2, v127
    v_fmac_f32 v88, v2, v128
    v_fmac_f32 v89, v2, v129
    v_fmac_f32 v90, v2, v130
    v_fmac_f32 v91, v2, v131
    v_fmac_f32 v92, v2, v132
    v_fmac_f32 v93, v2, v133
    v_fmac_f32 v94, v2, v134
    v_fmac_f32 v95, v2, v135
    v_mul_f32 v80, v80, v8
    v_mul_f32 v81, v81, v9
    v_mul_f32 v82, v82, v10
    v_mul_f32 v83, v83, v11
    v_mul_f32 v84, v84, v8
    v_mul_f32 v85, v85, v9
    v_mul_f32 v86, v86, v10
    v_mul_f32 v87, v87, v11
    v_mul_f32 v88, v88, v8
    v_mul_f32 v89, v89, v9
    v_mul_f32 v90, v90, v10
    v_mul_f32 v91, v91, v11
    v_mul_f32 v92, v92, v8
    v_mul_f32 v93, v93, v9
    v_mul_f32 v94, v94, v10
    v_mul_f32 v95, v95, v11
    v_cvt_pk_bf16_f32 v16, v80, v81
    v_cvt_pk_bf16_f32 v17, v82, v83
    v_cvt_pk_bf16_f32 v18, v88, v89
    v_cvt_pk_bf16_f32 v19, v90, v91
    v_cvt_pk_bf16_f32 v20, v84, v85
    v_cvt_pk_bf16_f32 v21, v86, v87
    v_cvt_pk_bf16_f32 v22, v92, v93
    v_cvt_pk_bf16_f32 v23, v94, v95
    v_mfma_f32_16x16x32_bf16 v[24:27], v[136:139], v[16:19], 0
    v_mfma_f32_16x16x32_bf16 v[28:31], v[140:143], v[16:19], 0
    v_mfma_f32_16x16x32_bf16 v[32:35], v[136:139], v[20:23], 0
    v_mfma_f32_16x16x32_bf16 v[36:39], v[140:143], v[20:23], 0
    v_and_b32 v2, 15, v1
    v_lshrrev_b32 v3, 4, v1
    v_lshlrev_b32_e64 v2, 4, v2
    v_lshl_add_u32 v2, v3, 11, v2
    s_lshl_b32 s40, s30, 2
    s_add_u32 s40, s40, 65536
    v_add_u32 v2, s40, v2
    v_cvt_pk_bf16_f32 v40, v24, v28
    ds_write_b32 v2, v40 offset:0
    v_cvt_pk_bf16_f32 v41, v25, v29
    ds_write_b32 v2, v41 offset:512
    v_cvt_pk_bf16_f32 v42, v26, v30
    ds_write_b32 v2, v42 offset:1024
    v_cvt_pk_bf16_f32 v43, v27, v31
    ds_write_b32 v2, v43 offset:1536
    v_cvt_pk_bf16_f32 v44, v32, v36
    ds_write_b32 v2, v44 offset:256
    v_cvt_pk_bf16_f32 v45, v33, v37
    ds_write_b32 v2, v45 offset:768
    v_cvt_pk_bf16_f32 v46, v34, v38
    ds_write_b32 v2, v46 offset:1280
    v_cvt_pk_bf16_f32 v47, v35, v39
    ds_write_b32 v2, v47 offset:1792
    s_waitcnt lgkmcnt(0)
    s_barrier
    v_lshlrev_b32_e64 v2, 4, v0
    v_add_u32 v3, 65536, v2
    ds_read_b128 v[16:19], v3
    ds_read_b128 v[20:23], v3 offset:4096
    v_lshrrev_b32 v4, 5, v0
    v_and_b32 v5, 31, v0
    v_lshlrev_b32_e64 v4, 17, v4
    v_lshl_add_u32 v4, v5, 4, v4
    s_lshl_b32 s40, s28, 1
    s_add_u32 s40, s40, s34
    s_lshl_b32 s40, s40, 13
    s_lshl_b32 s41, s36, 12
    s_add_u32 s40, s40, s41
    s_lshl_b32 s41, s35, 9
    s_add_u32 s40, s40, s41
    s_add_u32 s40, s40, 3145728
    s_add_u32 s41, s40, 0x100000
    s_waitcnt lgkmcnt(1)
    buffer_store_dwordx4 v[16:19], v4, s[24:27], s40 offen sc1
    s_waitcnt lgkmcnt(0)
    buffer_store_dwordx4 v[20:23], v4, s[24:27], s41 offen sc1
    v_and_b32 v2, 15, v1
    v_lshrrev_b32 v3, 4, v1
    v_and_b32 v4, 7, v2
    v_lshrrev_b32_e64 v2, 3, v2
    v_lshl_add_u32 v2, v4, 3, v2
    s_lshl_b32 s40, s36, 6
    s_lshl_b32 s41, s30, 1
    s_add_u32 s40, s40, s41
    v_add_u32 v2, s40, v2
    v_cvt_f32_u32_e64 v4, v2
    v_mul_f32 v4, 0x3c000000, v4
    v_and_b32 v5, 1, v3
    v_lshrrev_b32 v6, 1, v3
    v_cvt_f32_u32 v5, v5
    v_cvt_f32_u32 v6, v6
    v_mul_f32 v6, v4, v6
    v_mul_f32 v5, v4, v5
    v_mul_f32 v5, 0x42800000, v5
    v_mul_f32 v7, 0x41000000, v6
    v_add_f32_e64 v5, v5, v7
    v_mul_f32 v7, 0x40c00000, v6
    v_add_f32 v7, v4, v7
    v_add_f32 v8, v6, v6
    v_sub_f32_e64 v8, v4, v8
    v_mul_f32 v9, 0x41800000, v4
    v_add_f32 v10, v9, v9
    v_add_f32 v49, v5, v9
    v_add_f32 v50, v5, v10
    v_fract_f32 v48, v5
    v_add_f32 v51, v49, v10
    v_fract_f32 v49, v49
    v_fract_f32 v50, v50
    v_fract_f32 v51, v51
    v_cos_f32 v52, v48
    v_cos_f32 v53, v49
    v_cos_f32 v54, v50
    v_cos_f32 v55, v51
    v_sin_f32 v56, v48
    v_sin_f32 v57, v49
    v_sin_f32 v58, v50
    v_sin_f32 v59, v51
    v_cvt_pk_bf16_f32 v16, v52, v56
    v_cvt_pk_bf16_f32 v17, v53, v57
    v_cvt_pk_bf16_f32 v18, v54, v58
    v_cvt_pk_bf16_f32 v19, v55, v59
    v_add_f32 v5, v5, v7
    v_add_f32 v49, v5, v9
    v_add_f32 v50, v5, v10
    v_fract_f32 v48, v5
    v_add_f32 v51, v49, v10
    v_fract_f32 v49, v49
    v_fract_f32 v50, v50
    v_fract_f32 v51, v51
    v_cos_f32 v52, v48
    v_cos_f32 v53, v49
    v_cos_f32 v54, v50
    v_cos_f32 v55, v51
    v_sin_f32 v56, v48
    v_sin_f32 v57, v49
    v_sin_f32 v58, v50
    v_sin_f32 v59, v51
    v_cvt_pk_bf16_f32 v20, v52, v56
    v_cvt_pk_bf16_f32 v21, v53, v57
    v_cvt_pk_bf16_f32 v22, v54, v58
    v_cvt_pk_bf16_f32 v23, v55, v59
    v_add_f32 v5, v5, v8
    v_add_f32 v49, v5, v9
    v_add_f32 v50, v5, v10
    v_fract_f32 v48, v5
    v_add_f32 v51, v49, v10
    v_fract_f32 v49, v49
    v_fract_f32 v50, v50
    v_fract_f32 v51, v51
    v_cos_f32 v52, v48
    v_cos_f32 v53, v49
    v_cos_f32 v54, v50
    v_cos_f32 v55, v51
    v_sin_f32 v56, v48
    v_sin_f32 v57, v49
    v_sin_f32 v58, v50
    v_sin_f32 v59, v51
    v_cvt_pk_bf16_f32 v24, v52, v56
    v_cvt_pk_bf16_f32 v25, v53, v57
    v_cvt_pk_bf16_f32 v26, v54, v58
    v_cvt_pk_bf16_f32 v27, v55, v59
    v_add_f32 v5, v5, v8
    v_add_f32 v49, v5, v9
    v_add_f32 v50, v5, v10
    v_fract_f32 v48, v5
    v_add_f32 v51, v49, v10
    v_fract_f32 v49, v49
    v_fract_f32 v50, v50
    v_fract_f32 v51, v51
    v_cos_f32 v52, v48
    v_cos_f32 v53, v49
    v_cos_f32 v54, v50
    v_cos_f32 v55, v51
    v_sin_f32 v56, v48
    v_sin_f32 v57, v49
    v_sin_f32 v58, v50
    v_sin_f32 v59, v51
    v_cvt_pk_bf16_f32 v28, v52, v56
    v_cvt_pk_bf16_f32 v29, v53, v57
    v_cvt_pk_bf16_f32 v30, v54, v58
    v_cvt_pk_bf16_f32 v31, v55, v59
    v_add_f32 v5, v5, v8
    v_add_f32 v49, v5, v9
    v_add_f32 v50, v5, v10
    v_fract_f32 v48, v5
    v_add_f32 v51, v49, v10
    v_fract_f32 v49, v49
    v_fract_f32 v50, v50
    v_fract_f32 v51, v51
    v_cos_f32 v52, v48
    v_cos_f32 v53, v49
    v_cos_f32 v54, v50
    v_cos_f32 v55, v51
    v_sin_f32 v56, v48
    v_sin_f32 v57, v49
    v_sin_f32 v58, v50
    v_sin_f32 v59, v51
    v_cvt_pk_bf16_f32 v32, v52, v56
    v_cvt_pk_bf16_f32 v33, v53, v57
    v_cvt_pk_bf16_f32 v34, v54, v58
    v_cvt_pk_bf16_f32 v35, v55, v59
    v_add_f32 v5, v5, v8
    v_add_f32 v49, v5, v9
    v_add_f32 v50, v5, v10
    v_fract_f32 v48, v5
    v_add_f32 v51, v49, v10
    v_fract_f32 v49, v49
    v_fract_f32 v50, v50
    v_fract_f32 v51, v51
    v_cos_f32 v52, v48
    v_cos_f32 v53, v49
    v_cos_f32 v54, v50
    v_cos_f32 v55, v51
    v_sin_f32 v56, v48
    v_sin_f32 v57, v49
    v_sin_f32 v58, v50
    v_sin_f32 v59, v51
    v_cvt_pk_bf16_f32 v36, v52, v56
    v_cvt_pk_bf16_f32 v37, v53, v57
    v_cvt_pk_bf16_f32 v38, v54, v58
    v_cvt_pk_bf16_f32 v39, v55, v59
    v_add_f32 v5, v5, v8
    v_add_f32 v49, v5, v9
    v_add_f32 v50, v5, v10
    v_fract_f32 v48, v5
    v_add_f32 v51, v49, v10
    v_fract_f32 v49, v49
    v_fract_f32 v50, v50
    v_fract_f32 v51, v51
    v_cos_f32 v52, v48
    v_cos_f32 v53, v49
    v_cos_f32 v54, v50
    v_cos_f32 v55, v51
    v_sin_f32 v56, v48
    v_sin_f32 v57, v49
    v_sin_f32 v58, v50
    v_sin_f32 v59, v51
    v_cvt_pk_bf16_f32 v40, v52, v56
    v_cvt_pk_bf16_f32 v41, v53, v57
    v_cvt_pk_bf16_f32 v42, v54, v58
    v_cvt_pk_bf16_f32 v43, v55, v59
    v_add_f32 v5, v5, v8
    v_add_f32 v49, v5, v9
    v_add_f32 v50, v5, v10
    v_fract_f32 v48, v5
    v_add_f32 v51, v49, v10
    v_fract_f32 v49, v49
    v_fract_f32 v50, v50
    v_fract_f32 v51, v51
    v_cos_f32 v52, v48
    v_cos_f32 v53, v49
    v_cos_f32 v54, v50
    v_cos_f32 v55, v51
    v_sin_f32 v56, v48
    v_sin_f32 v57, v49
    v_sin_f32 v58, v50
    v_sin_f32 v59, v51
    v_cvt_pk_bf16_f32 v44, v52, v56
    v_cvt_pk_bf16_f32 v45, v53, v57
    v_cvt_pk_bf16_f32 v46, v54, v58
    v_cvt_pk_bf16_f32 v47, v55, v59
    s_waitcnt vmcnt(0)
    s_barrier
    s_cmp_lg_u32 s30, 0
    s_cbranch_scc1 L_fs_101
    s_add_u32 s40, s32, 2
    v_mov_b32 v2, s40
    v_mov_b32 v3, s33
    s_lshl_b32 s41, s2, 6
    s_add_u32 s41, s41, 81920
    v_mov_b32 v4, s41
    s_mov_b64 exec, 1
    buffer_store_dwordx2 v[2:3], v4, s[24:27], 0 offen sc1
    s_mov_b64 exec, -1
L_fs_101:
    v_lshrrev_b32 v2, 2, v1
    v_and_b32 v3, 3, v1
    v_and_b32 v4, 7, v2
    v_lshrrev_b32_e64 v2, 3, v2
    v_lshl_add_u32 v2, v4, 3, v2
    s_lshl_b32 s40, s36, 6
    s_lshl_b32 s41, s30, 1
    s_add_u32 s40, s40, s41
    v_add_u32 v2, s40, v2
    s_cmp_eq_u32 s37, 0
    s_cselect_b32 s43, 1, 0
    s_add_u32 s43, s43, 127
    v_sub_u32_e64 v4, s43, v2
    v_and_b32 v4, 127, v4
    s_sub_u32 s44, 1, s34
    s_cmp_eq_u32 s28, 0
    s_cselect_b32 s44, s34, s44
    v_bfe_u32 v60, v2, 1, 2
    v_lshlrev_b32 v60, 5, v60
    v_and_b32_e64 v61, 1, v2
    v_lshl_add_u32 v60, v61, 4, v60
    v_lshrrev_b32 v61, 3, v2
    v_add_u32 v60, v60, v61
    s_lshl_b32 s42, s34, 7
    v_add_u32 v5, s42, v60
    v_bfe_u32 v60, v4, 1, 2
    v_lshlrev_b32 v60, 5, v60
    v_and_b32 v61, 1, v4
    v_lshl_add_u32 v60, v61, 4, v60
    v_lshrrev_b32 v61, 3, v4
    v_add_u32 v60, v60, v61
    s_lshl_b32 s42, s44, 7
    v_add_u32 v6, s42, v60
    s_lshl_b32 s45, s28, 4
    s_add_u32 s45, s45, s35
    s_lshl_b32 s45, s45, 11
    v_lshlrev_b32 v10, 3, v5
    v_add_u32_e64 v10, s45, v10
    s_add_u32 s45, s45, 16384
    v_lshlrev_b32 v11, 3, v6
    v_add_u32 v11, s45, v11
    s_lshl_b32 s45, s28, 8
    v_add_u32 v5, s45, v5
    v_add_u32 v6, s45, v6
    s_lshl_b32 s46, s35, 6
    v_lshlrev_b32 v7, 4, v3
    v_add_u32 v7, s46, v7
    v_sub_u32 v12, 1010, v7
    s_movk_i32 s46, 1152
    v_mul_lo_u32 v5, v5, s46
    v_mul_lo_u32 v6, v6, s46
    v_add_u32 v8, v5, v7
    v_add_u32 v9, v6, v12
    s_cmp_eq_u32 s35, 0
    s_cselect_b32 s52, 0x11111111, 0
    s_mov_b32 s53, s52
    v_mov_b32 v13, v8
    v_mov_b32_e64 v14, v9
    v_add_u32 v15, 512, v6
    s_mov_b32 s47, 7864320
    v_subrev_u32_e64 v12, 2, v14
    v_cndmask_b32 v12, v14, v12, s[52:53]
    buffer_load_dwordx4 v[88:91], v13, s[24:27], s47 offen
    buffer_load_dwordx4 v[92:95], v12, s[24:27], s47 offen
    buffer_load_ushort v96, v15, s[24:27], s47 offen
    s_getpc_b64 s[42:43]
L_pc_102:
    s_lshl_b32 s40, s29, 2
    s_add_u32 s40, s40, s30
    s_lshl_b32 s40, s40, 10
    v_lshlrev_b32 v2, 4, v1
    v_add_u32 v2, s40, v2
    v_min_u32 v2, 24560, v2
    v_add_u32_e64 v2, 0, v2
    v_min_u32 v2, L_code_end-L_pc_102-16, v2
    global_load_dwordx4 v[128:131], v2, s[42:43]
    s_nop 1
    s_cmp_eq_u32 s30, 0
    s_cbranch_scc1 L_w0_103
    s_branch L_wj_104
L_w0_103:
    v_and_b32 v2, 7, v1
    v_lshrrev_b32 v3, 3, v1
    v_lshlrev_b32 v3, 6, v3
    v_add_u32 v2, v2, v3
    s_lshl_b32 s40, s35, 3
    v_add_u32 v2, s40, v2
    v_lshlrev_b32_e64 v2, 6, v2
    v_add_u32 v4, 81920, v2
    s_add_u32 s40, s32, 2
    s_mov_b32 exec_lo, -1
    s_mov_b32 exec_hi, 0
    s_mov_b32 s98, 0
    v_mov_b32 v2, 0
    v_mov_b32_e64 v3, 0
    s_nop 1
L_poll_105:
    buffer_load_dwordx2 v[2:3], v4, s[24:27], 0 offen sc1
    s_add_u32 s98, s98, 1
    s_cmp_gt_u32 s98, 0x40000
    s_cbranch_scc1 L_pd_106
    s_waitcnt vmcnt(0)
    v_subrev_u32_e64 v2, s40, v2
    v_cmp_gt_u32 vcc, 64, v2
    v_cmp_eq_u32 s[42:43], s33, v3
    s_nop 1
    s_and_b64 vcc, vcc, s[42:43]
    s_cmp_eq_u64 vcc, exec
    s_cbranch_scc0 L_poll_105
L_pd_106:
    s_waitcnt vmcnt(0)
    s_mov_b64 exec, -1
    v_and_b32 v2, 15, v1
    v_lshrrev_b32 v3, 4, v1
    v_lshlrev_b32_e64 v2, 4, v2
    v_lshl_add_u32 v2, v3, 12, v2
    s_lshl_b32 s40, s37, 17
    s_lshl_b32 s41, s35, 9
    s_add_u32 s40, s40, s41
    s_add_u32 s40, s40, 3145728
    s_mov_b32 m0, 0
    s_add_u32 s41, s40, 0
    buffer_load_dwordx4 v2, s[24:27], s41 offen lds
    s_mov_b32 m0, 1024
    s_add_u32 s41, s40, 16384
    buffer_load_dwordx4 v2, s[24:27], s41 offen lds
    s_mov_b32 m0, 2048
    s_add_u32 s41, s40, 32768
    buffer_load_dwordx4 v2, s[24:27], s41 offen lds
    s_mov_b32 m0, 3072
    s_add_u32 s41, s40, 49152
    buffer_load_dwordx4 v2, s[24:27], s41 offen lds
    s_mov_b32 m0, 4096
    s_add_u32 s41, s40, 65536
    buffer_load_dwordx4 v2, s[24:27], s41 offen lds
    s_mov_b32 m0, 5120
    s_add_u32 s41, s40, 81920
    buffer_load_dwordx4 v2, s[24:27], s41 offen lds
    s_mov_b32 m0, 6144
    s_add_u32 s41, s40, 98304
    buffer_load_dwordx4 v2, s[24:27], s41 offen lds
    s_mov_b32 m0, 7168
    s_add_u32 s41, s40, 114688
    buffer_load_dwordx4 v2, s[24:27], s41 offen lds
    s_mov_b32 m0, 8192
    s_add_u32 s41, s40, 256
    buffer_load_dwordx4 v2, s[24:27], s41 offen lds
    s_mov_b32 m0, 9216
    s_add_u32 s41, s40, 16640
    buffer_load_dwordx4 v2, s[24:27], s41 offen lds
    s_mov_b32 m0, 10240
    s_add_u32 s41, s40, 33024
    buffer_load_dwordx4 v2, s[24:27], s41 offen lds
    s_mov_b32 m0, 11264
    s_add_u32 s41, s40, 49408
    buffer_load_dwordx4 v2, s[24:27], s41 offen lds
    s_mov_b32 m0, 12288
    s_add_u32 s41, s40, 65792
    buffer_load_dwordx4 v2, s[24:27], s41 offen lds
    s_mov_b32 m0, 13312
    s_add_u32 s41, s40, 82176
    buffer_load_dwordx4 v2, s[24:27], s41 offen lds
    s_mov_b32 m0, 14336
    s_add_u32 s41, s40, 98560
    buffer_load_dwordx4 v2, s[24:27], s41 offen lds
    s_mov_b32 m0, 15360
    s_add_u32 s41, s40, 114944
    buffer_load_dwordx4 v2, s[24:27], s41 offen lds
    s_waitcnt vmcnt(0)
L_wj_104:
    s_barrier
    v_lshlrev_b32 v2, 4, v1
    v_add_u32_e64 v2, 0, v2
    ds_read_b128 v[48:51], v2 offset:0
    ds_read_b128 v[52:55], v2 offset:8192
    ds_read_b128 v[56:59], v2 offset:1024
    ds_read_b128 v[60:63], v2 offset:9216
    ds_read_b128 v[64:67], v2 offset:2048
    ds_read_b128 v[68:71], v2 offset:10240
    ds_read_b128 v[72:75], v2 offset:3072
    s_waitcnt lgkmcnt(6)
    v_mfma_f32_16x16x32_bf16 v[80:83], v[48:51], v[16:19], 0
    ds_read_b128 v[76:79], v2 offset:11264
    s_waitcnt lgkmcnt(6)
    v_mfma_f32_16x16x32_bf16 v[84:87], v[52:55], v[16:19], 0
    ds_read_b128 v[48:51], v2 offset:4096
    s_waitcnt lgkmcnt(6)
    v_mfma_f32_16x16x32_bf16 v[80:83], v[56:59], v[20:23], v[80:83]
    ds_read_b128 v[52:55], v2 offset:12288
    s_waitcnt lgkmcnt(6)
    v_mfma_f32_16x16x32_bf16 v[84:87], v[60:63], v[20:23], v[84:87]
    ds_read_b128 v[56:59], v2 offset:5120
    s_waitcnt lgkmcnt(6)
    v_mfma_f32_16x16x32_bf16 v[80:83], v[64:67], v[24:27], v[80:83]
    ds_read_b128 v[60:63], v2 offset:13312
    s_waitcnt lgkmcnt(6)
    v_mfma_f32_16x16x32_bf16 v[84:87], v[68:71], v[24:27], v[84:87]
    ds_read_b128 v[64:67], v2 offset:6144
    s_waitcnt lgkmcnt(6)
    v_mfma_f32_16x16x32_bf16 v[80:83], v[72:75], v[28:31], v[80:83]
    ds_read_b128 v[68:71], v2 offset:14336
    s_waitcnt lgkmcnt(6)
    v_mfma_f32_16x16x32_bf16 v[84:87], v[76:79], v[28:31], v[84:87]
    ds_read_b128 v[72:75], v2 offset:7168
    s_waitcnt lgkmcnt(6)
    v_mfma_f32_16x16x32_bf16 v[80:83], v[48:51], v[32:35], v[80:83]
    ds_read_b128 v[76:79], v2 offset:15360
    s_waitcnt lgkmcnt(6)
    v_mfma_f32_16x16x32_bf16 v[84:87], v[52:55], v[32:35], v[84:87]
    s_waitcnt lgkmcnt(5)
    v_mfma_f32_16x16x32_bf16 v[80:83], v[56:59], v[36:39], v[80:83]
    s_waitcnt lgkmcnt(4)
    v_mfma_f32_16x16x32_bf16 v[84:87], v[60:63], v[36:39], v[84:87]
    s_waitcnt lgkmcnt(3)
    v_mfma_f32_16x16x32_bf16 v[80:83], v[64:67], v[40:43], v[80:83]
    s_waitcnt lgkmcnt(2)
    v_mfma_f32_16x16x32_bf16 v[84:87], v[68:71], v[40:43], v[84:87]
    s_waitcnt lgkmcnt(1)
    v_mfma_f32_16x16x32_bf16 v[80:83], v[72:75], v[44:47], v[80:83]
    s_waitcnt lgkmcnt(0)
    v_mfma_f32_16x16x32_bf16 v[84:87], v[76:79], v[44:47], v[84:87]
    v_and_b32 v2, 15, v1
    v_lshrrev_b32 v3, 4, v1
    v_and_b32 v4, 7, v2
    v_xor_b32 v3, v3, v4
    v_lshlrev_b32_e64 v5, 4, v3
    v_lshl_add_u32 v5, v2, 7, v5
    s_lshl_b32 s40, s30, 11
    s_add_u32 s40, s40, 16384
    v_add_u32 v5, s40, v5
    v_xor_b32_e64 v6, 64, v5
    ds_write_b128 v5, v[80:83]
    ds_write_b128 v6, v[84:87]
    v_lshrrev_b32 v2, 2, v1
    v_and_b32 v3, 3, v1
    v_lshlrev_b32 v3, 1, v3
    v_and_b32 v4, 7, v2
    v_xor_b32 v3, v3, v4
    v_lshlrev_b32 v7, 4, v3
    v_lshl_add_u32 v7, v2, 7, v7
    v_add_u32 v7, s40, v7
    v_xor_b32 v6, 16, v7
    ds_read_b128 v[80:83], v7
    ds_read_b128 v[84:87], v6
    s_waitcnt vmcnt(0)
    v_alignbit_b32 v104, v93, v92, 16
    v_alignbit_b32 v105, v94, v93, 16
    v_alignbit_b32 v106, v95, v94, 16
    v_lshrrev_b32 v107, 16, v95
    v_lshl_or_b32 v107, v96, 16, v107
    v_cndmask_b32 v92, v92, v104, s[52:53]
    v_cndmask_b32 v93, v93, v105, s[52:53]
    v_cndmask_b32 v94, v94, v106, s[52:53]
    v_cndmask_b32 v95, v95, v107, s[52:53]
    s_mov_b32 s54, 0xffff0000
    v_lshlrev_b32 v104, 16, v88
    v_and_b32 v105, s54, v88
    v_lshlrev_b32 v119, 16, v92
    v_and_b32 v118, s54, v92
    v_lshlrev_b32 v106, 16, v89
    v_and_b32 v107, s54, v89
    v_lshlrev_b32 v117, 16, v93
    v_and_b32 v116, s54, v93
    v_lshlrev_b32 v108, 16, v90
    v_and_b32 v109, s54, v90
    v_lshlrev_b32 v115, 16, v94
    v_and_b32 v114, s54, v94
    v_lshlrev_b32 v110, 16, v91
    v_and_b32 v111, s54, v91
    v_lshlrev_b32 v113, 16, v95
    v_and_b32 v112, s54, v95
    s_waitcnt lgkmcnt(1)
    v_add_f32 v112, v112, v80
    v_add_f32 v113, v113, v81
    v_add_f32 v114, v114, v82
    v_add_f32 v115, v115, v83
    s_waitcnt lgkmcnt(0)
    v_add_f32 v116, v116, v84
    v_add_f32 v117, v117, v85
    v_add_f32 v118, v118, v86
    v_add_f32 v119, v119, v87
    v_mov_b32_e64 v99, 0
    v_cndmask_b32 v80, v80, v99, s[52:53]
    v_add_f32 v104, v104, v80
    v_add_f32 v105, v105, v81
    v_add_f32 v106, v106, v82
    v_add_f32 v107, v107, v83
    v_add_f32 v108, v108, v84
    v_add_f32 v109, v109, v85
    v_add_f32 v110, v110, v86
    v_add_f32 v111, v111, v87
    v_cvt_pk_bf16_f32 v120, v104, v105
    v_cvt_pk_bf16_f32 v121, v106, v107
    v_cvt_pk_bf16_f32 v122, v108, v109
    v_cvt_pk_bf16_f32 v123, v110, v111
    v_cvt_pk_bf16_f32 v124, v119, v118
    v_cvt_pk_bf16_f32 v125, v117, v116
    v_cvt_pk_bf16_f32 v126, v115, v114
    v_cvt_pk_bf16_f32 v127, v113, v112
    s_mov_b32 s46, 10485760
    s_mov_b32 s47, 13369344
    buffer_store_dwordx4 v[120:123], v8, s[24:27], s46 offen sc1
    s_not_b64 exec, s[52:53]
    buffer_store_dwordx4 v[124:127], v9, s[24:27], s46 offen sc1
    s_mov_b64 exec, -1
    s_nop 0
    s_cmp_lg_u32 s35, 0
    s_cbranch_scc1 L_qsp_108
    v_subrev_u32 v13, 498, v9
    s_mov_b64 exec, s[52:53]
    buffer_store_dwordx3 v[124:126], v9, s[24:27], s46 offen sc1
    buffer_store_short v127, v9, s[24:27], s46 offen offset:12 sc1
    buffer_store_short_d16_hi v127, v13, s[24:27], s46 offen sc1
    s_mov_b64 exec, -1
L_qsp_108:
    v_add_f32 v128, v104, v105
    v_mul_f32 v129, v104, v104
    v_fmac_f32 v129, v105, v105
    v_add_f32 v128, v128, v106
    v_fmac_f32 v129, v106, v106
    v_add_f32 v128, v128, v107
    v_fmac_f32 v129, v107, v107
    v_add_f32 v128, v128, v108
    v_fmac_f32 v129, v108, v108
    v_add_f32 v128, v128, v109
    v_fmac_f32 v129, v109, v109
    v_add_f32 v128, v128, v110
    v_fmac_f32 v129, v110, v110
    v_add_f32 v128, v128, v111
    v_fmac_f32 v129, v111, v111
    v_add_f32 v130, v112, v113
    v_mul_f32 v131, v112, v112
    v_fmac_f32 v131, v113, v113
    v_add_f32 v130, v130, v114
    v_fmac_f32 v131, v114, v114
    v_add_f32 v130, v130, v115
    v_fmac_f32 v131, v115, v115
    v_add_f32 v130, v130, v116
    v_fmac_f32 v131, v116, v116
    v_add_f32 v130, v130, v117
    v_fmac_f32 v131, v117, v117
    v_add_f32 v130, v130, v118
    v_fmac_f32 v131, v118, v118
    v_add_f32 v130, v130, v119
    v_fmac_f32_e64 v131, v119, v119
    v_add_f32_dpp v128, v128, v128 quad_perm:[1,0,3,2] row_mask:0xf bank_mask:0xf
    v_add_f32_dpp v129, v129, v129 quad_perm:[1,0,3,2] row_mask:0xf bank_mask:0xf
    v_add_f32_dpp v130, v130, v130 quad_perm:[1,0,3,2] row_mask:0xf bank_mask:0xf
    v_add_f32_dpp v131, v131, v131 quad_perm:[1,0,3,2] row_mask:0xf bank_mask:0xf
    v_add_f32_dpp v128, v128, v128 quad_perm:[2,3,0,1] row_mask:0xf bank_mask:0xf
    v_add_f32_dpp v129, v129, v129 quad_perm:[2,3,0,1] row_mask:0xf bank_mask:0xf
    v_add_f32_dpp v130, v130, v130 quad_perm:[2,3,0,1] row_mask:0xf bank_mask:0xf
    v_add_f32_dpp v131, v131, v131 quad_perm:[2,3,0,1] row_mask:0xf bank_mask:0xf
    s_mov_b32 exec_lo, 0x11111111
    s_mov_b32 exec_hi, 0x11111111
    buffer_store_dwordx2 v[128:129], v10, s[24:27], s47 offen sc1
    buffer_store_dwordx2 v[130:131], v11, s[24:27], s47 offen sc1
    s_mov_b64 exec, -1
    s_waitcnt vmcnt(0)
    s_barrier
    s_cmp_lg_u32 s30, 0
    s_cbranch_scc1 L_fs_109
    s_add_u32 s40, s32, 6
    v_mov_b32 v2, s40
    v_mov_b32_e64 v3, s33
    s_lshl_b32 s41, s2, 6
    s_add_u32 s41, s41, 98304
    v_mov_b32 v4, s41
    s_mov_b64 exec, 1
    buffer_store_dwordx2 v[2:3], v4, s[24:27], 0 offen sc1
    s_mov_b64 exec, -1
L_fs_109:
    s_cmp_ge_u32 s29, 28
    s_cbranch_scc1 L_idle_110
    s_and_b32 s40, s30, 1
    s_lshl_b32 s40, s40, 3
    s_or_b32 s41, s40, 0
    v_xor_b32 v2, s41, v1
    v_lshlrev_b32 v2, 4, v2
    v_add_u32 v120, 0, v2
    s_or_b32 s41, s40, 1
    v_xor_b32 v2, s41, v1
    v_lshlrev_b32 v2, 4, v2
    v_add_u32 v121, 128, v2
    s_or_b32 s41, s40, 2
    v_xor_b32 v2, s41, v1
    v_lshlrev_b32_e64 v2, 4, v2
    v_add_u32 v122, 256, v2
    s_or_b32 s41, s40, 3
    v_xor_b32 v2, s41, v1
    v_lshlrev_b32_e64 v2, 4, v2
    v_add_u32 v123, 384, v2
    s_or_b32 s41, s40, 4
    v_xor_b32 v2, s41, v1
    v_lshlrev_b32 v2, 4, v2
    v_add_u32 v124, 0, v2
    s_or_b32 s41, s40, 5
    v_xor_b32 v2, s41, v1
    v_lshlrev_b32_e64 v2, 4, v2
    v_add_u32 v125, 128, v2
    s_or_b32 s41, s40, 6
    v_xor_b32 v2, s41, v1
    v_lshlrev_b32_e64 v2, 4, v2
    v_add_u32 v126, 256, v2
    s_or_b32 s41, s40, 7
    v_xor_b32 v2, s41, v1
    v_lshlrev_b32_e64 v2, 4, v2
    v_add_u32 v127, 384, v2
    v_and_b32 v3, 31, v1
    v_lshrrev_b32 v4, 5, v1
    v_and_b32 v5, 15, v3
    v_add_u32 v6, 0, v4
    v_xor_b32 v6, v6, v5
    v_lshlrev_b32 v6, 4, v6
    v_lshl_add_u32 v128, v3, 10, v6
    v_add_u32 v6, 2, v4
    v_xor_b32 v6, v6, v5
    v_lshlrev_b32_e64 v6, 4, v6
    v_lshl_add_u32 v129, v3, 10, v6
    v_add_u32 v6, 4, v4
    v_xor_b32 v6, v6, v5
    v_lshlrev_b32_e64 v6, 4, v6
    v_lshl_add_u32 v130, v3, 10, v6
    v_add_u32 v6, 6, v4
    v_xor_b32 v6, v6, v5
    v_lshlrev_b32_e64 v6, 4, v6
    v_lshl_add_u32 v131, v3, 10, v6
    v_add_u32 v6, 8, v4
    v_xor_b32 v6, v6, v5
    v_lshlrev_b32_e64 v6, 4, v6
    v_lshl_add_u32 v132, v3, 10, v6
    v_add_u32 v6, 10, v4
    v_xor_b32 v6, v6, v5
    v_lshlrev_b32_e64 v6, 4, v6
    v_lshl_add_u32 v133, v3, 10, v6
    v_add_u32 v6, 12, v4
    v_xor_b32 v6, v6, v5
    v_lshlrev_b32_e64 v6, 4, v6
    v_lshl_add_u32 v134, v3, 10, v6
    v_add_u32 v6, 14, v4
    v_xor_b32 v6, v6, v5
    v_lshlrev_b32_e64 v6, 4, v6
    v_lshl_add_u32 v135, v3, 10, v6
    v_lshlrev_b32_e64 v115, 4, v3
    v_add_u32 v115, 0x20000, v115
    s_lshl_b32 s40, s30, 1
    v_add_u32 v6, s40, v4
    v_and_b32 v7, 7, v3
    v_xor_b32 v6, v6, v7
    v_lshlrev_b32_e64 v6, 4, v6
    v_lshl_add_u32 v6, v3, 7, v6
    v_add_u32 v112, 0x21000, v6
    v_lshrrev_b32 v6, 3, v1
    v_and_b32 v7, 7, v1
    v_xor_b32 v8, v6, v7
    v_lshlrev_b32 v8, 4, v8
    s_lshl_b32 s40, s30, 3
    v_add_u32 v6, s40, v6
    v_lshl_add_u32 v8, v6, 7, v8
    v_add_u32 v113, 0x21000, v8
    s_movk_i32 s40, 3712
    v_mul_lo_u32 v6, v6, s40
    v_lshl_add_u32 v114, v7, 4, v6
    s_lshl_b32 s57, s28, 8
    s_lshl_b32 s40, s30, 3
    s_add_u32 s57, s57, s40
    s_mul_i32 s57, s57, 1152
    s_add_u32 s57, s57, 10485760
    s_lshl_b32 s58, s30, 13
    s_mul_i32 s59, s28, 950272
    s_lshl_b32 s40, s29, 7
    s_add_u32 s59, s59, s40
    s_add_u32 s59, s59, 21495808
    s_movk_i32 s60, 4608
    s_mov_b32 s61, 32256
    s_mov_b32 s62, 118784
    v_lshlrev_b32 v2, 3, v1
    v_add_u32 v2, s28, v2
    v_lshlrev_b32_e64 v2, 6, v2
    v_add_u32 v4, 98304, v2
    s_nop 1
    s_cmp_lg_u32 s30, 0
    s_cbranch_scc1 L_ps_114
    s_add_u32 s40, s32, 6
    s_mov_b32 exec_lo, -1
    s_mov_b32 exec_hi, 0
    s_mov_b32 s98, 0
    v_mov_b32 v2, 0
    v_mov_b32 v3, 0
    s_nop 1
L_poll_112:
    buffer_load_dwordx2 v[2:3], v4, s[24:27], 0 offen sc1
    s_add_u32 s98, s98, 1
    s_cmp_gt_u32 s98, 0x40000
    s_cbranch_scc1 L_pd_113
    s_waitcnt vmcnt(0)
    v_subrev_u32_e64 v2, s40, v2
    v_cmp_gt_u32 vcc, 64, v2
    v_cmp_eq_u32 s[42:43], s33, v3
    s_nop 1
    s_and_b64 vcc, vcc, s[42:43]
    s_cmp_eq_u64 vcc, exec
    s_cbranch_scc0 L_poll_112
L_pd_113:
    s_waitcnt vmcnt(0)
    s_mov_b64 exec, -1
L_ps_114:
    s_barrier
    s_add_u32 m0, s58, 0
    s_nop 0
    buffer_load_dwordx4 v120, s[24:27], s57 offen offset:0 lds
    buffer_load_dwordx4 v121, s[24:27], s57 offen offset:1024 lds
    buffer_load_dwordx4 v122, s[24:27], s57 offen offset:2048 lds
    buffer_load_dwordx4 v123, s[24:27], s57 offen offset:3072 lds
    s_add_u32 s57, s57, s60
    s_add_u32 m0, s58, 4096
    s_nop 0
    buffer_load_dwordx4 v124, s[24:27], s57 offen offset:0 lds
    buffer_load_dwordx4 v125, s[24:27], s57 offen offset:1024 lds
    buffer_load_dwordx4 v126, s[24:27], s57 offen offset:2048 lds
    buffer_load_dwordx4 v127, s[24:27], s57 offen offset:3072 lds
    s_add_u32 s57, s57, s61
    s_lshl_b32 s41, s30, 6
    v_add_u32 v2, s41, v1
    v_lshlrev_b32_e64 v116, 4, v2
    v_add_u32 v116, 0x20000, v116
    v_lshlrev_b32 v2, 3, v2
    s_lshl_b32 s40, s28, 15
    s_add_u32 s40, s40, 13369344
    buffer_load_dwordx2 v[32:33], v2, s[24:27], s40 offen offset:0
    buffer_load_dwordx2 v[34:35], v2, s[24:27], s40 offen offset:2048
    s_add_u32 s40, s40, 4096
    buffer_load_dwordx2 v[36:37], v2, s[24:27], s40 offen offset:0
    buffer_load_dwordx2 v[38:39], v2, s[24:27], s40 offen offset:2048
    s_add_u32 s40, s40, 4096
    buffer_load_dwordx2 v[40:41], v2, s[24:27], s40 offen offset:0
    buffer_load_dwordx2 v[42:43], v2, s[24:27], s40 offen offset:2048
    s_add_u32 s40, s40, 4096
    buffer_load_dwordx2 v[44:45], v2, s[24:27], s40 offen offset:0
    buffer_load_dwordx2 v[46:47], v2, s[24:27], s40 offen offset:2048
    s_add_u32 s40, s40, 4096
    buffer_load_dwordx2 v[104:105], v2, s[24:27], s40 offen offset:0
    buffer_load_dwordx2 v[106:107], v2, s[24:27], s40 offen offset:2048
    s_add_u32 s40, s40, 4096
    buffer_load_dwordx2 v[108:109], v2, s[24:27], s40 offen offset:0
    buffer_load_dwordx2 v[110:111], v2, s[24:27], s40 offen offset:2048
    s_add_u32 s40, s40, 4096
    buffer_load_dwordx2 v[136:137], v2, s[24:27], s40 offen offset:0
    buffer_load_dwordx2 v[138:139], v2, s[24:27], s40 offen offset:2048
    s_add_u32 s40, s40, 4096
    buffer_load_dwordx2 v[140:141], v2, s[24:27], s40 offen offset:0
    buffer_load_dwordx2 v[142:143], v2, s[24:27], s40 offen offset:2048
    s_add_u32 m0, s58, 32768
    s_nop 0
    buffer_load_dwordx4 v120, s[24:27], s57 offen offset:0 lds
    buffer_load_dwordx4 v121, s[24:27], s57 offen offset:1024 lds
    buffer_load_dwordx4 v122, s[24:27], s57 offen offset:2048 lds
    buffer_load_dwordx4 v123, s[24:27], s57 offen offset:3072 lds
    s_add_u32 s57, s57, s60
    s_add_u32 m0, s58, 36864
    s_nop 0
    buffer_load_dwordx4 v124, s[24:27], s57 offen offset:0 lds
    buffer_load_dwordx4 v125, s[24:27], s57 offen offset:1024 lds
    buffer_load_dwordx4 v126, s[24:27], s57 offen offset:2048 lds
    buffer_load_dwordx4 v127, s[24:27], s57 offen offset:3072 lds
    s_add_u32 s57, s57, s61
    s_getpc_b64 s[42:43]
L_pc_115:
    s_lshl_b32 s40, s29, 2
    s_add_u32 s40, s40, s30
    s_lshl_b32 s40, s40, 10
    v_lshlrev_b32 v2, 4, v1
    v_add_u32 v2, s40, v2
    v_min_u32 v2, 24560, v2
    v_add_u32 v2, 12288, v2
    v_min_u32 v2, L_code_end-L_pc_115-16, v2
    global_load_dwordx4 v[92:95], v2, s[42:43]
    s_waitcnt vmcnt(25)
    s_barrier
    ds_read_b128 v[48:51], v128 offset:0
    ds_read_b128 v[52:55], v129 offset:0
    ds_read_b128 v[56:59], v130 offset:0
    ds_read_b128 v[60:63], v131 offset:0
    ds_read_b128 v[64:67], v132 offset:0
    ds_read_b128 v[68:71], v133 offset:0
    ds_read_b128 v[72:75], v134 offset:0
    s_waitcnt lgkmcnt(3)
    v_mfma_f32_32x32x16_bf16 v[16:31], a[0:3], v[48:51], 0
    ds_read_b128 v[76:79], v135 offset:0
    v_mfma_f32_32x32x16_bf16 v[16:31], a[4:7], v[52:55], v[16:31]
    ds_read_b128 v[80:83], v128 offset:256
    s_add_u32 m0, s58, 65536
    v_mfma_f32_32x32x16_bf16 v[16:31], a[8:11], v[56:59], v[16:31]
    ds_read_b128 v[84:87], v129 offset:256
    buffer_load_dwordx4 v120, s[24:27], s57 offen offset:0 lds
    s_waitcnt vmcnt(17)
    v_add_f32 v32, v32, v104
    v_add_f32 v33, v33, v105
    s_waitcnt vmcnt(16)
    v_add_f32 v34, v34, v106
    v_mfma_f32_32x32x16_bf16 v[16:31], a[12:15], v[60:63], v[16:31]
    ds_read_b128 v[48:51], v130 offset:256
    s_waitcnt lgkmcnt(3)
    buffer_load_dwordx4 v121, s[24:27], s57 offen offset:1024 lds
    v_add_f32 v35, v35, v107
    s_waitcnt vmcnt(16)
    v_add_f32 v36, v36, v108
    v_mfma_f32_32x32x16_bf16 v[16:31], a[16:19], v[64:67], v[16:31]
    ds_read_b128 v[52:55], v131 offset:256
    buffer_load_dwordx4 v122, s[24:27], s57 offen offset:2048 lds
    v_add_f32 v37, v37, v109
    s_waitcnt vmcnt(16)
    v_add_f32 v38, v38, v110
    v_add_f32 v39, v39, v111
    v_mfma_f32_32x32x16_bf16 v[16:31], a[20:23], v[68:71], v[16:31]
    ds_read_b128 v[56:59], v132 offset:256
    buffer_load_dwordx4 v123, s[24:27], s57 offen offset:3072 lds
    s_waitcnt vmcnt(16)
    v_add_f32 v40, v40, v136
    v_add_f32 v41, v41, v137
    s_waitcnt vmcnt(15)
    v_add_f32_e64 v42, v42, v138
    v_mfma_f32_32x32x16_bf16 v[16:31], a[24:27], v[72:75], v[16:31]
    ds_read_b128 v[60:63], v133 offset:256
    s_add_u32 s57, s57, s60
    v_add_f32 v43, v43, v139
    s_waitcnt vmcnt(14)
    v_add_f32 v44, v44, v140
    v_add_f32 v45, v45, v141
    s_waitcnt vmcnt(13)
    v_add_f32_e64 v46, v46, v142
    v_mfma_f32_32x32x16_bf16 v[16:31], a[28:31], v[76:79], v[16:31]
    ds_read_b128 v[64:67], v134 offset:256
    s_waitcnt lgkmcnt(3)
    v_add_f32 v47, v47, v143
    v_add_f32 v32, v32, v40
    v_add_f32 v33, v33, v41
    v_add_f32_e64 v34, v34, v42
    v_mfma_f32_32x32x16_bf16 v[16:31], a[32:35], v[80:83], v[16:31]
    ds_read_b128 v[68:71], v135 offset:256
    s_add_u32 m0, s58, 69632
    v_add_f32 v35, v35, v43
    v_add_f32 v36, v36, v44
    v_add_f32_e64 v37, v37, v45
    v_mfma_f32_32x32x16_bf16 v[16:31], a[36:39], v[84:87], v[16:31]
    ds_read_b128 v[72:75], v128 offset:512
    buffer_load_dwordx4 v124, s[24:27], s57 offen offset:0 lds
    v_add_f32 v38, v38, v46
    v_add_f32 v39, v39, v47
    v_add_f32_e64 v32, v32, v36
    v_mfma_f32_32x32x16_bf16 v[16:31], a[40:43], v[48:51], v[16:31]
    ds_read_b128 v[76:79], v129 offset:512
    buffer_load_dwordx4 v125, s[24:27], s57 offen offset:1024 lds
    v_add_f32 v33, v33, v37
    v_add_f32 v34, v34, v38
    v_add_f32_e64 v35, v35, v39
    v_mfma_f32_32x32x16_bf16 v[16:31], a[44:47], v[52:55], v[16:31]
    ds_read_b128 v[80:83], v130 offset:512
    s_waitcnt lgkmcnt(3)
    buffer_load_dwordx4 v126, s[24:27], s57 offen offset:2048 lds
    v_add_f32 v32, v32, v34
    v_add_f32_e64 v33, v33, v35
    v_mfma_f32_32x32x16_bf16 v[16:31], a[48:51], v[56:59], v[16:31]
    ds_read_b128 v[84:87], v131 offset:512
    buffer_load_dwordx4 v127, s[24:27], s57 offen offset:3072 lds
    v_mul_f32 v32, 0xbb000000, v32
    v_mul_f32 v33, 0x3b000000, v33
    v_fma_f32 v34, -v32, v32, v33
    v_mfma_f32_32x32x16_bf16 v[16:31], a[52:55], v[60:63], v[16:31]
    ds_read_b128 v[48:51], v132 offset:512
    s_add_u32 s57, s57, s61
    v_add_f32 v34, 0x3727c5ac, v34
    v_rsq_f32_e64 v33, v34
    s_nop 0
    v_mul_f32 v33, 0xbfb8aa3b, v33
    ds_write_b128 v116, v[32:35]
    v_mfma_f32_32x32x16_bf16 v[16:31], a[56:59], v[64:67], v[16:31]
    ds_read_b128 v[52:55], v133 offset:512
    v_mfma_f32_32x32x16_bf16 v[16:31], a[60:63], v[68:71], v[16:31]
    ds_read_b128 v[56:59], v134 offset:512
    s_waitcnt lgkmcnt(4)
    s_waitcnt vmcnt(9)
    s_waitcnt lgkmcnt(0)
    s_barrier
    v_mfma_f32_32x32x16_bf16 v[16:31], a[64:67], v[72:75], v[16:31]
    ds_read_b128 v[60:63], v135 offset:512
    s_add_u32 m0, s58, 98304
    v_mfma_f32_32x32x16_bf16 v[16:31], a[68:71], v[76:79], v[16:31]
    ds_read_b128 v[64:67], v128 offset:768
    buffer_load_dwordx4 v120, s[24:27], s57 offen offset:0 lds
    v_mfma_f32_32x32x16_bf16 v[16:31], a[72:75], v[80:83], v[16:31]
    ds_read_b128 v[68:71], v129 offset:768
    buffer_load_dwordx4 v121, s[24:27], s57 offen offset:1024 lds
    v_mfma_f32_32x32x16_bf16 v[16:31], a[76:79], v[84:87], v[16:31]
    ds_read_b128 v[72:75], v130 offset:768
    s_waitcnt lgkmcnt(3)
    buffer_load_dwordx4 v122, s[24:27], s57 offen offset:2048 lds
    v_mfma_f32_32x32x16_bf16 v[16:31], a[80:83], v[48:51], v[16:31]
    ds_read_b128 v[76:79], v131 offset:768
    buffer_load_dwordx4 v123, s[24:27], s57 offen offset:3072 lds
    v_mfma_f32_32x32x16_bf16 v[16:31], a[84:87], v[52:55], v[16:31]
    ds_read_b128 v[80:83], v132 offset:768
    s_add_u32 s57, s57, s60
    v_mfma_f32_32x32x16_bf16 v[16:31], a[88:91], v[56:59], v[16:31]
    ds_read_b128 v[84:87], v133 offset:768
    v_mfma_f32_32x32x16_bf16 v[16:31], a[92:95], v[60:63], v[16:31]
    ds_read_b128 v[48:51], v134 offset:768
    s_waitcnt lgkmcnt(3)
    s_add_u32 m0, s58, 102400
    v_mfma_f32_32x32x16_bf16 v[16:31], a[96:99], v[64:67], v[16:31]
    ds_read_b128 v[52:55], v135 offset:768
    ds_read_b128 v[96:99], v115 offset:0
    buffer_load_dwordx4 v124, s[24:27], s57 offen offset:0 lds
    v_mfma_f32_32x32x16_bf16 v[16:31], a[100:103], v[68:71], v[16:31]
    ds_read_b128 v[56:59], v128 offset:32768
    buffer_load_dwordx4 v125, s[24:27], s57 offen offset:1024 lds
    v_mfma_f32_32x32x16_bf16 v[16:31], a[104:107], v[72:75], v[16:31]
    ds_read_b128 v[60:63], v129 offset:32768
    buffer_load_dwordx4 v126, s[24:27], s57 offen offset:2048 lds
    v_mfma_f32_32x32x16_bf16 v[16:31], a[108:111], v[76:79], v[16:31]
    ds_read_b128 v[64:67], v130 offset:32768
    s_waitcnt lgkmcnt(4)
    buffer_load_dwordx4 v127, s[24:27], s57 offen offset:3072 lds
    v_mfma_f32_32x32x16_bf16 v[16:31], a[112:115], v[80:83], v[16:31]
    ds_read_b128 v[68:71], v131 offset:32768
    s_add_u32 s57, s57, s61
    v_mfma_f32_32x32x16_bf16 v[16:31], a[116:119], v[84:87], v[16:31]
    ds_read_b128 v[72:75], v132 offset:32768
    v_mfma_f32_32x32x16_bf16 v[16:31], a[120:123], v[48:51], v[16:31]
    ds_read_b128 v[76:79], v133 offset:32768
    v_mfma_f32_32x32x16_bf16 v[16:31], a[124:127], v[52:55], v[16:31]
    ds_read_b128 v[80:83], v134 offset:32768
    s_waitcnt lgkmcnt(3)
    v_mfma_f32_32x32x16_bf16 v[32:47], a[0:3], v[56:59], 0
    ds_read_b128 v[84:87], v135 offset:32768
    v_mfma_f32_32x32x16_bf16 v[32:47], a[4:7], v[60:63], v[32:47]
    ds_read_b128 v[48:51], v128 offset:33024
    v_mfma_f32_32x32x16_bf16 v[32:47], a[8:11], v[64:67], v[32:47]
    ds_read_b128 v[52:55], v129 offset:33024
    v_mfma_f32_32x32x16_bf16 v[32:47], a[12:15], v[68:71], v[32:47]
    ds_read_b128 v[56:59], v130 offset:33024
    s_waitcnt lgkmcnt(3)
    s_nop 0
    v_fmac_f32 v16, v96, v144
    v_fmac_f32 v17, v96, v145
    v_fmac_f32 v18, v96, v146
    v_fmac_f32 v19, v96, v147
    v_mfma_f32_32x32x16_bf16 v[32:47], a[16:19], v[72:75], v[32:47]
    ds_read_b128 v[60:63], v131 offset:33024
    v_fmac_f32 v20, v96, v148
    v_fmac_f32 v21, v96, v149
    v_fmac_f32 v22, v96, v150
    v_fmac_f32 v23, v96, v151
    v_mfma_f32_32x32x16_bf16 v[32:47], a[20:23], v[76:79], v[32:47]
    ds_read_b128 v[64:67], v132 offset:33024
    v_mul_f32 v104, v16, v97
    v_mul_f32 v105, v17, v97
    v_mul_f32 v106, v18, v97
    v_mul_f32 v107, v19, v97
    v_mfma_f32_32x32x16_bf16 v[32:47], a[24:27], v[80:83], v[32:47]
    ds_read_b128 v[68:71], v133 offset:33024
    v_mul_f32 v108, v20, v97
    v_mul_f32 v109, v21, v97
    v_mul_f32 v110, v22, v97
    v_mul_f32 v111, v23, v97
    v_mfma_f32_32x32x16_bf16 v[32:47], a[28:31], v[84:87], v[32:47]
    ds_read_b128 v[72:75], v134 offset:33024
    s_waitcnt lgkmcnt(3)
    v_fmac_f32 v24, v96, v152
    v_fmac_f32 v25, v96, v153
    v_fmac_f32 v26, v96, v154
    v_fmac_f32_e64 v27, v96, v155
    v_mfma_f32_32x32x16_bf16 v[32:47], a[32:35], v[48:51], v[32:47]
    ds_read_b128 v[76:79], v135 offset:33024
    ds_read_b128 v[140:143], v115 offset:512
    v_fmac_f32 v28, v96, v156
    v_fmac_f32 v29, v96, v157
    v_fmac_f32 v30, v96, v158
    v_fmac_f32 v31, v96, v159
    v_mfma_f32_32x32x16_bf16 v[32:47], a[36:39], v[52:55], v[32:47]
    ds_read_b128 v[80:83], v128 offset:33280
    v_exp_f32 v104, v104
    v_mul_f32 v16, v16, v24
    v_mfma_f32_32x32x16_bf16 v[32:47], a[40:43], v[56:59], v[32:47]
    ds_read_b128 v[84:87], v129 offset:33280
    v_exp_f32 v105, v105
    v_mul_f32 v17, v17, v25
    v_mfma_f32_32x32x16_bf16 v[32:47], a[44:47], v[60:63], v[32:47]
    ds_read_b128 v[48:51], v130 offset:33280
    s_waitcnt lgkmcnt(4)
    v_exp_f32 v106, v106
    v_mul_f32_e64 v18, v18, v26
    v_mfma_f32_32x32x16_bf16 v[32:47], a[48:51], v[64:67], v[32:47]
    ds_read_b128 v[52:55], v131 offset:33280
    v_exp_f32 v107, v107
    v_mul_f32 v19, v19, v27
    v_mfma_f32_32x32x16_bf16 v[32:47], a[52:55], v[68:71], v[32:47]
    ds_read_b128 v[56:59], v132 offset:33280
    v_exp_f32 v108, v108
    v_mul_f32 v20, v20, v28
    v_mfma_f32_32x32x16_bf16 v[32:47], a[56:59], v[72:75], v[32:47]
    ds_read_b128 v[60:63], v133 offset:33280
    v_exp_f32 v109, v109
    v_mul_f32 v21, v21, v29
    v_exp_f32_e64 v110, v110
    v_mfma_f32_32x32x16_bf16 v[32:47], a[60:63], v[76:79], v[32:47]
    ds_read_b128 v[64:67], v134 offset:33280
    s_waitcnt lgkmcnt(3)
    s_waitcnt vmcnt(8)
    s_barrier
    v_mul_f32 v22, v22, v30
    v_mfma_f32_32x32x16_bf16 v[32:47], a[64:67], v[80:83], v[32:47]
    ds_read_b128 v[68:71], v135 offset:33280
    s_add_u32 m0, s58, 0
    v_exp_f32 v111, v111
    v_mul_f32_e64 v23, v23, v31
    v_fma_f32 v104, v104, v98, v98
    v_mfma_f32_32x32x16_bf16 v[32:47], a[68:71], v[84:87], v[32:47]
    ds_read_b128 v[72:75], v128 offset:33536
    buffer_load_dwordx4 v120, s[24:27], s57 offen offset:0 lds
    v_fma_f32 v105, v105, v98, v98
    v_fma_f32 v106, v106, v98, v98
    v_fma_f32 v107, v107, v98, v98
    v_mfma_f32_32x32x16_bf16 v[32:47], a[72:75], v[48:51], v[32:47]
    ds_read_b128 v[76:79], v129 offset:33536
    buffer_load_dwordx4 v121, s[24:27], s57 offen offset:1024 lds
    v_fma_f32 v108, v108, v98, v98
    v_fma_f32 v109, v109, v98, v98
    v_fma_f32 v110, v110, v98, v98
    v_mfma_f32_32x32x16_bf16 v[32:47], a[76:79], v[52:55], v[32:47]
    ds_read_b128 v[80:83], v130 offset:33536
    s_waitcnt lgkmcnt(3)
    buffer_load_dwordx4 v122, s[24:27], s57 offen offset:2048 lds
    v_fma_f32 v111, v111, v98, v98
    v_mfma_f32_32x32x16_bf16 v[32:47], a[80:83], v[56:59], v[32:47]
    ds_read_b128 v[84:87], v131 offset:33536
    buffer_load_dwordx4 v123, s[24:27], s57 offen offset:3072 lds
    v_rcp_f32 v104, v104
    v_mfma_f32_32x32x16_bf16 v[32:47], a[84:87], v[60:63], v[32:47]
    ds_read_b128 v[48:51], v132 offset:33536
    s_add_u32 s57, s57, s60
    v_rcp_f32 v105, v105
    v_mul_f32_e64 v16, v16, v104
    v_mfma_f32_32x32x16_bf16 v[32:47], a[88:91], v[64:67], v[32:47]
    ds_read_b128 v[52:55], v133 offset:33536
    v_rcp_f32 v106, v106
    v_mul_f32 v17, v17, v105
    v_mfma_f32_32x32x16_bf16 v[32:47], a[92:95], v[68:71], v[32:47]
    ds_read_b128 v[56:59], v134 offset:33536
    s_waitcnt lgkmcnt(3)
    s_add_u32 m0, s58, 4096
    v_rcp_f32 v107, v107
    v_mul_f32_e64 v18, v18, v106
    v_mfma_f32_32x32x16_bf16 v[32:47], a[96:99], v[72:75], v[32:47]
    ds_read_b128 v[60:63], v135 offset:33536
    buffer_load_dwordx4 v124, s[24:27], s57 offen offset:0 lds
    v_add_u32 v128, 65536, v128
    v_add_u32 v129, 65536, v129
    v_add_u32 v130, 65536, v130
    v_add_u32 v131, 65536, v131
    v_add_u32 v132, 65536, v132
    v_add_u32 v133, 65536, v133
    v_add_u32 v134, 65536, v134
    v_add_u32 v135, 65536, v135
    v_mfma_f32_32x32x16_bf16 v[32:47], a[100:103], v[76:79], v[32:47]
    ds_read_b128 v[64:67], v128 offset:0
    buffer_load_dwordx4 v125, s[24:27], s57 offen offset:1024 lds
    v_rcp_f32 v108, v108
    v_mul_f32 v19, v19, v107
    v_mfma_f32_32x32x16_bf16 v[32:47], a[104:107], v[80:83], v[32:47]
    ds_read_b128 v[68:71], v129 offset:0
    buffer_load_dwordx4 v126, s[24:27], s57 offen offset:2048 lds
    v_rcp_f32 v109, v109
    v_mul_f32 v20, v20, v108
    v_mfma_f32_32x32x16_bf16 v[32:47], a[108:111], v[84:87], v[32:47]
    ds_read_b128 v[72:75], v130 offset:0
    s_waitcnt lgkmcnt(3)
    buffer_load_dwordx4 v127, s[24:27], s57 offen offset:3072 lds
    v_rcp_f32 v110, v110
    v_mfma_f32_32x32x16_bf16 v[32:47], a[112:115], v[48:51], v[32:47]
    ds_read_b128 v[76:79], v131 offset:0
    s_add_u32 s57, s57, s61
    v_mul_f32 v21, v21, v109
    v_rcp_f32_e64 v111, v111
    v_mfma_f32_32x32x16_bf16 v[32:47], a[116:119], v[52:55], v[32:47]
    ds_read_b128 v[80:83], v132 offset:0
    v_mul_f32 v22, v22, v110
    v_mul_f32 v23, v23, v111
    v_cvt_pk_bf16_f32 v100, v16, v17
    v_mfma_f32_32x32x16_bf16 v[32:47], a[120:123], v[56:59], v[32:47]
    ds_read_b128 v[84:87], v133 offset:0
    v_cvt_pk_bf16_f32 v101, v18, v19
    v_mfma_f32_32x32x16_bf16 v[32:47], a[124:127], v[60:63], v[32:47]
    ds_read_b128 v[48:51], v134 offset:0
    s_waitcnt lgkmcnt(3)
    v_cvt_pk_bf16_f32 v102, v20, v21
    v_cvt_pk_bf16_f32 v103, v22, v23
    v_mfma_f32_32x32x16_bf16 v[16:31], a[0:3], v[64:67], 0
    ds_read_b128 v[52:55], v135 offset:0
    v_mfma_f32_32x32x16_bf16 v[16:31], a[4:7], v[68:71], v[16:31]
    ds_read_b128 v[56:59], v128 offset:256
    ds_write_b128 v112, v[100:103] offset:0
    v_mfma_f32_32x32x16_bf16 v[16:31], a[8:11], v[72:75], v[16:31]
    ds_read_b128 v[60:63], v129 offset:256
    v_mfma_f32_32x32x16_bf16 v[16:31], a[12:15], v[76:79], v[16:31]
    ds_read_b128 v[64:67], v130 offset:256
    s_waitcnt lgkmcnt(4)
    v_fmac_f32 v32, v140, v144
    v_fmac_f32 v33, v140, v145
    v_fmac_f32 v34, v140, v146
    v_fmac_f32 v35, v140, v147
    v_mfma_f32_32x32x16_bf16 v[16:31], a[16:19], v[80:83], v[16:31]
    ds_read_b128 v[68:71], v131 offset:256
    v_fmac_f32 v36, v140, v148
    v_fmac_f32 v37, v140, v149
    v_fmac_f32 v38, v140, v150
    v_fmac_f32 v39, v140, v151
    v_mfma_f32_32x32x16_bf16 v[16:31], a[20:23], v[84:87], v[16:31]
    ds_read_b128 v[72:75], v132 offset:256
    v_mul_f32 v104, v32, v141
    v_mul_f32 v105, v33, v141
    v_mul_f32 v106, v34, v141
    v_mul_f32 v107, v35, v141
    v_mfma_f32_32x32x16_bf16 v[16:31], a[24:27], v[48:51], v[16:31]
    ds_read_b128 v[76:79], v133 offset:256
    v_mul_f32 v108, v36, v141
    v_mul_f32 v109, v37, v141
    v_mul_f32 v110, v38, v141
    v_mul_f32 v111, v39, v141
    v_mfma_f32_32x32x16_bf16 v[16:31], a[28:31], v[52:55], v[16:31]
    ds_read_b128 v[80:83], v134 offset:256
    s_waitcnt lgkmcnt(3)
    v_fmac_f32 v40, v140, v152
    v_fmac_f32 v41, v140, v153
    v_fmac_f32 v42, v140, v154
    v_fmac_f32_e64 v43, v140, v155
    v_mfma_f32_32x32x16_bf16 v[16:31], a[32:35], v[56:59], v[16:31]
    ds_read_b128 v[84:87], v135 offset:256
    ds_read_b128 v[96:99], v115 offset:1024
    v_fmac_f32 v44, v140, v156
    v_fmac_f32 v45, v140, v157
    v_fmac_f32_e64 v46, v140, v158
    v_mfma_f32_32x32x16_bf16 v[16:31], a[36:39], v[60:63], v[16:31]
    ds_read_b128 v[48:51], v128 offset:512
    v_fmac_f32 v47, v140, v159
    v_exp_f32 v104, v104
    v_mul_f32_e64 v32, v32, v40
    v_mfma_f32_32x32x16_bf16 v[16:31], a[40:43], v[64:67], v[16:31]
    ds_read_b128 v[52:55], v129 offset:512
    v_exp_f32 v105, v105
    v_mul_f32 v33, v33, v41
    v_mfma_f32_32x32x16_bf16 v[16:31], a[44:47], v[68:71], v[16:31]
    ds_read_b128 v[56:59], v130 offset:512
    s_waitcnt lgkmcnt(4)
    v_exp_f32 v106, v106
    v_mul_f32_e64 v34, v34, v42
    v_mfma_f32_32x32x16_bf16 v[16:31], a[48:51], v[72:75], v[16:31]
    ds_read_b128 v[60:63], v131 offset:512
    v_exp_f32 v107, v107
    v_mul_f32 v35, v35, v43
    v_mfma_f32_32x32x16_bf16 v[16:31], a[52:55], v[76:79], v[16:31]
    ds_read_b128 v[64:67], v132 offset:512
    v_exp_f32 v108, v108
    v_mul_f32 v36, v36, v44
    v_mfma_f32_32x32x16_bf16 v[16:31], a[56:59], v[80:83], v[16:31]
    ds_read_b128 v[68:71], v133 offset:512
    v_exp_f32 v109, v109
    v_mul_f32 v37, v37, v45
    v_mfma_f32_32x32x16_bf16 v[16:31], a[60:63], v[84:87], v[16:31]
    ds_read_b128 v[72:75], v134 offset:512
    s_waitcnt lgkmcnt(3)
    s_waitcnt vmcnt(8)
    s_barrier
    ds_read_b128 v[92:95], v113 offset:0
    v_mfma_f32_32x32x16_bf16 v[16:31], a[64:67], v[48:51], v[16:31]
    ds_read_b128 v[76:79], v135 offset:512
    s_add_u32 m0, s58, 32768
    v_exp_f32 v110, v110
    v_mul_f32_e64 v38, v38, v46
    v_mfma_f32_32x32x16_bf16 v[16:31], a[68:71], v[52:55], v[16:31]
    ds_read_b128 v[80:83], v128 offset:768
    buffer_load_dwordx4 v120, s[24:27], s57 offen offset:0 lds
    v_exp_f32 v111, v111
    v_mul_f32 v39, v39, v47
    v_mfma_f32_32x32x16_bf16 v[16:31], a[72:75], v[56:59], v[16:31]
    ds_read_b128 v[84:87], v129 offset:768
    buffer_load_dwordx4 v121, s[24:27], s57 offen offset:1024 lds
    v_fma_f32 v104, v104, v142, v142
    v_fma_f32 v105, v105, v142, v142
    v_fma_f32 v106, v106, v142, v142
    v_mfma_f32_32x32x16_bf16 v[16:31], a[76:79], v[60:63], v[16:31]
    ds_read_b128 v[48:51], v130 offset:768
    s_waitcnt lgkmcnt(3)
    buffer_load_dwordx4 v122, s[24:27], s57 offen offset:2048 lds
    v_fma_f32 v107, v107, v142, v142
    v_fma_f32 v108, v108, v142, v142
    v_mfma_f32_32x32x16_bf16 v[16:31], a[80:83], v[64:67], v[16:31]
    ds_read_b128 v[52:55], v131 offset:768
    buffer_load_dwordx4 v123, s[24:27], s57 offen offset:3072 lds
    v_fma_f32 v109, v109, v142, v142
    v_fma_f32 v110, v110, v142, v142
    v_fma_f32 v111, v111, v142, v142
    v_mfma_f32_32x32x16_bf16 v[16:31], a[84:87], v[68:71], v[16:31]
    ds_read_b128 v[56:59], v132 offset:768
    s_add_u32 s57, s57, s60
    v_rcp_f32 v104, v104
    v_rcp_f32 v105, v105
    v_mfma_f32_32x32x16_bf16 v[16:31], a[88:91], v[72:75], v[16:31]
    ds_read_b128 v[60:63], v133 offset:768
    v_mul_f32 v32, v32, v104
    v_rcp_f32 v106, v106
    v_mul_f32_e64 v33, v33, v105
    v_mfma_f32_32x32x16_bf16 v[16:31], a[92:95], v[76:79], v[16:31]
    ds_read_b128 v[64:67], v134 offset:768
    s_waitcnt lgkmcnt(3)
    s_add_u32 m0, s58, 36864
    v_rcp_f32 v107, v107
    v_mul_f32_e64 v34, v34, v106
    v_mfma_f32_32x32x16_bf16 v[16:31], a[96:99], v[80:83], v[16:31]
    ds_read_b128 v[68:71], v135 offset:768
    buffer_load_dwordx4 v124, s[24:27], s57 offen offset:0 lds
    v_rcp_f32 v108, v108
    v_mul_f32 v35, v35, v107
    v_mfma_f32_32x32x16_bf16 v[16:31], a[100:103], v[84:87], v[16:31]
    ds_read_b128 v[72:75], v128 offset:32768
    buffer_load_dwordx4 v125, s[24:27], s57 offen offset:1024 lds
    v_rcp_f32_e64 v109, v109
    v_mfma_f32_32x32x16_bf16 v[16:31], a[104:107], v[48:51], v[16:31]
    ds_read_b128 v[76:79], v129 offset:32768
    buffer_load_dwordx4 v126, s[24:27], s57 offen offset:2048 lds
    v_mul_f32_e64 v36, v36, v108
    v_mfma_f32_32x32x16_bf16 v[16:31], a[108:111], v[52:55], v[16:31]
    ds_read_b128 v[80:83], v130 offset:32768
    s_waitcnt lgkmcnt(3)
    buffer_load_dwordx4 v127, s[24:27], s57 offen offset:3072 lds
    v_rcp_f32 v110, v110
    v_mfma_f32_32x32x16_bf16 v[16:31], a[112:115], v[56:59], v[16:31]
    ds_read_b128 v[84:87], v131 offset:32768
    s_add_u32 s57, s57, s61
    v_mul_f32 v37, v37, v109
    v_rcp_f32_e64 v111, v111
    v_mfma_f32_32x32x16_bf16 v[16:31], a[116:119], v[60:63], v[16:31]
    ds_read_b128 v[48:51], v132 offset:32768
    v_mul_f32 v38, v38, v110
    v_mul_f32 v39, v39, v111
    v_cvt_pk_bf16_f32 v100, v32, v33
    v_mfma_f32_32x32x16_bf16 v[16:31], a[120:123], v[64:67], v[16:31]
    ds_read_b128 v[52:55], v133 offset:32768
    buffer_store_dwordx4 v[92:95], v114, s[24:27], s59 offen sc1
    s_add_u32 s59, s59, s62
    v_cvt_pk_bf16_f32 v101, v34, v35
    v_mfma_f32_32x32x16_bf16 v[16:31], a[124:127], v[68:71], v[16:31]
    ds_read_b128 v[56:59], v134 offset:32768
    s_waitcnt lgkmcnt(3)
    v_cvt_pk_bf16_f32 v102, v36, v37
    v_cvt_pk_bf16_f32 v103, v38, v39
    v_mfma_f32_32x32x16_bf16 v[32:47], a[0:3], v[72:75], 0
    ds_read_b128 v[60:63], v135 offset:32768
    v_mfma_f32_32x32x16_bf16 v[32:47], a[4:7], v[76:79], v[32:47]
    ds_read_b128 v[64:67], v128 offset:33024
    ds_write_b128 v112, v[100:103] offset:4096
    v_mfma_f32_32x32x16_bf16 v[32:47], a[8:11], v[80:83], v[32:47]
    ds_read_b128 v[68:71], v129 offset:33024
    v_mfma_f32_32x32x16_bf16 v[32:47], a[12:15], v[84:87], v[32:47]
    ds_read_b128 v[72:75], v130 offset:33024
    s_waitcnt lgkmcnt(4)
    v_fmac_f32 v16, v96, v144
    v_fmac_f32 v17, v96, v145
    v_fmac_f32 v18, v96, v146
    v_fmac_f32_e64 v19, v96, v147
    v_mfma_f32_32x32x16_bf16 v[32:47], a[16:19], v[48:51], v[32:47]
    ds_read_b128 v[76:79], v131 offset:33024
    v_fmac_f32 v20, v96, v148
    v_fmac_f32 v21, v96, v149
    v_fmac_f32 v22, v96, v150
    v_fmac_f32 v23, v96, v151
    v_mfma_f32_32x32x16_bf16 v[32:47], a[20:23], v[52:55], v[32:47]
    ds_read_b128 v[80:83], v132 offset:33024
    v_mul_f32 v104, v16, v97
    v_mul_f32 v105, v17, v97
    v_mul_f32 v106, v18, v97
    v_mul_f32 v107, v19, v97
    v_mfma_f32_32x32x16_bf16 v[32:47], a[24:27], v[56:59], v[32:47]
    ds_read_b128 v[84:87], v133 offset:33024
    v_mul_f32 v108, v20, v97
    v_mul_f32 v109, v21, v97
    v_mul_f32 v110, v22, v97
    v_mul_f32 v111, v23, v97
    v_mfma_f32_32x32x16_bf16 v[32:47], a[28:31], v[60:63], v[32:47]
    ds_read_b128 v[48:51], v134 offset:33024
    s_waitcnt lgkmcnt(3)
    v_fmac_f32 v24, v96, v152
    v_fmac_f32 v25, v96, v153
    v_fmac_f32 v26, v96, v154
    v_fmac_f32_e64 v27, v96, v155
    v_mfma_f32_32x32x16_bf16 v[32:47], a[32:35], v[64:67], v[32:47]
    ds_read_b128 v[52:55], v135 offset:33024
    ds_read_b128 v[140:143], v115 offset:1536
    v_fmac_f32 v28, v96, v156
    v_fmac_f32 v29, v96, v157
    v_fmac_f32 v30, v96, v158
    v_fmac_f32 v31, v96, v159
    v_mfma_f32_32x32x16_bf16 v[32:47], a[36:39], v[68:71], v[32:47]
    ds_read_b128 v[56:59], v128 offset:33280
    v_exp_f32 v104, v104
    v_mul_f32 v16, v16, v24
    v_mfma_f32_32x32x16_bf16 v[32:47], a[40:43], v[72:75], v[32:47]
    ds_read_b128 v[60:63], v129 offset:33280
    v_exp_f32 v105, v105
    v_mul_f32 v17, v17, v25
    v_mfma_f32_32x32x16_bf16 v[32:47], a[44:47], v[76:79], v[32:47]
    ds_read_b128 v[64:67], v130 offset:33280
    s_waitcnt lgkmcnt(4)
    v_exp_f32 v106, v106
    v_mul_f32_e64 v18, v18, v26
    v_mfma_f32_32x32x16_bf16 v[32:47], a[48:51], v[80:83], v[32:47]
    ds_read_b128 v[68:71], v131 offset:33280
    v_exp_f32 v107, v107
    v_mul_f32 v19, v19, v27
    v_mfma_f32_32x32x16_bf16 v[32:47], a[52:55], v[84:87], v[32:47]
    ds_read_b128 v[72:75], v132 offset:33280
    v_exp_f32 v108, v108
    v_mul_f32 v20, v20, v28
    v_mfma_f32_32x32x16_bf16 v[32:47], a[56:59], v[48:51], v[32:47]
    ds_read_b128 v[76:79], v133 offset:33280
    v_exp_f32 v109, v109
    v_mul_f32 v21, v21, v29
    v_exp_f32_e64 v110, v110
    v_mfma_f32_32x32x16_bf16 v[32:47], a[60:63], v[52:55], v[32:47]
    ds_read_b128 v[80:83], v134 offset:33280
    s_waitcnt lgkmcnt(3)
    s_waitcnt vmcnt(9)
    s_barrier
    ds_read_b128 v[92:95], v113 offset:4096
    v_mul_f32 v22, v22, v30
    v_mfma_f32_32x32x16_bf16 v[32:47], a[64:67], v[56:59], v[32:47]
    ds_read_b128 v[84:87], v135 offset:33280
    s_add_u32 m0, s58, 65536
    v_exp_f32 v111, v111
    v_mul_f32 v23, v23, v31
    v_fma_f32 v104, v104, v98, v98
    v_mfma_f32_32x32x16_bf16 v[32:47], a[68:71], v[60:63], v[32:47]
    ds_read_b128 v[48:51], v128 offset:33536
    buffer_load_dwordx4 v120, s[24:27], s57 offen offset:0 lds
    v_fma_f32 v105, v105, v98, v98
    v_fma_f32 v106, v106, v98, v98
    v_fma_f32 v107, v107, v98, v98
    v_mfma_f32_32x32x16_bf16 v[32:47], a[72:75], v[64:67], v[32:47]
    ds_read_b128 v[52:55], v129 offset:33536
    buffer_load_dwordx4 v121, s[24:27], s57 offen offset:1024 lds
    v_fma_f32 v108, v108, v98, v98
    v_fma_f32 v109, v109, v98, v98
    v_fma_f32 v110, v110, v98, v98
    v_mfma_f32_32x32x16_bf16 v[32:47], a[76:79], v[68:71], v[32:47]
    ds_read_b128 v[56:59], v130 offset:33536
    s_waitcnt lgkmcnt(3)
    buffer_load_dwordx4 v122, s[24:27], s57 offen offset:2048 lds
    v_fma_f32 v111, v111, v98, v98
    v_mfma_f32_32x32x16_bf16 v[32:47], a[80:83], v[72:75], v[32:47]
    ds_read_b128 v[60:63], v131 offset:33536
    buffer_load_dwordx4 v123, s[24:27], s57 offen offset:3072 lds
    v_rcp_f32 v104, v104
    v_mfma_f32_32x32x16_bf16 v[32:47], a[84:87], v[76:79], v[32:47]
    ds_read_b128 v[64:67], v132 offset:33536
    s_add_u32 s57, s57, s60
    v_rcp_f32 v105, v105
    v_mul_f32_e64 v16, v16, v104
    v_mfma_f32_32x32x16_bf16 v[32:47], a[88:91], v[80:83], v[32:47]
    ds_read_b128 v[68:71], v133 offset:33536
    v_rcp_f32 v106, v106
    v_mul_f32 v17, v17, v105
    v_mfma_f32_32x32x16_bf16 v[32:47], a[92:95], v[84:87], v[32:47]
    ds_read_b128 v[72:75], v134 offset:33536
    s_waitcnt lgkmcnt(3)
    s_add_u32 m0, s58, 69632
    v_rcp_f32 v107, v107
    v_mul_f32_e64 v18, v18, v106
    v_mfma_f32_32x32x16_bf16 v[32:47], a[96:99], v[48:51], v[32:47]
    ds_read_b128 v[76:79], v135 offset:33536
    buffer_load_dwordx4 v124, s[24:27], s57 offen offset:0 lds
    v_add_u32 v128, 4294901760, v128
    v_add_u32 v129, 4294901760, v129
    v_add_u32 v130, 4294901760, v130
    v_add_u32 v131, 4294901760, v131
    v_add_u32 v132, 4294901760, v132
    v_add_u32 v133, 4294901760, v133
    v_add_u32 v134, 4294901760, v134
    v_add_u32 v135, 4294901760, v135
    v_mfma_f32_32x32x16_bf16 v[32:47], a[100:103], v[52:55], v[32:47]
    ds_read_b128 v[80:83], v128 offset:0
    buffer_load_dwordx4 v125, s[24:27], s57 offen offset:1024 lds
    v_rcp_f32 v108, v108
    v_mul_f32 v19, v19, v107
    v_mfma_f32_32x32x16_bf16 v[32:47], a[104:107], v[56:59], v[32:47]
    ds_read_b128 v[84:87], v129 offset:0
    buffer_load_dwordx4 v126, s[24:27], s57 offen offset:2048 lds
    v_rcp_f32 v109, v109
    v_mul_f32 v20, v20, v108
    v_mfma_f32_32x32x16_bf16 v[32:47], a[108:111], v[60:63], v[32:47]
    ds_read_b128 v[48:51], v130 offset:0
    s_waitcnt lgkmcnt(3)
    buffer_load_dwordx4 v127, s[24:27], s57 offen offset:3072 lds
    v_rcp_f32 v110, v110
    v_mfma_f32_32x32x16_bf16 v[32:47], a[112:115], v[64:67], v[32:47]
    ds_read_b128 v[52:55], v131 offset:0
    s_add_u32 s57, s57, s61
    v_mul_f32 v21, v21, v109
    v_rcp_f32_e64 v111, v111
    v_mfma_f32_32x32x16_bf16 v[32:47], a[116:119], v[68:71], v[32:47]
    ds_read_b128 v[56:59], v132 offset:0
    v_mul_f32 v22, v22, v110
    v_mul_f32 v23, v23, v111
    v_cvt_pk_bf16_f32 v100, v16, v17
    v_mfma_f32_32x32x16_bf16 v[32:47], a[120:123], v[72:75], v[32:47]
    ds_read_b128 v[60:63], v133 offset:0
    buffer_store_dwordx4 v[92:95], v114, s[24:27], s59 offen sc1
    s_add_u32 s59, s59, s62
    v_cvt_pk_bf16_f32 v101, v18, v19
    v_mfma_f32_32x32x16_bf16 v[32:47], a[124:127], v[76:79], v[32:47]
    ds_read_b128 v[64:67], v134 offset:0
    s_waitcnt lgkmcnt(3)
    v_cvt_pk_bf16_f32 v102, v20, v21
    v_cvt_pk_bf16_f32 v103, v22, v23
    v_mfma_f32_32x32x16_bf16 v[16:31], a[0:3], v[80:83], 0
    ds_read_b128 v[68:71], v135 offset:0
    v_mfma_f32_32x32x16_bf16 v[16:31], a[4:7], v[84:87], v[16:31]
    ds_read_b128 v[72:75], v128 offset:256
    ds_write_b128 v112, v[100:103] offset:0
    v_mfma_f32_32x32x16_bf16 v[16:31], a[8:11], v[48:51], v[16:31]
    ds_read_b128 v[76:79], v129 offset:256
    v_mfma_f32_32x32x16_bf16 v[16:31], a[12:15], v[52:55], v[16:31]
    ds_read_b128 v[80:83], v130 offset:256
    s_waitcnt lgkmcnt(4)
    v_fmac_f32 v32, v140, v144
    v_fmac_f32 v33, v140, v145
    v_fmac_f32 v34, v140, v146
    v_fmac_f32_e64 v35, v140, v147
    v_mfma_f32_32x32x16_bf16 v[16:31], a[16:19], v[56:59], v[16:31]
    ds_read_b128 v[84:87], v131 offset:256
    v_fmac_f32 v36, v140, v148
    v_fmac_f32 v37, v140, v149
    v_fmac_f32 v38, v140, v150
    v_fmac_f32 v39, v140, v151
    v_mfma_f32_32x32x16_bf16 v[16:31], a[20:23], v[60:63], v[16:31]
    ds_read_b128 v[48:51], v132 offset:256
    v_mul_f32 v104, v32, v141
    v_mul_f32 v105, v33, v141
    v_mul_f32 v106, v34, v141
    v_mul_f32 v107, v35, v141
    v_mfma_f32_32x32x16_bf16 v[16:31], a[24:27], v[64:67], v[16:31]
    ds_read_b128 v[52:55], v133 offset:256
    v_mul_f32 v108, v36, v141
    v_mul_f32 v109, v37, v141
    v_mul_f32 v110, v38, v141
    v_mul_f32 v111, v39, v141
    v_mfma_f32_32x32x16_bf16 v[16:31], a[28:31], v[68:71], v[16:31]
    ds_read_b128 v[56:59], v134 offset:256
    s_waitcnt lgkmcnt(3)
    v_fmac_f32 v40, v140, v152
    v_fmac_f32 v41, v140, v153
    v_fmac_f32 v42, v140, v154
    v_fmac_f32_e64 v43, v140, v155
    v_mfma_f32_32x32x16_bf16 v[16:31], a[32:35], v[72:75], v[16:31]
    ds_read_b128 v[60:63], v135 offset:256
    ds_read_b128 v[96:99], v115 offset:2048
    v_fmac_f32 v44, v140, v156
    v_fmac_f32 v45, v140, v157
    v_fmac_f32_e64 v46, v140, v158
    v_mfma_f32_32x32x16_bf16 v[16:31], a[36:39], v[76:79], v[16:31]
    ds_read_b128 v[64:67], v128 offset:512
    v_fmac_f32 v47, v140, v159
    v_exp_f32 v104, v104
    v_mul_f32_e64 v32, v32, v40
    v_mfma_f32_32x32x16_bf16 v[16:31], a[40:43], v[80:83], v[16:31]
    ds_read_b128 v[68:71], v129 offset:512
    v_exp_f32 v105, v105
    v_mul_f32 v33, v33, v41
    v_mfma_f32_32x32x16_bf16 v[16:31], a[44:47], v[84:87], v[16:31]
    ds_read_b128 v[72:75], v130 offset:512
    s_waitcnt lgkmcnt(4)
    v_exp_f32 v106, v106
    v_mul_f32_e64 v34, v34, v42
    v_mfma_f32_32x32x16_bf16 v[16:31], a[48:51], v[48:51], v[16:31]
    ds_read_b128 v[76:79], v131 offset:512
    v_exp_f32 v107, v107
    v_mul_f32 v35, v35, v43
    v_mfma_f32_32x32x16_bf16 v[16:31], a[52:55], v[52:55], v[16:31]
    ds_read_b128 v[80:83], v132 offset:512
    v_exp_f32 v108, v108
    v_mul_f32 v36, v36, v44
    v_mfma_f32_32x32x16_bf16 v[16:31], a[56:59], v[56:59], v[16:31]
    ds_read_b128 v[84:87], v133 offset:512
    v_exp_f32 v109, v109
    v_mul_f32 v37, v37, v45
    v_mfma_f32_32x32x16_bf16 v[16:31], a[60:63], v[60:63], v[16:31]
    ds_read_b128 v[48:51], v134 offset:512
    s_waitcnt lgkmcnt(3)
    s_waitcnt vmcnt(10)
    s_barrier
    ds_read_b128 v[92:95], v113 offset:0
    v_mfma_f32_32x32x16_bf16 v[16:31], a[64:67], v[64:67], v[16:31]
    ds_read_b128 v[52:55], v135 offset:512
    s_add_u32 m0, s58, 98304
    v_exp_f32 v110, v110
    v_mul_f32_e64 v38, v38, v46
    v_mfma_f32_32x32x16_bf16 v[16:31], a[68:71], v[68:71], v[16:31]
    ds_read_b128 v[56:59], v128 offset:768
    buffer_load_dwordx4 v120, s[24:27], s57 offen offset:0 lds
    v_exp_f32 v111, v111
    v_mul_f32 v39, v39, v47
    v_mfma_f32_32x32x16_bf16 v[16:31], a[72:75], v[72:75], v[16:31]
    ds_read_b128 v[60:63], v129 offset:768
    buffer_load_dwordx4 v121, s[24:27], s57 offen offset:1024 lds
    v_fma_f32 v104, v104, v142, v142
    v_fma_f32 v105, v105, v142, v142
    v_fma_f32 v106, v106, v142, v142
    v_mfma_f32_32x32x16_bf16 v[16:31], a[76:79], v[76:79], v[16:31]
    ds_read_b128 v[64:67], v130 offset:768
    s_waitcnt lgkmcnt(3)
    buffer_load_dwordx4 v122, s[24:27], s57 offen offset:2048 lds
    v_fma_f32 v107, v107, v142, v142
    v_fma_f32 v108, v108, v142, v142
    v_mfma_f32_32x32x16_bf16 v[16:31], a[80:83], v[80:83], v[16:31]
    ds_read_b128 v[68:71], v131 offset:768
    buffer_load_dwordx4 v123, s[24:27], s57 offen offset:3072 lds
    v_fma_f32 v109, v109, v142, v142
    v_fma_f32 v110, v110, v142, v142
    v_fma_f32 v111, v111, v142, v142
    v_mfma_f32_32x32x16_bf16 v[16:31], a[84:87], v[84:87], v[16:31]
    ds_read_b128 v[72:75], v132 offset:768
    s_add_u32 s57, s57, s60
    v_rcp_f32 v104, v104
    v_rcp_f32 v105, v105
    v_mfma_f32_32x32x16_bf16 v[16:31], a[88:91], v[48:51], v[16:31]
    ds_read_b128 v[76:79], v133 offset:768
    v_mul_f32 v32, v32, v104
    v_rcp_f32 v106, v106
    v_mul_f32_e64 v33, v33, v105
    v_mfma_f32_32x32x16_bf16 v[16:31], a[92:95], v[52:55], v[16:31]
    ds_read_b128 v[80:83], v134 offset:768
    s_waitcnt lgkmcnt(3)
    s_add_u32 m0, s58, 102400
    v_rcp_f32 v107, v107
    v_mul_f32_e64 v34, v34, v106
    v_mfma_f32_32x32x16_bf16 v[16:31], a[96:99], v[56:59], v[16:31]
    ds_read_b128 v[84:87], v135 offset:768
    buffer_load_dwordx4 v124, s[24:27], s57 offen offset:0 lds
    v_rcp_f32 v108, v108
    v_mul_f32 v35, v35, v107
    v_mfma_f32_32x32x16_bf16 v[16:31], a[100:103], v[60:63], v[16:31]
    ds_read_b128 v[48:51], v128 offset:32768
    buffer_load_dwordx4 v125, s[24:27], s57 offen offset:1024 lds
    v_rcp_f32_e64 v109, v109
    v_mfma_f32_32x32x16_bf16 v[16:31], a[104:107], v[64:67], v[16:31]
    ds_read_b128 v[52:55], v129 offset:32768
    buffer_load_dwordx4 v126, s[24:27], s57 offen offset:2048 lds
    v_mul_f32_e64 v36, v36, v108
    v_mfma_f32_32x32x16_bf16 v[16:31], a[108:111], v[68:71], v[16:31]
    ds_read_b128 v[56:59], v130 offset:32768
    s_waitcnt lgkmcnt(3)
    buffer_load_dwordx4 v127, s[24:27], s57 offen offset:3072 lds
    v_rcp_f32 v110, v110
    v_mfma_f32_32x32x16_bf16 v[16:31], a[112:115], v[72:75], v[16:31]
    ds_read_b128 v[60:63], v131 offset:32768
    s_add_u32 s57, s57, s61
    v_mul_f32 v37, v37, v109
    v_rcp_f32_e64 v111, v111
    v_mfma_f32_32x32x16_bf16 v[16:31], a[116:119], v[76:79], v[16:31]
    ds_read_b128 v[64:67], v132 offset:32768
    v_mul_f32 v38, v38, v110
    v_mul_f32 v39, v39, v111
    v_cvt_pk_bf16_f32 v100, v32, v33
    v_mfma_f32_32x32x16_bf16 v[16:31], a[120:123], v[80:83], v[16:31]
    ds_read_b128 v[68:71], v133 offset:32768
    buffer_store_dwordx4 v[92:95], v114, s[24:27], s59 offen sc1
    s_add_u32 s59, s59, s62
    v_cvt_pk_bf16_f32 v101, v34, v35
    v_mfma_f32_32x32x16_bf16 v[16:31], a[124:127], v[84:87], v[16:31]
    ds_read_b128 v[72:75], v134 offset:32768
    s_waitcnt lgkmcnt(3)
    v_cvt_pk_bf16_f32 v102, v36, v37
    v_cvt_pk_bf16_f32 v103, v38, v39
    v_mfma_f32_32x32x16_bf16 v[32:47], a[0:3], v[48:51], 0
    ds_read_b128 v[76:79], v135 offset:32768
    v_mfma_f32_32x32x16_bf16 v[32:47], a[4:7], v[52:55], v[32:47]
    ds_read_b128 v[80:83], v128 offset:33024
    ds_write_b128 v112, v[100:103] offset:4096
    v_mfma_f32_32x32x16_bf16 v[32:47], a[8:11], v[56:59], v[32:47]
    ds_read_b128 v[84:87], v129 offset:33024
    v_mfma_f32_32x32x16_bf16 v[32:47], a[12:15], v[60:63], v[32:47]
    ds_read_b128 v[48:51], v130 offset:33024
    s_waitcnt lgkmcnt(4)
    v_fmac_f32 v16, v96, v144
    v_fmac_f32 v17, v96, v145
    v_fmac_f32 v18, v96, v146
    v_mfma_f32_32x32x16_bf16 v[32:47], a[16:19], v[64:67], v[32:47]
    ds_read_b128 v[52:55], v131 offset:33024
    v_fmac_f32 v19, v96, v147
    v_fmac_f32 v20, v96, v148
    v_fmac_f32 v21, v96, v149
    v_fmac_f32 v22, v96, v150
    v_mfma_f32_32x32x16_bf16 v[32:47], a[20:23], v[68:71], v[32:47]
    ds_read_b128 v[56:59], v132 offset:33024
    v_fmac_f32 v23, v96, v151
    v_mul_f32 v104, v16, v97
    v_mul_f32 v105, v17, v97
    v_mul_f32 v106, v18, v97
    v_mfma_f32_32x32x16_bf16 v[32:47], a[24:27], v[72:75], v[32:47]
    ds_read_b128 v[60:63], v133 offset:33024
    v_mul_f32 v107, v19, v97
    v_mul_f32 v108, v20, v97
    v_mul_f32 v109, v21, v97
    v_mul_f32 v110, v22, v97
    v_mfma_f32_32x32x16_bf16 v[32:47], a[28:31], v[76:79], v[32:47]
    ds_read_b128 v[64:67], v134 offset:33024
    s_waitcnt lgkmcnt(3)
    v_mul_f32 v111, v23, v97
    v_fmac_f32 v24, v96, v152
    v_fmac_f32 v25, v96, v153
    v_mfma_f32_32x32x16_bf16 v[32:47], a[32:35], v[80:83], v[32:47]
    ds_read_b128 v[68:71], v135 offset:33024
    ds_read_b128 v[140:143], v115 offset:2560
    v_fmac_f32 v26, v96, v154
    v_fmac_f32 v27, v96, v155
    v_fmac_f32_e64 v28, v96, v156
    v_mfma_f32_32x32x16_bf16 v[32:47], a[36:39], v[84:87], v[32:47]
    ds_read_b128 v[72:75], v128 offset:33280
    v_fmac_f32 v29, v96, v157
    v_fmac_f32 v30, v96, v158
    v_fmac_f32_e64 v31, v96, v159
    v_mfma_f32_32x32x16_bf16 v[32:47], a[40:43], v[48:51], v[32:47]
    ds_read_b128 v[76:79], v129 offset:33280
    v_exp_f32 v104, v104
    v_mul_f32 v16, v16, v24
    v_mfma_f32_32x32x16_bf16 v[32:47], a[44:47], v[52:55], v[32:47]
    ds_read_b128 v[80:83], v130 offset:33280
    s_waitcnt lgkmcnt(4)
    v_exp_f32 v105, v105
    v_mul_f32_e64 v17, v17, v25
    v_mfma_f32_32x32x16_bf16 v[32:47], a[48:51], v[56:59], v[32:47]
    ds_read_b128 v[84:87], v131 offset:33280
    v_exp_f32 v106, v106
    v_mul_f32 v18, v18, v26
    v_mfma_f32_32x32x16_bf16 v[32:47], a[52:55], v[60:63], v[32:47]
    ds_read_b128 v[48:51], v132 offset:33280
    v_exp_f32 v107, v107
    v_mul_f32 v19, v19, v27
    v_mfma_f32_32x32x16_bf16 v[32:47], a[56:59], v[64:67], v[32:47]
    ds_read_b128 v[52:55], v133 offset:33280
    v_exp_f32 v108, v108
    v_mul_f32 v20, v20, v28
    v_mfma_f32_32x32x16_bf16 v[32:47], a[60:63], v[68:71], v[32:47]
    ds_read_b128 v[56:59], v134 offset:33280
    s_waitcnt lgkmcnt(3)
    s_waitcnt vmcnt(10)
    s_barrier
    ds_read_b128 v[92:95], v113 offset:4096
    v_mfma_f32_32x32x16_bf16 v[32:47], a[64:67], v[72:75], v[32:47]
    ds_read_b128 v[60:63], v135 offset:33280
    v_exp_f32 v109, v109
    v_mul_f32_e64 v21, v21, v29
    v_mfma_f32_32x32x16_bf16 v[32:47], a[68:71], v[76:79], v[32:47]
    ds_read_b128 v[64:67], v128 offset:33536
    v_exp_f32 v110, v110
    v_mul_f32 v22, v22, v30
    v_mfma_f32_32x32x16_bf16 v[32:47], a[72:75], v[80:83], v[32:47]
    ds_read_b128 v[68:71], v129 offset:33536
    v_exp_f32 v111, v111
    v_mul_f32 v23, v23, v31
    v_fma_f32 v104, v104, v98, v98
    v_mfma_f32_32x32x16_bf16 v[32:47], a[76:79], v[84:87], v[32:47]
    ds_read_b128 v[72:75], v130 offset:33536
    s_waitcnt lgkmcnt(3)
    v_fma_f32 v105, v105, v98, v98
    v_fma_f32 v106, v106, v98, v98
    v_fma_f32 v107, v107, v98, v98
    v_mfma_f32_32x32x16_bf16 v[32:47], a[80:83], v[48:51], v[32:47]
    ds_read_b128 v[76:79], v131 offset:33536
    v_fma_f32 v108, v108, v98, v98
    v_fma_f32 v109, v109, v98, v98
    v_fma_f32 v110, v110, v98, v98
    v_fma_f32 v111, v111, v98, v98
    v_mfma_f32_32x32x16_bf16 v[32:47], a[84:87], v[52:55], v[32:47]
    ds_read_b128 v[80:83], v132 offset:33536
    v_rcp_f32 v104, v104
    v_rcp_f32_e64 v105, v105
    v_mfma_f32_32x32x16_bf16 v[32:47], a[88:91], v[56:59], v[32:47]
    ds_read_b128 v[84:87], v133 offset:33536
    v_mul_f32 v16, v16, v104
    v_rcp_f32 v106, v106
    v_mul_f32_e64 v17, v17, v105
    v_mfma_f32_32x32x16_bf16 v[32:47], a[92:95], v[60:63], v[32:47]
    ds_read_b128 v[48:51], v134 offset:33536
    s_waitcnt lgkmcnt(3)
    v_rcp_f32 v107, v107
    v_mul_f32_e64 v18, v18, v106
    v_mfma_f32_32x32x16_bf16 v[32:47], a[96:99], v[64:67], v[32:47]
    ds_read_b128 v[52:55], v135 offset:33536
    v_add_u32 v128, 65536, v128
    v_add_u32 v129, 65536, v129
    v_add_u32 v130, 65536, v130
    v_add_u32 v131, 65536, v131
    v_add_u32 v132, 65536, v132
    v_add_u32 v133, 65536, v133
    v_add_u32 v134, 65536, v134
    v_add_u32 v135, 65536, v135
    v_mfma_f32_32x32x16_bf16 v[32:47], a[100:103], v[68:71], v[32:47]
    ds_read_b128 v[56:59], v128 offset:0
    v_rcp_f32 v108, v108
    v_mul_f32 v19, v19, v107
    v_mfma_f32_32x32x16_bf16 v[32:47], a[104:107], v[72:75], v[32:47]
    ds_read_b128 v[60:63], v129 offset:0
    v_rcp_f32 v109, v109
    v_mul_f32 v20, v20, v108
    v_mfma_f32_32x32x16_bf16 v[32:47], a[108:111], v[76:79], v[32:47]
    ds_read_b128 v[64:67], v130 offset:0
    s_waitcnt lgkmcnt(3)
    v_rcp_f32 v110, v110
    v_mul_f32_e64 v21, v21, v109
    v_mfma_f32_32x32x16_bf16 v[32:47], a[112:115], v[80:83], v[32:47]
    ds_read_b128 v[68:71], v131 offset:0
    v_rcp_f32 v111, v111
    v_mul_f32 v22, v22, v110
    v_mfma_f32_32x32x16_bf16 v[32:47], a[116:119], v[84:87], v[32:47]
    ds_read_b128 v[72:75], v132 offset:0
    v_mul_f32_e64 v23, v23, v111
    v_cvt_pk_bf16_f32 v100, v16, v17
    v_cvt_pk_bf16_f32 v101, v18, v19
    v_mfma_f32_32x32x16_bf16 v[32:47], a[120:123], v[48:51], v[32:47]
    ds_read_b128 v[76:79], v133 offset:0
    buffer_store_dwordx4 v[92:95], v114, s[24:27], s59 offen sc1
    s_add_u32 s59, s59, s62
    v_cvt_pk_bf16_f32 v102, v20, v21
    v_mfma_f32_32x32x16_bf16 v[32:47], a[124:127], v[52:55], v[32:47]
    ds_read_b128 v[80:83], v134 offset:0
    s_waitcnt lgkmcnt(3)
    v_cvt_pk_bf16_f32 v103, v22, v23
    v_mfma_f32_32x32x16_bf16 v[16:31], a[0:3], v[56:59], 0
    ds_read_b128 v[84:87], v135 offset:0
    v_mfma_f32_32x32x16_bf16 v[16:31], a[4:7], v[60:63], v[16:31]
    ds_read_b128 v[48:51], v128 offset:256
    ds_write_b128 v112, v[100:103] offset:0
    v_mfma_f32_32x32x16_bf16 v[16:31], a[8:11], v[64:67], v[16:31]
    ds_read_b128 v[52:55], v129 offset:256
    v_mfma_f32_32x32x16_bf16 v[16:31], a[12:15], v[68:71], v[16:31]
    ds_read_b128 v[56:59], v130 offset:256
    s_waitcnt lgkmcnt(4)
    v_fmac_f32 v32, v140, v144
    v_fmac_f32 v33, v140, v145
    v_fmac_f32 v34, v140, v146
    v_mfma_f32_32x32x16_bf16 v[16:31], a[16:19], v[72:75], v[16:31]
    ds_read_b128 v[60:63], v131 offset:256
    v_fmac_f32 v35, v140, v147
    v_fmac_f32 v36, v140, v148
    v_fmac_f32 v37, v140, v149
    v_fmac_f32 v38, v140, v150
    v_mfma_f32_32x32x16_bf16 v[16:31], a[20:23], v[76:79], v[16:31]
    ds_read_b128 v[64:67], v132 offset:256
    v_fmac_f32 v39, v140, v151
    v_mul_f32 v104, v32, v141
    v_mul_f32 v105, v33, v141
    v_mul_f32 v106, v34, v141
    v_mfma_f32_32x32x16_bf16 v[16:31], a[24:27], v[80:83], v[16:31]
    ds_read_b128 v[68:71], v133 offset:256
    v_mul_f32 v107, v35, v141
    v_mul_f32 v108, v36, v141
    v_mul_f32 v109, v37, v141
    v_mul_f32 v110, v38, v141
    v_mfma_f32_32x32x16_bf16 v[16:31], a[28:31], v[84:87], v[16:31]
    ds_read_b128 v[72:75], v134 offset:256
    s_waitcnt lgkmcnt(3)
    v_mul_f32 v111, v39, v141
    v_fmac_f32 v40, v140, v152
    v_fmac_f32 v41, v140, v153
    v_mfma_f32_32x32x16_bf16 v[16:31], a[32:35], v[48:51], v[16:31]
    ds_read_b128 v[76:79], v135 offset:256
    ds_read_b128 v[96:99], v115 offset:3072
    v_fmac_f32 v42, v140, v154
    v_fmac_f32 v43, v140, v155
    v_fmac_f32_e64 v44, v140, v156
    v_mfma_f32_32x32x16_bf16 v[16:31], a[36:39], v[52:55], v[16:31]
    ds_read_b128 v[80:83], v128 offset:512
    v_fmac_f32 v45, v140, v157
    v_fmac_f32 v46, v140, v158
    v_fmac_f32_e64 v47, v140, v159
    v_mfma_f32_32x32x16_bf16 v[16:31], a[40:43], v[56:59], v[16:31]
    ds_read_b128 v[84:87], v129 offset:512
    v_exp_f32 v104, v104
    v_mul_f32 v32, v32, v40
    v_mfma_f32_32x32x16_bf16 v[16:31], a[44:47], v[60:63], v[16:31]
    ds_read_b128 v[48:51], v130 offset:512
    s_waitcnt lgkmcnt(4)
    v_exp_f32 v105, v105
    v_mul_f32_e64 v33, v33, v41
    v_mfma_f32_32x32x16_bf16 v[16:31], a[48:51], v[64:67], v[16:31]
    ds_read_b128 v[52:55], v131 offset:512
    v_exp_f32 v106, v106
    v_mul_f32 v34, v34, v42
    v_mfma_f32_32x32x16_bf16 v[16:31], a[52:55], v[68:71], v[16:31]
    ds_read_b128 v[56:59], v132 offset:512
    v_exp_f32 v107, v107
    v_mul_f32 v35, v35, v43
    v_mfma_f32_32x32x16_bf16 v[16:31], a[56:59], v[72:75], v[16:31]
    ds_read_b128 v[60:63], v133 offset:512
    v_exp_f32 v108, v108
    v_mul_f32 v36, v36, v44
    v_mfma_f32_32x32x16_bf16 v[16:31], a[60:63], v[76:79], v[16:31]
    ds_read_b128 v[64:67], v134 offset:512
    s_waitcnt lgkmcnt(3)
    s_waitcnt vmcnt(2)
    s_waitcnt vmcnt(0)
    s_barrier
    s_nop 6
    s_cmp_lg_u32 s30, 0
    s_cbranch_scc1 L_fs_116
    s_add_u32 s40, s32, 7
    v_mov_b32 v2, s40
    v_mov_b32_e64 v3, s33
    s_lshl_b32 s41, s2, 6
    s_add_u32 s41, s41, 98304
    v_mov_b32 v4, s41
    s_mov_b64 exec, 1
    buffer_store_dwordx2 v[2:3], v4, s[24:27], 0 offen sc1
    s_mov_b64 exec, -1
L_fs_116:
    ds_read_b128 v[92:95], v113 offset:0
    v_mfma_f32_32x32x16_bf16 v[16:31], a[64:67], v[80:83], v[16:31]
    ds_read_b128 v[68:71], v135 offset:512
    v_exp_f32 v109, v109
    v_mul_f32_e64 v37, v37, v45
    v_mfma_f32_32x32x16_bf16 v[16:31], a[68:71], v[84:87], v[16:31]
    ds_read_b128 v[72:75], v128 offset:768
    v_exp_f32 v110, v110
    v_mul_f32 v38, v38, v46
    v_mfma_f32_32x32x16_bf16 v[16:31], a[72:75], v[48:51], v[16:31]
    ds_read_b128 v[76:79], v129 offset:768
    v_exp_f32 v111, v111
    v_mul_f32 v39, v39, v47
    v_fma_f32 v104, v104, v142, v142
    v_mfma_f32_32x32x16_bf16 v[16:31], a[76:79], v[52:55], v[16:31]
    ds_read_b128 v[80:83], v130 offset:768
    s_waitcnt lgkmcnt(3)
    v_fma_f32 v105, v105, v142, v142
    v_fma_f32 v106, v106, v142, v142
    v_fma_f32 v107, v107, v142, v142
    v_mfma_f32_32x32x16_bf16 v[16:31], a[80:83], v[56:59], v[16:31]
    ds_read_b128 v[84:87], v131 offset:768
    v_fma_f32 v108, v108, v142, v142
    v_fma_f32 v109, v109, v142, v142
    v_fma_f32 v110, v110, v142, v142
    v_fma_f32 v111, v111, v142, v142
    v_mfma_f32_32x32x16_bf16 v[16:31], a[84:87], v[60:63], v[16:31]
    ds_read_b128 v[48:51], v132 offset:768
    v_rcp_f32 v104, v104
    v_mfma_f32_32x32x16_bf16 v[16:31], a[88:91], v[64:67], v[16:31]
    ds_read_b128 v[52:55], v133 offset:768
    v_rcp_f32 v105, v105
    v_mul_f32 v32, v32, v104
    v_mfma_f32_32x32x16_bf16 v[16:31], a[92:95], v[68:71], v[16:31]
    ds_read_b128 v[56:59], v134 offset:768
    s_waitcnt lgkmcnt(3)
    v_rcp_f32 v106, v106
    v_mul_f32_e64 v33, v33, v105
    v_mfma_f32_32x32x16_bf16 v[16:31], a[96:99], v[72:75], v[16:31]
    ds_read_b128 v[60:63], v135 offset:768
    v_rcp_f32 v107, v107
    v_mul_f32 v34, v34, v106
    v_mfma_f32_32x32x16_bf16 v[16:31], a[100:103], v[76:79], v[16:31]
    ds_read_b128 v[64:67], v128 offset:32768
    v_rcp_f32 v108, v108
    v_mul_f32 v35, v35, v107
    v_mfma_f32_32x32x16_bf16 v[16:31], a[104:107], v[80:83], v[16:31]
    ds_read_b128 v[68:71], v129 offset:32768
    v_rcp_f32 v109, v109
    v_mul_f32 v36, v36, v108
    v_mfma_f32_32x32x16_bf16 v[16:31], a[108:111], v[84:87], v[16:31]
    ds_read_b128 v[72:75], v130 offset:32768
    s_waitcnt lgkmcnt(3)
    v_rcp_f32 v110, v110
    v_mul_f32_e64 v37, v37, v109
    v_mfma_f32_32x32x16_bf16 v[16:31], a[112:115], v[48:51], v[16:31]
    ds_read_b128 v[76:79], v131 offset:32768
    v_rcp_f32 v111, v111
    v_mul_f32 v38, v38, v110
    v_mfma_f32_32x32x16_bf16 v[16:31], a[116:119], v[52:55], v[16:31]
    ds_read_b128 v[80:83], v132 offset:32768
    v_mul_f32_e64 v39, v39, v111
    v_cvt_pk_bf16_f32 v100, v32, v33
    v_cvt_pk_bf16_f32 v101, v34, v35
    v_mfma_f32_32x32x16_bf16 v[16:31], a[120:123], v[56:59], v[16:31]
    ds_read_b128 v[84:87], v133 offset:32768
    buffer_store_dwordx4 v[92:95], v114, s[24:27], s59 offen sc1
    s_add_u32 s59, s59, s62
    v_cvt_pk_bf16_f32 v102, v36, v37
    v_mfma_f32_32x32x16_bf16 v[16:31], a[124:127], v[60:63], v[16:31]
    ds_read_b128 v[48:51], v134 offset:32768
    s_waitcnt lgkmcnt(3)
    v_cvt_pk_bf16_f32 v103, v38, v39
    v_mfma_f32_32x32x16_bf16 v[32:47], a[0:3], v[64:67], 0
    ds_read_b128 v[52:55], v135 offset:32768
    v_mfma_f32_32x32x16_bf16 v[32:47], a[4:7], v[68:71], v[32:47]
    ds_read_b128 v[56:59], v128 offset:33024
    ds_write_b128 v112, v[100:103] offset:4096
    v_mfma_f32_32x32x16_bf16 v[32:47], a[8:11], v[72:75], v[32:47]
    ds_read_b128 v[60:63], v129 offset:33024
    v_mfma_f32_32x32x16_bf16 v[32:47], a[12:15], v[76:79], v[32:47]
    ds_read_b128 v[64:67], v130 offset:33024
    s_waitcnt lgkmcnt(4)
    v_fmac_f32 v16, v96, v144
    v_fmac_f32 v17, v96, v145
    v_fmac_f32 v18, v96, v146
    v_mfma_f32_32x32x16_bf16 v[32:47], a[16:19], v[80:83], v[32:47]
    ds_read_b128 v[68:71], v131 offset:33024
    v_fmac_f32 v19, v96, v147
    v_fmac_f32 v20, v96, v148
    v_fmac_f32 v21, v96, v149
    v_fmac_f32 v22, v96, v150
    v_mfma_f32_32x32x16_bf16 v[32:47], a[20:23], v[84:87], v[32:47]
    ds_read_b128 v[72:75], v132 offset:33024
    v_fmac_f32 v23, v96, v151
    v_mul_f32 v104, v16, v97
    v_mul_f32 v105, v17, v97
    v_mul_f32 v106, v18, v97
    v_mfma_f32_32x32x16_bf16 v[32:47], a[24:27], v[48:51], v[32:47]
    ds_read_b128 v[76:79], v133 offset:33024
    v_mul_f32 v107, v19, v97
    v_mul_f32 v108, v20, v97
    v_mul_f32 v109, v21, v97
    v_mul_f32 v110, v22, v97
    v_mfma_f32_32x32x16_bf16 v[32:47], a[28:31], v[52:55], v[32:47]
    ds_read_b128 v[80:83], v134 offset:33024
    s_waitcnt lgkmcnt(3)
    v_mul_f32 v111, v23, v97
    v_fmac_f32 v24, v96, v152
    v_fmac_f32 v25, v96, v153
    v_mfma_f32_32x32x16_bf16 v[32:47], a[32:35], v[56:59], v[32:47]
    ds_read_b128 v[84:87], v135 offset:33024
    ds_read_b128 v[140:143], v115 offset:3584
    v_fmac_f32 v26, v96, v154
    v_fmac_f32 v27, v96, v155
    v_fmac_f32_e64 v28, v96, v156
    v_mfma_f32_32x32x16_bf16 v[32:47], a[36:39], v[60:63], v[32:47]
    ds_read_b128 v[48:51], v128 offset:33280
    v_fmac_f32 v29, v96, v157
    v_fmac_f32 v30, v96, v158
    v_fmac_f32_e64 v31, v96, v159
    v_mfma_f32_32x32x16_bf16 v[32:47], a[40:43], v[64:67], v[32:47]
    ds_read_b128 v[52:55], v129 offset:33280
    v_exp_f32 v104, v104
    v_mul_f32 v16, v16, v24
    v_mfma_f32_32x32x16_bf16 v[32:47], a[44:47], v[68:71], v[32:47]
    ds_read_b128 v[56:59], v130 offset:33280
    s_waitcnt lgkmcnt(4)
    v_exp_f32 v105, v105
    v_mul_f32_e64 v17, v17, v25
    v_mfma_f32_32x32x16_bf16 v[32:47], a[48:51], v[72:75], v[32:47]
    ds_read_b128 v[60:63], v131 offset:33280
    v_exp_f32 v106, v106
    v_mul_f32 v18, v18, v26
    v_mfma_f32_32x32x16_bf16 v[32:47], a[52:55], v[76:79], v[32:47]
    ds_read_b128 v[64:67], v132 offset:33280
    v_exp_f32 v107, v107
    v_mul_f32 v19, v19, v27
    v_mfma_f32_32x32x16_bf16 v[32:47], a[56:59], v[80:83], v[32:47]
    ds_read_b128 v[68:71], v133 offset:33280
    v_exp_f32 v108, v108
    v_mul_f32 v20, v20, v28
    v_mfma_f32_32x32x16_bf16 v[32:47], a[60:63], v[84:87], v[32:47]
    ds_read_b128 v[72:75], v134 offset:33280
    s_waitcnt lgkmcnt(3)
    s_barrier
    ds_read_b128 v[92:95], v113 offset:4096
    v_mfma_f32_32x32x16_bf16 v[32:47], a[64:67], v[48:51], v[32:47]
    ds_read_b128 v[76:79], v135 offset:33280
    v_exp_f32 v109, v109
    v_mul_f32 v21, v21, v29
    v_mfma_f32_32x32x16_bf16 v[32:47], a[68:71], v[52:55], v[32:47]
    ds_read_b128 v[80:83], v128 offset:33536
    v_exp_f32 v110, v110
    v_mul_f32 v22, v22, v30
    v_mfma_f32_32x32x16_bf16 v[32:47], a[72:75], v[56:59], v[32:47]
    ds_read_b128 v[84:87], v129 offset:33536
    v_exp_f32 v111, v111
    v_mul_f32 v23, v23, v31
    v_fma_f32 v104, v104, v98, v98
    v_mfma_f32_32x32x16_bf16 v[32:47], a[76:79], v[60:63], v[32:47]
    ds_read_b128 v[48:51], v130 offset:33536
    s_waitcnt lgkmcnt(3)
    v_fma_f32 v105, v105, v98, v98
    v_fma_f32 v106, v106, v98, v98
    v_fma_f32 v107, v107, v98, v98
    v_mfma_f32_32x32x16_bf16 v[32:47], a[80:83], v[64:67], v[32:47]
    ds_read_b128 v[52:55], v131 offset:33536
    v_fma_f32 v108, v108, v98, v98
    v_fma_f32 v109, v109, v98, v98
    v_fma_f32 v110, v110, v98, v98
    v_fma_f32 v111, v111, v98, v98
    v_mfma_f32_32x32x16_bf16 v[32:47], a[84:87], v[68:71], v[32:47]
    ds_read_b128 v[56:59], v132 offset:33536
    v_rcp_f32 v104, v104
    v_rcp_f32_e64 v105, v105
    v_mfma_f32_32x32x16_bf16 v[32:47], a[88:91], v[72:75], v[32:47]
    ds_read_b128 v[60:63], v133 offset:33536
    v_mul_f32 v16, v16, v104
    v_rcp_f32 v106, v106
    v_mul_f32_e64 v17, v17, v105
    v_mfma_f32_32x32x16_bf16 v[32:47], a[92:95], v[76:79], v[32:47]
    ds_read_b128 v[64:67], v134 offset:33536
    s_waitcnt lgkmcnt(3)
    v_rcp_f32 v107, v107
    v_mul_f32_e64 v18, v18, v106
    v_mfma_f32_32x32x16_bf16 v[32:47], a[96:99], v[80:83], v[32:47]
    ds_read_b128 v[68:71], v135 offset:33536
    v_mfma_f32_32x32x16_bf16 v[32:47], a[100:103], v[84:87], v[32:47]
    v_rcp_f32 v108, v108
    v_mul_f32 v19, v19, v107
    v_mfma_f32_32x32x16_bf16 v[32:47], a[104:107], v[48:51], v[32:47]
    v_rcp_f32 v109, v109
    v_mul_f32 v20, v20, v108
    v_mfma_f32_32x32x16_bf16 v[32:47], a[108:111], v[52:55], v[32:47]
    s_waitcnt lgkmcnt(0)
    v_rcp_f32 v110, v110
    v_mul_f32_e64 v21, v21, v109
    v_mfma_f32_32x32x16_bf16 v[32:47], a[112:115], v[56:59], v[32:47]
    v_rcp_f32 v111, v111
    v_mul_f32 v22, v22, v110
    v_mfma_f32_32x32x16_bf16 v[32:47], a[116:119], v[60:63], v[32:47]
    v_mul_f32_e64 v23, v23, v111
    v_cvt_pk_bf16_f32 v100, v16, v17
    v_cvt_pk_bf16_f32 v101, v18, v19
    v_mfma_f32_32x32x16_bf16 v[32:47], a[120:123], v[64:67], v[32:47]
    buffer_store_dwordx4 v[92:95], v114, s[24:27], s59 offen sc1
    s_add_u32 s59, s59, s62
    v_cvt_pk_bf16_f32 v102, v20, v21
    v_mfma_f32_32x32x16_bf16 v[32:47], a[124:127], v[68:71], v[32:47]
    v_cvt_pk_bf16_f32 v103, v22, v23
    ds_write_b128 v112, v[100:103]
    s_nop 9
    v_fmac_f32 v32, v140, v144
    v_fmac_f32 v33, v140, v145
    v_fmac_f32 v34, v140, v146
    v_fmac_f32 v35, v140, v147
    v_fmac_f32 v36, v140, v148
    v_fmac_f32 v37, v140, v149
    v_fmac_f32 v38, v140, v150
    v_fmac_f32 v39, v140, v151
    v_mul_f32 v104, v32, v141
    v_mul_f32 v105, v33, v141
    v_mul_f32 v106, v34, v141
    v_mul_f32 v107, v35, v141
    v_mul_f32 v108, v36, v141
    v_mul_f32 v109, v37, v141
    v_mul_f32 v110, v38, v141
    v_mul_f32 v111, v39, v141
    v_fmac_f32 v40, v140, v152
    v_fmac_f32 v41, v140, v153
    v_fmac_f32 v42, v140, v154
    v_fmac_f32 v43, v140, v155
    v_fmac_f32 v44, v140, v156
    v_fmac_f32 v45, v140, v157
    v_fmac_f32 v46, v140, v158
    v_fmac_f32 v47, v140, v159
    v_exp_f32 v104, v104
    v_mul_f32 v32, v32, v40
    v_exp_f32 v105, v105
    v_mul_f32 v33, v33, v41
    v_exp_f32 v106, v106
    v_mul_f32 v34, v34, v42
    v_exp_f32 v107, v107
    v_mul_f32 v35, v35, v43
    v_exp_f32 v108, v108
    v_mul_f32 v36, v36, v44
    v_exp_f32 v109, v109
    v_mul_f32 v37, v37, v45
    v_exp_f32 v110, v110
    v_mul_f32 v38, v38, v46
    v_exp_f32 v111, v111
    v_mul_f32 v39, v39, v47
    v_fma_f32 v104, v104, v142, v142
    v_fma_f32 v105, v105, v142, v142
    v_fma_f32 v106, v106, v142, v142
    v_fma_f32 v107, v107, v142, v142
    v_fma_f32 v108, v108, v142, v142
    v_fma_f32 v109, v109, v142, v142
    v_fma_f32 v110, v110, v142, v142
    v_fma_f32 v111, v111, v142, v142
    v_rcp_f32 v104, v104
    v_rcp_f32 v105, v105
    v_mul_f32 v32, v32, v104
    v_rcp_f32 v106, v106
    v_mul_f32 v33, v33, v105
    v_rcp_f32 v107, v107
    v_mul_f32 v34, v34, v106
    v_rcp_f32 v108, v108
    v_mul_f32 v35, v35, v107
    v_rcp_f32 v109, v109
    v_mul_f32 v36, v36, v108
    v_rcp_f32 v110, v110
    v_mul_f32 v37, v37, v109
    v_rcp_f32 v111, v111
    v_mul_f32 v38, v38, v110
    v_mul_f32 v39, v39, v111
    v_cvt_pk_bf16_f32 v100, v32, v33
    v_cvt_pk_bf16_f32 v101, v34, v35
    v_cvt_pk_bf16_f32 v102, v36, v37
    v_cvt_pk_bf16_f32 v103, v38, v39
    ds_write_b128 v112, v[100:103] offset:4096
    s_waitcnt lgkmcnt(0)
    s_barrier
    ds_read_b128 v[92:95], v113
    ds_read_b128 v[88:91], v113 offset:4096
    s_waitcnt lgkmcnt(1)
    buffer_store_dwordx4 v[92:95], v114, s[24:27], s59 offen sc1
    s_add_u32 s59, s59, s62
    s_waitcnt lgkmcnt(0)
    buffer_store_dwordx4 v[88:91], v114, s[24:27], s59 offen sc1
    s_waitcnt vmcnt(0)
    s_barrier
    s_cmp_lg_u32 s30, 0
    s_cbranch_scc1 L_fs_117
    s_add_u32 s40, s32, 8
    v_mov_b32 v2, s40
    v_mov_b32_e64 v3, s33
    s_lshl_b32 s41, s2, 6
    s_add_u32 s41, s41, 98304
    v_mov_b32 v4, s41
    s_mov_b64 exec, 1
    buffer_store_dwordx2 v[2:3], v4, s[24:27], 0 offen sc1
    s_mov_b64 exec, -1
L_fs_117:
    s_waitcnt vmcnt(0)
    s_branch L_gudone_111
L_idle_110:
    s_cmp_lg_u32 s30, 0
    s_cbranch_scc1 L_fs_118
    s_add_u32 s40, s32, 8
    v_mov_b32 v2, s40
    v_mov_b32_e64 v3, s33
    s_lshl_b32 s41, s2, 6
    s_add_u32 s41, s41, 98304
    v_mov_b32 v4, s41
    s_mov_b64 exec, 1
    buffer_store_dwordx2 v[2:3], v4, s[24:27], 0 offen sc1
    s_mov_b64 exec, -1
L_fs_118:
    s_waitcnt vmcnt(0)
L_gudone_111:
    s_lshr_b32 s44, s29, 3
    v_and_b32 v3, 31, v1
    v_lshrrev_b32_e64 v4, 5, v1
    v_bfe_u32 v5, v3, 1, 3
    s_lshl_b32 s40, s30, 14
    v_add_u32 v6, 0, v4
    v_xor_b32 v6, v6, v5
    v_lshlrev_b32 v6, 4, v6
    v_lshl_add_u32 v6, v3, 7, v6
    v_add_u32 v104, s40, v6
    v_add_u32 v6, 2, v4
    v_xor_b32 v6, v6, v5
    v_lshlrev_b32 v6, 4, v6
    v_lshl_add_u32 v6, v3, 7, v6
    v_add_u32 v105, s40, v6
    v_add_u32 v6, 4, v4
    v_xor_b32 v6, v6, v5
    v_lshlrev_b32 v6, 4, v6
    v_lshl_add_u32 v6, v3, 7, v6
    v_add_u32 v106, s40, v6
    v_add_u32 v6, 6, v4
    v_xor_b32 v6, v6, v5
    v_lshlrev_b32 v6, 4, v6
    v_lshl_add_u32 v6, v3, 7, v6
    v_add_u32 v107, s40, v6
    v_lshrrev_b32 v6, 3, v1
    v_and_b32 v7, 7, v1
    s_movk_i32 s41, 3712
    v_add_u32_e64 v8, 0, v6
    v_bfe_u32 v9, v8, 1, 3
    v_xor_b32_e64 v9, v9, v7
    v_mul_lo_u32 v8, v8, s41
    v_lshl_add_u32 v108, v9, 4, v8
    v_add_u32_e64 v8, 8, v6
    v_bfe_u32 v9, v8, 1, 3
    v_xor_b32_e64 v9, v9, v7
    v_mul_lo_u32 v8, v8, s41
    v_lshl_add_u32 v109, v9, 4, v8
    v_add_u32_e64 v8, 16, v6
    v_bfe_u32 v9, v8, 1, 3
    v_xor_b32_e64 v9, v9, v7
    v_mul_lo_u32 v8, v8, s41
    v_lshl_add_u32 v110, v9, 4, v8
    v_add_u32_e64 v8, 24, v6
    v_bfe_u32 v9, v8, 1, 3
    v_xor_b32_e64 v9, v9, v7
    v_mul_lo_u32 v8, v8, s41
    v_lshl_add_u32 v111, v9, 4, v8
    s_lshl_b32 s57, s28, 8
    s_lshl_b32 s41, s44, 5
    s_add_u32 s57, s57, s41
    s_mul_i32 s57, s57, 3712
    s_mul_i32 s41, s30, 896
    s_add_u32 s57, s57, s41
    s_add_u32 s57, s57, 21495808
    s_lshl_b32 s58, s30, 14
    s_lshl_b32 s41, s35, 7
    s_lshr_b32 s42, s30, 1
    s_lshl_b32 s42, s42, 6
    s_add_u32 s41, s41, s42
    s_and_b32 s42, s30, 1
    s_lshl_b32 s42, s42, 5
    s_add_u32 s41, s41, s42
    v_lshlrev_b32 v12, 4, v4
    v_add_u32 v12, s41, v12
    s_lshl_b32 s42, s28, 8
    s_lshl_b32 s43, s44, 5
    s_add_u32 s42, s42, s43
    v_add_u32_e64 v13, s42, v3
    s_movk_i32 s43, 1152
    v_mul_lo_u32 v13, v13, s43
    v_add_u32 v13, v13, v12
    v_and_b32 v8, 15, v3
    v_lshrrev_b32 v9, 4, v3
    v_lshlrev_b32 v8, 7, v8
    v_lshl_add_u32 v8, v9, 4, v8
    s_lshl_b32 s42, s44, 5
    v_add_u32 v8, s42, v8
    v_add_u32_e64 v9, s38, v8
    v_lshl_add_u32 v14, v9, 10, v12
    v_add_u32_e64 v9, s39, v8
    v_lshl_add_u32 v15, v9, 10, v12
    v_lshlrev_b32 v2, 3, v1
    v_add_u32 v2, s28, v2
    v_lshlrev_b32_e64 v2, 6, v2
    v_add_u32 v115, 98304, v2
    s_add_u32 s40, s32, 7
    s_mov_b32 exec_lo, -1
    s_mov_b32 exec_hi, 0
    s_mov_b32 s98, 0
    v_mov_b32 v2, 0
    v_mov_b32_e64 v3, 0
    s_nop 1
L_poll_119:
    buffer_load_dwordx2 v[2:3], v115, s[24:27], 0 offen sc1
    s_add_u32 s98, s98, 1
    s_cmp_gt_u32 s98, 0x40000
    s_cbranch_scc1 L_pd_120
    s_waitcnt vmcnt(0)
    v_subrev_u32_e64 v2, s40, v2
    v_cmp_gt_u32 vcc, 64, v2
    v_cmp_eq_u32 s[42:43], s33, v3
    s_nop 1
    s_and_b64 vcc, vcc, s[42:43]
    s_cmp_eq_u64 vcc, exec
    s_cbranch_scc1 L_pd_120
    s_sleep 8
    s_branch L_poll_119
L_pd_120:
    s_waitcnt vmcnt(0)
    s_mov_b64 exec, -1
    s_add_u32 m0, s58, 0
    s_nop 0
    buffer_load_dwordx4 v108, s[24:27], s57 offen lds
    s_add_u32 m0, s58, 1024
    s_nop 0
    buffer_load_dwordx4 v109, s[24:27], s57 offen lds
    s_add_u32 m0, s58, 2048
    s_nop 0
    buffer_load_dwordx4 v110, s[24:27], s57 offen lds
    s_add_u32 m0, s58, 3072
    s_nop 0
    buffer_load_dwordx4 v111, s[24:27], s57 offen lds
    s_add_u32 s57, s57, 128
    s_add_u32 m0, s58, 4096
    s_nop 0
    buffer_load_dwordx4 v108, s[24:27], s57 offen lds
    s_add_u32 m0, s58, 5120
    s_nop 0
    buffer_load_dwordx4 v109, s[24:27], s57 offen lds
    s_add_u32 m0, s58, 6144
    s_nop 0
    buffer_load_dwordx4 v110, s[24:27], s57 offen lds
    s_add_u32 m0, s58, 7168
    s_nop 0
    buffer_load_dwordx4 v111, s[24:27], s57 offen lds
    s_add_u32 s57, s57, 128
    s_add_u32 m0, s58, 8192
    s_nop 0
    buffer_load_dwordx4 v108, s[24:27], s57 offen lds
    s_add_u32 m0, s58, 9216
    s_nop 0
    buffer_load_dwordx4 v109, s[24:27], s57 offen lds
    s_add_u32 m0, s58, 10240
    s_nop 0
    buffer_load_dwordx4 v110, s[24:27], s57 offen lds
    s_add_u32 m0, s58, 11264
    s_nop 0
    buffer_load_dwordx4 v111, s[24:27], s57 offen lds
    s_add_u32 s57, s57, 128
    s_mov_b32 s47, 10485760
    buffer_load_dwordx4 v[96:99], v13, s[24:27], s47 offen
    v_add_u32 v13, 147456, v13
    buffer_load_dwordx4 v[100:103], v13, s[24:27], s47 offen
    s_waitcnt vmcnt(10)
    ds_read_b128 v[80:83], v104 offset:0
    ds_read_b128 v[84:87], v105 offset:0
    s_waitcnt lgkmcnt(1)
    v_mfma_f32_32x32x16_bf16 v[16:31], a[128:131], v[80:83], 0
    ds_read_b128 v[88:91], v106 offset:0
    v_mfma_f32_32x32x16_bf16 v[32:47], a[132:135], v[80:83], 0
    s_add_u32 m0, s58, 12288
    s_nop 0
    buffer_load_dwordx4 v108, s[24:27], s57 offen lds
    s_waitcnt lgkmcnt(1)
    v_mfma_f32_32x32x16_bf16 v[16:31], a[136:139], v[84:87], v[16:31]
    ds_read_b128 v[92:95], v107 offset:0
    v_mfma_f32_32x32x16_bf16 v[32:47], a[140:143], v[84:87], v[32:47]
    s_add_u32 m0, s58, 13312
    s_nop 0
    buffer_load_dwordx4 v109, s[24:27], s57 offen lds
    s_waitcnt vmcnt(8)
    s_waitcnt lgkmcnt(1)
    v_mfma_f32_32x32x16_bf16 v[16:31], a[144:147], v[88:91], v[16:31]
    ds_read_b128 v[80:83], v104 offset:4096
    v_mfma_f32_32x32x16_bf16 v[32:47], a[148:151], v[88:91], v[32:47]
    s_add_u32 m0, s58, 14336
    s_nop 0
    buffer_load_dwordx4 v110, s[24:27], s57 offen lds
    s_waitcnt lgkmcnt(1)
    v_mfma_f32_32x32x16_bf16 v[16:31], a[152:155], v[92:95], v[16:31]
    ds_read_b128 v[84:87], v105 offset:4096
    v_mfma_f32_32x32x16_bf16 v[32:47], a[156:159], v[92:95], v[32:47]
    s_add_u32 m0, s58, 15360
    s_nop 0
    buffer_load_dwordx4 v111, s[24:27], s57 offen lds
    s_add_u32 s57, s57, 128
    s_waitcnt lgkmcnt(1)
    v_mfma_f32_32x32x16_bf16 v[16:31], a[160:163], v[80:83], v[16:31]
    ds_read_b128 v[88:91], v106 offset:4096
    v_mfma_f32_32x32x16_bf16 v[32:47], a[164:167], v[80:83], v[32:47]
    s_add_u32 m0, s58, 0
    s_nop 0
    buffer_load_dwordx4 v108, s[24:27], s57 offen lds
    s_waitcnt lgkmcnt(1)
    v_mfma_f32_32x32x16_bf16 v[16:31], a[168:171], v[84:87], v[16:31]
    ds_read_b128 v[92:95], v107 offset:4096
    v_mfma_f32_32x32x16_bf16 v[32:47], a[172:175], v[84:87], v[32:47]
    s_add_u32 m0, s58, 1024
    s_nop 0
    buffer_load_dwordx4 v109, s[24:27], s57 offen lds
    s_waitcnt vmcnt(8)
    s_waitcnt lgkmcnt(1)
    v_mfma_f32_32x32x16_bf16 v[16:31], a[176:179], v[88:91], v[16:31]
    ds_read_b128 v[80:83], v104 offset:8192
    v_mfma_f32_32x32x16_bf16 v[32:47], a[180:183], v[88:91], v[32:47]
    s_add_u32 m0, s58, 2048
    s_nop 0
    buffer_load_dwordx4 v110, s[24:27], s57 offen lds
    s_waitcnt lgkmcnt(1)
    v_mfma_f32_32x32x16_bf16 v[16:31], a[184:187], v[92:95], v[16:31]
    ds_read_b128 v[84:87], v105 offset:8192
    v_mfma_f32_32x32x16_bf16 v[32:47], a[188:191], v[92:95], v[32:47]
    s_add_u32 m0, s58, 3072
    s_nop 0
    buffer_load_dwordx4 v111, s[24:27], s57 offen lds
    s_add_u32 s57, s57, 128
    s_waitcnt lgkmcnt(1)
    v_mfma_f32_32x32x16_bf16 v[16:31], a[192:195], v[80:83], v[16:31]
    ds_read_b128 v[88:91], v106 offset:8192
    v_mfma_f32_32x32x16_bf16 v[32:47], a[196:199], v[80:83], v[32:47]
    s_add_u32 m0, s58, 4096
    s_nop 0
    buffer_load_dwordx4 v108, s[24:27], s57 offen lds
    s_waitcnt lgkmcnt(1)
    v_mfma_f32_32x32x16_bf16 v[16:31], a[200:203], v[84:87], v[16:31]
    ds_read_b128 v[92:95], v107 offset:8192
    v_mfma_f32_32x32x16_bf16 v[32:47], a[204:207], v[84:87], v[32:47]
    s_add_u32 m0, s58, 5120
    s_nop 0
    buffer_load_dwordx4 v109, s[24:27], s57 offen lds
    s_waitcnt vmcnt(6)
    s_waitcnt lgkmcnt(1)
    v_mfma_f32_32x32x16_bf16 v[16:31], a[208:211], v[88:91], v[16:31]
    ds_read_b128 v[80:83], v104 offset:12288
    v_mfma_f32_32x32x16_bf16 v[32:47], a[212:215], v[88:91], v[32:47]
    s_add_u32 m0, s58, 6144
    s_nop 0
    buffer_load_dwordx4 v110, s[24:27], s57 offen lds
    s_waitcnt lgkmcnt(1)
    v_mfma_f32_32x32x16_bf16 v[16:31], a[216:219], v[92:95], v[16:31]
    ds_read_b128 v[84:87], v105 offset:12288
    v_mfma_f32_32x32x16_bf16 v[32:47], a[220:223], v[92:95], v[32:47]
    s_add_u32 m0, s58, 7168
    s_nop 0
    buffer_load_dwordx4 v111, s[24:27], s57 offen lds
    s_add_u32 s57, s57, 128
    s_waitcnt lgkmcnt(1)
    v_mfma_f32_32x32x16_bf16 v[16:31], a[224:227], v[80:83], v[16:31]
    ds_read_b128 v[88:91], v106 offset:12288
    v_mfma_f32_32x32x16_bf16 v[32:47], a[228:231], v[80:83], v[32:47]
    s_add_u32 m0, s58, 8192
    s_nop 0
    buffer_load_dwordx4 v108, s[24:27], s57 offen lds
    s_waitcnt lgkmcnt(1)
    v_mfma_f32_32x32x16_bf16 v[16:31], a[232:235], v[84:87], v[16:31]
    ds_read_b128 v[92:95], v107 offset:12288
    v_mfma_f32_32x32x16_bf16 v[32:47], a[236:239], v[84:87], v[32:47]
    s_add_u32 m0, s58, 9216
    s_nop 0
    buffer_load_dwordx4 v109, s[24:27], s57 offen lds
    s_waitcnt vmcnt(6)
    s_waitcnt lgkmcnt(1)
    v_mfma_f32_32x32x16_bf16 v[16:31], a[240:243], v[88:91], v[16:31]
    ds_read_b128 v[80:83], v104 offset:0
    v_mfma_f32_32x32x16_bf16 v[32:47], a[244:247], v[88:91], v[32:47]
    s_add_u32 m0, s58, 10240
    s_nop 0
    buffer_load_dwordx4 v110, s[24:27], s57 offen lds
    s_waitcnt lgkmcnt(1)
    v_mfma_f32_32x32x16_bf16 v[16:31], a[248:251], v[92:95], v[16:31]
    ds_read_b128 v[84:87], v105 offset:0
    v_mfma_f32_32x32x16_bf16 v[32:47], a[252:255], v[92:95], v[32:47]
    s_add_u32 m0, s58, 11264
    s_nop 0
    buffer_load_dwordx4 v111, s[24:27], s57 offen lds
    s_add_u32 s57, s57, 474368
    s_waitcnt lgkmcnt(1)
    v_mfma_f32_32x32x16_bf16 v[16:31], v[160:163], v[80:83], v[16:31]
    ds_read_b128 v[88:91], v106 offset:0
    v_mfma_f32_32x32x16_bf16 v[32:47], v[164:167], v[80:83], v[32:47]
    s_add_u32 s40, s32, 8
    s_mov_b32 exec_lo, -1
    s_mov_b32 exec_hi, 0
    s_mov_b32 s98, 0
    v_mov_b32 v2, 0
    v_mov_b32_e64 v3, 0
    s_nop 5
L_poll_122:
    buffer_load_dwordx2 v[2:3], v115, s[24:27], 0 offen sc1
    s_add_u32 s98, s98, 1
    s_cmp_gt_u32 s98, 0x40000
    s_cbranch_scc1 L_pd_123
    s_waitcnt vmcnt(0)
    v_subrev_u32_e64 v2, s40, v2
    v_cmp_gt_u32 vcc, 64, v2
    v_cmp_eq_u32 s[42:43], s33, v3
    s_nop 1
    s_and_b64 vcc, vcc, s[42:43]
    s_cmp_eq_u64 vcc, exec
    s_cbranch_scc0 L_poll_122
L_pd_123:
    s_waitcnt vmcnt(0)
    s_mov_b64 exec, -1
    s_add_u32 m0, s58, 12288
    s_nop 0
    buffer_load_dwordx4 v108, s[24:27], s57 offen lds
    s_waitcnt lgkmcnt(1)
    v_mfma_f32_32x32x16_bf16 v[16:31], v[168:171], v[84:87], v[16:31]
    ds_read_b128 v[92:95], v107 offset:0
    v_mfma_f32_32x32x16_bf16 v[32:47], v[172:175], v[84:87], v[32:47]
    s_add_u32 m0, s58, 13312
    s_nop 0
    buffer_load_dwordx4 v109, s[24:27], s57 offen lds
    s_waitcnt lgkmcnt(1)
    v_mfma_f32_32x32x16_bf16 v[16:31], v[176:179], v[88:91], v[16:31]
    ds_read_b128 v[80:83], v104 offset:4096
    v_mfma_f32_32x32x16_bf16 v[32:47], v[180:183], v[88:91], v[32:47]
    s_add_u32 m0, s58, 14336
    s_nop 0
    buffer_load_dwordx4 v110, s[24:27], s57 offen lds
    s_waitcnt lgkmcnt(1)
    v_mfma_f32_32x32x16_bf16 v[16:31], v[184:187], v[92:95], v[16:31]
    ds_read_b128 v[84:87], v105 offset:4096
    v_mfma_f32_32x32x16_bf16 v[32:47], v[188:191], v[92:95], v[32:47]
    s_add_u32 m0, s58, 15360
    s_nop 0
    buffer_load_dwordx4 v111, s[24:27], s57 offen lds
    s_add_u32 s57, s57, 128
    s_waitcnt lgkmcnt(1)
    v_mfma_f32_32x32x16_bf16 v[16:31], v[192:195], v[80:83], v[16:31]
    ds_read_b128 v[88:91], v106 offset:4096
    v_mfma_f32_32x32x16_bf16 v[32:47], v[196:199], v[80:83], v[32:47]
    s_add_u32 m0, s58, 0
    s_nop 0
    buffer_load_dwordx4 v108, s[24:27], s57 offen lds
    s_waitcnt lgkmcnt(1)
    v_mfma_f32_32x32x16_bf16 v[16:31], v[200:203], v[84:87], v[16:31]
    ds_read_b128 v[92:95], v107 offset:4096
    v_mfma_f32_32x32x16_bf16 v[32:47], v[204:207], v[84:87], v[32:47]
    s_add_u32 m0, s58, 1024
    s_nop 0
    buffer_load_dwordx4 v109, s[24:27], s57 offen lds
    s_waitcnt lgkmcnt(1)
    v_mfma_f32_32x32x16_bf16 v[16:31], v[208:211], v[88:91], v[16:31]
    ds_read_b128 v[80:83], v104 offset:8192
    v_mfma_f32_32x32x16_bf16 v[32:47], v[212:215], v[88:91], v[32:47]
    s_add_u32 m0, s58, 2048
    s_nop 0
    buffer_load_dwordx4 v110, s[24:27], s57 offen lds
    s_waitcnt lgkmcnt(1)
    v_mfma_f32_32x32x16_bf16 v[16:31], v[216:219], v[92:95], v[16:31]
    ds_read_b128 v[84:87], v105 offset:8192
    v_mfma_f32_32x32x16_bf16 v[32:47], v[220:223], v[92:95], v[32:47]
    s_add_u32 m0, s58, 3072
    s_nop 0
    buffer_load_dwordx4 v111, s[24:27], s57 offen lds
    s_add_u32 s57, s57, 128
    s_waitcnt lgkmcnt(1)
    v_mfma_f32_32x32x16_bf16 v[16:31], v[224:227], v[80:83], v[16:31]
    ds_read_b128 v[88:91], v106 offset:8192
    v_mfma_f32_32x32x16_bf16 v[32:47], v[228:231], v[80:83], v[32:47]
    s_add_u32 m0, s58, 4096
    s_nop 0
    buffer_load_dwordx4 v108, s[24:27], s57 offen lds
    s_waitcnt lgkmcnt(1)
    v_mfma_f32_32x32x16_bf16 v[16:31], v[232:235], v[84:87], v[16:31]
    ds_read_b128 v[92:95], v107 offset:8192
    v_mfma_f32_32x32x16_bf16 v[32:47], v[236:239], v[84:87], v[32:47]
    s_add_u32 m0, s58, 5120
    s_nop 0
    buffer_load_dwordx4 v109, s[24:27], s57 offen lds
    s_waitcnt vmcnt(6)
    s_waitcnt lgkmcnt(1)
    v_mfma_f32_32x32x16_bf16 v[16:31], v[240:243], v[88:91], v[16:31]
    ds_read_b128 v[80:83], v104 offset:12288
    v_mfma_f32_32x32x16_bf16 v[32:47], v[244:247], v[88:91], v[32:47]
    s_add_u32 m0, s58, 6144
    s_nop 0
    buffer_load_dwordx4 v110, s[24:27], s57 offen lds
    s_waitcnt lgkmcnt(1)
    v_mfma_f32_32x32x16_bf16 v[16:31], v[248:251], v[92:95], v[16:31]
    ds_read_b128 v[84:87], v105 offset:12288
    v_mfma_f32_32x32x16_bf16 v[32:47], v[252:255], v[92:95], v[32:47]
    s_add_u32 m0, s58, 7168
    s_nop 0
    buffer_load_dwordx4 v111, s[24:27], s57 offen lds
    s_add_u32 s57, s57, 128
    s_waitcnt lgkmcnt(1)
    v_mfma_f32_32x32x16_bf16 v[48:63], a[128:131], v[80:83], 0
    ds_read_b128 v[88:91], v106 offset:12288
    v_mfma_f32_32x32x16_bf16 v[64:79], a[132:135], v[80:83], 0
    s_add_u32 m0, s58, 8192
    s_nop 0
    buffer_load_dwordx4 v108, s[24:27], s57 offen lds
    s_waitcnt lgkmcnt(1)
    v_mfma_f32_32x32x16_bf16 v[48:63], a[136:139], v[84:87], v[48:63]
    ds_read_b128 v[92:95], v107 offset:12288
    v_mfma_f32_32x32x16_bf16 v[64:79], a[140:143], v[84:87], v[64:79]
    s_add_u32 m0, s58, 9216
    s_nop 0
    buffer_load_dwordx4 v109, s[24:27], s57 offen lds
    s_waitcnt vmcnt(6)
    s_waitcnt lgkmcnt(1)
    v_mfma_f32_32x32x16_bf16 v[48:63], a[144:147], v[88:91], v[48:63]
    ds_read_b128 v[80:83], v104 offset:0
    v_mfma_f32_32x32x16_bf16 v[64:79], a[148:151], v[88:91], v[64:79]
    s_add_u32 m0, s58, 10240
    s_nop 0
    buffer_load_dwordx4 v110, s[24:27], s57 offen lds
    s_waitcnt lgkmcnt(1)
    v_mfma_f32_32x32x16_bf16 v[48:63], a[152:155], v[92:95], v[48:63]
    ds_read_b128 v[84:87], v105 offset:0
    v_mfma_f32_32x32x16_bf16 v[64:79], a[156:159], v[92:95], v[64:79]
    s_add_u32 m0, s58, 11264
    s_nop 0
    buffer_load_dwordx4 v111, s[24:27], s57 offen lds
    s_add_u32 s57, s57, 128
    s_waitcnt lgkmcnt(1)
    v_mfma_f32_32x32x16_bf16 v[48:63], a[160:163], v[80:83], v[48:63]
    ds_read_b128 v[88:91], v106 offset:0
    v_mfma_f32_32x32x16_bf16 v[64:79], a[164:167], v[80:83], v[64:79]
    s_add_u32 m0, s58, 12288
    s_nop 0
    buffer_load_dwordx4 v108, s[24:27], s57 offen lds
    s_waitcnt lgkmcnt(1)
    v_mfma_f32_32x32x16_bf16 v[48:63], a[168:171], v[84:87], v[48:63]
    ds_read_b128 v[92:95], v107 offset:0
    v_mfma_f32_32x32x16_bf16 v[64:79], a[172:175], v[84:87], v[64:79]
    s_add_u32 m0, s58, 13312
    s_nop 0
    buffer_load_dwordx4 v109, s[24:27], s57 offen lds
    s_waitcnt vmcnt(6)
    s_waitcnt lgkmcnt(1)
    v_mfma_f32_32x32x16_bf16 v[48:63], a[176:179], v[88:91], v[48:63]
    ds_read_b128 v[80:83], v104 offset:4096
    v_mfma_f32_32x32x16_bf16 v[64:79], a[180:183], v[88:91], v[64:79]
    s_add_u32 m0, s58, 14336
    s_nop 0
    buffer_load_dwordx4 v110, s[24:27], s57 offen lds
    s_waitcnt lgkmcnt(1)
    v_mfma_f32_32x32x16_bf16 v[48:63], a[184:187], v[92:95], v[48:63]
    ds_read_b128 v[84:87], v105 offset:4096
    v_mfma_f32_32x32x16_bf16 v[64:79], a[188:191], v[92:95], v[64:79]
    s_add_u32 m0, s58, 15360
    s_nop 0
    buffer_load_dwordx4 v111, s[24:27], s57 offen lds
    s_add_u32 s57, s57, 128
    s_waitcnt lgkmcnt(1)
    v_mfma_f32_32x32x16_bf16 v[48:63], a[192:195], v[80:83], v[48:63]
    ds_read_b128 v[88:91], v106 offset:4096
    v_mfma_f32_32x32x16_bf16 v[64:79], a[196:199], v[80:83], v[64:79]
    s_add_u32 m0, s58, 0
    s_nop 0
    buffer_load_dwordx4 v108, s[24:27], s57 offen lds
    s_waitcnt lgkmcnt(1)
    v_mfma_f32_32x32x16_bf16 v[48:63], a[200:203], v[84:87], v[48:63]
    ds_read_b128 v[92:95], v107 offset:4096
    v_mfma_f32_32x32x16_bf16 v[64:79], a[204:207], v[84:87], v[64:79]
    s_add_u32 m0, s58, 1024
    s_nop 0
    buffer_load_dwordx4 v109, s[24:27], s57 offen lds
    s_waitcnt vmcnt(6)
    s_waitcnt lgkmcnt(1)
    v_mfma_f32_32x32x16_bf16 v[48:63], a[208:211], v[88:91], v[48:63]
    ds_read_b128 v[80:83], v104 offset:8192
    v_mfma_f32_32x32x16_bf16 v[64:79], a[212:215], v[88:91], v[64:79]
    s_add_u32 m0, s58, 2048
    s_nop 0
    buffer_load_dwordx4 v110, s[24:27], s57 offen lds
    s_waitcnt lgkmcnt(1)
    v_mfma_f32_32x32x16_bf16 v[48:63], a[216:219], v[92:95], v[48:63]
    ds_read_b128 v[84:87], v105 offset:8192
    v_mfma_f32_32x32x16_bf16 v[64:79], a[220:223], v[92:95], v[64:79]
    s_add_u32 m0, s58, 3072
    s_nop 0
    buffer_load_dwordx4 v111, s[24:27], s57 offen lds
    s_add_u32 s57, s57, 128
    s_waitcnt lgkmcnt(1)
    v_mfma_f32_32x32x16_bf16 v[48:63], a[224:227], v[80:83], v[48:63]
    ds_read_b128 v[88:91], v106 offset:8192
    v_mfma_f32_32x32x16_bf16 v[64:79], a[228:231], v[80:83], v[64:79]
    s_add_u32 m0, s58, 4096
    s_nop 0
    buffer_load_dwordx4 v108, s[24:27], s57 offen lds
    s_waitcnt lgkmcnt(1)
    v_mfma_f32_32x32x16_bf16 v[48:63], a[232:235], v[84:87], v[48:63]
    ds_read_b128 v[92:95], v107 offset:8192
    v_mfma_f32_32x32x16_bf16 v[64:79], a[236:239], v[84:87], v[64:79]
    s_add_u32 m0, s58, 5120
    s_nop 0
    buffer_load_dwordx4 v109, s[24:27], s57 offen lds
    s_waitcnt vmcnt(6)
    s_waitcnt lgkmcnt(1)
    v_mfma_f32_32x32x16_bf16 v[48:63], a[240:243], v[88:91], v[48:63]
    ds_read_b128 v[80:83], v104 offset:12288
    v_mfma_f32_32x32x16_bf16 v[64:79], a[244:247], v[88:91], v[64:79]
    s_add_u32 m0, s58, 6144
    s_nop 0
    buffer_load_dwordx4 v110, s[24:27], s57 offen lds
    s_waitcnt lgkmcnt(1)
    v_mfma_f32_32x32x16_bf16 v[48:63], a[248:251], v[92:95], v[48:63]
    ds_read_b128 v[84:87], v105 offset:12288
    v_mfma_f32_32x32x16_bf16 v[64:79], a[252:255], v[92:95], v[64:79]
    s_add_u32 m0, s58, 7168
    s_nop 0
    buffer_load_dwordx4 v111, s[24:27], s57 offen lds
    s_add_u32 s57, s57, 128
    s_waitcnt lgkmcnt(1)
    v_mfma_f32_32x32x16_bf16 v[48:63], v[160:163], v[80:83], v[48:63]
    ds_read_b128 v[88:91], v106 offset:12288
    v_mfma_f32_32x32x16_bf16 v[64:79], v[164:167], v[80:83], v[64:79]
    s_waitcnt lgkmcnt(1)
    v_mfma_f32_32x32x16_bf16 v[48:63], v[168:171], v[84:87], v[48:63]
    ds_read_b128 v[92:95], v107 offset:12288
    v_mfma_f32_32x32x16_bf16 v[64:79], v[172:175], v[84:87], v[64:79]
    s_waitcnt vmcnt(4)
    s_waitcnt lgkmcnt(1)
    v_mfma_f32_32x32x16_bf16 v[48:63], v[176:179], v[88:91], v[48:63]
    ds_read_b128 v[80:83], v104 offset:0
    v_mfma_f32_32x32x16_bf16 v[64:79], v[180:183], v[88:91], v[64:79]
    s_waitcnt lgkmcnt(1)
    v_mfma_f32_32x32x16_bf16 v[48:63], v[184:187], v[92:95], v[48:63]
    ds_read_b128 v[84:87], v105 offset:0
    v_mfma_f32_32x32x16_bf16 v[64:79], v[188:191], v[92:95], v[64:79]
    s_waitcnt lgkmcnt(1)
    v_mfma_f32_32x32x16_bf16 v[48:63], v[192:195], v[80:83], v[48:63]
    ds_read_b128 v[88:91], v106 offset:0
    v_mfma_f32_32x32x16_bf16 v[64:79], v[196:199], v[80:83], v[64:79]
    s_waitcnt lgkmcnt(1)
    v_mfma_f32_32x32x16_bf16 v[48:63], v[200:203], v[84:87], v[48:63]
    ds_read_b128 v[92:95], v107 offset:0
    v_mfma_f32_32x32x16_bf16 v[64:79], v[204:207], v[84:87], v[64:79]
    s_waitcnt vmcnt(0)
    s_waitcnt lgkmcnt(1)
    v_mfma_f32_32x32x16_bf16 v[48:63], v[208:211], v[88:91], v[48:63]
    ds_read_b128 v[80:83], v104 offset:4096
    v_mfma_f32_32x32x16_bf16 v[64:79], v[212:215], v[88:91], v[64:79]
    s_waitcnt lgkmcnt(1)
    v_mfma_f32_32x32x16_bf16 v[48:63], v[216:219], v[92:95], v[48:63]
    ds_read_b128 v[84:87], v105 offset:4096
    v_mfma_f32_32x32x16_bf16 v[64:79], v[220:223], v[92:95], v[64:79]
    s_waitcnt lgkmcnt(1)
    v_mfma_f32_32x32x16_bf16 v[48:63], v[224:227], v[80:83], v[48:63]
    ds_read_b128 v[88:91], v106 offset:4096
    v_mfma_f32_32x32x16_bf16 v[64:79], v[228:231], v[80:83], v[64:79]
    s_waitcnt lgkmcnt(1)
    v_mfma_f32_32x32x16_bf16 v[48:63], v[232:235], v[84:87], v[48:63]
    ds_read_b128 v[92:95], v107 offset:4096
    v_mfma_f32_32x32x16_bf16 v[64:79], v[236:239], v[84:87], v[64:79]
    s_waitcnt lgkmcnt(1)
    v_mfma_f32_32x32x16_bf16 v[48:63], v[240:243], v[88:91], v[48:63]
    v_mfma_f32_32x32x16_bf16 v[64:79], v[244:247], v[88:91], v[64:79]
    s_waitcnt lgkmcnt(0)
    v_mfma_f32_32x32x16_bf16 v[48:63], v[248:251], v[92:95], v[48:63]
    v_mfma_f32_32x32x16_bf16 v[64:79], v[252:255], v[92:95], v[64:79]
    v_lshlrev_b32 v2, 4, v1
    s_lshl_b32 s40, s30, 14
    v_add_u32_e64 v3, s40, v2
    ds_write_b128 v3, v[16:19] offset:0
    ds_write_b128 v3, v[20:23] offset:1024
    ds_write_b128 v3, v[24:27] offset:2048
    ds_write_b128 v3, v[28:31] offset:3072
    ds_write_b128 v3, v[32:35] offset:4096
    ds_write_b128 v3, v[36:39] offset:5120
    ds_write_b128 v3, v[40:43] offset:6144
    ds_write_b128 v3, v[44:47] offset:7168
    ds_write_b128 v3, v[48:51] offset:8192
    ds_write_b128 v3, v[52:55] offset:9216
    ds_write_b128 v3, v[56:59] offset:10240
    ds_write_b128 v3, v[60:63] offset:11264
    ds_write_b128 v3, v[64:67] offset:12288
    ds_write_b128 v3, v[68:71] offset:13312
    ds_write_b128 v3, v[72:75] offset:14336
    ds_write_b128 v3, v[76:79] offset:15360
    s_waitcnt lgkmcnt(0)
    s_barrier
    s_lshl_b32 s40, s30, 11
    v_add_u32 v3, s40, v2
    ds_read_b128 v[16:19], v3 offset:0
    ds_read_b128 v[20:23], v3 offset:1024
    ds_read_b128 v[24:27], v3 offset:16384
    ds_read_b128 v[28:31], v3 offset:17408
    ds_read_b128 v[32:35], v3 offset:32768
    ds_read_b128 v[36:39], v3 offset:33792
    ds_read_b128 v[40:43], v3 offset:49152
    ds_read_b128 v[44:47], v3 offset:50176
    ds_read_b128 v[48:51], v3 offset:8192
    ds_read_b128 v[52:55], v3 offset:9216
    ds_read_b128 v[56:59], v3 offset:24576
    ds_read_b128 v[60:63], v3 offset:25600
    ds_read_b128 v[64:67], v3 offset:40960
    ds_read_b128 v[68:71], v3 offset:41984
    ds_read_b128 v[72:75], v3 offset:57344
    ds_read_b128 v[76:79], v3 offset:58368
    s_mov_b32 s54, 0xffff0000
    s_waitcnt lgkmcnt(13)
    v_add_f32 v16, v16, v24
    v_add_f32 v17, v17, v25
    v_add_f32 v18, v18, v26
    v_add_f32 v19, v19, v27
    s_waitcnt lgkmcnt(12)
    v_add_f32 v20, v20, v28
    v_add_f32 v21, v21, v29
    v_add_f32 v22, v22, v30
    v_add_f32 v23, v23, v31
    s_waitcnt lgkmcnt(9)
    v_add_f32 v32, v32, v40
    v_add_f32 v33, v33, v41
    v_add_f32 v34, v34, v42
    v_add_f32 v35, v35, v43
    s_waitcnt lgkmcnt(8)
    v_add_f32 v36, v36, v44
    v_add_f32 v37, v37, v45
    v_add_f32 v38, v38, v46
    v_add_f32 v39, v39, v47
    v_add_f32 v16, v16, v32
    v_add_f32 v17, v17, v33
    v_add_f32 v18, v18, v34
    v_add_f32 v19, v19, v35
    v_add_f32 v20, v20, v36
    v_add_f32 v21, v21, v37
    v_add_f32 v22, v22, v38
    v_add_f32 v23, v23, v39
    v_lshlrev_b32 v24, 16, v96
    v_and_b32 v25, s54, v96
    v_lshlrev_b32 v26, 16, v97
    v_and_b32 v27, s54, v97
    v_lshlrev_b32 v28, 16, v98
    v_and_b32 v29, s54, v98
    v_lshlrev_b32 v30, 16, v99
    v_and_b32 v31, s54, v99
    v_add_f32 v16, v16, v24
    v_add_f32 v17, v17, v25
    v_add_f32 v18, v18, v26
    v_add_f32 v19, v19, v27
    v_add_f32 v20, v20, v28
    v_add_f32 v21, v21, v29
    v_add_f32 v22, v22, v30
    v_add_f32 v23, v23, v31
    v_cvt_pk_bf16_f32 v32, v16, v17
    v_cvt_pk_bf16_f32 v33, v18, v19
    v_cvt_pk_bf16_f32 v34, v20, v21
    v_cvt_pk_bf16_f32 v35, v22, v23
    buffer_store_dwordx4 v[32:35], v14, s[20:23], 0 offen
    s_waitcnt lgkmcnt(5)
    v_add_f32 v48, v48, v56
    v_add_f32 v49, v49, v57
    v_add_f32 v50, v50, v58
    v_add_f32 v51, v51, v59
    s_waitcnt lgkmcnt(4)
    v_add_f32 v52, v52, v60
    v_add_f32 v53, v53, v61
    v_add_f32 v54, v54, v62
    v_add_f32 v55, v55, v63
    s_waitcnt lgkmcnt(1)
    v_add_f32 v64, v64, v72
    v_add_f32 v65, v65, v73
    v_add_f32 v66, v66, v74
    v_add_f32 v67, v67, v75
    s_waitcnt lgkmcnt(0)
    v_add_f32 v68, v68, v76
    v_add_f32 v69, v69, v77
    v_add_f32 v70, v70, v78
    v_add_f32 v71, v71, v79
    v_add_f32 v48, v48, v64
    v_add_f32 v49, v49, v65
    v_add_f32 v50, v50, v66
    v_add_f32 v51, v51, v67
    v_add_f32 v52, v52, v68
    v_add_f32 v53, v53, v69
    v_add_f32 v54, v54, v70
    v_add_f32 v55, v55, v71
    v_lshlrev_b32 v56, 16, v100
    v_and_b32 v57, s54, v100
    v_lshlrev_b32 v58, 16, v101
    v_and_b32 v59, s54, v101
    v_lshlrev_b32 v60, 16, v102
    v_and_b32 v61, s54, v102
    v_lshlrev_b32 v62, 16, v103
    v_and_b32 v63, s54, v103
    v_add_f32 v48, v48, v56
    v_add_f32 v49, v49, v57
    v_add_f32 v50, v50, v58
    v_add_f32 v51, v51, v59
    v_add_f32 v52, v52, v60
    v_add_f32 v53, v53, v61
    v_add_f32 v54, v54, v62
    v_add_f32 v55, v55, v63
    v_cvt_pk_bf16_f32 v64, v48, v49
    v_cvt_pk_bf16_f32 v65, v50, v51
    v_cvt_pk_bf16_f32 v66, v52, v53
    v_cvt_pk_bf16_f32 v67, v54, v55
    buffer_store_dwordx4 v[64:67], v15, s[20:23], 0 offen
    s_waitcnt vmcnt(0)
    s_nop 0
L_fin:
    s_or_b32 s40, s2, s30
    s_cmp_lg_u32 s40, 0
    s_cbranch_scc1 L_noep_125
    v_mov_b32 v2, s99
    v_mov_b32 v3, s33
    v_mov_b32_e64 v4, 0
    s_mov_b64 exec, 1
    buffer_store_dwordx2 v[2:3], v4, s[24:27], 0 offen
L_noep_125:
    s_waitcnt vmcnt(0)
L_end:
    s_endpgm
L_code_end:
    s_endpgm
.section .rodata,"a"
.p2align 6
.amdhsa_kernel interleave_layers__spectral_fnet__swiglu_ffn__prompt_kernel
  .amdhsa_next_free_vgpr 512
  .amdhsa_next_free_sgpr 102
  .amdhsa_accum_offset 256
  .amdhsa_group_segment_fixed_size 0
  .amdhsa_kernarg_size 96
  .amdhsa_user_sgpr_count 2
  .amdhsa_user_sgpr_kernarg_segment_ptr 1
  .amdhsa_system_sgpr_workgroup_id_x 1
  .amdhsa_float_denorm_mode_32 3
.end_amdhsa_kernel
```
